```python
import torch

def _softmax(x, axis=-1):
    return torch.softmax(x, dim=axis)

def _gelu(x):
    return torch.nn.functional.gelu(x, approximate='tanh')

def _silu(x):
    return torch.nn.functional.silu(x)

def _sigmoid(x):
    return torch.sigmoid(x)

def _layernorm(x, axis=-1, eps=1e-05):
    m = x.mean(dim=axis, keepdim=True)
    v = x.var(dim=axis, keepdim=True, unbiased=False)
    return (x - m) / torch.sqrt(v + eps)

def _scatter_add(tgt, idx, src, axis=0):
    return tgt.clone().index_add_(axis, idx, src)

def _segment_sum(src, seg, n):
    out = torch.zeros((n,) + src.shape[1:], dtype=src.dtype)
    return out.index_add_(0, seg, src)

def _pad(x, pw):
    flat = tuple((v for pair in reversed(pw) for v in pair))
    return torch.nn.functional.pad(x, flat)
kernel_name = 'standalone__conformer_family_e_branchformer__speech'

def setup_inputs():

    _w = lambda a: (lambda t: t.to(torch.bfloat16) if t.is_floating_point() else t)(torch.as_tensor(a))
    B, T, D, K = (2, 4000, 512, 31)
    return {'x': _w((lambda *s: torch.randn(*s, dtype=torch.bfloat16) * 0.05)(B, T, D)), 'w_qkv': _w((lambda *s: torch.randn(*s, dtype=torch.bfloat16) * 0.05)(D, 3 * D)), 'w_att_out': _w((lambda *s: torch.randn(*s, dtype=torch.bfloat16) * 0.05)(D, D)), 'w_mlp_in': _w((lambda *s: torch.randn(*s, dtype=torch.bfloat16) * 0.05)(D, 2 * D)), 'dw_csgu': _w((lambda *s: torch.randn(*s, dtype=torch.bfloat16) * 0.05)(K, D)), 'w_mlp_out': _w((lambda *s: torch.randn(*s, dtype=torch.bfloat16) * 0.05)(D, D)), 'dw_merge': _w((lambda *s: torch.randn(*s, dtype=torch.bfloat16) * 0.05)(K, 2 * D)), 'w_merge': _w((lambda *s: torch.randn(*s, dtype=torch.bfloat16) * 0.05)(2 * D, D))}

def reference(x, w_qkv, w_att_out, w_mlp_in, dw_csgu, w_mlp_out, dw_merge, w_merge):
    B, T, D = x.shape
    K = dw_csgu.shape[0]
    pad = K // 2
    xa = _layernorm(x, axis=-1)
    qkv = torch.einsum('btd,de->bte', xa, w_qkv)
    q, k, v = (qkv[..., :D].clone(), qkv[..., D:2 * D].clone(), qkv[..., 2 * D:].clone())
    scores = torch.einsum('btd,bsd->bts', q, k) * D ** (-0.5)
    p = _softmax(scores, axis=-1)
    attn = torch.einsum('bts,bsd->btd', p, v)
    glob = torch.einsum('btd,de->bte', attn, w_att_out)
    xc = _layernorm(x, axis=-1)
    h = _gelu(torch.einsum('btd,de->bte', xc, w_mlp_in))
    u, g = (h[..., :D].clone(), h[..., D:].clone())
    g = _layernorm(g, axis=-1)
    gp = _pad(g, ((0, 0), (pad, pad), (0, 0)))
    gc = torch.zeros_like(g)
    for i in range(K):
        gc = gc + gp[:, i:i + T, :] * dw_csgu[i][None, None, :]
    loc = torch.einsum('btd,de->bte', u * gc, w_mlp_out)
    m = torch.concatenate([glob, loc], axis=-1)
    mp = _pad(m, ((0, 0), (pad, pad), (0, 0)))
    mc = torch.zeros_like(m)
    for i in range(K):
        mc = mc + mp[:, i:i + T, :] * dw_merge[i][None, None, :]
    m = m + mc
    return x + torch.einsum('btc,cd->btd', m, w_merge)
```

```asm
; @launch grid=(256,1,1) block=(256,1,1) lds=163840
.amdgcn_target "amdgcn-amd-amdhsa--gfx950"
.text
.globl standalone__conformer_family_e_branchformer__speech_kernel
.p2align 8
.type standalone__conformer_family_e_branchformer__speech_kernel,@function
standalone__conformer_family_e_branchformer__speech_kernel:
  s_cmp_ge_u32 s2, 256
  s_cbranch_scc0 MEGA_GO
  s_endpgm
MEGA_GO:
  s_getpc_b64 s[96:97]
PCS:
  s_and_b32 s97, s97, 0xffff
  s_mov_b32 s98, PF_ATT_END-PCS
  s_mov_b32 s99, 0x20000
  s_lshr_b32 s100, s2, 3
  s_lshl_b32 s100, s100, 12
  v_lshrrev_b32 v140, 3, v0
  v_lshlrev_b32 v140, 7, v140
  buffer_load_dword v141, v140, s[96:99], s100 offen
  s_load_dwordx2 s[8:9], s[0:1], 0
  s_load_dwordx2 s[40:41], s[0:1], 24
  s_load_dwordx2 s[44:45], s[0:1], 8
  s_load_dwordx2 s[20:21], s[0:1], 80
  s_load_dwordx2 s[60:61], s[0:1], 32
  s_load_dwordx2 s[62:63], s[0:1], 48
  s_load_dwordx2 s[12:13], s[0:1], 64
  s_load_dwordx2 s[16:17], s[0:1], 72
  v_lshrrev_b32 v1, 6, v0
  v_and_b32 v0, 63, v0
  v_readfirstlane_b32 s3, v1
  v_lshlrev_b32 v1, 4, v0
  s_and_b32 s28, s2, 7
  s_lshr_b32 s29, s2, 3
  s_and_b32 s30, s29, 3
  s_lshr_b32 s29, s29, 2
  s_lshl_b32 s28, s28, 3
  s_add_u32 s28, s28, s29
  s_lshl_b32 s31, s30, 2
  s_add_u32 s31, s31, s3
  s_mov_b32 s49, 0xffff0000
  s_lshl_b32 s24, s28, 7
  s_add_u32 s24, s24, 90177536
  s_mov_b32 s25, 0x100000
  s_waitcnt lgkmcnt(0)
  s_and_b32 s9, s9, 0xffff
  s_mov_b32 s10, 8192000
  s_mov_b32 s11, 0x20000
  s_and_b32 s41, s41, 0xffff
  s_mov_b32 s42, 1048576
  s_mov_b32 s43, 0x20000
  s_and_b32 s45, s45, 0xffff
  s_mov_b32 s46, 1572864
  s_mov_b32 s47, 0x20000
  s_and_b32 s21, s21, 0xffff
  s_mov_b32 s22, 268435456
  s_mov_b32 s23, 0x20000
  s_and_b32 s13, s13, 0xffff
  s_mov_b32 s14, 8192000
  s_mov_b32 s15, 0x20000
  s_and_b32 s17, s17, 0xffff
  s_mov_b32 s18, 256
  s_mov_b32 s19, 0x20000
PF_P0:
  s_memrealtime s[4:5]
  s_or_b32 s26, s2, s3
  s_cmp_eq_u32 s26, 0
  s_cselect_b32 s26, 0, 2130706432
  s_waitcnt lgkmcnt(0)
  s_or_b32 s4, s4, 1
  v_mov_b32 v142, s4
  s_mov_b64 exec, 1
  buffer_store_dword v142, off, s[16:19], s26 sc1
  s_mov_b64 exec, -1
  v_and_b32 v4, 7, v0
  v_lshrrev_b32 v5, 3, v0
  v_xor_b32 v2, v4, v5
  v_lshlrev_b32 v2, 4, v2
  v_lshl_add_u32 v2, v5, 10, v2
  v_lshrrev_b32 v12, 4, v0
  v_and_b32 v13, 15, v0
  v_lshlrev_b32 v3, 2, v12
  v_xor_b32 v3, v3, v13
  v_lshlrev_b32 v3, 4, v3
  v_lshl_add_u32 v3, v12, 11, v3
  s_and_b32 s32, s28, 31
  s_lshl_b32 s32, s32, 7
  s_sub_u32 s32, s32, 16
  s_mul_i32 s33, s3, 40
  s_add_u32 s32, s32, s33
  s_lshr_b32 s33, s28, 5
  s_mul_i32 s33, s33, 4000
  s_add_u32 s34, s32, 0
  s_add_u32 s35, s34, s33
  s_lshl_b32 s35, s35, 10
  s_cmp_lt_u32 s34, 4000
  s_cselect_b32 s52, s35, 0x7f000000
  s_add_u32 s34, s32, 8
  s_add_u32 s35, s34, s33
  s_lshl_b32 s35, s35, 10
  s_cmp_lt_u32 s34, 4000
  s_cselect_b32 s53, s35, 0x7f000000
  s_add_u32 s34, s32, 16
  s_add_u32 s35, s34, s33
  s_lshl_b32 s35, s35, 10
  s_cmp_lt_u32 s34, 4000
  s_cselect_b32 s54, s35, 0x7f000000
  s_add_u32 s34, s32, 24
  s_add_u32 s35, s34, s33
  s_lshl_b32 s35, s35, 10
  s_cmp_lt_u32 s34, 4000
  s_cselect_b32 s55, s35, 0x7f000000
  s_add_u32 s34, s32, 32
  s_add_u32 s35, s34, s33
  s_lshl_b32 s35, s35, 10
  s_cmp_lt_u32 s34, 4000
  s_cselect_b32 s56, s35, 0x7f000000
  s_mul_i32 s50, s3, 5120
  s_lshl_b32 s51, s3, 13
  s_add_u32 s51, s51, 20480
  s_lshr_b32 s34, s3, 1
  s_lshl_b32 s34, s34, 10
  s_lshl_b32 s35, s30, 8
  s_add_u32 s34, s34, s35
  s_and_b32 s35, s3, 1
  s_lshl_b32 s35, s35, 16
  s_add_u32 s57, s34, s35
  s_and_b32 s32, s28, 31
  s_lshl_b32 s32, s32, 7
  s_lshl_b32 s33, s31, 3
  s_add_u32 s32, s32, s33
  s_lshr_b32 s33, s28, 5
  s_mul_i32 s33, s33, 4000
  s_add_u32 s33, s33, s32
  s_lshl_b32 s33, s33, 10
  s_cmp_lt_u32 s32, 4000
  s_cselect_b32 s33, s33, 2130706432
  s_lshl_b32 s48, s3, 13
  s_add_u32 s48, s48, 118784
  s_add_u32 m0, s48, 0
  s_nop 0
  buffer_load_dwordx4 v2, s[8:11], s33 offen offset:0 lds
  s_add_u32 m0, s48, 896
  s_nop 0
  buffer_load_dwordx4 v2, s[8:11], s33 offen offset:128 lds
  s_add_u32 m0, s48, 1792
  s_nop 0
  buffer_load_dwordx4 v2, s[8:11], s33 offen offset:256 lds
  s_add_u32 m0, s48, 2688
  s_nop 0
  buffer_load_dwordx4 v2, s[8:11], s33 offen offset:384 lds
  s_add_u32 m0, s48, 3584
  s_nop 0
  buffer_load_dwordx4 v2, s[8:11], s33 offen offset:512 lds
  s_add_u32 m0, s48, 4480
  s_nop 0
  buffer_load_dwordx4 v2, s[8:11], s33 offen offset:640 lds
  s_add_u32 m0, s48, 5376
  s_nop 0
  buffer_load_dwordx4 v2, s[8:11], s33 offen offset:768 lds
  s_add_u32 m0, s48, 6272
  s_nop 0
  buffer_load_dwordx4 v2, s[8:11], s33 offen offset:896 lds
  s_lshl_b32 s33, s30, 1
  s_add_u32 s33, s33, s28
  s_and_b32 s33, s33, 7
  s_lshl_b32 s34, s33, 7
  v_add_u32 v2, s34, v2
  s_lshl_b32 s34, s33, 17
  s_add_u32 s57, s57, s34
  s_movk_i32 s29, 0x380
  v_lshrrev_b32 v12, 4, v0
  v_and_b32 v13, 15, v0
  v_mul_u32_u24 v14, 3072, v12
  v_add_u32 v8, 0, v12
  v_xor_b32 v8, v8, v13
  v_lshl_add_u32 v8, v8, 4, v14
  v_add_u32 v9, 4, v12
  v_xor_b32 v9, v9, v13
  v_lshl_add_u32 v9, v9, 4, v14
  v_add_u32 v10, 8, v12
  v_xor_b32 v10, v10, v13
  v_lshl_add_u32 v10, v10, 4, v14
  v_add_u32 v11, 12, v12
  v_xor_b32 v11, v11, v13
  v_lshl_add_u32 v11, v11, 4, v14
  s_and_b32 s34, s2, 15
  s_lshr_b32 s35, s2, 4
  s_lshl_b32 s37, s3, 8
  s_mul_i32 s38, s34, 98304
  s_add_u32 s38, s38, s37
  s_mul_i32 s39, s35, 98304
  s_add_u32 s39, s39, s37
  s_add_u32 s39, s39, 1024
  s_lshl_b32 s36, s3, 14
  s_add_u32 s36, s36, 53248
  s_cmp_lt_u32 s2, 32
  s_cselect_b32 s68, s60, s62
  s_cselect_b32 s69, s61, s63
  s_cselect_b32 s37, 10, 11
  s_cselect_b32 s32, 0, 32
  s_and_b32 s69, s69, 0xffff
  s_sub_u32 s32, s2, s32
  s_lshl_b32 s33, 1, s37
  s_mul_i32 s70, s33, 31
  s_mov_b32 s71, 0x20000
  s_cmp_lt_u32 s2, 96
  s_cselect_b32 s70, s70, 0
  v_lshrrev_b32 v112, 2, v0
  v_and_b32 v113, 3, v0
  v_lshrrev_b32 v115, 2, v112
  v_and_b32 v114, 3, v112
  v_lshl_add_u32 v114, v115, 3, v114
  s_lshr_b32 s33, s32, 1
  s_lshl_b32 s33, s33, 5
  s_and_b32 s34, s32, 1
  s_lshl_b32 s34, s34, 2
  s_add_u32 s33, s33, s34
  v_add_u32 v114, s33, v114
  v_lshlrev_b32 v114, 1, v114
  v_bfrev_b32 v116, -2
  s_lshl_b32 s33, s3, 3
  v_sub_u32 v115, s33, v113
  v_add_u32 v117, -1, v115
  v_cmp_gt_i32 vcc, 0, v117
  v_lshlrev_b32 v117, s37, v117
  v_add_u32 v117, v117, v114
  v_cndmask_b32 v120, v117, v116, vcc
  v_add_u32 v117, 0, v115
  v_cmp_gt_i32 vcc, 0, v117
  v_lshlrev_b32 v117, s37, v117
  v_add_u32 v117, v117, v114
  v_cndmask_b32 v121, v117, v116, vcc
  v_add_u32 v117, 1, v115
  v_cmp_gt_i32 vcc, 0, v117
  v_lshlrev_b32 v117, s37, v117
  v_add_u32 v117, v117, v114
  v_cndmask_b32 v122, v117, v116, vcc
  v_add_u32 v117, 2, v115
  v_cmp_gt_i32 vcc, 0, v117
  v_lshlrev_b32 v117, s37, v117
  v_add_u32 v117, v117, v114
  v_cndmask_b32 v123, v117, v116, vcc
  v_add_u32 v117, 3, v115
  v_cmp_gt_i32 vcc, 0, v117
  v_lshlrev_b32 v117, s37, v117
  v_add_u32 v117, v117, v114
  v_cndmask_b32 v124, v117, v116, vcc
  v_add_u32 v117, 4, v115
  v_cmp_gt_i32 vcc, 0, v117
  v_lshlrev_b32 v117, s37, v117
  v_add_u32 v117, v117, v114
  v_cndmask_b32 v125, v117, v116, vcc
  v_add_u32 v117, 5, v115
  v_cmp_gt_i32 vcc, 0, v117
  v_lshlrev_b32 v117, s37, v117
  v_add_u32 v117, v117, v114
  v_cndmask_b32 v126, v117, v116, vcc
  v_add_u32 v117, 6, v115
  v_cmp_gt_i32 vcc, 0, v117
  v_lshlrev_b32 v117, s37, v117
  v_add_u32 v117, v117, v114
  v_cndmask_b32 v127, v117, v116, vcc
  v_sub_u32 v117, 31, v113
  v_cmp_gt_i32 vcc, 0, v117
  v_lshlrev_b32 v117, s37, v117
  v_add_u32 v117, v117, v114
  v_cndmask_b32 v128, v117, v116, vcc
  v_sub_u32 v117, 32, v113
  v_cmp_gt_i32 vcc, 0, v117
  v_lshlrev_b32 v117, s37, v117
  v_add_u32 v117, v117, v114
  v_cndmask_b32 v129, v117, v116, vcc
  v_sub_u32 v117, 33, v113
  v_cmp_gt_i32 vcc, 0, v117
  v_lshlrev_b32 v117, s37, v117
  v_add_u32 v117, v117, v114
  v_cndmask_b32 v130, v117, v116, vcc
  v_sub_u32 v117, 34, v113
  v_cmp_gt_i32 vcc, 0, v117
  v_lshlrev_b32 v117, s37, v117
  v_add_u32 v117, v117, v114
  v_cndmask_b32 v131, v117, v116, vcc
  v_mov_b32 v118, 0
  v_mul_u32_u24 v119, 8192, v0
  v_cmp_gt_u32 vcc, 4, v0
  s_nop 1
  v_cndmask_b32 v119, v116, v119, vcc
  s_mul_i32 s32, s30, 32768
  s_add_u32 s32, s32, s24
  v_lshrrev_b32 v13, 4, v0
  v_and_b32 v14, 7, v0
  v_xor_b32 v14, v14, v13
  v_lshlrev_b32 v14, 4, v14
  v_and_b32 v12, 15, v0
  v_lshl_add_u32 v240, v12, 7, v14
  v_bfe_u32 v12, v0, 2, 2
  v_lshl_add_u32 v14, v13, 3, v12
  v_xor_b32 v12, s3, v12
  v_lshlrev_b32 v12, 6, v12
  v_lshl_add_u32 v12, v14, 8, v12
  v_and_b32 v14, 3, v0
  v_lshl_add_u32 v12, v14, 4, v12
  v_add_u32 v244, 20480, v12
  v_add_u32 v241, 53248, v240
  v_add_u32 v245, 53248, v244
  v_add_u32 v242, 106496, v240
  v_add_u32 v246, 106496, v244
  v_xor_b32 v253, 64, v240
  v_xor_b32 v254, 64, v241
  v_xor_b32 v255, 64, v242
  v_and_b32 v12, 15, v0
  v_cmp_eq_u32 s[58:59], 0, v12
  v_mov_b32 v243, 0x3f803f80
  s_lshl_b32 s33, s28, 7
  s_lshl_b32 s34, s31, 3
  s_add_u32 s33, s33, s34
  s_lshl_b32 s35, s33, 3
  s_add_u32 s35, s35, 90308608
  s_lshr_b32 s34, s33, 4
  s_lshl_b32 s34, s34, 14
  s_and_b32 s33, s33, 15
  s_lshl_b32 s33, s33, 4
  s_add_u32 s34, s34, s33
  s_add_u32 s34, s34, 65536
  v_lshlrev_b32 v220, 4, v4
  v_lshl_add_u32 v220, v5, 8, v220
  s_mov_b32 s6, s34
  v_lshlrev_b32 v6, 3, v0
  v_cmp_gt_u32 vcc, 8, v0
  s_nop 1
  v_cndmask_b32 v6, v116, v6, vcc
  s_add_u32 m0, s36, 0
  s_nop 0
  buffer_load_dwordx4 v8, s[44:47], s38 offen lds
  s_add_u32 s38, s38, 12288
  s_add_u32 m0, s36, 1024
  s_nop 0
  buffer_load_dwordx4 v9, s[44:47], s38 offen lds
  s_add_u32 s38, s38, 12288
  s_add_u32 m0, s36, 2048
  s_nop 0
  buffer_load_dwordx4 v10, s[44:47], s38 offen lds
  s_add_u32 s38, s38, 12288
  s_add_u32 m0, s36, 3072
  s_nop 0
  buffer_load_dwordx4 v11, s[44:47], s38 offen lds
  s_add_u32 s38, s38, 12288
  s_add_u32 m0, s36, 4096
  s_nop 0
  buffer_load_dwordx4 v8, s[44:47], s38 offen lds
  s_add_u32 s38, s38, 12288
  s_add_u32 m0, s36, 5120
  s_nop 0
  buffer_load_dwordx4 v9, s[44:47], s38 offen lds
  s_add_u32 s38, s38, 12288
  s_add_u32 m0, s36, 6144
  s_nop 0
  buffer_load_dwordx4 v10, s[44:47], s38 offen lds
  s_add_u32 s38, s38, 12288
  s_add_u32 m0, s36, 7168
  s_nop 0
  buffer_load_dwordx4 v11, s[44:47], s38 offen lds
  s_add_u32 s38, s38, 12288
  s_add_u32 m0, s36, 8192
  s_nop 0
  buffer_load_dwordx4 v8, s[44:47], s39 offen lds
  s_add_u32 s39, s39, 12288
  s_add_u32 m0, s36, 9216
  s_nop 0
  buffer_load_dwordx4 v9, s[44:47], s39 offen lds
  s_add_u32 s39, s39, 12288
  s_add_u32 m0, s36, 10240
  s_nop 0
  buffer_load_dwordx4 v10, s[44:47], s39 offen lds
  s_add_u32 s39, s39, 12288
  s_add_u32 m0, s36, 11264
  s_nop 0
  buffer_load_dwordx4 v11, s[44:47], s39 offen lds
  s_add_u32 s39, s39, 12288
  s_add_u32 m0, s36, 12288
  s_nop 0
  buffer_load_dwordx4 v8, s[44:47], s39 offen lds
  s_add_u32 s39, s39, 12288
  s_add_u32 m0, s36, 13312
  s_nop 0
  buffer_load_dwordx4 v9, s[44:47], s39 offen lds
  s_add_u32 s39, s39, 12288
  s_add_u32 m0, s36, 14336
  s_nop 0
  buffer_load_dwordx4 v10, s[44:47], s39 offen lds
  s_add_u32 s39, s39, 12288
  s_add_u32 m0, s36, 15360
  s_nop 0
  buffer_load_dwordx4 v11, s[44:47], s39 offen lds
  s_add_u32 s39, s39, 12288
  v_xor_b32 v142, v4, v5
  v_lshlrev_b32 v142, 4, v142
  v_lshl_add_u32 v142, v4, 7, v142
  v_add_u32 v142, s48, v142
  s_waitcnt vmcnt(16)
  ds_read_b128 v[188:191], v142 offset:0
  ds_read_b128 v[192:195], v142 offset:1024
  ds_read_b128 v[196:199], v142 offset:2048
  ds_read_b128 v[200:203], v142 offset:3072
  ds_read_b128 v[204:207], v142 offset:4096
  ds_read_b128 v[208:211], v142 offset:5120
  ds_read_b128 v[212:215], v142 offset:6144
  ds_read_b128 v[216:219], v142 offset:7168
  buffer_load_ushort v120, v120, s[68:71], 0 offen
  buffer_load_ushort v121, v121, s[68:71], 0 offen
  buffer_load_ushort v122, v122, s[68:71], 0 offen
  buffer_load_ushort v123, v123, s[68:71], 0 offen
  buffer_load_ushort v124, v124, s[68:71], 0 offen
  buffer_load_ushort v125, v125, s[68:71], 0 offen
  buffer_load_ushort v126, v126, s[68:71], 0 offen
  buffer_load_ushort v127, v127, s[68:71], 0 offen
  buffer_load_ushort v128, v128, s[68:71], 0 offen
  buffer_load_ushort v129, v129, s[68:71], 0 offen
  buffer_load_ushort v130, v130, s[68:71], 0 offen
  buffer_load_ushort v131, v131, s[68:71], 0 offen
  s_waitcnt lgkmcnt(7)
  v_lshlrev_b32 v48, 16, v188
  v_and_b32 v49, s49, v188
  v_lshlrev_b32 v50, 16, v189
  v_and_b32 v51, s49, v189
  v_lshlrev_b32 v52, 16, v190
  v_and_b32 v53, s49, v190
  v_lshlrev_b32 v54, 16, v191
  v_and_b32 v55, s49, v191
  s_add_u32 m0, s50, 0
  s_nop 0
  buffer_load_dwordx4 v2, s[8:11], s52 offen lds
  s_waitcnt lgkmcnt(6)
  v_lshlrev_b32 v56, 16, v192
  v_and_b32 v57, s49, v192
  v_lshlrev_b32 v58, 16, v193
  v_and_b32 v59, s49, v193
  v_lshlrev_b32 v60, 16, v194
  v_and_b32 v61, s49, v194
  v_lshlrev_b32 v62, 16, v195
  v_and_b32 v63, s49, v195
  s_add_u32 m0, s50, 1024
  s_nop 0
  buffer_load_dwordx4 v2, s[8:11], s53 offen lds
  s_waitcnt lgkmcnt(5)
  v_lshlrev_b32 v64, 16, v196
  v_and_b32 v65, s49, v196
  v_lshlrev_b32 v66, 16, v197
  v_and_b32 v67, s49, v197
  v_lshlrev_b32 v68, 16, v198
  v_and_b32 v69, s49, v198
  v_lshlrev_b32 v70, 16, v199
  v_and_b32 v71, s49, v199
  s_add_u32 m0, s50, 2048
  s_nop 0
  buffer_load_dwordx4 v2, s[8:11], s54 offen lds
  s_waitcnt lgkmcnt(4)
  v_lshlrev_b32 v72, 16, v200
  v_and_b32 v73, s49, v200
  v_lshlrev_b32 v74, 16, v201
  v_and_b32 v75, s49, v201
  v_lshlrev_b32 v76, 16, v202
  v_and_b32 v77, s49, v202
  v_lshlrev_b32 v78, 16, v203
  v_and_b32 v79, s49, v203
  s_add_u32 m0, s50, 3072
  s_nop 0
  buffer_load_dwordx4 v2, s[8:11], s55 offen lds
  s_waitcnt lgkmcnt(3)
  v_lshlrev_b32 v80, 16, v204
  v_and_b32 v81, s49, v204
  v_lshlrev_b32 v82, 16, v205
  v_and_b32 v83, s49, v205
  v_lshlrev_b32 v84, 16, v206
  v_and_b32 v85, s49, v206
  v_lshlrev_b32 v86, 16, v207
  v_and_b32 v87, s49, v207
  s_add_u32 m0, s50, 4096
  s_nop 0
  buffer_load_dwordx4 v2, s[8:11], s56 offen lds
  s_waitcnt lgkmcnt(2)
  v_lshlrev_b32 v88, 16, v208
  v_and_b32 v89, s49, v208
  v_lshlrev_b32 v90, 16, v209
  v_and_b32 v91, s49, v209
  v_lshlrev_b32 v92, 16, v210
  v_and_b32 v93, s49, v210
  v_lshlrev_b32 v94, 16, v211
  v_and_b32 v95, s49, v211
  v_add_u32 v247, 128, v2
  v_bfi_b32 v2, s29, v247, v2
  s_add_u32 m0, s51, 0
  s_nop 0
  buffer_load_dwordx4 v3, s[40:43], s57 offen lds
  s_waitcnt lgkmcnt(1)
  v_lshlrev_b32 v96, 16, v212
  v_and_b32 v97, s49, v212
  v_lshlrev_b32 v98, 16, v213
  v_and_b32 v99, s49, v213
  v_lshlrev_b32 v100, 16, v214
  v_and_b32 v101, s49, v214
  v_lshlrev_b32 v102, 16, v215
  v_and_b32 v103, s49, v215
  s_add_u32 s57, s57, 8192
  s_add_u32 m0, s51, 1024
  s_nop 0
  buffer_load_dwordx4 v3, s[40:43], s57 offen lds
  s_waitcnt lgkmcnt(0)
  v_lshlrev_b32 v104, 16, v216
  v_and_b32 v105, s49, v216
  v_lshlrev_b32 v106, 16, v217
  v_and_b32 v107, s49, v217
  v_lshlrev_b32 v108, 16, v218
  v_and_b32 v109, s49, v218
  v_lshlrev_b32 v110, 16, v219
  v_and_b32 v111, s49, v219
  s_add_u32 s57, s57, 8192
  s_add_u32 m0, s51, 2048
  s_nop 0
  buffer_load_dwordx4 v3, s[40:43], s57 offen lds
  v_pk_add_f32 v[132:133], v[48:49], v[50:51]
  v_pk_add_f32 v[134:135], v[52:53], v[54:55]
  v_pk_add_f32 v[132:133], v[132:133], v[56:57]
  s_add_u32 s57, s57, 8192
  s_add_u32 m0, s51, 3072
  s_nop 0
  buffer_load_dwordx4 v3, s[40:43], s57 offen lds
  v_pk_add_f32 v[134:135], v[134:135], v[58:59]
  v_pk_add_f32 v[132:133], v[132:133], v[60:61]
  v_pk_add_f32 v[134:135], v[134:135], v[62:63]
  v_pk_add_f32 v[132:133], v[132:133], v[64:65]
  s_add_u32 s57, s57, 8192
  s_add_u32 m0, s51, 4096
  s_nop 0
  buffer_load_dwordx4 v3, s[40:43], s57 offen lds
  v_pk_add_f32 v[134:135], v[134:135], v[66:67]
  v_pk_add_f32 v[132:133], v[132:133], v[68:69]
  v_pk_add_f32 v[134:135], v[134:135], v[70:71]
  v_pk_add_f32 v[132:133], v[132:133], v[72:73]
  s_add_u32 s57, s57, 8192
  s_add_u32 m0, s51, 5120
  s_nop 0
  buffer_load_dwordx4 v3, s[40:43], s57 offen lds
  v_pk_add_f32 v[134:135], v[134:135], v[74:75]
  v_pk_add_f32 v[132:133], v[132:133], v[76:77]
  v_pk_add_f32 v[134:135], v[134:135], v[78:79]
  v_pk_add_f32 v[132:133], v[132:133], v[80:81]
  s_add_u32 s57, s57, 8192
  s_add_u32 m0, s51, 6144
  s_nop 0
  buffer_load_dwordx4 v3, s[40:43], s57 offen lds
  v_pk_add_f32 v[134:135], v[134:135], v[82:83]
  v_pk_add_f32 v[132:133], v[132:133], v[84:85]
  v_pk_add_f32 v[134:135], v[134:135], v[86:87]
  v_pk_add_f32 v[132:133], v[132:133], v[88:89]
  s_add_u32 s57, s57, 8192
  s_add_u32 m0, s51, 7168
  s_nop 0
  buffer_load_dwordx4 v3, s[40:43], s57 offen lds
  s_add_u32 s57, s57, 73728
  s_and_b32 s57, s57, 0xfffff
  v_pk_add_f32 v[134:135], v[134:135], v[90:91]
  v_pk_add_f32 v[132:133], v[132:133], v[92:93]
  v_pk_add_f32 v[134:135], v[134:135], v[94:95]
  v_pk_add_f32 v[132:133], v[132:133], v[96:97]
  buffer_store_dword v118, v119, s[20:23], s32 offen sc1
  v_pk_add_f32 v[134:135], v[134:135], v[98:99]
  v_pk_add_f32 v[132:133], v[132:133], v[100:101]
  v_pk_add_f32 v[134:135], v[134:135], v[102:103]
  v_pk_add_f32 v[132:133], v[132:133], v[104:105]
  v_pk_add_f32 v[134:135], v[134:135], v[106:107]
  v_pk_add_f32 v[132:133], v[132:133], v[108:109]
  v_pk_add_f32 v[134:135], v[134:135], v[110:111]
  v_pk_add_f32 v[132:133], v[132:133], v[134:135]
  v_add_f32 v132, v132, v133
  s_nop 1
  v_add_f32_dpp v132, v132, v132 row_ror:8 row_mask:0xf bank_mask:0xf
  v_mov_b32 v133, v132
  s_nop 1
  v_permlane16_swap_b32 v132, v133
  v_add_f32 v132, v132, v133
  v_mov_b32 v133, v132
  s_nop 1
  v_permlane32_swap_b32 v132, v133
  v_add_f32 v132, v132, v133
  v_mul_f32 v132, 0xbb000000, v132
  v_pk_add_f32 v[48:49], v[48:49], v[132:133] op_sel_hi:[1,0]
  v_pk_add_f32 v[50:51], v[50:51], v[132:133] op_sel_hi:[1,0]
  v_pk_add_f32 v[52:53], v[52:53], v[132:133] op_sel_hi:[1,0]
  v_pk_add_f32 v[54:55], v[54:55], v[132:133] op_sel_hi:[1,0]
  v_pk_add_f32 v[56:57], v[56:57], v[132:133] op_sel_hi:[1,0]
  v_pk_add_f32 v[58:59], v[58:59], v[132:133] op_sel_hi:[1,0]
  v_pk_add_f32 v[60:61], v[60:61], v[132:133] op_sel_hi:[1,0]
  v_pk_add_f32 v[62:63], v[62:63], v[132:133] op_sel_hi:[1,0]
  v_pk_add_f32 v[64:65], v[64:65], v[132:133] op_sel_hi:[1,0]
  v_pk_add_f32 v[66:67], v[66:67], v[132:133] op_sel_hi:[1,0]
  v_pk_add_f32 v[68:69], v[68:69], v[132:133] op_sel_hi:[1,0]
  v_pk_add_f32 v[70:71], v[70:71], v[132:133] op_sel_hi:[1,0]
  v_pk_add_f32 v[72:73], v[72:73], v[132:133] op_sel_hi:[1,0]
  v_pk_add_f32 v[74:75], v[74:75], v[132:133] op_sel_hi:[1,0]
  v_pk_add_f32 v[76:77], v[76:77], v[132:133] op_sel_hi:[1,0]
  v_pk_add_f32 v[78:79], v[78:79], v[132:133] op_sel_hi:[1,0]
  v_pk_add_f32 v[80:81], v[80:81], v[132:133] op_sel_hi:[1,0]
  v_pk_add_f32 v[82:83], v[82:83], v[132:133] op_sel_hi:[1,0]
  v_pk_add_f32 v[84:85], v[84:85], v[132:133] op_sel_hi:[1,0]
  v_pk_add_f32 v[86:87], v[86:87], v[132:133] op_sel_hi:[1,0]
  v_pk_add_f32 v[88:89], v[88:89], v[132:133] op_sel_hi:[1,0]
  v_pk_add_f32 v[90:91], v[90:91], v[132:133] op_sel_hi:[1,0]
  v_pk_add_f32 v[92:93], v[92:93], v[132:133] op_sel_hi:[1,0]
  v_pk_add_f32 v[94:95], v[94:95], v[132:133] op_sel_hi:[1,0]
  v_pk_add_f32 v[96:97], v[96:97], v[132:133] op_sel_hi:[1,0]
  v_pk_add_f32 v[98:99], v[98:99], v[132:133] op_sel_hi:[1,0]
  v_pk_add_f32 v[100:101], v[100:101], v[132:133] op_sel_hi:[1,0]
  v_pk_add_f32 v[102:103], v[102:103], v[132:133] op_sel_hi:[1,0]
  v_pk_add_f32 v[104:105], v[104:105], v[132:133] op_sel_hi:[1,0]
  v_pk_add_f32 v[106:107], v[106:107], v[132:133] op_sel_hi:[1,0]
  v_pk_add_f32 v[108:109], v[108:109], v[132:133] op_sel_hi:[1,0]
  v_pk_add_f32 v[110:111], v[110:111], v[132:133] op_sel_hi:[1,0]
  v_pk_mul_f32 v[136:137], v[48:49], v[48:49]
  v_pk_mul_f32 v[138:139], v[50:51], v[50:51]
  v_pk_fma_f32 v[136:137], v[52:53], v[52:53], v[136:137]
  v_pk_fma_f32 v[138:139], v[54:55], v[54:55], v[138:139]
  v_pk_fma_f32 v[136:137], v[56:57], v[56:57], v[136:137]
  v_pk_fma_f32 v[138:139], v[58:59], v[58:59], v[138:139]
  v_pk_fma_f32 v[136:137], v[60:61], v[60:61], v[136:137]
  v_pk_fma_f32 v[138:139], v[62:63], v[62:63], v[138:139]
  v_pk_fma_f32 v[136:137], v[64:65], v[64:65], v[136:137]
  v_pk_fma_f32 v[138:139], v[66:67], v[66:67], v[138:139]
  v_pk_fma_f32 v[136:137], v[68:69], v[68:69], v[136:137]
  v_pk_fma_f32 v[138:139], v[70:71], v[70:71], v[138:139]
  v_pk_fma_f32 v[136:137], v[72:73], v[72:73], v[136:137]
  v_pk_fma_f32 v[138:139], v[74:75], v[74:75], v[138:139]
  v_pk_fma_f32 v[136:137], v[76:77], v[76:77], v[136:137]
  v_pk_fma_f32 v[138:139], v[78:79], v[78:79], v[138:139]
  v_pk_fma_f32 v[136:137], v[80:81], v[80:81], v[136:137]
  v_pk_fma_f32 v[138:139], v[82:83], v[82:83], v[138:139]
  v_pk_fma_f32 v[136:137], v[84:85], v[84:85], v[136:137]
  v_pk_fma_f32 v[138:139], v[86:87], v[86:87], v[138:139]
  v_pk_fma_f32 v[136:137], v[88:89], v[88:89], v[136:137]
  v_pk_fma_f32 v[138:139], v[90:91], v[90:91], v[138:139]
  v_pk_fma_f32 v[136:137], v[92:93], v[92:93], v[136:137]
  v_pk_fma_f32 v[138:139], v[94:95], v[94:95], v[138:139]
  v_pk_fma_f32 v[136:137], v[96:97], v[96:97], v[136:137]
  v_pk_fma_f32 v[138:139], v[98:99], v[98:99], v[138:139]
  v_pk_fma_f32 v[136:137], v[100:101], v[100:101], v[136:137]
  v_pk_fma_f32 v[138:139], v[102:103], v[102:103], v[138:139]
  v_pk_fma_f32 v[136:137], v[104:105], v[104:105], v[136:137]
  v_pk_fma_f32 v[138:139], v[106:107], v[106:107], v[138:139]
  v_pk_fma_f32 v[136:137], v[108:109], v[108:109], v[136:137]
  v_pk_fma_f32 v[138:139], v[110:111], v[110:111], v[138:139]
  s_cmp_eq_u32 s3, 0
  s_cselect_b32 s5, 0, 2130706432
  buffer_load_dword v143, off, s[16:19], s5 sc1
  v_pk_add_f32 v[136:137], v[136:137], v[138:139]
  v_add_f32 v136, v136, v137
  s_nop 1
  v_add_f32_dpp v136, v136, v136 row_ror:8 row_mask:0xf bank_mask:0xf
  v_mov_b32 v137, v136
  s_nop 1
  v_permlane16_swap_b32 v136, v137
  v_add_f32 v136, v136, v137
  v_mov_b32 v137, v136
  s_nop 1
  v_permlane32_swap_b32 v136, v137
  v_add_f32 v136, v136, v137
  v_mov_b32 v137, 0x3727c5ac
  v_fmac_f32 v137, 0x3b000000, v136
  v_rsq_f32 v136, v137
  v_mov_b32 v137, v132
  buffer_store_dwordx2 v[136:137], v6, s[20:23], s35 offen sc1
  v_pk_mul_f32 v[48:49], v[48:49], v[136:137] op_sel_hi:[1,0]
  v_pk_mul_f32 v[50:51], v[50:51], v[136:137] op_sel_hi:[1,0]
  v_pk_mul_f32 v[52:53], v[52:53], v[136:137] op_sel_hi:[1,0]
  v_pk_mul_f32 v[54:55], v[54:55], v[136:137] op_sel_hi:[1,0]
  v_cvt_pk_bf16_f32 v188, v48, v49
  v_cvt_pk_bf16_f32 v189, v50, v51
  v_cvt_pk_bf16_f32 v190, v52, v53
  v_cvt_pk_bf16_f32 v191, v54, v55
  v_pk_mul_f32 v[56:57], v[56:57], v[136:137] op_sel_hi:[1,0]
  v_pk_mul_f32 v[58:59], v[58:59], v[136:137] op_sel_hi:[1,0]
  v_pk_mul_f32 v[60:61], v[60:61], v[136:137] op_sel_hi:[1,0]
  v_pk_mul_f32 v[62:63], v[62:63], v[136:137] op_sel_hi:[1,0]
  v_cvt_pk_bf16_f32 v192, v56, v57
  v_cvt_pk_bf16_f32 v193, v58, v59
  v_cvt_pk_bf16_f32 v194, v60, v61
  v_cvt_pk_bf16_f32 v195, v62, v63
  v_pk_mul_f32 v[64:65], v[64:65], v[136:137] op_sel_hi:[1,0]
  v_pk_mul_f32 v[66:67], v[66:67], v[136:137] op_sel_hi:[1,0]
  v_pk_mul_f32 v[68:69], v[68:69], v[136:137] op_sel_hi:[1,0]
  v_pk_mul_f32 v[70:71], v[70:71], v[136:137] op_sel_hi:[1,0]
  v_cvt_pk_bf16_f32 v196, v64, v65
  v_cvt_pk_bf16_f32 v197, v66, v67
  v_cvt_pk_bf16_f32 v198, v68, v69
  v_cvt_pk_bf16_f32 v199, v70, v71
  v_pk_mul_f32 v[72:73], v[72:73], v[136:137] op_sel_hi:[1,0]
  v_pk_mul_f32 v[74:75], v[74:75], v[136:137] op_sel_hi:[1,0]
  v_pk_mul_f32 v[76:77], v[76:77], v[136:137] op_sel_hi:[1,0]
  v_pk_mul_f32 v[78:79], v[78:79], v[136:137] op_sel_hi:[1,0]
  v_cvt_pk_bf16_f32 v200, v72, v73
  v_cvt_pk_bf16_f32 v201, v74, v75
  v_cvt_pk_bf16_f32 v202, v76, v77
  v_cvt_pk_bf16_f32 v203, v78, v79
  v_pk_mul_f32 v[80:81], v[80:81], v[136:137] op_sel_hi:[1,0]
  v_pk_mul_f32 v[82:83], v[82:83], v[136:137] op_sel_hi:[1,0]
  v_pk_mul_f32 v[84:85], v[84:85], v[136:137] op_sel_hi:[1,0]
  v_pk_mul_f32 v[86:87], v[86:87], v[136:137] op_sel_hi:[1,0]
  v_cvt_pk_bf16_f32 v204, v80, v81
  v_cvt_pk_bf16_f32 v205, v82, v83
  v_cvt_pk_bf16_f32 v206, v84, v85
  v_cvt_pk_bf16_f32 v207, v86, v87
  v_pk_mul_f32 v[88:89], v[88:89], v[136:137] op_sel_hi:[1,0]
  v_pk_mul_f32 v[90:91], v[90:91], v[136:137] op_sel_hi:[1,0]
  v_pk_mul_f32 v[92:93], v[92:93], v[136:137] op_sel_hi:[1,0]
  v_pk_mul_f32 v[94:95], v[94:95], v[136:137] op_sel_hi:[1,0]
  v_cvt_pk_bf16_f32 v208, v88, v89
  v_cvt_pk_bf16_f32 v209, v90, v91
  v_cvt_pk_bf16_f32 v210, v92, v93
  v_cvt_pk_bf16_f32 v211, v94, v95
  v_pk_mul_f32 v[96:97], v[96:97], v[136:137] op_sel_hi:[1,0]
  v_pk_mul_f32 v[98:99], v[98:99], v[136:137] op_sel_hi:[1,0]
  v_pk_mul_f32 v[100:101], v[100:101], v[136:137] op_sel_hi:[1,0]
  v_pk_mul_f32 v[102:103], v[102:103], v[136:137] op_sel_hi:[1,0]
  v_cvt_pk_bf16_f32 v212, v96, v97
  v_cvt_pk_bf16_f32 v213, v98, v99
  v_cvt_pk_bf16_f32 v214, v100, v101
  v_cvt_pk_bf16_f32 v215, v102, v103
  v_pk_mul_f32 v[104:105], v[104:105], v[136:137] op_sel_hi:[1,0]
  v_pk_mul_f32 v[106:107], v[106:107], v[136:137] op_sel_hi:[1,0]
  v_pk_mul_f32 v[108:109], v[108:109], v[136:137] op_sel_hi:[1,0]
  v_pk_mul_f32 v[110:111], v[110:111], v[136:137] op_sel_hi:[1,0]
  v_cvt_pk_bf16_f32 v216, v104, v105
  v_cvt_pk_bf16_f32 v217, v106, v107
  v_cvt_pk_bf16_f32 v218, v108, v109
  v_cvt_pk_bf16_f32 v219, v110, v111
  v_and_b32 v14, 15, v0
  v_lshrrev_b32 v13, 2, v14
  v_and_b32 v12, 3, v14
  v_lshl_add_u32 v12, v13, 3, v12
  v_and_b32 v13, 15, v12
  v_lshrrev_b32 v14, 4, v0
  v_xor_b32 v13, v13, v14
  v_lshlrev_b32 v13, 4, v13
  v_lshl_add_u32 v13, v12, 8, v13
  v_add_u32 v160, s36, v13
  v_xor_b32 v161, 64, v160
  v_xor_b32 v162, 128, v160
  v_xor_b32 v163, 192, v160
  s_waitcnt vmcnt(16)
  ds_read_b128 v[48:51], v160 offset:0
  ds_read_b128 v[80:83], v160 offset:8192
  ds_read_b128 v[64:67], v161 offset:1024
  ds_read_b128 v[96:99], v161 offset:9216
  ds_read_b128 v[52:55], v161 offset:0
  ds_read_b128 v[84:87], v161 offset:8192
  ds_read_b128 v[68:71], v160 offset:1024
  ds_read_b128 v[100:103], v160 offset:9216
  s_waitcnt lgkmcnt(0)
  ds_read_b128 v[56:59], v162 offset:0
  ds_read_b128 v[88:91], v162 offset:8192
  ds_read_b128 v[72:75], v163 offset:1024
  ds_read_b128 v[104:107], v163 offset:9216
  ds_read_b128 v[60:63], v163 offset:0
  ds_read_b128 v[92:95], v163 offset:8192
  ds_read_b128 v[76:79], v162 offset:1024
  ds_read_b128 v[108:111], v162 offset:9216
  v_lshl_or_b32 v120, v121, 16, v120
  v_lshl_or_b32 v121, v123, 16, v122
  v_lshl_or_b32 v122, v125, 16, v124
  v_lshl_or_b32 v123, v127, 16, v126
  v_lshl_or_b32 v124, v129, 16, v128
  v_lshl_or_b32 v125, v131, 16, v130
  v_and_b32 v117, 1, v113
  v_lshlrev_b32 v117, 4, v117
  v_mov_b32 v118, 0x3f80
  v_lshlrev_b32 v118, v117, v118
  v_cmp_gt_u32 vcc, 2, v113
  s_nop 1
  v_cndmask_b32 v126, 0, v118, vcc
  v_cndmask_b32 v127, v118, 0, vcc
  s_mul_i32 s33, s2, 5120
  s_add_u32 s33, s33, 87818240
  s_cmp_lt_u32 s2, 96
  s_cselect_b32 s33, s33, 2130706432
  s_add_u32 s34, s33, 4096
  s_lshl_b32 s35, s3, 10
  s_add_u32 s33, s33, s35
  buffer_store_dwordx4 v[120:123], v1, s[20:23], s33 offen sc1
  buffer_store_dwordx4 v[124:127], v1, s[20:23], s34 offen sc1
  s_waitcnt lgkmcnt(0)
  v_mfma_f32_16x16x32_bf16 v[144:147], v[48:51], v[80:83], 0
  v_mfma_f32_16x16x32_bf16 v[152:155], v[48:51], v[96:99], 0
  v_mfma_f32_16x16x32_bf16 v[148:151], v[64:67], v[80:83], 0
  v_mfma_f32_16x16x32_bf16 v[156:159], v[64:67], v[96:99], 0
  v_mfma_f32_16x16x32_bf16 v[144:147], v[52:55], v[84:87], v[144:147]
  v_mfma_f32_16x16x32_bf16 v[152:155], v[52:55], v[100:103], v[152:155]
  v_mfma_f32_16x16x32_bf16 v[148:151], v[68:71], v[84:87], v[148:151]
  v_mfma_f32_16x16x32_bf16 v[156:159], v[68:71], v[100:103], v[156:159]
  v_mfma_f32_16x16x32_bf16 v[144:147], v[56:59], v[88:91], v[144:147]
  v_mfma_f32_16x16x32_bf16 v[152:155], v[56:59], v[104:107], v[152:155]
  v_mfma_f32_16x16x32_bf16 v[148:151], v[72:75], v[88:91], v[148:151]
  v_mfma_f32_16x16x32_bf16 v[156:159], v[72:75], v[104:107], v[156:159]
  v_mfma_f32_16x16x32_bf16 v[144:147], v[60:63], v[92:95], v[144:147]
  v_mfma_f32_16x16x32_bf16 v[152:155], v[60:63], v[108:111], v[152:155]
  v_mfma_f32_16x16x32_bf16 v[148:151], v[76:79], v[92:95], v[148:151]
  v_mfma_f32_16x16x32_bf16 v[156:159], v[76:79], v[108:111], v[156:159]
  s_lshl_b32 s33, s3, 13
  s_add_u32 s33, s33, 118784
  v_add_u32 v12, s33, v1
  s_and_b32 s33, s3, 1
  s_lshl_b32 s33, s33, 11
  s_add_u32 s33, s33, 118784
  v_add_u32 v13, s33, v1
  ds_write_b128 v12, v[144:147] offset:0
  ds_write_b128 v12, v[148:151] offset:1024
  ds_write_b128 v12, v[152:155] offset:2048
  ds_write_b128 v12, v[156:159] offset:3072
  s_waitcnt lgkmcnt(0)
  s_barrier
  ds_read_b128 v[48:51], v13 offset:0
  ds_read_b128 v[52:55], v13 offset:1024
  ds_read_b128 v[56:59], v13 offset:8192
  ds_read_b128 v[60:63], v13 offset:9216
  ds_read_b128 v[64:67], v13 offset:16384
  ds_read_b128 v[68:71], v13 offset:17408
  ds_read_b128 v[72:75], v13 offset:24576
  ds_read_b128 v[76:79], v13 offset:25600
  s_add_u32 m0, s50, 53248
  s_nop 0
  buffer_load_dwordx4 v2, s[8:11], s52 offen lds
  s_add_u32 m0, s50, 54272
  s_nop 0
  buffer_load_dwordx4 v2, s[8:11], s53 offen lds
  s_add_u32 m0, s50, 55296
  s_nop 0
  buffer_load_dwordx4 v2, s[8:11], s54 offen lds
  s_add_u32 m0, s50, 56320
  s_nop 0
  buffer_load_dwordx4 v2, s[8:11], s55 offen lds
  s_add_u32 m0, s50, 57344
  s_nop 0
  buffer_load_dwordx4 v2, s[8:11], s56 offen lds
  v_add_u32 v247, 128, v2
  v_bfi_b32 v2, s29, v247, v2
  s_add_u32 m0, s51, 53248
  s_nop 0
  buffer_load_dwordx4 v3, s[40:43], s57 offen lds
  s_add_u32 s57, s57, 8192
  s_add_u32 m0, s51, 54272
  s_nop 0
  buffer_load_dwordx4 v3, s[40:43], s57 offen lds
  s_add_u32 s57, s57, 8192
  s_add_u32 m0, s51, 55296
  s_nop 0
  buffer_load_dwordx4 v3, s[40:43], s57 offen lds
  s_add_u32 s57, s57, 8192
  s_add_u32 m0, s51, 56320
  s_nop 0
  buffer_load_dwordx4 v3, s[40:43], s57 offen lds
  s_add_u32 s57, s57, 8192
  s_add_u32 m0, s51, 57344
  s_nop 0
  buffer_load_dwordx4 v3, s[40:43], s57 offen lds
  s_add_u32 s57, s57, 8192
  s_add_u32 m0, s51, 58368
  s_nop 0
  buffer_load_dwordx4 v3, s[40:43], s57 offen lds
  s_add_u32 s57, s57, 8192
  s_add_u32 m0, s51, 59392
  s_nop 0
  buffer_load_dwordx4 v3, s[40:43], s57 offen lds
  s_add_u32 s57, s57, 8192
  s_add_u32 m0, s51, 60416
  s_nop 0
  buffer_load_dwordx4 v3, s[40:43], s57 offen lds
  s_add_u32 s57, s57, 73728
  s_and_b32 s57, s57, 0xfffff
  s_lshr_b32 s33, s2, 4
  s_lshl_b32 s33, s33, 1
  s_and_b32 s34, s3, 1
  s_add_u32 s33, s33, s34
  s_lshl_b32 s33, s33, 14
  s_and_b32 s34, s2, 15
  s_lshl_b32 s34, s34, 10
  s_add_u32 s33, s33, s34
  s_add_u32 s33, s33, 84148224
  s_waitcnt lgkmcnt(0)
  v_pk_add_f32 v[48:49], v[48:49], v[56:57]
  v_pk_add_f32 v[50:51], v[50:51], v[58:59]
  v_pk_add_f32 v[52:53], v[52:53], v[60:61]
  v_pk_add_f32 v[54:55], v[54:55], v[62:63]
  v_pk_add_f32 v[48:49], v[48:49], v[64:65]
  v_pk_add_f32 v[50:51], v[50:51], v[66:67]
  v_pk_add_f32 v[52:53], v[52:53], v[68:69]
  v_pk_add_f32 v[54:55], v[54:55], v[70:71]
  v_pk_add_f32 v[48:49], v[48:49], v[72:73]
  v_pk_add_f32 v[50:51], v[50:51], v[74:75]
  v_pk_add_f32 v[52:53], v[52:53], v[76:77]
  v_pk_add_f32 v[54:55], v[54:55], v[78:79]
  v_mul_f32 v48, 0x3d8293ee, v48
  v_mul_f32 v49, 0x3d8293ee, v49
  v_mul_f32 v50, 0x3d8293ee, v50
  v_mul_f32 v51, 0x3d8293ee, v51
  v_mul_f32 v52, 0x3d8293ee, v52
  v_mul_f32 v53, 0x3d8293ee, v53
  v_mul_f32 v54, 0x3d8293ee, v54
  v_mul_f32 v55, 0x3d8293ee, v55
  v_cvt_pk_bf16_f32 v80, v48, v49
  v_cvt_pk_bf16_f32 v81, v50, v51
  v_cvt_pk_bf16_f32 v82, v52, v53
  v_cvt_pk_bf16_f32 v83, v54, v55
  buffer_store_dwordx4 v[80:83], v1, s[20:23], s33 offen sc1
  s_waitcnt vmcnt(17)
  s_cmp_lg_u32 s3, 0
  s_cbranch_scc1 NOK_1
NLP_2:
  v_readfirstlane_b32 s4, v143
  s_cmp_lg_u32 s4, 0
  s_cbranch_scc1 NOK_1
  s_sleep 1
  buffer_load_dword v143, off, s[16:19], 0 sc1
  s_sub_u32 s25, s25, 1
  s_waitcnt vmcnt(0)
  s_cbranch_scc0 NLP_2
  s_endpgm
NOK_1:
  s_barrier
  s_add_u32 m0, s50, 106496
  s_nop 0
  buffer_load_dwordx4 v2, s[8:11], s52 offen lds
  s_add_u32 m0, s50, 107520
  s_nop 0
  buffer_load_dwordx4 v2, s[8:11], s53 offen lds
  s_add_u32 m0, s50, 108544
  s_nop 0
  buffer_load_dwordx4 v2, s[8:11], s54 offen lds
  s_add_u32 m0, s50, 109568
  s_nop 0
  buffer_load_dwordx4 v2, s[8:11], s55 offen lds
  s_add_u32 m0, s50, 110592
  s_nop 0
  buffer_load_dwordx4 v2, s[8:11], s56 offen lds
  v_add_u32 v247, 128, v2
  v_bfi_b32 v2, s29, v247, v2
  s_add_u32 m0, s51, 106496
  s_nop 0
  buffer_load_dwordx4 v3, s[40:43], s57 offen lds
  s_add_u32 s57, s57, 8192
  s_add_u32 m0, s51, 107520
  s_nop 0
  buffer_load_dwordx4 v3, s[40:43], s57 offen lds
  s_add_u32 s57, s57, 8192
  s_add_u32 m0, s51, 108544
  s_nop 0
  buffer_load_dwordx4 v3, s[40:43], s57 offen lds
  s_add_u32 s57, s57, 8192
  s_add_u32 m0, s51, 109568
  s_nop 0
  buffer_load_dwordx4 v3, s[40:43], s57 offen lds
  s_add_u32 s57, s57, 8192
  s_add_u32 m0, s51, 110592
  s_nop 0
  buffer_load_dwordx4 v3, s[40:43], s57 offen lds
  s_add_u32 s57, s57, 8192
  s_add_u32 m0, s51, 111616
  s_nop 0
  buffer_load_dwordx4 v3, s[40:43], s57 offen lds
  s_add_u32 s57, s57, 8192
  s_add_u32 m0, s51, 112640
  s_nop 0
  buffer_load_dwordx4 v3, s[40:43], s57 offen lds
  s_add_u32 s57, s57, 8192
  s_add_u32 m0, s51, 113664
  s_nop 0
  buffer_load_dwordx4 v3, s[40:43], s57 offen lds
  s_add_u32 s57, s57, 73728
  s_and_b32 s57, s57, 0xfffff
  v_mov_b32 v6, 0xc0135761
  v_mov_b32 v7, v6
  v_mov_b32 v8, 0xbdd2d3e8
  v_mov_b32 v9, v8
  v_mov_b32 v10, 1.0
  v_mov_b32 v11, 1.0
  s_lshl_b32 s32, s28, 17
  s_add_u32 s32, s32, 65536
  s_lshl_b32 s66, s31, 15
  s_add_u32 s66, s66, 84148224
  s_lshl_b32 s67, s31, 15
  s_add_u32 s67, s67, 84164608
  s_mul_i32 s60, s3, 4
  s_add_u32 s60, s60, 0
  s_lshr_b32 s61, s60, 1
  s_mul_i32 s61, s61, 16384
  s_and_b32 s60, s60, 1
  s_lshl_b32 s60, s60, 10
  s_add_u32 s61, s61, s60
  s_add_u32 s62, s61, s32
  s_mul_i32 s60, s3, 4
  s_add_u32 s60, s60, 1
  s_lshr_b32 s61, s60, 1
  s_mul_i32 s61, s61, 16384
  s_and_b32 s60, s60, 1
  s_lshl_b32 s60, s60, 10
  s_add_u32 s61, s61, s60
  s_add_u32 s63, s61, s32
  s_mul_i32 s60, s3, 4
  s_add_u32 s60, s60, 2
  s_lshr_b32 s61, s60, 1
  s_mul_i32 s61, s61, 16384
  s_and_b32 s60, s60, 1
  s_lshl_b32 s60, s60, 10
  s_add_u32 s61, s61, s60
  s_add_u32 s64, s61, s32
  s_mul_i32 s60, s3, 4
  s_add_u32 s60, s60, 3
  s_lshr_b32 s61, s60, 1
  s_mul_i32 s61, s61, 16384
  s_and_b32 s60, s60, 1
  s_lshl_b32 s60, s60, 10
  s_add_u32 s61, s61, s60
  s_add_u32 s65, s61, s32
  s_mul_i32 s60, s3, 4096
  v_mov_b32 v248, v1
  v_mov_b32 v249, v1
  v_add_u32 v250, 0x10000, v1
  v_add_u32 v251, 0x20000, v1
  v_and_b32 v252, 15, v0
  v_lshlrev_b32 v252, 3, v252
  s_lshl_b32 s48, s28, 10
  s_add_u32 s48, s48, 90308480
  s_cmp_eq_u32 s28, 0
  s_cselect_b32 s38, 2130706432, s48
  s_cmp_eq_u32 s28, 63
  s_cselect_b32 s39, 2130706432, s48
  ds_read_b64_tr_b16 a[80:81], v244 offset:0
  ds_read_b64_tr_b16 a[82:83], v244 offset:1024
  ds_read_b64_tr_b16 a[84:85], v244 offset:8
  ds_read_b64_tr_b16 a[86:87], v244 offset:1032
  ds_read_b64_tr_b16 a[88:89], v244 offset:16384
  ds_read_b64_tr_b16 a[90:91], v244 offset:17408
  ds_read_b64_tr_b16 a[92:93], v244 offset:16392
  ds_read_b64_tr_b16 a[94:95], v244 offset:17416
  ds_read_b128 a[4:7], v240 offset:2048
  ds_read_b128 a[8:11], v240 offset:4096
  ds_read_b128 a[12:15], v240 offset:6144
  ds_read_b128 a[16:19], v240 offset:8192
  ds_read_b128 a[20:23], v240 offset:10240
  ds_read_b128 a[24:27], v240 offset:12288
  ds_read_b128 a[28:31], v240 offset:14336
  ds_read_b128 a[32:35], v240 offset:16384
  ds_read_b128 a[36:39], v240 offset:18432
  ds_read_b128 v[232:235], v240 offset:0
  s_waitcnt lgkmcnt(5)
  v_mfma_f32_16x16x32_bf16 v[24:27], a[80:83], a[4:7], 0
  ds_read_b64_tr_b16 a[96:97], v244 offset:8192
  v_mfma_f32_16x16x32_bf16 v[28:31], a[84:87], a[4:7], 0
  ds_read_b64_tr_b16 a[98:99], v244 offset:9216
  v_mfma_f32_16x16x32_bf16 v[96:99], a[88:91], a[4:7], 0
  buffer_store_dwordx4 v[188:191], v220, s[20:23], s6 offen offset:0 sc1
  v_mfma_f32_16x16x32_bf16 v[100:103], a[92:95], a[4:7], 0
  ds_read_b64_tr_b16 a[100:101], v244 offset:8200
  v_mfma_f32_16x16x32_bf16 v[32:35], a[80:83], a[8:11], 0
  v_mfma_f32_16x16x32_bf16 v[36:39], a[84:87], a[8:11], 0
  ds_read_b64_tr_b16 a[102:103], v244 offset:9224
  v_mfma_f32_16x16x32_bf16 v[104:107], a[88:91], a[8:11], 0
  buffer_store_dwordx4 v[192:195], v220, s[20:23], s6 offen offset:2048 sc1
  v_mfma_f32_16x16x32_bf16 v[108:111], a[92:95], a[8:11], 0
  ds_read_b64_tr_b16 a[104:105], v244 offset:24576
  v_mfma_f32_16x16x32_bf16 v[40:43], a[80:83], a[12:15], 0
  v_mfma_f32_16x16x32_bf16 v[44:47], a[84:87], a[12:15], 0
  ds_read_b64_tr_b16 a[106:107], v244 offset:25600
  v_mfma_f32_16x16x32_bf16 v[112:115], a[88:91], a[12:15], 0
  v_mfma_f32_16x16x32_bf16 v[116:119], a[92:95], a[12:15], 0
  ds_read_b64_tr_b16 a[108:109], v244 offset:24584
  v_mfma_f32_16x16x32_bf16 v[48:51], a[80:83], a[16:19], 0
  v_mfma_f32_16x16x32_bf16 v[52:55], a[84:87], a[16:19], 0
  ds_read_b64_tr_b16 a[110:111], v244 offset:25608
  v_mfma_f32_16x16x32_bf16 v[120:123], a[88:91], a[16:19], 0
  v_mfma_f32_16x16x32_bf16 v[124:127], a[92:95], a[16:19], 0
  ds_read_b128 a[44:47], v253 offset:2048
  v_mfma_f32_16x16x32_bf16 v[56:59], a[80:83], a[20:23], 0
  v_mfma_f32_16x16x32_bf16 v[60:63], a[84:87], a[20:23], 0
  ds_read_b128 a[48:51], v253 offset:4096
  v_mfma_f32_16x16x32_bf16 v[128:131], a[88:91], a[20:23], 0
  v_mfma_f32_16x16x32_bf16 v[132:135], a[92:95], a[20:23], 0
  ds_read_b128 a[52:55], v253 offset:6144
  s_waitcnt lgkmcnt(11)
  v_mfma_f32_16x16x32_bf16 v[64:67], a[80:83], a[24:27], 0
  v_cndmask_b32 v232, v232, v243, s[58:59]
  v_cndmask_b32 v233, v233, v243, s[58:59]
  v_mfma_f32_16x16x32_bf16 v[68:71], a[84:87], a[24:27], 0
  ds_read_b128 a[56:59], v253 offset:8192
  v_cndmask_b32 v234, v234, v243, s[58:59]
  v_mfma_f32_16x16x32_bf16 v[136:139], a[88:91], a[24:27], 0
  v_cndmask_b32 v235, v235, v243, s[58:59]
  v_mfma_f32_16x16x32_bf16 v[140:143], a[92:95], a[24:27], 0
  ds_read_b128 a[60:63], v253 offset:10240
  v_mfma_f32_16x16x32_bf16 v[72:75], a[80:83], a[28:31], 0
  v_mfma_f32_16x16x32_bf16 v[76:79], a[84:87], a[28:31], 0
  ds_read_b128 a[64:67], v253 offset:12288
  v_mfma_f32_16x16x32_bf16 v[144:147], a[88:91], a[28:31], 0
  v_mfma_f32_16x16x32_bf16 v[148:151], a[92:95], a[28:31], 0
  ds_read_b128 a[68:71], v253 offset:14336
  v_mfma_f32_16x16x32_bf16 v[80:83], a[80:83], a[32:35], 0
  v_mfma_f32_16x16x32_bf16 v[84:87], a[84:87], a[32:35], 0
  ds_read_b128 a[72:75], v253 offset:16384
  v_mfma_f32_16x16x32_bf16 v[152:155], a[88:91], a[32:35], 0
  v_mfma_f32_16x16x32_bf16 v[156:159], a[92:95], a[32:35], 0
  ds_read_b128 a[76:79], v253 offset:18432
  v_mfma_f32_16x16x32_bf16 v[160:163], a[88:91], a[36:39], 0
  v_mfma_f32_16x16x32_bf16 v[164:167], a[92:95], a[36:39], 0
  ds_read_b128 v[236:239], v253 offset:0
  v_mfma_f32_16x16x32_bf16 v[16:19], a[80:83], v[232:235], 0
  v_mfma_f32_16x16x32_bf16 v[20:23], a[84:87], v[232:235], 0
  v_mfma_f32_16x16x32_bf16 v[88:91], a[88:91], v[232:235], 0
  v_mfma_f32_16x16x32_bf16 v[92:95], a[92:95], v[232:235], 0
  s_waitcnt vmcnt(16) lgkmcnt(0)
  s_barrier
  v_mfma_f32_16x16x32_bf16 v[24:27], a[96:99], a[44:47], v[24:27]
  ds_read_b64_tr_b16 a[80:81], v245 offset:0
  s_add_u32 m0, s50, 0
  v_mfma_f32_16x16x32_bf16 v[28:31], a[100:103], a[44:47], v[28:31]
  ds_read_b64_tr_b16 a[82:83], v245 offset:1024
  v_mfma_f32_16x16x32_bf16 v[96:99], a[104:107], a[44:47], v[96:99]
  buffer_load_dwordx4 v2, s[8:11], s52 offen lds
  s_add_u32 m0, s50, 1024
  v_mfma_f32_16x16x32_bf16 v[100:103], a[108:111], a[44:47], v[100:103]
  ds_read_b64_tr_b16 a[84:85], v245 offset:8
  v_mfma_f32_16x16x32_bf16 v[32:35], a[96:99], a[48:51], v[32:35]
  v_mfma_f32_16x16x32_bf16 v[36:39], a[100:103], a[48:51], v[36:39]
  ds_read_b64_tr_b16 a[86:87], v245 offset:1032
  v_mfma_f32_16x16x32_bf16 v[104:107], a[104:107], a[48:51], v[104:107]
  buffer_load_dwordx4 v2, s[8:11], s53 offen lds
  s_add_u32 m0, s50, 2048
  v_mfma_f32_16x16x32_bf16 v[108:111], a[108:111], a[48:51], v[108:111]
  ds_read_b64_tr_b16 a[88:89], v245 offset:16384
  v_mfma_f32_16x16x32_bf16 v[40:43], a[96:99], a[52:55], v[40:43]
  v_mfma_f32_16x16x32_bf16 v[44:47], a[100:103], a[52:55], v[44:47]
  ds_read_b64_tr_b16 a[90:91], v245 offset:17408
  v_mfma_f32_16x16x32_bf16 v[112:115], a[104:107], a[52:55], v[112:115]
  buffer_load_dwordx4 v2, s[8:11], s54 offen lds
  s_add_u32 m0, s50, 3072
  v_mfma_f32_16x16x32_bf16 v[116:119], a[108:111], a[52:55], v[116:119]
  ds_read_b64_tr_b16 a[92:93], v245 offset:16392
  v_mfma_f32_16x16x32_bf16 v[48:51], a[96:99], a[56:59], v[48:51]
  v_mfma_f32_16x16x32_bf16 v[52:55], a[100:103], a[56:59], v[52:55]
  ds_read_b64_tr_b16 a[94:95], v245 offset:17416
  v_mfma_f32_16x16x32_bf16 v[120:123], a[104:107], a[56:59], v[120:123]
  buffer_load_dwordx4 v2, s[8:11], s55 offen lds
  s_add_u32 m0, s50, 4096
  v_mfma_f32_16x16x32_bf16 v[124:127], a[108:111], a[56:59], v[124:127]
  ds_read_b128 a[4:7], v241 offset:2048
  v_mfma_f32_16x16x32_bf16 v[56:59], a[96:99], a[60:63], v[56:59]
  v_mfma_f32_16x16x32_bf16 v[60:63], a[100:103], a[60:63], v[60:63]
  ds_read_b128 a[8:11], v241 offset:4096
  v_mfma_f32_16x16x32_bf16 v[128:131], a[104:107], a[60:63], v[128:131]
  buffer_load_dwordx4 v2, s[8:11], s56 offen lds
  v_add_u32 v247, 128, v2
  v_mfma_f32_16x16x32_bf16 v[132:135], a[108:111], a[60:63], v[132:135]
  ds_read_b128 a[12:15], v241 offset:6144
  v_mfma_f32_16x16x32_bf16 v[64:67], a[96:99], a[64:67], v[64:67]
  v_cndmask_b32 v236, v236, v243, s[58:59]
  v_cndmask_b32 v237, v237, v243, s[58:59]
  v_mfma_f32_16x16x32_bf16 v[68:71], a[100:103], a[64:67], v[68:71]
  ds_read_b128 a[16:19], v241 offset:8192
  v_cndmask_b32 v238, v238, v243, s[58:59]
  v_mfma_f32_16x16x32_bf16 v[136:139], a[104:107], a[64:67], v[136:139]
  v_cndmask_b32 v239, v239, v243, s[58:59]
  v_bfi_b32 v2, s29, v247, v2
  v_mfma_f32_16x16x32_bf16 v[140:143], a[108:111], a[64:67], v[140:143]
  ds_read_b128 a[20:23], v241 offset:10240
  s_add_u32 m0, s51, 0
  v_mfma_f32_16x16x32_bf16 v[72:75], a[96:99], a[68:71], v[72:75]
  buffer_load_dwordx4 v3, s[40:43], s57 offen lds
  s_add_u32 s57, s57, 8192
  v_mfma_f32_16x16x32_bf16 v[76:79], a[100:103], a[68:71], v[76:79]
  ds_read_b128 a[24:27], v241 offset:12288
  s_add_u32 m0, s51, 1024
  v_mfma_f32_16x16x32_bf16 v[144:147], a[104:107], a[68:71], v[144:147]
  v_mfma_f32_16x16x32_bf16 v[148:151], a[108:111], a[68:71], v[148:151]
  ds_read_b128 a[28:31], v241 offset:14336
  v_mfma_f32_16x16x32_bf16 v[80:83], a[96:99], a[72:75], v[80:83]
  buffer_load_dwordx4 v3, s[40:43], s57 offen lds
  s_add_u32 s57, s57, 8192
  v_mfma_f32_16x16x32_bf16 v[84:87], a[100:103], a[72:75], v[84:87]
  ds_read_b128 a[32:35], v241 offset:16384
  s_add_u32 m0, s51, 2048
  v_mfma_f32_16x16x32_bf16 v[152:155], a[104:107], a[72:75], v[152:155]
  v_mfma_f32_16x16x32_bf16 v[156:159], a[108:111], a[72:75], v[156:159]
  ds_read_b128 a[36:39], v241 offset:18432
  v_mfma_f32_16x16x32_bf16 v[160:163], a[104:107], a[76:79], v[160:163]
  buffer_load_dwordx4 v3, s[40:43], s57 offen lds
  s_add_u32 s57, s57, 8192
  v_mfma_f32_16x16x32_bf16 v[164:167], a[108:111], a[76:79], v[164:167]
  ds_read_b128 v[232:235], v241 offset:0
  s_add_u32 m0, s51, 3072
  v_mfma_f32_16x16x32_bf16 v[16:19], a[96:99], v[236:239], v[16:19]
  v_mfma_f32_16x16x32_bf16 v[20:23], a[100:103], v[236:239], v[20:23]
  v_mfma_f32_16x16x32_bf16 v[88:91], a[104:107], v[236:239], v[88:91]
  buffer_load_dwordx4 v3, s[40:43], s57 offen lds
  s_add_u32 s57, s57, 8192
  v_mfma_f32_16x16x32_bf16 v[92:95], a[108:111], v[236:239], v[92:95]
  s_add_u32 m0, s51, 4096
  s_waitcnt lgkmcnt(5)
  v_mfma_f32_16x16x32_bf16 v[24:27], a[80:83], a[4:7], v[24:27]
  ds_read_b64_tr_b16 a[96:97], v245 offset:8192
  v_mfma_f32_16x16x32_bf16 v[28:31], a[84:87], a[4:7], v[28:31]
  ds_read_b64_tr_b16 a[98:99], v245 offset:9216
  v_mfma_f32_16x16x32_bf16 v[96:99], a[88:91], a[4:7], v[96:99]
  buffer_load_dwordx4 v3, s[40:43], s57 offen lds
  s_add_u32 s57, s57, 8192
  v_mfma_f32_16x16x32_bf16 v[100:103], a[92:95], a[4:7], v[100:103]
  ds_read_b64_tr_b16 a[100:101], v245 offset:8200
  s_add_u32 m0, s51, 5120
  v_mfma_f32_16x16x32_bf16 v[32:35], a[80:83], a[8:11], v[32:35]
  v_mfma_f32_16x16x32_bf16 v[36:39], a[84:87], a[8:11], v[36:39]
  ds_read_b64_tr_b16 a[102:103], v245 offset:9224
  v_mfma_f32_16x16x32_bf16 v[104:107], a[88:91], a[8:11], v[104:107]
  buffer_load_dwordx4 v3, s[40:43], s57 offen lds
  s_add_u32 s57, s57, 8192
  v_mfma_f32_16x16x32_bf16 v[108:111], a[92:95], a[8:11], v[108:111]
  ds_read_b64_tr_b16 a[104:105], v245 offset:24576
  s_add_u32 m0, s51, 6144
  v_mfma_f32_16x16x32_bf16 v[40:43], a[80:83], a[12:15], v[40:43]
  v_mfma_f32_16x16x32_bf16 v[44:47], a[84:87], a[12:15], v[44:47]
  ds_read_b64_tr_b16 a[106:107], v245 offset:25600
  v_mfma_f32_16x16x32_bf16 v[112:115], a[88:91], a[12:15], v[112:115]
  buffer_load_dwordx4 v3, s[40:43], s57 offen lds
  s_add_u32 s57, s57, 8192
  v_mfma_f32_16x16x32_bf16 v[116:119], a[92:95], a[12:15], v[116:119]
  ds_read_b64_tr_b16 a[108:109], v245 offset:24584
  s_add_u32 m0, s51, 7168
  v_mfma_f32_16x16x32_bf16 v[48:51], a[80:83], a[16:19], v[48:51]
  v_mfma_f32_16x16x32_bf16 v[52:55], a[84:87], a[16:19], v[52:55]
  ds_read_b64_tr_b16 a[110:111], v245 offset:25608
  v_mfma_f32_16x16x32_bf16 v[120:123], a[88:91], a[16:19], v[120:123]
  buffer_load_dwordx4 v3, s[40:43], s57 offen lds
  s_add_u32 s57, s57, 73728
  v_mfma_f32_16x16x32_bf16 v[124:127], a[92:95], a[16:19], v[124:127]
  ds_read_b128 a[44:47], v254 offset:2048
  s_and_b32 s57, s57, 0xfffff
  v_mfma_f32_16x16x32_bf16 v[56:59], a[80:83], a[20:23], v[56:59]
  s_add_u32 s6, s6, 4096
  v_mfma_f32_16x16x32_bf16 v[60:63], a[84:87], a[20:23], v[60:63]
  ds_read_b128 a[48:51], v254 offset:4096
  v_mfma_f32_16x16x32_bf16 v[128:131], a[88:91], a[20:23], v[128:131]
  buffer_store_dwordx4 v[196:199], v220, s[20:23], s6 offen offset:0 sc1
  v_mfma_f32_16x16x32_bf16 v[132:135], a[92:95], a[20:23], v[132:135]
  ds_read_b128 a[52:55], v254 offset:6144
  s_waitcnt lgkmcnt(11)
  v_mfma_f32_16x16x32_bf16 v[64:67], a[80:83], a[24:27], v[64:67]
  v_cndmask_b32 v232, v232, v243, s[58:59]
  v_cndmask_b32 v233, v233, v243, s[58:59]
  v_mfma_f32_16x16x32_bf16 v[68:71], a[84:87], a[24:27], v[68:71]
  ds_read_b128 a[56:59], v254 offset:8192
  v_cndmask_b32 v234, v234, v243, s[58:59]
  v_mfma_f32_16x16x32_bf16 v[136:139], a[88:91], a[24:27], v[136:139]
  v_cndmask_b32 v235, v235, v243, s[58:59]
  buffer_store_dwordx4 v[200:203], v220, s[20:23], s6 offen offset:2048 sc1
  v_mfma_f32_16x16x32_bf16 v[140:143], a[92:95], a[24:27], v[140:143]
  ds_read_b128 a[60:63], v254 offset:10240
  s_add_u32 s6, s6, 4096
  v_mfma_f32_16x16x32_bf16 v[72:75], a[80:83], a[28:31], v[72:75]
  v_mfma_f32_16x16x32_bf16 v[76:79], a[84:87], a[28:31], v[76:79]
  ds_read_b128 a[64:67], v254 offset:12288
  v_mfma_f32_16x16x32_bf16 v[144:147], a[88:91], a[28:31], v[144:147]
  buffer_store_dwordx4 v[204:207], v220, s[20:23], s6 offen offset:0 sc1
  v_mfma_f32_16x16x32_bf16 v[148:151], a[92:95], a[28:31], v[148:151]
  ds_read_b128 a[68:71], v254 offset:14336
  v_mfma_f32_16x16x32_bf16 v[80:83], a[80:83], a[32:35], v[80:83]
  v_mfma_f32_16x16x32_bf16 v[84:87], a[84:87], a[32:35], v[84:87]
  ds_read_b128 a[72:75], v254 offset:16384
  v_mfma_f32_16x16x32_bf16 v[152:155], a[88:91], a[32:35], v[152:155]
  buffer_store_dwordx4 v[208:211], v220, s[20:23], s6 offen offset:2048 sc1
  v_mfma_f32_16x16x32_bf16 v[156:159], a[92:95], a[32:35], v[156:159]
  ds_read_b128 a[76:79], v254 offset:18432
  v_mfma_f32_16x16x32_bf16 v[160:163], a[88:91], a[36:39], v[160:163]
  v_mfma_f32_16x16x32_bf16 v[164:167], a[92:95], a[36:39], v[164:167]
  ds_read_b128 v[236:239], v254 offset:0
  v_mfma_f32_16x16x32_bf16 v[16:19], a[80:83], v[232:235], v[16:19]
  v_mfma_f32_16x16x32_bf16 v[20:23], a[84:87], v[232:235], v[20:23]
  v_mfma_f32_16x16x32_bf16 v[88:91], a[88:91], v[232:235], v[88:91]
  v_mfma_f32_16x16x32_bf16 v[92:95], a[92:95], v[232:235], v[92:95]
  s_waitcnt vmcnt(19) lgkmcnt(0)
  s_barrier
  v_mfma_f32_16x16x32_bf16 v[24:27], a[96:99], a[44:47], v[24:27]
  ds_read_b64_tr_b16 a[80:81], v246 offset:0
  v_mfma_f32_16x16x32_bf16 v[28:31], a[100:103], a[44:47], v[28:31]
  ds_read_b64_tr_b16 a[82:83], v246 offset:1024
  v_mfma_f32_16x16x32_bf16 v[96:99], a[104:107], a[44:47], v[96:99]
  v_mov_b32 v14, s4
  s_lshr_b32 s26, s2, 3
  s_lshl_b32 s26, s26, 7
  s_and_b32 s5, s2, 7
  s_lshl_b32 s5, s5, 2
  s_add_u32 s26, s26, s5
  s_add_u32 s26, s26, 90374144
  s_cmp_eq_u32 s3, 0
  s_cselect_b32 s26, s26, 2130706432
  s_mov_b64 exec, 1
  buffer_store_dword v14, off, s[20:23], s26 sc1
  s_mov_b64 exec, -1
  s_add_u32 m0, s50, 53248
  v_mfma_f32_16x16x32_bf16 v[100:103], a[108:111], a[44:47], v[100:103]
  ds_read_b64_tr_b16 a[84:85], v246 offset:8
  v_mfma_f32_16x16x32_bf16 v[32:35], a[96:99], a[48:51], v[32:35]
  v_mfma_f32_16x16x32_bf16 v[36:39], a[100:103], a[48:51], v[36:39]
  ds_read_b64_tr_b16 a[86:87], v246 offset:1032
  v_mfma_f32_16x16x32_bf16 v[104:107], a[104:107], a[48:51], v[104:107]
  buffer_load_dwordx4 v2, s[8:11], s52 offen lds
  s_add_u32 m0, s50, 54272
  v_mfma_f32_16x16x32_bf16 v[108:111], a[108:111], a[48:51], v[108:111]
  ds_read_b64_tr_b16 a[88:89], v246 offset:16384
  v_mfma_f32_16x16x32_bf16 v[40:43], a[96:99], a[52:55], v[40:43]
  v_mfma_f32_16x16x32_bf16 v[44:47], a[100:103], a[52:55], v[44:47]
  ds_read_b64_tr_b16 a[90:91], v246 offset:17408
  v_mfma_f32_16x16x32_bf16 v[112:115], a[104:107], a[52:55], v[112:115]
  buffer_load_dwordx4 v2, s[8:11], s53 offen lds
  s_add_u32 m0, s50, 55296
  v_mfma_f32_16x16x32_bf16 v[116:119], a[108:111], a[52:55], v[116:119]
  ds_read_b64_tr_b16 a[92:93], v246 offset:16392
  v_mfma_f32_16x16x32_bf16 v[48:51], a[96:99], a[56:59], v[48:51]
  v_mfma_f32_16x16x32_bf16 v[52:55], a[100:103], a[56:59], v[52:55]
  ds_read_b64_tr_b16 a[94:95], v246 offset:17416
  v_mfma_f32_16x16x32_bf16 v[120:123], a[104:107], a[56:59], v[120:123]
  buffer_load_dwordx4 v2, s[8:11], s54 offen lds
  s_add_u32 m0, s50, 56320
  v_mfma_f32_16x16x32_bf16 v[124:127], a[108:111], a[56:59], v[124:127]
  ds_read_b128 a[4:7], v242 offset:2048
  v_mfma_f32_16x16x32_bf16 v[56:59], a[96:99], a[60:63], v[56:59]
  v_mfma_f32_16x16x32_bf16 v[60:63], a[100:103], a[60:63], v[60:63]
  ds_read_b128 a[8:11], v242 offset:4096
  v_mfma_f32_16x16x32_bf16 v[128:131], a[104:107], a[60:63], v[128:131]
  buffer_load_dwordx4 v2, s[8:11], s55 offen lds
  s_add_u32 m0, s50, 57344
  v_mfma_f32_16x16x32_bf16 v[132:135], a[108:111], a[60:63], v[132:135]
  ds_read_b128 a[12:15], v242 offset:6144
  v_mfma_f32_16x16x32_bf16 v[64:67], a[96:99], a[64:67], v[64:67]
  v_cndmask_b32 v236, v236, v243, s[58:59]
  v_cndmask_b32 v237, v237, v243, s[58:59]
  v_mfma_f32_16x16x32_bf16 v[68:71], a[100:103], a[64:67], v[68:71]
  ds_read_b128 a[16:19], v242 offset:8192
  v_cndmask_b32 v238, v238, v243, s[58:59]
  v_mfma_f32_16x16x32_bf16 v[136:139], a[104:107], a[64:67], v[136:139]
  v_cndmask_b32 v239, v239, v243, s[58:59]
  buffer_load_dwordx4 v2, s[8:11], s56 offen lds
  v_mfma_f32_16x16x32_bf16 v[140:143], a[108:111], a[64:67], v[140:143]
  ds_read_b128 a[20:23], v242 offset:10240
  v_add_u32 v247, 128, v2
  v_mfma_f32_16x16x32_bf16 v[72:75], a[96:99], a[68:71], v[72:75]
  v_bfi_b32 v2, s29, v247, v2
  s_add_u32 m0, s51, 53248
  v_mfma_f32_16x16x32_bf16 v[76:79], a[100:103], a[68:71], v[76:79]
  ds_read_b128 a[24:27], v242 offset:12288
  v_mfma_f32_16x16x32_bf16 v[144:147], a[104:107], a[68:71], v[144:147]
  buffer_load_dwordx4 v3, s[40:43], s57 offen lds
  s_add_u32 s57, s57, 8192
  v_mfma_f32_16x16x32_bf16 v[148:151], a[108:111], a[68:71], v[148:151]
  ds_read_b128 a[28:31], v242 offset:14336
  s_add_u32 m0, s51, 54272
  v_mfma_f32_16x16x32_bf16 v[80:83], a[96:99], a[72:75], v[80:83]
  v_mfma_f32_16x16x32_bf16 v[84:87], a[100:103], a[72:75], v[84:87]
  ds_read_b128 a[32:35], v242 offset:16384
  v_mfma_f32_16x16x32_bf16 v[152:155], a[104:107], a[72:75], v[152:155]
  buffer_load_dwordx4 v3, s[40:43], s57 offen lds
  s_add_u32 s57, s57, 8192
  v_mfma_f32_16x16x32_bf16 v[156:159], a[108:111], a[72:75], v[156:159]
  ds_read_b128 a[36:39], v242 offset:18432
  s_add_u32 m0, s51, 55296
  v_mfma_f32_16x16x32_bf16 v[160:163], a[104:107], a[76:79], v[160:163]
  v_mfma_f32_16x16x32_bf16 v[164:167], a[108:111], a[76:79], v[164:167]
  ds_read_b128 v[232:235], v242 offset:0
  v_mfma_f32_16x16x32_bf16 v[16:19], a[96:99], v[236:239], v[16:19]
  buffer_load_dwordx4 v3, s[40:43], s57 offen lds
  s_add_u32 s57, s57, 8192
  v_mfma_f32_16x16x32_bf16 v[20:23], a[100:103], v[236:239], v[20:23]
  s_add_u32 m0, s51, 56320
  v_mfma_f32_16x16x32_bf16 v[88:91], a[104:107], v[236:239], v[88:91]
  v_mfma_f32_16x16x32_bf16 v[92:95], a[108:111], v[236:239], v[92:95]
  s_waitcnt lgkmcnt(5)
  v_mfma_f32_16x16x32_bf16 v[24:27], a[80:83], a[4:7], v[24:27]
  ds_read_b64_tr_b16 a[96:97], v246 offset:8192
  v_mfma_f32_16x16x32_bf16 v[28:31], a[84:87], a[4:7], v[28:31]
  ds_read_b64_tr_b16 a[98:99], v246 offset:9216
  v_mfma_f32_16x16x32_bf16 v[96:99], a[88:91], a[4:7], v[96:99]
  buffer_load_dwordx4 v3, s[40:43], s57 offen lds
  s_add_u32 s57, s57, 8192
  v_mfma_f32_16x16x32_bf16 v[100:103], a[92:95], a[4:7], v[100:103]
  ds_read_b64_tr_b16 a[100:101], v246 offset:8200
  s_add_u32 m0, s51, 57344
  v_mfma_f32_16x16x32_bf16 v[32:35], a[80:83], a[8:11], v[32:35]
  v_mfma_f32_16x16x32_bf16 v[36:39], a[84:87], a[8:11], v[36:39]
  ds_read_b64_tr_b16 a[102:103], v246 offset:9224
  v_mfma_f32_16x16x32_bf16 v[104:107], a[88:91], a[8:11], v[104:107]
  buffer_load_dwordx4 v3, s[40:43], s57 offen lds
  s_add_u32 s57, s57, 8192
  v_mfma_f32_16x16x32_bf16 v[108:111], a[92:95], a[8:11], v[108:111]
  ds_read_b64_tr_b16 a[104:105], v246 offset:24576
  s_add_u32 m0, s51, 58368
  v_mfma_f32_16x16x32_bf16 v[40:43], a[80:83], a[12:15], v[40:43]
  v_mfma_f32_16x16x32_bf16 v[44:47], a[84:87], a[12:15], v[44:47]
  ds_read_b64_tr_b16 a[106:107], v246 offset:25600
  v_mfma_f32_16x16x32_bf16 v[112:115], a[88:91], a[12:15], v[112:115]
  buffer_load_dwordx4 v3, s[40:43], s57 offen lds
  s_add_u32 s57, s57, 8192
  v_mfma_f32_16x16x32_bf16 v[116:119], a[92:95], a[12:15], v[116:119]
  ds_read_b64_tr_b16 a[108:109], v246 offset:24584
  s_add_u32 m0, s51, 59392
  v_mfma_f32_16x16x32_bf16 v[48:51], a[80:83], a[16:19], v[48:51]
  v_mfma_f32_16x16x32_bf16 v[52:55], a[84:87], a[16:19], v[52:55]
  ds_read_b64_tr_b16 a[110:111], v246 offset:25608
  v_mfma_f32_16x16x32_bf16 v[120:123], a[88:91], a[16:19], v[120:123]
  buffer_load_dwordx4 v3, s[40:43], s57 offen lds
  s_add_u32 s57, s57, 8192
  v_mfma_f32_16x16x32_bf16 v[124:127], a[92:95], a[16:19], v[124:127]
  ds_read_b128 a[44:47], v255 offset:2048
  s_add_u32 m0, s51, 60416
  v_mfma_f32_16x16x32_bf16 v[56:59], a[80:83], a[20:23], v[56:59]
  v_mfma_f32_16x16x32_bf16 v[60:63], a[84:87], a[20:23], v[60:63]
  ds_read_b128 a[48:51], v255 offset:4096
  v_mfma_f32_16x16x32_bf16 v[128:131], a[88:91], a[20:23], v[128:131]
  buffer_load_dwordx4 v3, s[40:43], s57 offen lds
  s_add_u32 s57, s57, 73728
  v_mfma_f32_16x16x32_bf16 v[132:135], a[92:95], a[20:23], v[132:135]
  ds_read_b128 a[52:55], v255 offset:6144
  s_waitcnt lgkmcnt(11)
  v_mfma_f32_16x16x32_bf16 v[64:67], a[80:83], a[24:27], v[64:67]
  v_cndmask_b32 v232, v232, v243, s[58:59]
  v_cndmask_b32 v233, v233, v243, s[58:59]
  v_mfma_f32_16x16x32_bf16 v[68:71], a[84:87], a[24:27], v[68:71]
  ds_read_b128 a[56:59], v255 offset:8192
  v_cndmask_b32 v234, v234, v243, s[58:59]
  v_mfma_f32_16x16x32_bf16 v[136:139], a[88:91], a[24:27], v[136:139]
  v_cndmask_b32 v235, v235, v243, s[58:59]
  s_and_b32 s57, s57, 0xfffff
  v_mfma_f32_16x16x32_bf16 v[140:143], a[92:95], a[24:27], v[140:143]
  ds_read_b128 a[60:63], v255 offset:10240
  s_add_u32 s6, s6, 4096
  v_mfma_f32_16x16x32_bf16 v[72:75], a[80:83], a[28:31], v[72:75]
  buffer_store_dwordx4 v[212:215], v220, s[20:23], s6 offen offset:0 sc1
  v_mfma_f32_16x16x32_bf16 v[76:79], a[84:87], a[28:31], v[76:79]
  ds_read_b128 a[64:67], v255 offset:12288
  v_mfma_f32_16x16x32_bf16 v[144:147], a[88:91], a[28:31], v[144:147]
  v_mfma_f32_16x16x32_bf16 v[148:151], a[92:95], a[28:31], v[148:151]
  ds_read_b128 a[68:71], v255 offset:14336
  v_mfma_f32_16x16x32_bf16 v[80:83], a[80:83], a[32:35], v[80:83]
  buffer_store_dwordx4 v[216:219], v220, s[20:23], s6 offen offset:2048 sc1
  v_mfma_f32_16x16x32_bf16 v[84:87], a[84:87], a[32:35], v[84:87]
  ds_read_b128 a[72:75], v255 offset:16384
  v_mfma_f32_16x16x32_bf16 v[152:155], a[88:91], a[32:35], v[152:155]
  v_mfma_f32_16x16x32_bf16 v[156:159], a[92:95], a[32:35], v[156:159]
  ds_read_b128 a[76:79], v255 offset:18432
  v_mfma_f32_16x16x32_bf16 v[160:163], a[88:91], a[36:39], v[160:163]
  v_mfma_f32_16x16x32_bf16 v[164:167], a[92:95], a[36:39], v[164:167]
  ds_read_b128 v[236:239], v255 offset:0
  v_mfma_f32_16x16x32_bf16 v[16:19], a[80:83], v[232:235], v[16:19]
  v_mfma_f32_16x16x32_bf16 v[20:23], a[84:87], v[232:235], v[20:23]
  v_mfma_f32_16x16x32_bf16 v[88:91], a[88:91], v[232:235], v[88:91]
  v_mfma_f32_16x16x32_bf16 v[92:95], a[92:95], v[232:235], v[92:95]
  s_waitcnt vmcnt(20) lgkmcnt(0)
  s_barrier
  v_mfma_f32_16x16x32_bf16 v[24:27], a[96:99], a[44:47], v[24:27]
  ds_read_b64_tr_b16 a[80:81], v244 offset:0
  s_add_u32 m0, s50, 106496
  v_mfma_f32_16x16x32_bf16 v[28:31], a[100:103], a[44:47], v[28:31]
  ds_read_b64_tr_b16 a[82:83], v244 offset:1024
  v_mfma_f32_16x16x32_bf16 v[96:99], a[104:107], a[44:47], v[96:99]
  buffer_load_dwordx4 v2, s[8:11], s52 offen lds
  s_add_u32 m0, s50, 107520
  v_mfma_f32_16x16x32_bf16 v[100:103], a[108:111], a[44:47], v[100:103]
  ds_read_b64_tr_b16 a[84:85], v244 offset:8
  v_mfma_f32_16x16x32_bf16 v[32:35], a[96:99], a[48:51], v[32:35]
  v_mfma_f32_16x16x32_bf16 v[36:39], a[100:103], a[48:51], v[36:39]
  ds_read_b64_tr_b16 a[86:87], v244 offset:1032
  v_mfma_f32_16x16x32_bf16 v[104:107], a[104:107], a[48:51], v[104:107]
  buffer_load_dwordx4 v2, s[8:11], s53 offen lds
  s_add_u32 m0, s50, 108544
  v_mfma_f32_16x16x32_bf16 v[108:111], a[108:111], a[48:51], v[108:111]
  ds_read_b64_tr_b16 a[88:89], v244 offset:16384
  v_mfma_f32_16x16x32_bf16 v[40:43], a[96:99], a[52:55], v[40:43]
  v_mfma_f32_16x16x32_bf16 v[44:47], a[100:103], a[52:55], v[44:47]
  ds_read_b64_tr_b16 a[90:91], v244 offset:17408
  v_mfma_f32_16x16x32_bf16 v[112:115], a[104:107], a[52:55], v[112:115]
  buffer_load_dwordx4 v2, s[8:11], s54 offen lds
  s_add_u32 m0, s50, 109568
  v_mfma_f32_16x16x32_bf16 v[116:119], a[108:111], a[52:55], v[116:119]
  ds_read_b64_tr_b16 a[92:93], v244 offset:16392
  v_mfma_f32_16x16x32_bf16 v[48:51], a[96:99], a[56:59], v[48:51]
  v_mfma_f32_16x16x32_bf16 v[52:55], a[100:103], a[56:59], v[52:55]
  ds_read_b64_tr_b16 a[94:95], v244 offset:17416
  v_mfma_f32_16x16x32_bf16 v[120:123], a[104:107], a[56:59], v[120:123]
  buffer_load_dwordx4 v2, s[8:11], s55 offen lds
  s_add_u32 m0, s50, 110592
  v_mfma_f32_16x16x32_bf16 v[124:127], a[108:111], a[56:59], v[124:127]
  ds_read_b128 a[4:7], v240 offset:2048
  v_mfma_f32_16x16x32_bf16 v[56:59], a[96:99], a[60:63], v[56:59]
  v_mfma_f32_16x16x32_bf16 v[60:63], a[100:103], a[60:63], v[60:63]
  ds_read_b128 a[8:11], v240 offset:4096
  v_mfma_f32_16x16x32_bf16 v[128:131], a[104:107], a[60:63], v[128:131]
  buffer_load_dwordx4 v2, s[8:11], s56 offen lds
  v_add_u32 v247, 128, v2
  v_mfma_f32_16x16x32_bf16 v[132:135], a[108:111], a[60:63], v[132:135]
  ds_read_b128 a[12:15], v240 offset:6144
  v_mfma_f32_16x16x32_bf16 v[64:67], a[96:99], a[64:67], v[64:67]
  v_cndmask_b32 v236, v236, v243, s[58:59]
  v_cndmask_b32 v237, v237, v243, s[58:59]
  v_mfma_f32_16x16x32_bf16 v[68:71], a[100:103], a[64:67], v[68:71]
  ds_read_b128 a[16:19], v240 offset:8192
  v_cndmask_b32 v238, v238, v243, s[58:59]
  v_mfma_f32_16x16x32_bf16 v[136:139], a[104:107], a[64:67], v[136:139]
  v_cndmask_b32 v239, v239, v243, s[58:59]
  v_bfi_b32 v2, s29, v247, v2
  v_mfma_f32_16x16x32_bf16 v[140:143], a[108:111], a[64:67], v[140:143]
  ds_read_b128 a[20:23], v240 offset:10240
  s_add_u32 m0, s51, 106496
  v_mfma_f32_16x16x32_bf16 v[72:75], a[96:99], a[68:71], v[72:75]
  buffer_load_dwordx4 v3, s[40:43], s57 offen lds
  s_add_u32 s57, s57, 8192
  v_mfma_f32_16x16x32_bf16 v[76:79], a[100:103], a[68:71], v[76:79]
  ds_read_b128 a[24:27], v240 offset:12288
  s_add_u32 m0, s51, 107520
  v_mfma_f32_16x16x32_bf16 v[144:147], a[104:107], a[68:71], v[144:147]
  v_mfma_f32_16x16x32_bf16 v[148:151], a[108:111], a[68:71], v[148:151]
  ds_read_b128 a[28:31], v240 offset:14336
  v_mfma_f32_16x16x32_bf16 v[80:83], a[96:99], a[72:75], v[80:83]
  buffer_load_dwordx4 v3, s[40:43], s57 offen lds
  s_add_u32 s57, s57, 8192
  v_mfma_f32_16x16x32_bf16 v[84:87], a[100:103], a[72:75], v[84:87]
  ds_read_b128 a[32:35], v240 offset:16384
  s_add_u32 m0, s51, 108544
  v_mfma_f32_16x16x32_bf16 v[152:155], a[104:107], a[72:75], v[152:155]
  v_mfma_f32_16x16x32_bf16 v[156:159], a[108:111], a[72:75], v[156:159]
  ds_read_b128 a[36:39], v240 offset:18432
  v_mfma_f32_16x16x32_bf16 v[160:163], a[104:107], a[76:79], v[160:163]
  buffer_load_dwordx4 v3, s[40:43], s57 offen lds
  s_add_u32 s57, s57, 8192
  v_mfma_f32_16x16x32_bf16 v[164:167], a[108:111], a[76:79], v[164:167]
  ds_read_b128 v[232:235], v240 offset:0
  s_add_u32 m0, s51, 109568
  v_mfma_f32_16x16x32_bf16 v[16:19], a[96:99], v[236:239], v[16:19]
  v_mfma_f32_16x16x32_bf16 v[20:23], a[100:103], v[236:239], v[20:23]
  v_mfma_f32_16x16x32_bf16 v[88:91], a[104:107], v[236:239], v[88:91]
  buffer_load_dwordx4 v3, s[40:43], s57 offen lds
  s_add_u32 s57, s57, 8192
  v_mfma_f32_16x16x32_bf16 v[92:95], a[108:111], v[236:239], v[92:95]
  s_add_u32 m0, s51, 110592
  s_waitcnt lgkmcnt(5)
  v_mfma_f32_16x16x32_bf16 v[24:27], a[80:83], a[4:7], v[24:27]
  ds_read_b64_tr_b16 a[96:97], v244 offset:8192
  v_mfma_f32_16x16x32_bf16 v[28:31], a[84:87], a[4:7], v[28:31]
  ds_read_b64_tr_b16 a[98:99], v244 offset:9216
  v_mfma_f32_16x16x32_bf16 v[96:99], a[88:91], a[4:7], v[96:99]
  buffer_load_dwordx4 v3, s[40:43], s57 offen lds
  s_add_u32 s57, s57, 8192
  v_mfma_f32_16x16x32_bf16 v[100:103], a[92:95], a[4:7], v[100:103]
  ds_read_b64_tr_b16 a[100:101], v244 offset:8200
  s_add_u32 m0, s51, 111616
  v_mfma_f32_16x16x32_bf16 v[32:35], a[80:83], a[8:11], v[32:35]
  v_mfma_f32_16x16x32_bf16 v[36:39], a[84:87], a[8:11], v[36:39]
  ds_read_b64_tr_b16 a[102:103], v244 offset:9224
  v_mfma_f32_16x16x32_bf16 v[104:107], a[88:91], a[8:11], v[104:107]
  buffer_load_dwordx4 v3, s[40:43], s57 offen lds
  s_add_u32 s57, s57, 8192
  v_mfma_f32_16x16x32_bf16 v[108:111], a[92:95], a[8:11], v[108:111]
  ds_read_b64_tr_b16 a[104:105], v244 offset:24576
  s_add_u32 m0, s51, 112640
  v_mfma_f32_16x16x32_bf16 v[40:43], a[80:83], a[12:15], v[40:43]
  v_mfma_f32_16x16x32_bf16 v[44:47], a[84:87], a[12:15], v[44:47]
  ds_read_b64_tr_b16 a[106:107], v244 offset:25600
  v_mfma_f32_16x16x32_bf16 v[112:115], a[88:91], a[12:15], v[112:115]
  buffer_load_dwordx4 v3, s[40:43], s57 offen lds
  s_add_u32 s57, s57, 8192
  v_mfma_f32_16x16x32_bf16 v[116:119], a[92:95], a[12:15], v[116:119]
  ds_read_b64_tr_b16 a[108:109], v244 offset:24584
  s_add_u32 m0, s51, 113664
  v_mfma_f32_16x16x32_bf16 v[48:51], a[80:83], a[16:19], v[48:51]
  v_mfma_f32_16x16x32_bf16 v[52:55], a[84:87], a[16:19], v[52:55]
  ds_read_b64_tr_b16 a[110:111], v244 offset:25608
  v_mfma_f32_16x16x32_bf16 v[120:123], a[88:91], a[16:19], v[120:123]
  buffer_load_dwordx4 v3, s[40:43], s57 offen lds
  s_add_u32 s57, s57, 73728
  v_mfma_f32_16x16x32_bf16 v[124:127], a[92:95], a[16:19], v[124:127]
  ds_read_b128 a[44:47], v253 offset:2048
  s_and_b32 s57, s57, 0xfffff
  v_mfma_f32_16x16x32_bf16 v[56:59], a[80:83], a[20:23], v[56:59]
  v_mfma_f32_16x16x32_bf16 v[60:63], a[84:87], a[20:23], v[60:63]
  ds_read_b128 a[48:51], v253 offset:4096
  v_mfma_f32_16x16x32_bf16 v[128:131], a[88:91], a[20:23], v[128:131]
  v_mfma_f32_16x16x32_bf16 v[132:135], a[92:95], a[20:23], v[132:135]
  ds_read_b128 a[52:55], v253 offset:6144
  s_waitcnt lgkmcnt(11)
  v_mfma_f32_16x16x32_bf16 v[64:67], a[80:83], a[24:27], v[64:67]
  v_cndmask_b32 v232, v232, v243, s[58:59]
  v_cndmask_b32 v233, v233, v243, s[58:59]
  v_mfma_f32_16x16x32_bf16 v[68:71], a[84:87], a[24:27], v[68:71]
  ds_read_b128 a[56:59], v253 offset:8192
  v_cndmask_b32 v234, v234, v243, s[58:59]
  v_mfma_f32_16x16x32_bf16 v[136:139], a[88:91], a[24:27], v[136:139]
  v_cndmask_b32 v235, v235, v243, s[58:59]
  v_mfma_f32_16x16x32_bf16 v[140:143], a[92:95], a[24:27], v[140:143]
  ds_read_b128 a[60:63], v253 offset:10240
  v_mfma_f32_16x16x32_bf16 v[72:75], a[80:83], a[28:31], v[72:75]
  v_mfma_f32_16x16x32_bf16 v[76:79], a[84:87], a[28:31], v[76:79]
  ds_read_b128 a[64:67], v253 offset:12288
  v_mfma_f32_16x16x32_bf16 v[144:147], a[88:91], a[28:31], v[144:147]
  v_mfma_f32_16x16x32_bf16 v[148:151], a[92:95], a[28:31], v[148:151]
  ds_read_b128 a[68:71], v253 offset:14336
  v_mfma_f32_16x16x32_bf16 v[80:83], a[80:83], a[32:35], v[80:83]
  v_mfma_f32_16x16x32_bf16 v[84:87], a[84:87], a[32:35], v[84:87]
  ds_read_b128 a[72:75], v253 offset:16384
  v_mfma_f32_16x16x32_bf16 v[152:155], a[88:91], a[32:35], v[152:155]
  v_mfma_f32_16x16x32_bf16 v[156:159], a[92:95], a[32:35], v[156:159]
  ds_read_b128 a[76:79], v253 offset:18432
  v_mfma_f32_16x16x32_bf16 v[160:163], a[88:91], a[36:39], v[160:163]
  v_mfma_f32_16x16x32_bf16 v[164:167], a[92:95], a[36:39], v[164:167]
  ds_read_b128 v[236:239], v253 offset:0
  v_mfma_f32_16x16x32_bf16 v[16:19], a[80:83], v[232:235], v[16:19]
  v_mfma_f32_16x16x32_bf16 v[20:23], a[84:87], v[232:235], v[20:23]
  v_mfma_f32_16x16x32_bf16 v[88:91], a[88:91], v[232:235], v[88:91]
  v_mfma_f32_16x16x32_bf16 v[92:95], a[92:95], v[232:235], v[92:95]
  s_waitcnt vmcnt(15) lgkmcnt(0)
  s_barrier
  v_mfma_f32_16x16x32_bf16 v[24:27], a[96:99], a[44:47], v[24:27]
  ds_read_b64_tr_b16 a[80:81], v245 offset:0
  s_add_u32 m0, s50, 0
  v_mfma_f32_16x16x32_bf16 v[28:31], a[100:103], a[44:47], v[28:31]
  ds_read_b64_tr_b16 a[82:83], v245 offset:1024
  v_mfma_f32_16x16x32_bf16 v[96:99], a[104:107], a[44:47], v[96:99]
  buffer_load_dwordx4 v2, s[8:11], s52 offen lds
  s_add_u32 m0, s50, 1024
  v_mfma_f32_16x16x32_bf16 v[100:103], a[108:111], a[44:47], v[100:103]
  ds_read_b64_tr_b16 a[84:85], v245 offset:8
  v_mfma_f32_16x16x32_bf16 v[32:35], a[96:99], a[48:51], v[32:35]
  v_mfma_f32_16x16x32_bf16 v[36:39], a[100:103], a[48:51], v[36:39]
  ds_read_b64_tr_b16 a[86:87], v245 offset:1032
  v_mfma_f32_16x16x32_bf16 v[104:107], a[104:107], a[48:51], v[104:107]
  buffer_load_dwordx4 v2, s[8:11], s53 offen lds
  s_add_u32 m0, s50, 2048
  v_mfma_f32_16x16x32_bf16 v[108:111], a[108:111], a[48:51], v[108:111]
  ds_read_b64_tr_b16 a[88:89], v245 offset:16384
  v_mfma_f32_16x16x32_bf16 v[40:43], a[96:99], a[52:55], v[40:43]
  v_mfma_f32_16x16x32_bf16 v[44:47], a[100:103], a[52:55], v[44:47]
  ds_read_b64_tr_b16 a[90:91], v245 offset:17408
  v_mfma_f32_16x16x32_bf16 v[112:115], a[104:107], a[52:55], v[112:115]
  buffer_load_dwordx4 v2, s[8:11], s54 offen lds
  s_add_u32 m0, s50, 3072
  v_mfma_f32_16x16x32_bf16 v[116:119], a[108:111], a[52:55], v[116:119]
  ds_read_b64_tr_b16 a[92:93], v245 offset:16392
  v_mfma_f32_16x16x32_bf16 v[48:51], a[96:99], a[56:59], v[48:51]
  v_mfma_f32_16x16x32_bf16 v[52:55], a[100:103], a[56:59], v[52:55]
  ds_read_b64_tr_b16 a[94:95], v245 offset:17416
  v_mfma_f32_16x16x32_bf16 v[120:123], a[104:107], a[56:59], v[120:123]
  buffer_load_dwordx4 v2, s[8:11], s55 offen lds
  s_add_u32 m0, s50, 4096
  v_mfma_f32_16x16x32_bf16 v[124:127], a[108:111], a[56:59], v[124:127]
  ds_read_b128 a[4:7], v241 offset:2048
  v_mfma_f32_16x16x32_bf16 v[56:59], a[96:99], a[60:63], v[56:59]
  v_mfma_f32_16x16x32_bf16 v[60:63], a[100:103], a[60:63], v[60:63]
  ds_read_b128 a[8:11], v241 offset:4096
  v_mfma_f32_16x16x32_bf16 v[128:131], a[104:107], a[60:63], v[128:131]
  buffer_load_dwordx4 v2, s[8:11], s56 offen lds
  v_add_u32 v247, 128, v2
  v_mfma_f32_16x16x32_bf16 v[132:135], a[108:111], a[60:63], v[132:135]
  ds_read_b128 a[12:15], v241 offset:6144
  v_mfma_f32_16x16x32_bf16 v[64:67], a[96:99], a[64:67], v[64:67]
  v_cndmask_b32 v236, v236, v243, s[58:59]
  v_cndmask_b32 v237, v237, v243, s[58:59]
  v_mfma_f32_16x16x32_bf16 v[68:71], a[100:103], a[64:67], v[68:71]
  ds_read_b128 a[16:19], v241 offset:8192
  v_cndmask_b32 v238, v238, v243, s[58:59]
  v_mfma_f32_16x16x32_bf16 v[136:139], a[104:107], a[64:67], v[136:139]
  v_cndmask_b32 v239, v239, v243, s[58:59]
  v_bfi_b32 v2, s29, v247, v2
  v_mfma_f32_16x16x32_bf16 v[140:143], a[108:111], a[64:67], v[140:143]
  ds_read_b128 a[20:23], v241 offset:10240
  s_add_u32 m0, s51, 0
  v_mfma_f32_16x16x32_bf16 v[72:75], a[96:99], a[68:71], v[72:75]
  buffer_load_dwordx4 v3, s[40:43], s57 offen lds
  s_add_u32 s57, s57, 8192
  v_mfma_f32_16x16x32_bf16 v[76:79], a[100:103], a[68:71], v[76:79]
  ds_read_b128 a[24:27], v241 offset:12288
  s_add_u32 m0, s51, 1024
  v_mfma_f32_16x16x32_bf16 v[144:147], a[104:107], a[68:71], v[144:147]
  v_mfma_f32_16x16x32_bf16 v[148:151], a[108:111], a[68:71], v[148:151]
  ds_read_b128 a[28:31], v241 offset:14336
  v_mfma_f32_16x16x32_bf16 v[80:83], a[96:99], a[72:75], v[80:83]
  buffer_load_dwordx4 v3, s[40:43], s57 offen lds
  s_add_u32 s57, s57, 8192
  v_mfma_f32_16x16x32_bf16 v[84:87], a[100:103], a[72:75], v[84:87]
  ds_read_b128 a[32:35], v241 offset:16384
  s_add_u32 m0, s51, 2048
  v_mfma_f32_16x16x32_bf16 v[152:155], a[104:107], a[72:75], v[152:155]
  v_mfma_f32_16x16x32_bf16 v[156:159], a[108:111], a[72:75], v[156:159]
  ds_read_b128 a[36:39], v241 offset:18432
  v_mfma_f32_16x16x32_bf16 v[160:163], a[104:107], a[76:79], v[160:163]
  buffer_load_dwordx4 v3, s[40:43], s57 offen lds
  s_add_u32 s57, s57, 8192
  v_mfma_f32_16x16x32_bf16 v[164:167], a[108:111], a[76:79], v[164:167]
  ds_read_b128 v[232:235], v241 offset:0
  s_add_u32 m0, s51, 3072
  v_mfma_f32_16x16x32_bf16 v[16:19], a[96:99], v[236:239], v[16:19]
  v_mfma_f32_16x16x32_bf16 v[20:23], a[100:103], v[236:239], v[20:23]
  v_mfma_f32_16x16x32_bf16 v[88:91], a[104:107], v[236:239], v[88:91]
  buffer_load_dwordx4 v3, s[40:43], s57 offen lds
  s_add_u32 s57, s57, 8192
  v_mfma_f32_16x16x32_bf16 v[92:95], a[108:111], v[236:239], v[92:95]
  s_add_u32 m0, s51, 4096
  s_waitcnt lgkmcnt(5)
  v_mfma_f32_16x16x32_bf16 v[24:27], a[80:83], a[4:7], v[24:27]
  ds_read_b64_tr_b16 a[96:97], v245 offset:8192
  v_mfma_f32_16x16x32_bf16 v[28:31], a[84:87], a[4:7], v[28:31]
  ds_read_b64_tr_b16 a[98:99], v245 offset:9216
  v_mfma_f32_16x16x32_bf16 v[96:99], a[88:91], a[4:7], v[96:99]
  s_waitcnt vmcnt(22)
  v_mfma_f32_16x16x32_bf16 v[100:103], a[92:95], a[4:7], v[100:103]
  ds_read_b64_tr_b16 a[100:101], v245 offset:8200
  v_mfma_f32_16x16x32_bf16 v[32:35], a[80:83], a[8:11], v[32:35]
  v_mfma_f32_16x16x32_bf16 v[36:39], a[84:87], a[8:11], v[36:39]
  ds_read_b64_tr_b16 a[102:103], v245 offset:9224
  v_mfma_f32_16x16x32_bf16 v[104:107], a[88:91], a[8:11], v[104:107]
  buffer_load_dwordx4 v3, s[40:43], s57 offen lds
  s_add_u32 s57, s57, 8192
  v_mfma_f32_16x16x32_bf16 v[108:111], a[92:95], a[8:11], v[108:111]
  ds_read_b64_tr_b16 a[104:105], v245 offset:24576
  s_add_u32 m0, s51, 5120
  v_mfma_f32_16x16x32_bf16 v[40:43], a[80:83], a[12:15], v[40:43]
  v_mfma_f32_16x16x32_bf16 v[44:47], a[84:87], a[12:15], v[44:47]
  ds_read_b64_tr_b16 a[106:107], v245 offset:25600
  v_mfma_f32_16x16x32_bf16 v[112:115], a[88:91], a[12:15], v[112:115]
  buffer_load_dwordx4 v3, s[40:43], s57 offen lds
  s_add_u32 s57, s57, 8192
  v_mfma_f32_16x16x32_bf16 v[116:119], a[92:95], a[12:15], v[116:119]
  ds_read_b64_tr_b16 a[108:109], v245 offset:24584
  s_add_u32 m0, s51, 6144
  v_mfma_f32_16x16x32_bf16 v[48:51], a[80:83], a[16:19], v[48:51]
  v_mfma_f32_16x16x32_bf16 v[52:55], a[84:87], a[16:19], v[52:55]
  ds_read_b64_tr_b16 a[110:111], v245 offset:25608
  v_mfma_f32_16x16x32_bf16 v[120:123], a[88:91], a[16:19], v[120:123]
  buffer_load_dwordx4 v3, s[40:43], s57 offen lds
  s_add_u32 s57, s57, 8192
  v_mfma_f32_16x16x32_bf16 v[124:127], a[92:95], a[16:19], v[124:127]
  ds_read_b128 a[44:47], v254 offset:2048
  s_add_u32 m0, s51, 7168
  v_mfma_f32_16x16x32_bf16 v[56:59], a[80:83], a[20:23], v[56:59]
  v_mfma_f32_16x16x32_bf16 v[60:63], a[84:87], a[20:23], v[60:63]
  ds_read_b128 a[48:51], v254 offset:4096
  v_mfma_f32_16x16x32_bf16 v[128:131], a[88:91], a[20:23], v[128:131]
  buffer_load_dwordx4 v3, s[40:43], s57 offen lds
  s_add_u32 s57, s57, 73728
  v_mfma_f32_16x16x32_bf16 v[132:135], a[92:95], a[20:23], v[132:135]
  ds_read_b128 a[52:55], v254 offset:6144
  s_waitcnt lgkmcnt(11)
  v_mfma_f32_16x16x32_bf16 v[64:67], a[80:83], a[24:27], v[64:67]
  v_cndmask_b32 v232, v232, v243, s[58:59]
  v_cndmask_b32 v233, v233, v243, s[58:59]
  v_mfma_f32_16x16x32_bf16 v[68:71], a[84:87], a[24:27], v[68:71]
  ds_read_b128 a[56:59], v254 offset:8192
  v_cndmask_b32 v234, v234, v243, s[58:59]
  v_mfma_f32_16x16x32_bf16 v[136:139], a[88:91], a[24:27], v[136:139]
  v_cndmask_b32 v235, v235, v243, s[58:59]
  s_and_b32 s57, s57, 0xfffff
  v_mfma_f32_16x16x32_bf16 v[140:143], a[92:95], a[24:27], v[140:143]
  ds_read_b128 a[60:63], v254 offset:10240
  v_mfma_f32_16x16x32_bf16 v[72:75], a[80:83], a[28:31], v[72:75]
  v_mfma_f32_16x16x32_bf16 v[76:79], a[84:87], a[28:31], v[76:79]
  ds_read_b128 a[64:67], v254 offset:12288
  v_mfma_f32_16x16x32_bf16 v[144:147], a[88:91], a[28:31], v[144:147]
  v_mfma_f32_16x16x32_bf16 v[148:151], a[92:95], a[28:31], v[148:151]
  ds_read_b128 a[68:71], v254 offset:14336
  v_mfma_f32_16x16x32_bf16 v[80:83], a[80:83], a[32:35], v[80:83]
  v_mfma_f32_16x16x32_bf16 v[84:87], a[84:87], a[32:35], v[84:87]
  ds_read_b128 a[72:75], v254 offset:16384
  v_mfma_f32_16x16x32_bf16 v[152:155], a[88:91], a[32:35], v[152:155]
  v_mfma_f32_16x16x32_bf16 v[156:159], a[92:95], a[32:35], v[156:159]
  ds_read_b128 a[76:79], v254 offset:18432
  v_mfma_f32_16x16x32_bf16 v[160:163], a[88:91], a[36:39], v[160:163]
  v_mfma_f32_16x16x32_bf16 v[164:167], a[92:95], a[36:39], v[164:167]
  ds_read_b128 v[236:239], v254 offset:0
  v_mfma_f32_16x16x32_bf16 v[16:19], a[80:83], v[232:235], v[16:19]
  v_mfma_f32_16x16x32_bf16 v[20:23], a[84:87], v[232:235], v[20:23]
  v_mfma_f32_16x16x32_bf16 v[88:91], a[88:91], v[232:235], v[88:91]
  v_mfma_f32_16x16x32_bf16 v[92:95], a[92:95], v[232:235], v[92:95]
  s_waitcnt vmcnt(13) lgkmcnt(0)
  s_barrier
  v_mfma_f32_16x16x32_bf16 v[24:27], a[96:99], a[44:47], v[24:27]
  ds_read_b64_tr_b16 a[80:81], v246 offset:0
  v_mfma_f32_16x16x32_bf16 v[28:31], a[100:103], a[44:47], v[28:31]
  ds_read_b64_tr_b16 a[82:83], v246 offset:1024
  v_mfma_f32_16x16x32_bf16 v[96:99], a[104:107], a[44:47], v[96:99]
  v_mov_b32 v14, s4
  s_lshr_b32 s26, s2, 3
  s_lshl_b32 s26, s26, 7
  s_and_b32 s5, s2, 7
  s_lshl_b32 s5, s5, 2
  s_add_u32 s26, s26, s5
  s_add_u32 s26, s26, 90382336
  s_cmp_eq_u32 s3, 0
  s_cselect_b32 s26, s26, 2130706432
  s_mov_b64 exec, 1
  buffer_store_dword v14, off, s[20:23], s26 sc1
  s_mov_b64 exec, -1
  s_add_u32 m0, s50, 53248
  v_mfma_f32_16x16x32_bf16 v[100:103], a[108:111], a[44:47], v[100:103]
  ds_read_b64_tr_b16 a[84:85], v246 offset:8
  v_mfma_f32_16x16x32_bf16 v[32:35], a[96:99], a[48:51], v[32:35]
  v_mfma_f32_16x16x32_bf16 v[36:39], a[100:103], a[48:51], v[36:39]
  ds_read_b64_tr_b16 a[86:87], v246 offset:1032
  v_mfma_f32_16x16x32_bf16 v[104:107], a[104:107], a[48:51], v[104:107]
  buffer_load_dwordx4 v2, s[8:11], s52 offen lds
  s_add_u32 m0, s50, 54272
  v_mfma_f32_16x16x32_bf16 v[108:111], a[108:111], a[48:51], v[108:111]
  ds_read_b64_tr_b16 a[88:89], v246 offset:16384
  v_mfma_f32_16x16x32_bf16 v[40:43], a[96:99], a[52:55], v[40:43]
  v_mfma_f32_16x16x32_bf16 v[44:47], a[100:103], a[52:55], v[44:47]
  ds_read_b64_tr_b16 a[90:91], v246 offset:17408
  v_mfma_f32_16x16x32_bf16 v[112:115], a[104:107], a[52:55], v[112:115]
  buffer_load_dwordx4 v2, s[8:11], s53 offen lds
  s_add_u32 m0, s50, 55296
  v_mfma_f32_16x16x32_bf16 v[116:119], a[108:111], a[52:55], v[116:119]
  ds_read_b64_tr_b16 a[92:93], v246 offset:16392
  v_mfma_f32_16x16x32_bf16 v[48:51], a[96:99], a[56:59], v[48:51]
  v_mfma_f32_16x16x32_bf16 v[52:55], a[100:103], a[56:59], v[52:55]
  ds_read_b64_tr_b16 a[94:95], v246 offset:17416
  v_mfma_f32_16x16x32_bf16 v[120:123], a[104:107], a[56:59], v[120:123]
  buffer_load_dwordx4 v2, s[8:11], s54 offen lds
  s_add_u32 m0, s50, 56320
  v_mfma_f32_16x16x32_bf16 v[124:127], a[108:111], a[56:59], v[124:127]
  ds_read_b128 a[4:7], v242 offset:2048
  v_mfma_f32_16x16x32_bf16 v[56:59], a[96:99], a[60:63], v[56:59]
  v_mfma_f32_16x16x32_bf16 v[60:63], a[100:103], a[60:63], v[60:63]
  ds_read_b128 a[8:11], v242 offset:4096
  v_mfma_f32_16x16x32_bf16 v[128:131], a[104:107], a[60:63], v[128:131]
  buffer_load_dwordx4 v2, s[8:11], s55 offen lds
  s_add_u32 m0, s50, 57344
  v_mfma_f32_16x16x32_bf16 v[132:135], a[108:111], a[60:63], v[132:135]
  ds_read_b128 a[12:15], v242 offset:6144
  v_mfma_f32_16x16x32_bf16 v[64:67], a[96:99], a[64:67], v[64:67]
  v_cndmask_b32 v236, v236, v243, s[58:59]
  v_cndmask_b32 v237, v237, v243, s[58:59]
  v_mfma_f32_16x16x32_bf16 v[68:71], a[100:103], a[64:67], v[68:71]
  ds_read_b128 a[16:19], v242 offset:8192
  v_cndmask_b32 v238, v238, v243, s[58:59]
  v_mfma_f32_16x16x32_bf16 v[136:139], a[104:107], a[64:67], v[136:139]
  v_cndmask_b32 v239, v239, v243, s[58:59]
  buffer_load_dwordx4 v2, s[8:11], s56 offen lds
  v_mfma_f32_16x16x32_bf16 v[140:143], a[108:111], a[64:67], v[140:143]
  ds_read_b128 a[20:23], v242 offset:10240
  v_add_u32 v247, 128, v2
  v_mfma_f32_16x16x32_bf16 v[72:75], a[96:99], a[68:71], v[72:75]
  v_bfi_b32 v2, s29, v247, v2
  s_add_u32 m0, s51, 53248
  v_mfma_f32_16x16x32_bf16 v[76:79], a[100:103], a[68:71], v[76:79]
  ds_read_b128 a[24:27], v242 offset:12288
  v_mfma_f32_16x16x32_bf16 v[144:147], a[104:107], a[68:71], v[144:147]
  buffer_load_dwordx4 v3, s[40:43], s57 offen lds
  s_add_u32 s57, s57, 8192
  v_mfma_f32_16x16x32_bf16 v[148:151], a[108:111], a[68:71], v[148:151]
  ds_read_b128 a[28:31], v242 offset:14336
  s_add_u32 m0, s51, 54272
  v_mfma_f32_16x16x32_bf16 v[80:83], a[96:99], a[72:75], v[80:83]
  v_mfma_f32_16x16x32_bf16 v[84:87], a[100:103], a[72:75], v[84:87]
  ds_read_b128 a[32:35], v242 offset:16384
  v_mfma_f32_16x16x32_bf16 v[152:155], a[104:107], a[72:75], v[152:155]
  buffer_load_dwordx4 v3, s[40:43], s57 offen lds
  s_add_u32 s57, s57, 8192
  v_mfma_f32_16x16x32_bf16 v[156:159], a[108:111], a[72:75], v[156:159]
  ds_read_b128 a[36:39], v242 offset:18432
  s_add_u32 m0, s51, 55296
  v_mfma_f32_16x16x32_bf16 v[160:163], a[104:107], a[76:79], v[160:163]
  v_mfma_f32_16x16x32_bf16 v[164:167], a[108:111], a[76:79], v[164:167]
  ds_read_b128 v[232:235], v242 offset:0
  v_mfma_f32_16x16x32_bf16 v[16:19], a[96:99], v[236:239], v[16:19]
  buffer_load_dwordx4 v3, s[40:43], s57 offen lds
  s_add_u32 s57, s57, 8192
  v_mfma_f32_16x16x32_bf16 v[20:23], a[100:103], v[236:239], v[20:23]
  s_add_u32 m0, s51, 56320
  v_mfma_f32_16x16x32_bf16 v[88:91], a[104:107], v[236:239], v[88:91]
  v_mfma_f32_16x16x32_bf16 v[92:95], a[108:111], v[236:239], v[92:95]
  s_waitcnt lgkmcnt(5)
  v_mfma_f32_16x16x32_bf16 v[24:27], a[80:83], a[4:7], v[24:27]
  ds_read_b64_tr_b16 a[96:97], v246 offset:8192
  v_mfma_f32_16x16x32_bf16 v[28:31], a[84:87], a[4:7], v[28:31]
  ds_read_b64_tr_b16 a[98:99], v246 offset:9216
  v_mfma_f32_16x16x32_bf16 v[96:99], a[88:91], a[4:7], v[96:99]
  v_lshrrev_b32 v228, 1, v0
  v_lshlrev_b32 v228, 7, v228
  v_and_b32 v224, 1, v0
  v_lshl_add_u32 v228, v224, 4, v228
  s_mov_b32 s5, 90374144
  s_cmp_eq_u32 s3, 0
  s_cselect_b32 s5, s5, 2130706432
  buffer_load_dwordx4 v[224:227], v228, s[20:23], s5 offen sc1
  v_mfma_f32_16x16x32_bf16 v[100:103], a[92:95], a[4:7], v[100:103]
  ds_read_b64_tr_b16 a[100:101], v246 offset:8200
  v_mfma_f32_16x16x32_bf16 v[32:35], a[80:83], a[8:11], v[32:35]
  v_mfma_f32_16x16x32_bf16 v[36:39], a[84:87], a[8:11], v[36:39]
  ds_read_b64_tr_b16 a[102:103], v246 offset:9224
  v_mfma_f32_16x16x32_bf16 v[104:107], a[88:91], a[8:11], v[104:107]
  buffer_load_dwordx4 v3, s[40:43], s57 offen lds
  s_add_u32 s57, s57, 8192
  v_mfma_f32_16x16x32_bf16 v[108:111], a[92:95], a[8:11], v[108:111]
  ds_read_b64_tr_b16 a[104:105], v246 offset:24576
  s_add_u32 m0, s51, 57344
  v_mfma_f32_16x16x32_bf16 v[40:43], a[80:83], a[12:15], v[40:43]
  v_mfma_f32_16x16x32_bf16 v[44:47], a[84:87], a[12:15], v[44:47]
  ds_read_b64_tr_b16 a[106:107], v246 offset:25600
  v_mfma_f32_16x16x32_bf16 v[112:115], a[88:91], a[12:15], v[112:115]
  buffer_load_dwordx4 v3, s[40:43], s57 offen lds
  s_add_u32 s57, s57, 8192
  v_mfma_f32_16x16x32_bf16 v[116:119], a[92:95], a[12:15], v[116:119]
  ds_read_b64_tr_b16 a[108:109], v246 offset:24584
  s_add_u32 m0, s51, 58368
  v_mfma_f32_16x16x32_bf16 v[48:51], a[80:83], a[16:19], v[48:51]
  v_mfma_f32_16x16x32_bf16 v[52:55], a[84:87], a[16:19], v[52:55]
  ds_read_b64_tr_b16 a[110:111], v246 offset:25608
  v_mfma_f32_16x16x32_bf16 v[120:123], a[88:91], a[16:19], v[120:123]
  buffer_load_dwordx4 v3, s[40:43], s57 offen lds
  s_add_u32 s57, s57, 8192
  v_mfma_f32_16x16x32_bf16 v[124:127], a[92:95], a[16:19], v[124:127]
  ds_read_b128 a[44:47], v255 offset:2048
  s_add_u32 m0, s51, 59392
  v_mfma_f32_16x16x32_bf16 v[56:59], a[80:83], a[20:23], v[56:59]
  v_mfma_f32_16x16x32_bf16 v[60:63], a[84:87], a[20:23], v[60:63]
  ds_read_b128 a[48:51], v255 offset:4096
  v_mfma_f32_16x16x32_bf16 v[128:131], a[88:91], a[20:23], v[128:131]
  buffer_load_dwordx4 v3, s[40:43], s57 offen lds
  s_add_u32 s57, s57, 8192
  v_mfma_f32_16x16x32_bf16 v[132:135], a[92:95], a[20:23], v[132:135]
  ds_read_b128 a[52:55], v255 offset:6144
  s_waitcnt lgkmcnt(11)
  v_mfma_f32_16x16x32_bf16 v[64:67], a[80:83], a[24:27], v[64:67]
  v_cndmask_b32 v232, v232, v243, s[58:59]
  v_cndmask_b32 v233, v233, v243, s[58:59]
  v_mfma_f32_16x16x32_bf16 v[68:71], a[84:87], a[24:27], v[68:71]
  ds_read_b128 a[56:59], v255 offset:8192
  v_cndmask_b32 v234, v234, v243, s[58:59]
  v_mfma_f32_16x16x32_bf16 v[136:139], a[88:91], a[24:27], v[136:139]
  v_cndmask_b32 v235, v235, v243, s[58:59]
  s_add_u32 m0, s51, 60416
  v_mfma_f32_16x16x32_bf16 v[140:143], a[92:95], a[24:27], v[140:143]
  ds_read_b128 a[60:63], v255 offset:10240
  v_mfma_f32_16x16x32_bf16 v[72:75], a[80:83], a[28:31], v[72:75]
  buffer_load_dwordx4 v3, s[40:43], s57 offen lds
  s_add_u32 s57, s57, 73728
  v_mfma_f32_16x16x32_bf16 v[76:79], a[84:87], a[28:31], v[76:79]
  ds_read_b128 a[64:67], v255 offset:12288
  s_and_b32 s57, s57, 0xfffff
  v_mfma_f32_16x16x32_bf16 v[144:147], a[88:91], a[28:31], v[144:147]
  v_mfma_f32_16x16x32_bf16 v[148:151], a[92:95], a[28:31], v[148:151]
  ds_read_b128 a[68:71], v255 offset:14336
  v_mfma_f32_16x16x32_bf16 v[80:83], a[80:83], a[32:35], v[80:83]
  v_mfma_f32_16x16x32_bf16 v[84:87], a[84:87], a[32:35], v[84:87]
  ds_read_b128 a[72:75], v255 offset:16384
  v_mfma_f32_16x16x32_bf16 v[152:155], a[88:91], a[32:35], v[152:155]
  v_mfma_f32_16x16x32_bf16 v[156:159], a[92:95], a[32:35], v[156:159]
  ds_read_b128 a[76:79], v255 offset:18432
  v_mfma_f32_16x16x32_bf16 v[160:163], a[88:91], a[36:39], v[160:163]
  v_mfma_f32_16x16x32_bf16 v[164:167], a[92:95], a[36:39], v[164:167]
  ds_read_b128 v[236:239], v255 offset:0
  v_mfma_f32_16x16x32_bf16 v[16:19], a[80:83], v[232:235], v[16:19]
  v_mfma_f32_16x16x32_bf16 v[20:23], a[84:87], v[232:235], v[20:23]
  v_mfma_f32_16x16x32_bf16 v[88:91], a[88:91], v[232:235], v[88:91]
  v_mfma_f32_16x16x32_bf16 v[92:95], a[92:95], v[232:235], v[92:95]
  s_waitcnt vmcnt(15) lgkmcnt(0)
  s_barrier
  v_mfma_f32_16x16x32_bf16 v[24:27], a[96:99], a[44:47], v[24:27]
  ds_read_b64_tr_b16 a[80:81], v244 offset:0
  v_mfma_f32_16x16x32_bf16 v[28:31], a[100:103], a[44:47], v[28:31]
  ds_read_b64_tr_b16 a[82:83], v244 offset:1024
  v_mfma_f32_16x16x32_bf16 v[96:99], a[104:107], a[44:47], v[96:99]
  s_load_dwordx2 s[96:97], s[0:1], 16
  s_load_dwordx2 s[68:69], s[0:1], 56
  v_and_b32 v229, 31, v0
  v_lshlrev_b32 v229, 7, v229
  s_lshr_b32 s33, s2, 3
  s_lshl_b32 s33, s33, 2
  s_add_u32 s33, s33, s3
  s_lshl_b32 s33, s33, 12
  s_waitcnt lgkmcnt(0)
  s_and_b32 s97, s97, 0xffff
  s_mov_b32 s98, 524288
  s_mov_b32 s99, 0x20000
  buffer_load_dword v230, v229, s[96:99], s33 offen
  v_mfma_f32_16x16x32_bf16 v[100:103], a[108:111], a[44:47], v[100:103]
  ds_read_b64_tr_b16 a[84:85], v244 offset:8
  v_mfma_f32_16x16x32_bf16 v[32:35], a[96:99], a[48:51], v[32:35]
  v_mfma_f32_16x16x32_bf16 v[36:39], a[100:103], a[48:51], v[36:39]
  ds_read_b64_tr_b16 a[86:87], v244 offset:1032
  v_mfma_f32_16x16x32_bf16 v[104:107], a[104:107], a[48:51], v[104:107]
  v_mfma_f32_16x16x32_bf16 v[108:111], a[108:111], a[48:51], v[108:111]
  ds_read_b64_tr_b16 a[88:89], v244 offset:16384
  v_mfma_f32_16x16x32_bf16 v[40:43], a[96:99], a[52:55], v[40:43]
  v_mfma_f32_16x16x32_bf16 v[44:47], a[100:103], a[52:55], v[44:47]
  ds_read_b64_tr_b16 a[90:91], v244 offset:17408
  v_mfma_f32_16x16x32_bf16 v[112:115], a[104:107], a[52:55], v[112:115]
  v_mfma_f32_16x16x32_bf16 v[116:119], a[108:111], a[52:55], v[116:119]
  ds_read_b64_tr_b16 a[92:93], v244 offset:16392
  v_mfma_f32_16x16x32_bf16 v[48:51], a[96:99], a[56:59], v[48:51]
  v_mfma_f32_16x16x32_bf16 v[52:55], a[100:103], a[56:59], v[52:55]
  ds_read_b64_tr_b16 a[94:95], v244 offset:17416
  v_mfma_f32_16x16x32_bf16 v[120:123], a[104:107], a[56:59], v[120:123]
  v_mfma_f32_16x16x32_bf16 v[124:127], a[108:111], a[56:59], v[124:127]
  ds_read_b128 a[4:7], v240 offset:2048
  v_mfma_f32_16x16x32_bf16 v[56:59], a[96:99], a[60:63], v[56:59]
  v_mfma_f32_16x16x32_bf16 v[60:63], a[100:103], a[60:63], v[60:63]
  ds_read_b128 a[8:11], v240 offset:4096
  v_mfma_f32_16x16x32_bf16 v[128:131], a[104:107], a[60:63], v[128:131]
  v_mfma_f32_16x16x32_bf16 v[132:135], a[108:111], a[60:63], v[132:135]
  ds_read_b128 a[12:15], v240 offset:6144
  v_mfma_f32_16x16x32_bf16 v[64:67], a[96:99], a[64:67], v[64:67]
  v_cndmask_b32 v236, v236, v243, s[58:59]
  v_cndmask_b32 v237, v237, v243, s[58:59]
  v_mfma_f32_16x16x32_bf16 v[68:71], a[100:103], a[64:67], v[68:71]
  ds_read_b128 a[16:19], v240 offset:8192
  v_cndmask_b32 v238, v238, v243, s[58:59]
  v_mfma_f32_16x16x32_bf16 v[136:139], a[104:107], a[64:67], v[136:139]
  v_cndmask_b32 v239, v239, v243, s[58:59]
  v_mfma_f32_16x16x32_bf16 v[140:143], a[108:111], a[64:67], v[140:143]
  ds_read_b128 a[20:23], v240 offset:10240
  v_mfma_f32_16x16x32_bf16 v[72:75], a[96:99], a[68:71], v[72:75]
  v_mfma_f32_16x16x32_bf16 v[76:79], a[100:103], a[68:71], v[76:79]
  ds_read_b128 a[24:27], v240 offset:12288
  v_mfma_f32_16x16x32_bf16 v[144:147], a[104:107], a[68:71], v[144:147]
  v_mfma_f32_16x16x32_bf16 v[148:151], a[108:111], a[68:71], v[148:151]
  ds_read_b128 a[28:31], v240 offset:14336
  v_mfma_f32_16x16x32_bf16 v[80:83], a[96:99], a[72:75], v[80:83]
  v_mfma_f32_16x16x32_bf16 v[84:87], a[100:103], a[72:75], v[84:87]
  ds_read_b128 a[32:35], v240 offset:16384
  v_mfma_f32_16x16x32_bf16 v[152:155], a[104:107], a[72:75], v[152:155]
  v_mfma_f32_16x16x32_bf16 v[156:159], a[108:111], a[72:75], v[156:159]
  ds_read_b128 a[36:39], v240 offset:18432
  v_mfma_f32_16x16x32_bf16 v[160:163], a[104:107], a[76:79], v[160:163]
  v_mfma_f32_16x16x32_bf16 v[164:167], a[108:111], a[76:79], v[164:167]
  ds_read_b128 v[232:235], v240 offset:0
  v_mfma_f32_16x16x32_bf16 v[16:19], a[96:99], v[236:239], v[16:19]
  v_mfma_f32_16x16x32_bf16 v[20:23], a[100:103], v[236:239], v[20:23]
  v_mfma_f32_16x16x32_bf16 v[88:91], a[104:107], v[236:239], v[88:91]
  v_mfma_f32_16x16x32_bf16 v[92:95], a[108:111], v[236:239], v[92:95]
  s_waitcnt lgkmcnt(5)
  v_mfma_f32_16x16x32_bf16 v[24:27], a[80:83], a[4:7], v[24:27]
  ds_read_b64_tr_b16 a[96:97], v244 offset:8192
  v_mfma_f32_16x16x32_bf16 v[28:31], a[84:87], a[4:7], v[28:31]
  ds_read_b64_tr_b16 a[98:99], v244 offset:9216
  v_mfma_f32_16x16x32_bf16 v[96:99], a[88:91], a[4:7], v[96:99]
  s_waitcnt vmcnt(6)
  s_cmp_lg_u32 s3, 0
  s_cbranch_scc1 GOK_3
GLP_4:
  v_xor_b32 v224, s4, v224
  v_xor_b32 v225, s4, v225
  v_xor_b32 v226, s4, v226
  v_xor_b32 v227, s4, v227
  v_or3_b32 v224, v224, v225, v226
  v_or_b32 v224, v224, v227
  v_cmp_ne_u32 vcc, 0, v224
  s_cbranch_vccz GOK_3
  s_sleep 1
  buffer_load_dwordx4 v[224:227], v228, s[20:23], s5 offen sc1
  s_sub_u32 s25, s25, 1
  s_waitcnt vmcnt(0)
  s_cbranch_scc0 GLP_4
  s_endpgm
GOK_3:
  v_mfma_f32_16x16x32_bf16 v[100:103], a[92:95], a[4:7], v[100:103]
  ds_read_b64_tr_b16 a[100:101], v244 offset:8200
  v_mfma_f32_16x16x32_bf16 v[32:35], a[80:83], a[8:11], v[32:35]
  v_mfma_f32_16x16x32_bf16 v[36:39], a[84:87], a[8:11], v[36:39]
  ds_read_b64_tr_b16 a[102:103], v244 offset:9224
  v_mfma_f32_16x16x32_bf16 v[104:107], a[88:91], a[8:11], v[104:107]
  v_mfma_f32_16x16x32_bf16 v[108:111], a[92:95], a[8:11], v[108:111]
  ds_read_b64_tr_b16 a[104:105], v244 offset:24576
  v_mfma_f32_16x16x32_bf16 v[40:43], a[80:83], a[12:15], v[40:43]
  v_mfma_f32_16x16x32_bf16 v[44:47], a[84:87], a[12:15], v[44:47]
  ds_read_b64_tr_b16 a[106:107], v244 offset:25600
  v_mfma_f32_16x16x32_bf16 v[112:115], a[88:91], a[12:15], v[112:115]
  v_mfma_f32_16x16x32_bf16 v[116:119], a[92:95], a[12:15], v[116:119]
  ds_read_b64_tr_b16 a[108:109], v244 offset:24584
  v_mfma_f32_16x16x32_bf16 v[48:51], a[80:83], a[16:19], v[48:51]
  v_mfma_f32_16x16x32_bf16 v[52:55], a[84:87], a[16:19], v[52:55]
  ds_read_b64_tr_b16 a[110:111], v244 offset:25608
  v_mfma_f32_16x16x32_bf16 v[120:123], a[88:91], a[16:19], v[120:123]
  v_mfma_f32_16x16x32_bf16 v[124:127], a[92:95], a[16:19], v[124:127]
  ds_read_b128 a[44:47], v253 offset:2048
  v_mfma_f32_16x16x32_bf16 v[56:59], a[80:83], a[20:23], v[56:59]
  v_mfma_f32_16x16x32_bf16 v[60:63], a[84:87], a[20:23], v[60:63]
  ds_read_b128 a[48:51], v253 offset:4096
  v_mfma_f32_16x16x32_bf16 v[128:131], a[88:91], a[20:23], v[128:131]
  v_mfma_f32_16x16x32_bf16 v[132:135], a[92:95], a[20:23], v[132:135]
  ds_read_b128 a[52:55], v253 offset:6144
  s_waitcnt lgkmcnt(11)
  v_mfma_f32_16x16x32_bf16 v[64:67], a[80:83], a[24:27], v[64:67]
  v_cndmask_b32 v232, v232, v243, s[58:59]
  v_cndmask_b32 v233, v233, v243, s[58:59]
  v_mfma_f32_16x16x32_bf16 v[68:71], a[84:87], a[24:27], v[68:71]
  ds_read_b128 a[56:59], v253 offset:8192
  v_cndmask_b32 v234, v234, v243, s[58:59]
  v_mfma_f32_16x16x32_bf16 v[136:139], a[88:91], a[24:27], v[136:139]
  v_cndmask_b32 v235, v235, v243, s[58:59]
  v_mfma_f32_16x16x32_bf16 v[140:143], a[92:95], a[24:27], v[140:143]
  ds_read_b128 a[60:63], v253 offset:10240
  v_mfma_f32_16x16x32_bf16 v[72:75], a[80:83], a[28:31], v[72:75]
  v_mfma_f32_16x16x32_bf16 v[76:79], a[84:87], a[28:31], v[76:79]
  ds_read_b128 a[64:67], v253 offset:12288
  v_mfma_f32_16x16x32_bf16 v[144:147], a[88:91], a[28:31], v[144:147]
  v_mfma_f32_16x16x32_bf16 v[148:151], a[92:95], a[28:31], v[148:151]
  ds_read_b128 a[68:71], v253 offset:14336
  v_mfma_f32_16x16x32_bf16 v[80:83], a[80:83], a[32:35], v[80:83]
  v_mfma_f32_16x16x32_bf16 v[84:87], a[84:87], a[32:35], v[84:87]
  ds_read_b128 a[72:75], v253 offset:16384
  v_mfma_f32_16x16x32_bf16 v[152:155], a[88:91], a[32:35], v[152:155]
  v_mfma_f32_16x16x32_bf16 v[156:159], a[92:95], a[32:35], v[156:159]
  ds_read_b128 a[76:79], v253 offset:18432
  v_mfma_f32_16x16x32_bf16 v[160:163], a[88:91], a[36:39], v[160:163]
  v_mfma_f32_16x16x32_bf16 v[164:167], a[92:95], a[36:39], v[164:167]
  ds_read_b128 v[236:239], v253 offset:0
  v_mfma_f32_16x16x32_bf16 v[16:19], a[80:83], v[232:235], v[16:19]
  v_mfma_f32_16x16x32_bf16 v[20:23], a[84:87], v[232:235], v[20:23]
  v_mfma_f32_16x16x32_bf16 v[88:91], a[88:91], v[232:235], v[88:91]
  v_mfma_f32_16x16x32_bf16 v[92:95], a[92:95], v[232:235], v[92:95]
  s_waitcnt vmcnt(1) lgkmcnt(0)
  s_barrier
  v_mfma_f32_16x16x32_bf16 v[24:27], a[96:99], a[44:47], v[24:27]
  ds_read_b64_tr_b16 a[80:81], v245 offset:0
  v_mfma_f32_16x16x32_bf16 v[28:31], a[100:103], a[44:47], v[28:31]
  ds_read_b64_tr_b16 a[82:83], v245 offset:1024
  v_mfma_f32_16x16x32_bf16 v[96:99], a[104:107], a[44:47], v[96:99]
  buffer_load_dwordx2 v[168:169], v252, s[20:23], s38 offen offset:0 sc1
  v_mfma_f32_16x16x32_bf16 v[100:103], a[108:111], a[44:47], v[100:103]
  ds_read_b64_tr_b16 a[84:85], v245 offset:8
  v_mfma_f32_16x16x32_bf16 v[32:35], a[96:99], a[48:51], v[32:35]
  v_mfma_f32_16x16x32_bf16 v[36:39], a[100:103], a[48:51], v[36:39]
  ds_read_b64_tr_b16 a[86:87], v245 offset:1032
  v_mfma_f32_16x16x32_bf16 v[104:107], a[104:107], a[48:51], v[104:107]
  buffer_load_dwordx2 v[170:171], v252, s[20:23], s48 offen offset:128 sc1
  v_mfma_f32_16x16x32_bf16 v[108:111], a[108:111], a[48:51], v[108:111]
  ds_read_b64_tr_b16 a[88:89], v245 offset:16384
  v_mfma_f32_16x16x32_bf16 v[40:43], a[96:99], a[52:55], v[40:43]
  v_mfma_f32_16x16x32_bf16 v[44:47], a[100:103], a[52:55], v[44:47]
  ds_read_b64_tr_b16 a[90:91], v245 offset:17408
  v_mfma_f32_16x16x32_bf16 v[112:115], a[104:107], a[52:55], v[112:115]
  buffer_load_dwordx2 v[172:173], v252, s[20:23], s48 offen offset:256 sc1
  v_mfma_f32_16x16x32_bf16 v[116:119], a[108:111], a[52:55], v[116:119]
  ds_read_b64_tr_b16 a[92:93], v245 offset:16392
  v_mfma_f32_16x16x32_bf16 v[48:51], a[96:99], a[56:59], v[48:51]
  v_mfma_f32_16x16x32_bf16 v[52:55], a[100:103], a[56:59], v[52:55]
  ds_read_b64_tr_b16 a[94:95], v245 offset:17416
  v_mfma_f32_16x16x32_bf16 v[120:123], a[104:107], a[56:59], v[120:123]
  buffer_load_dwordx2 v[174:175], v252, s[20:23], s48 offen offset:384 sc1
  v_mfma_f32_16x16x32_bf16 v[124:127], a[108:111], a[56:59], v[124:127]
  ds_read_b128 a[4:7], v241 offset:2048
  v_mfma_f32_16x16x32_bf16 v[56:59], a[96:99], a[60:63], v[56:59]
  v_mfma_f32_16x16x32_bf16 v[60:63], a[100:103], a[60:63], v[60:63]
  ds_read_b128 a[8:11], v241 offset:4096
  v_mfma_f32_16x16x32_bf16 v[128:131], a[104:107], a[60:63], v[128:131]
  buffer_load_dwordx2 v[176:177], v252, s[20:23], s48 offen offset:512 sc1
  v_mfma_f32_16x16x32_bf16 v[132:135], a[108:111], a[60:63], v[132:135]
  ds_read_b128 a[12:15], v241 offset:6144
  v_mfma_f32_16x16x32_bf16 v[64:67], a[96:99], a[64:67], v[64:67]
  v_cndmask_b32 v236, v236, v243, s[58:59]
  v_cndmask_b32 v237, v237, v243, s[58:59]
  v_mfma_f32_16x16x32_bf16 v[68:71], a[100:103], a[64:67], v[68:71]
  ds_read_b128 a[16:19], v241 offset:8192
  v_cndmask_b32 v238, v238, v243, s[58:59]
  v_mfma_f32_16x16x32_bf16 v[136:139], a[104:107], a[64:67], v[136:139]
  v_cndmask_b32 v239, v239, v243, s[58:59]
  buffer_load_dwordx2 v[178:179], v252, s[20:23], s48 offen offset:640 sc1
  v_mfma_f32_16x16x32_bf16 v[140:143], a[108:111], a[64:67], v[140:143]
  ds_read_b128 a[20:23], v241 offset:10240
  v_mfma_f32_16x16x32_bf16 v[72:75], a[96:99], a[68:71], v[72:75]
  v_mfma_f32_16x16x32_bf16 v[76:79], a[100:103], a[68:71], v[76:79]
  ds_read_b128 a[24:27], v241 offset:12288
  v_mfma_f32_16x16x32_bf16 v[144:147], a[104:107], a[68:71], v[144:147]
  buffer_load_dwordx2 v[180:181], v252, s[20:23], s48 offen offset:768 sc1
  v_mfma_f32_16x16x32_bf16 v[148:151], a[108:111], a[68:71], v[148:151]
  ds_read_b128 a[28:31], v241 offset:14336
  v_mfma_f32_16x16x32_bf16 v[80:83], a[96:99], a[72:75], v[80:83]
  v_mfma_f32_16x16x32_bf16 v[84:87], a[100:103], a[72:75], v[84:87]
  ds_read_b128 a[32:35], v241 offset:16384
  v_mfma_f32_16x16x32_bf16 v[152:155], a[104:107], a[72:75], v[152:155]
  buffer_load_dwordx2 v[182:183], v252, s[20:23], s48 offen offset:896 sc1
  v_mfma_f32_16x16x32_bf16 v[156:159], a[108:111], a[72:75], v[156:159]
  ds_read_b128 a[36:39], v241 offset:18432
  v_mfma_f32_16x16x32_bf16 v[160:163], a[104:107], a[76:79], v[160:163]
  v_mfma_f32_16x16x32_bf16 v[164:167], a[108:111], a[76:79], v[164:167]
  ds_read_b128 v[232:235], v241 offset:0
  v_mfma_f32_16x16x32_bf16 v[16:19], a[96:99], v[236:239], v[16:19]
  buffer_load_dwordx2 v[184:185], v252, s[20:23], s48 offen offset:1024 sc1
  v_mfma_f32_16x16x32_bf16 v[20:23], a[100:103], v[236:239], v[20:23]
  v_mfma_f32_16x16x32_bf16 v[88:91], a[104:107], v[236:239], v[88:91]
  v_mfma_f32_16x16x32_bf16 v[92:95], a[108:111], v[236:239], v[92:95]
  s_waitcnt lgkmcnt(5)
  v_mfma_f32_16x16x32_bf16 v[24:27], a[80:83], a[4:7], v[24:27]
  ds_read_b64_tr_b16 a[96:97], v245 offset:8192
  v_mfma_f32_16x16x32_bf16 v[28:31], a[84:87], a[4:7], v[28:31]
  ds_read_b64_tr_b16 a[98:99], v245 offset:9216
  v_mfma_f32_16x16x32_bf16 v[96:99], a[88:91], a[4:7], v[96:99]
  buffer_load_dwordx2 v[186:187], v252, s[20:23], s39 offen offset:1152 sc1
  v_mfma_f32_16x16x32_bf16 v[100:103], a[92:95], a[4:7], v[100:103]
  ds_read_b64_tr_b16 a[100:101], v245 offset:8200
  v_mfma_f32_16x16x32_bf16 v[32:35], a[80:83], a[8:11], v[32:35]
  v_mfma_f32_16x16x32_bf16 v[36:39], a[84:87], a[8:11], v[36:39]
  ds_read_b64_tr_b16 a[102:103], v245 offset:9224
  v_mfma_f32_16x16x32_bf16 v[104:107], a[88:91], a[8:11], v[104:107]
  buffer_load_dwordx4 a[112:115], v249, s[20:23], s66 offen offset:0 sc1
  v_mfma_f32_16x16x32_bf16 v[108:111], a[92:95], a[8:11], v[108:111]
  ds_read_b64_tr_b16 a[104:105], v245 offset:24576
  v_mfma_f32_16x16x32_bf16 v[40:43], a[80:83], a[12:15], v[40:43]
  v_mfma_f32_16x16x32_bf16 v[44:47], a[84:87], a[12:15], v[44:47]
  ds_read_b64_tr_b16 a[106:107], v245 offset:25600
  v_mfma_f32_16x16x32_bf16 v[112:115], a[88:91], a[12:15], v[112:115]
  buffer_load_dwordx4 a[116:119], v249, s[20:23], s67 offen offset:0 sc1
  v_mfma_f32_16x16x32_bf16 v[116:119], a[92:95], a[12:15], v[116:119]
  ds_read_b64_tr_b16 a[108:109], v245 offset:24584
  v_mfma_f32_16x16x32_bf16 v[48:51], a[80:83], a[16:19], v[48:51]
  v_mfma_f32_16x16x32_bf16 v[52:55], a[84:87], a[16:19], v[52:55]
  ds_read_b64_tr_b16 a[110:111], v245 offset:25608
  v_mfma_f32_16x16x32_bf16 v[120:123], a[88:91], a[16:19], v[120:123]
  buffer_load_dwordx4 a[120:123], v249, s[20:23], s66 offen offset:1024 sc1
  v_mfma_f32_16x16x32_bf16 v[124:127], a[92:95], a[16:19], v[124:127]
  ds_read_b128 a[44:47], v254 offset:2048
  v_mfma_f32_16x16x32_bf16 v[56:59], a[80:83], a[20:23], v[56:59]
  v_mfma_f32_16x16x32_bf16 v[60:63], a[84:87], a[20:23], v[60:63]
  ds_read_b128 a[48:51], v254 offset:4096
  v_mfma_f32_16x16x32_bf16 v[128:131], a[88:91], a[20:23], v[128:131]
  buffer_load_dwordx4 a[124:127], v249, s[20:23], s67 offen offset:1024 sc1
  v_mfma_f32_16x16x32_bf16 v[132:135], a[92:95], a[20:23], v[132:135]
  ds_read_b128 a[52:55], v254 offset:6144
  s_waitcnt lgkmcnt(11)
  v_mfma_f32_16x16x32_bf16 v[64:67], a[80:83], a[24:27], v[64:67]
  v_cndmask_b32 v232, v232, v243, s[58:59]
  v_cndmask_b32 v233, v233, v243, s[58:59]
  v_mfma_f32_16x16x32_bf16 v[68:71], a[84:87], a[24:27], v[68:71]
  ds_read_b128 a[56:59], v254 offset:8192
  v_cndmask_b32 v234, v234, v243, s[58:59]
  v_mfma_f32_16x16x32_bf16 v[136:139], a[88:91], a[24:27], v[136:139]
  v_cndmask_b32 v235, v235, v243, s[58:59]
  buffer_load_dwordx4 a[128:131], v249, s[20:23], s66 offen offset:2048 sc1
  v_mfma_f32_16x16x32_bf16 v[140:143], a[92:95], a[24:27], v[140:143]
  ds_read_b128 a[60:63], v254 offset:10240
  v_mfma_f32_16x16x32_bf16 v[72:75], a[80:83], a[28:31], v[72:75]
  v_mfma_f32_16x16x32_bf16 v[76:79], a[84:87], a[28:31], v[76:79]
  ds_read_b128 a[64:67], v254 offset:12288
  v_mfma_f32_16x16x32_bf16 v[144:147], a[88:91], a[28:31], v[144:147]
  buffer_load_dwordx4 a[132:135], v249, s[20:23], s67 offen offset:2048 sc1
  v_mfma_f32_16x16x32_bf16 v[148:151], a[92:95], a[28:31], v[148:151]
  ds_read_b128 a[68:71], v254 offset:14336
  v_mfma_f32_16x16x32_bf16 v[80:83], a[80:83], a[32:35], v[80:83]
  v_mfma_f32_16x16x32_bf16 v[84:87], a[84:87], a[32:35], v[84:87]
  ds_read_b128 a[72:75], v254 offset:16384
  v_mfma_f32_16x16x32_bf16 v[152:155], a[88:91], a[32:35], v[152:155]
  buffer_load_dwordx4 a[136:139], v249, s[20:23], s66 offen offset:3072 sc1
  v_mfma_f32_16x16x32_bf16 v[156:159], a[92:95], a[32:35], v[156:159]
  ds_read_b128 a[76:79], v254 offset:18432
  v_mfma_f32_16x16x32_bf16 v[160:163], a[88:91], a[36:39], v[160:163]
  v_mfma_f32_16x16x32_bf16 v[164:167], a[92:95], a[36:39], v[164:167]
  ds_read_b128 v[236:239], v254 offset:0
  v_mfma_f32_16x16x32_bf16 v[16:19], a[80:83], v[232:235], v[16:19]
  buffer_load_dwordx4 a[140:143], v249, s[20:23], s67 offen offset:3072 sc1
  v_add_u32 v249, 4096, v249
  v_mfma_f32_16x16x32_bf16 v[20:23], a[84:87], v[232:235], v[20:23]
  v_mfma_f32_16x16x32_bf16 v[88:91], a[88:91], v[232:235], v[88:91]
  v_mfma_f32_16x16x32_bf16 v[92:95], a[92:95], v[232:235], v[92:95]
  s_waitcnt lgkmcnt(5)
  v_mfma_f32_16x16x32_bf16 v[24:27], a[96:99], a[44:47], v[24:27]
  v_lshrrev_b32 v228, 1, v0
  v_lshlrev_b32 v228, 7, v228
  v_and_b32 v224, 1, v0
  v_lshl_add_u32 v228, v224, 4, v228
  s_mov_b32 s5, 90382336
  s_cmp_eq_u32 s3, 0
  s_cselect_b32 s5, s5, 2130706432
  buffer_load_dwordx4 v[224:227], v228, s[20:23], s5 offen sc1
  v_mfma_f32_16x16x32_bf16 v[28:31], a[100:103], a[44:47], v[28:31]
  v_mfma_f32_16x16x32_bf16 v[96:99], a[104:107], a[44:47], v[96:99]
  v_mfma_f32_16x16x32_bf16 v[100:103], a[108:111], a[44:47], v[100:103]
  v_mfma_f32_16x16x32_bf16 v[32:35], a[96:99], a[48:51], v[32:35]
  buffer_load_dwordx4 a[144:147], v249, s[20:23], s66 offen offset:0 sc1
  v_mfma_f32_16x16x32_bf16 v[36:39], a[100:103], a[48:51], v[36:39]
  v_mfma_f32_16x16x32_bf16 v[104:107], a[104:107], a[48:51], v[104:107]
  v_mfma_f32_16x16x32_bf16 v[108:111], a[108:111], a[48:51], v[108:111]
  v_mfma_f32_16x16x32_bf16 v[40:43], a[96:99], a[52:55], v[40:43]
  buffer_load_dwordx4 a[148:151], v249, s[20:23], s67 offen offset:0 sc1
  v_mfma_f32_16x16x32_bf16 v[44:47], a[100:103], a[52:55], v[44:47]
  v_mfma_f32_16x16x32_bf16 v[112:115], a[104:107], a[52:55], v[112:115]
  v_mfma_f32_16x16x32_bf16 v[116:119], a[108:111], a[52:55], v[116:119]
  v_mfma_f32_16x16x32_bf16 v[48:51], a[96:99], a[56:59], v[48:51]
  buffer_load_dwordx4 a[152:155], v249, s[20:23], s66 offen offset:1024 sc1
  v_mfma_f32_16x16x32_bf16 v[52:55], a[100:103], a[56:59], v[52:55]
  v_mfma_f32_16x16x32_bf16 v[120:123], a[104:107], a[56:59], v[120:123]
  v_mfma_f32_16x16x32_bf16 v[124:127], a[108:111], a[56:59], v[124:127]
  v_mfma_f32_16x16x32_bf16 v[56:59], a[96:99], a[60:63], v[56:59]
  buffer_load_dwordx4 a[156:159], v249, s[20:23], s67 offen offset:1024 sc1
  v_mfma_f32_16x16x32_bf16 v[60:63], a[100:103], a[60:63], v[60:63]
  v_mfma_f32_16x16x32_bf16 v[128:131], a[104:107], a[60:63], v[128:131]
  v_mfma_f32_16x16x32_bf16 v[132:135], a[108:111], a[60:63], v[132:135]
  s_waitcnt lgkmcnt(0)
  v_mfma_f32_16x16x32_bf16 v[64:67], a[96:99], a[64:67], v[64:67]
  v_cndmask_b32 v236, v236, v243, s[58:59]
  v_cndmask_b32 v237, v237, v243, s[58:59]
  v_mfma_f32_16x16x32_bf16 v[68:71], a[100:103], a[64:67], v[68:71]
  v_cndmask_b32 v238, v238, v243, s[58:59]
  v_cndmask_b32 v239, v239, v243, s[58:59]
  v_mfma_f32_16x16x32_bf16 v[136:139], a[104:107], a[64:67], v[136:139]
  buffer_load_dwordx4 a[160:163], v249, s[20:23], s66 offen offset:2048 sc1
  v_mfma_f32_16x16x32_bf16 v[140:143], a[108:111], a[64:67], v[140:143]
  v_mfma_f32_16x16x32_bf16 v[72:75], a[96:99], a[68:71], v[72:75]
  v_mfma_f32_16x16x32_bf16 v[76:79], a[100:103], a[68:71], v[76:79]
  v_mfma_f32_16x16x32_bf16 v[144:147], a[104:107], a[68:71], v[144:147]
  buffer_load_dwordx4 a[164:167], v249, s[20:23], s67 offen offset:2048 sc1
  v_mfma_f32_16x16x32_bf16 v[148:151], a[108:111], a[68:71], v[148:151]
  v_mfma_f32_16x16x32_bf16 v[80:83], a[96:99], a[72:75], v[80:83]
  v_mfma_f32_16x16x32_bf16 v[84:87], a[100:103], a[72:75], v[84:87]
  v_mfma_f32_16x16x32_bf16 v[152:155], a[104:107], a[72:75], v[152:155]
  buffer_load_dwordx4 a[168:171], v249, s[20:23], s66 offen offset:3072 sc1
  v_mfma_f32_16x16x32_bf16 v[156:159], a[108:111], a[72:75], v[156:159]
  v_mfma_f32_16x16x32_bf16 v[160:163], a[104:107], a[76:79], v[160:163]
  v_mfma_f32_16x16x32_bf16 v[164:167], a[108:111], a[76:79], v[164:167]
  v_mfma_f32_16x16x32_bf16 v[16:19], a[96:99], v[236:239], v[16:19]
  buffer_load_dwordx4 a[172:175], v249, s[20:23], s67 offen offset:3072 sc1
  v_add_u32 v249, 4096, v249
  v_mfma_f32_16x16x32_bf16 v[20:23], a[100:103], v[236:239], v[20:23]
  v_mfma_f32_16x16x32_bf16 v[88:91], a[104:107], v[236:239], v[88:91]
  v_mfma_f32_16x16x32_bf16 v[92:95], a[108:111], v[236:239], v[92:95]
PF_U_END:
  s_waitcnt vmcnt(8)
  s_cmp_lg_u32 s3, 0
  s_cbranch_scc1 GOK_5
GLP_6:
  v_xor_b32 v224, s4, v224
  v_xor_b32 v225, s4, v225
  v_xor_b32 v226, s4, v226
  v_xor_b32 v227, s4, v227
  v_or3_b32 v224, v224, v225, v226
  v_or_b32 v224, v224, v227
  v_cmp_ne_u32 vcc, 0, v224
  s_cbranch_vccz GOK_5
  s_sleep 1
  buffer_load_dwordx4 v[224:227], v228, s[20:23], s5 offen sc1
  s_sub_u32 s25, s25, 1
  s_waitcnt vmcnt(0)
  s_cbranch_scc0 GLP_6
  s_endpgm
GOK_5:
  s_barrier
  s_load_dwordx2 s[44:45], s[0:1], 8
  s_load_dwordx2 s[40:41], s[0:1], 16
  s_load_dwordx2 s[52:53], s[0:1], 56
  s_load_dwordx2 s[56:57], s[0:1], 40
  v_lshrrev_b32 v236, 4, v0
  v_and_b32 v237, 15, v0
  v_mul_u32_u24 v238, 3072, v236
  v_add_u32 v232, 0, v236
  v_xor_b32 v232, v232, v237
  v_lshl_add_u32 v232, v232, 4, v238
  v_add_u32 v233, 4, v236
  v_xor_b32 v233, v233, v237
  v_lshl_add_u32 v233, v233, 4, v238
  v_add_u32 v234, 8, v236
  v_xor_b32 v234, v234, v237
  v_lshl_add_u32 v234, v234, 4, v238
  v_add_u32 v235, 12, v236
  v_xor_b32 v235, v235, v237
  v_lshl_add_u32 v235, v235, 4, v238
  v_lshrrev_b32 v236, 2, v0
  v_and_b32 v237, 3, v0
  v_lshlrev_b32 v236, 10, v236
  v_lshl_add_u32 v236, v237, 4, v236
  v_lshrrev_b32 v237, 3, v0
  v_and_b32 v238, 7, v0
  v_lshlrev_b32 v237, 10, v237
  v_lshl_add_u32 v237, v238, 4, v237
  s_and_b32 s34, s2, 15
  s_lshr_b32 s38, s34, 3
  s_lshl_b32 s38, s38, 8
  s_and_b32 s39, s34, 7
  s_lshl_b32 s39, s39, 4
  s_add_u32 s38, s38, s39
  s_mul_i32 s38, s38, 3072
  s_lshl_b32 s37, s3, 8
  s_add_u32 s38, s38, s37
  s_add_u32 s38, s38, 2048
  s_lshr_b32 s35, s2, 4
  s_lshl_b32 s39, s3, 17
  s_lshl_b32 s35, s35, 6
  s_add_u32 s39, s39, s35
  s_lshr_b32 s34, s2, 3
  s_lshl_b32 s34, s34, 5
  s_lshl_b32 s35, s3, 3
  s_add_u32 s34, s34, s35
  s_lshl_b32 s34, s34, 10
  s_and_b32 s35, s2, 7
  s_lshl_b32 s35, s35, 7
  s_add_u32 s37, s34, s35
  s_lshl_b32 s36, s3, 14
  s_lshl_b32 s35, s3, 10
  s_waitcnt lgkmcnt(0)
  s_and_b32 s45, s45, 0xffff
  s_mov_b32 s46, 1572864
  s_mov_b32 s47, 0x20000
  s_and_b32 s41, s41, 0xffff
  s_mov_b32 s42, 524288
  s_mov_b32 s43, 0x20000
  s_and_b32 s53, s53, 0xffff
  s_mov_b32 s54, 1048576
  s_mov_b32 s55, 0x20000
  s_and_b32 s57, s57, 0xffff
  s_mov_b32 s58, 524288
  s_mov_b32 s59, 0x20000
  s_mul_i32 s68, s31, 10240
  s_add_u32 s68, s68, 87818240
  s_add_u32 s69, s68, 4096
  s_add_u32 s70, s68, 8192
  v_mov_b32_dpp v16, v16 row_newbcast:0 row_mask:0xf bank_mask:0xf
  v_mov_b32_dpp v188, v88 row_newbcast:0 row_mask:0xf bank_mask:0xf
  v_mov_b32_dpp v17, v17 row_newbcast:0 row_mask:0xf bank_mask:0xf
  v_mov_b32_dpp v189, v89 row_newbcast:0 row_mask:0xf bank_mask:0xf
  v_mov_b32_dpp v18, v18 row_newbcast:0 row_mask:0xf bank_mask:0xf
  v_mov_b32_dpp v190, v90 row_newbcast:0 row_mask:0xf bank_mask:0xf
  v_mov_b32_dpp v19, v19 row_newbcast:0 row_mask:0xf bank_mask:0xf
  v_mov_b32_dpp v191, v91 row_newbcast:0 row_mask:0xf bank_mask:0xf
  v_mov_b32_dpp v20, v20 row_newbcast:0 row_mask:0xf bank_mask:0xf
  v_mov_b32_dpp v192, v92 row_newbcast:0 row_mask:0xf bank_mask:0xf
  v_mov_b32_dpp v21, v21 row_newbcast:0 row_mask:0xf bank_mask:0xf
  v_mov_b32_dpp v193, v93 row_newbcast:0 row_mask:0xf bank_mask:0xf
  v_mov_b32_dpp v22, v22 row_newbcast:0 row_mask:0xf bank_mask:0xf
  v_mov_b32_dpp v194, v94 row_newbcast:0 row_mask:0xf bank_mask:0xf
  v_mov_b32_dpp v23, v23 row_newbcast:0 row_mask:0xf bank_mask:0xf
  v_mov_b32_dpp v195, v95 row_newbcast:0 row_mask:0xf bank_mask:0xf
  v_mov_b32 v222, 0
  v_mov_b32 v223, 0
  v_mov_b32 v226, 0
  v_mov_b32 v227, 0
  v_pk_fma_f32 v[88:89], v[188:189], v[168:169], v[88:89] op_sel:[0,1,0] op_sel_hi:[1,1,1]
  v_pk_fma_f32 v[90:91], v[190:191], v[168:169], v[90:91] op_sel:[0,1,0] op_sel_hi:[1,1,1]
  v_pk_fma_f32 v[92:93], v[192:193], v[168:169], v[92:93] op_sel:[0,1,0] op_sel_hi:[1,1,1]
  v_pk_fma_f32 v[94:95], v[194:195], v[168:169], v[94:95] op_sel:[0,1,0] op_sel_hi:[1,1,1]
  v_pk_mul_f32 v[88:89], v[88:89], v[168:169] op_sel_hi:[1,0]
  v_pk_mul_f32 v[90:91], v[90:91], v[168:169] op_sel_hi:[1,0]
  v_pk_mul_f32 v[92:93], v[92:93], v[168:169] op_sel_hi:[1,0]
  v_pk_mul_f32 v[94:95], v[94:95], v[168:169] op_sel_hi:[1,0]
  s_add_u32 m0, s60, 106496
  s_nop 0
  buffer_load_dwordx4 v248, s[20:23], s62 offen sc1 lds
  v_pk_mul_f32 v[196:197], v[88:89], v[88:89]
  v_pk_mul_f32 v[198:199], v[90:91], v[90:91]
  v_pk_mul_f32 v[200:201], v[92:93], v[92:93]
  v_pk_mul_f32 v[202:203], v[94:95], v[94:95]
  v_pk_fma_f32 v[196:197], v[196:197], v[8:9], v[6:7]
  v_pk_fma_f32 v[198:199], v[198:199], v[8:9], v[6:7]
  v_pk_fma_f32 v[200:201], v[200:201], v[8:9], v[6:7]
  v_pk_fma_f32 v[202:203], v[202:203], v[8:9], v[6:7]
  v_pk_mul_f32 v[196:197], v[196:197], v[88:89]
  v_pk_mul_f32 v[198:199], v[198:199], v[90:91]
  v_pk_mul_f32 v[200:201], v[200:201], v[92:93]
  v_pk_mul_f32 v[202:203], v[202:203], v[94:95]
  s_add_u32 m0, s60, 107520
  s_nop 0
  buffer_load_dwordx4 v248, s[20:23], s63 offen sc1 lds
  v_exp_f32 v196, v196
  v_exp_f32 v197, v197
  v_exp_f32 v198, v198
  v_exp_f32 v199, v199
  v_exp_f32 v200, v200
  v_exp_f32 v201, v201
  v_exp_f32 v202, v202
  v_exp_f32 v203, v203
  s_add_u32 m0, s60, 108544
  s_nop 0
  buffer_load_dwordx4 v248, s[20:23], s64 offen sc1 lds
  v_pk_add_f32 v[196:197], v[196:197], v[10:11]
  v_pk_add_f32 v[198:199], v[198:199], v[10:11]
  v_pk_add_f32 v[200:201], v[200:201], v[10:11]
  v_pk_add_f32 v[202:203], v[202:203], v[10:11]
  v_rcp_f32 v196, v196
  v_rcp_f32 v197, v197
  v_rcp_f32 v198, v198
  v_rcp_f32 v199, v199
  v_rcp_f32 v200, v200
  v_rcp_f32 v201, v201
  v_rcp_f32 v202, v202
  v_rcp_f32 v203, v203
  s_add_u32 m0, s60, 109568
  s_nop 0
  buffer_load_dwordx4 v248, s[20:23], s65 offen sc1 lds
  v_pk_mul_f32 v[88:89], v[88:89], v[196:197]
  v_pk_mul_f32 v[90:91], v[90:91], v[198:199]
  v_pk_mul_f32 v[92:93], v[92:93], v[200:201]
  v_pk_mul_f32 v[94:95], v[94:95], v[202:203]
  v_pk_add_f32 v[12:13], v[88:89], v[90:91]
  v_pk_mul_f32 v[14:15], v[88:89], v[88:89]
  v_pk_add_f32 v[12:13], v[12:13], v[92:93]
  v_pk_fma_f32 v[14:15], v[90:91], v[90:91], v[14:15]
  v_pk_add_f32 v[12:13], v[12:13], v[94:95]
  v_pk_fma_f32 v[14:15], v[92:93], v[92:93], v[14:15]
  v_add_f32 v204, v12, v13
  v_pk_fma_f32 v[14:15], v[94:95], v[94:95], v[14:15]
  v_add_f32 v208, v14, v15
  v_pk_fma_f32 v[96:97], v[188:189], v[170:171], v[96:97] op_sel:[0,1,0] op_sel_hi:[1,1,1]
  v_pk_fma_f32 v[98:99], v[190:191], v[170:171], v[98:99] op_sel:[0,1,0] op_sel_hi:[1,1,1]
  v_pk_fma_f32 v[100:101], v[192:193], v[170:171], v[100:101] op_sel:[0,1,0] op_sel_hi:[1,1,1]
  v_pk_fma_f32 v[102:103], v[194:195], v[170:171], v[102:103] op_sel:[0,1,0] op_sel_hi:[1,1,1]
  v_pk_mul_f32 v[96:97], v[96:97], v[170:171] op_sel_hi:[1,0]
  v_pk_mul_f32 v[98:99], v[98:99], v[170:171] op_sel_hi:[1,0]
  v_pk_mul_f32 v[100:101], v[100:101], v[170:171] op_sel_hi:[1,0]
  v_pk_mul_f32 v[102:103], v[102:103], v[170:171] op_sel_hi:[1,0]
  v_add_u32 v248, 2048, v248
  s_add_u32 m0, s60, 122880
  s_nop 0
  buffer_load_dwordx4 v248, s[20:23], s62 offen sc1 lds
  v_pk_mul_f32 v[196:197], v[96:97], v[96:97]
  v_pk_mul_f32 v[198:199], v[98:99], v[98:99]
  v_pk_mul_f32 v[200:201], v[100:101], v[100:101]
  v_pk_mul_f32 v[202:203], v[102:103], v[102:103]
  v_pk_fma_f32 v[196:197], v[196:197], v[8:9], v[6:7]
  v_pk_fma_f32 v[198:199], v[198:199], v[8:9], v[6:7]
  v_pk_fma_f32 v[200:201], v[200:201], v[8:9], v[6:7]
  v_pk_fma_f32 v[202:203], v[202:203], v[8:9], v[6:7]
  v_pk_mul_f32 v[196:197], v[196:197], v[96:97]
  v_pk_mul_f32 v[198:199], v[198:199], v[98:99]
  v_pk_mul_f32 v[200:201], v[200:201], v[100:101]
  v_pk_mul_f32 v[202:203], v[202:203], v[102:103]
  s_add_u32 m0, s60, 123904
  s_nop 0
  buffer_load_dwordx4 v248, s[20:23], s63 offen sc1 lds
  v_exp_f32 v196, v196
  v_exp_f32 v197, v197
  v_exp_f32 v198, v198
  v_exp_f32 v199, v199
  v_exp_f32 v200, v200
  v_exp_f32 v201, v201
  v_exp_f32 v202, v202
  v_exp_f32 v203, v203
  s_add_u32 m0, s60, 124928
  s_nop 0
  buffer_load_dwordx4 v248, s[20:23], s64 offen sc1 lds
  v_pk_add_f32 v[196:197], v[196:197], v[10:11]
  v_pk_add_f32 v[198:199], v[198:199], v[10:11]
  v_pk_add_f32 v[200:201], v[200:201], v[10:11]
  v_pk_add_f32 v[202:203], v[202:203], v[10:11]
  v_rcp_f32 v196, v196
  v_rcp_f32 v197, v197
  v_rcp_f32 v198, v198
  v_rcp_f32 v199, v199
  v_rcp_f32 v200, v200
  v_rcp_f32 v201, v201
  v_rcp_f32 v202, v202
  v_rcp_f32 v203, v203
  s_add_u32 m0, s60, 125952
  s_nop 0
  buffer_load_dwordx4 v248, s[20:23], s65 offen sc1 lds
  v_pk_mul_f32 v[96:97], v[96:97], v[196:197]
  v_pk_mul_f32 v[98:99], v[98:99], v[198:199]
  v_pk_mul_f32 v[100:101], v[100:101], v[200:201]
  v_pk_mul_f32 v[102:103], v[102:103], v[202:203]
  v_pk_add_f32 v[12:13], v[96:97], v[98:99]
  v_pk_mul_f32 v[14:15], v[96:97], v[96:97]
  v_pk_add_f32 v[12:13], v[12:13], v[100:101]
  v_pk_fma_f32 v[14:15], v[98:99], v[98:99], v[14:15]
  v_pk_add_f32 v[12:13], v[12:13], v[102:103]
  v_pk_fma_f32 v[14:15], v[100:101], v[100:101], v[14:15]
  v_add_f32 v205, v12, v13
  v_pk_fma_f32 v[14:15], v[102:103], v[102:103], v[14:15]
  v_add_f32 v209, v14, v15
  v_pk_fma_f32 v[104:105], v[188:189], v[172:173], v[104:105] op_sel:[0,1,0] op_sel_hi:[1,1,1]
  v_pk_fma_f32 v[106:107], v[190:191], v[172:173], v[106:107] op_sel:[0,1,0] op_sel_hi:[1,1,1]
  v_pk_fma_f32 v[108:109], v[192:193], v[172:173], v[108:109] op_sel:[0,1,0] op_sel_hi:[1,1,1]
  v_pk_fma_f32 v[110:111], v[194:195], v[172:173], v[110:111] op_sel:[0,1,0] op_sel_hi:[1,1,1]
  v_pk_mul_f32 v[104:105], v[104:105], v[172:173] op_sel_hi:[1,0]
  v_pk_mul_f32 v[106:107], v[106:107], v[172:173] op_sel_hi:[1,0]
  v_pk_mul_f32 v[108:109], v[108:109], v[172:173] op_sel_hi:[1,0]
  v_pk_mul_f32 v[110:111], v[110:111], v[172:173] op_sel_hi:[1,0]
  v_add_u32 v248, 2048, v248
  buffer_load_dwordx4 a[176:179], v249, s[20:23], s66 offen offset:0 sc1
  v_pk_mul_f32 v[196:197], v[104:105], v[104:105]
  v_pk_mul_f32 v[198:199], v[106:107], v[106:107]
  v_pk_mul_f32 v[200:201], v[108:109], v[108:109]
  v_pk_mul_f32 v[202:203], v[110:111], v[110:111]
  v_pk_fma_f32 v[196:197], v[196:197], v[8:9], v[6:7]
  v_pk_fma_f32 v[198:199], v[198:199], v[8:9], v[6:7]
  v_pk_fma_f32 v[200:201], v[200:201], v[8:9], v[6:7]
  v_pk_fma_f32 v[202:203], v[202:203], v[8:9], v[6:7]
  v_pk_mul_f32 v[196:197], v[196:197], v[104:105]
  v_pk_mul_f32 v[198:199], v[198:199], v[106:107]
  v_pk_mul_f32 v[200:201], v[200:201], v[108:109]
  v_pk_mul_f32 v[202:203], v[202:203], v[110:111]
  buffer_load_dwordx4 a[180:183], v249, s[20:23], s67 offen offset:0 sc1
  v_exp_f32 v196, v196
  v_exp_f32 v197, v197
  v_exp_f32 v198, v198
  v_exp_f32 v199, v199
  v_exp_f32 v200, v200
  v_exp_f32 v201, v201
  v_exp_f32 v202, v202
  v_exp_f32 v203, v203
  buffer_load_dwordx4 a[184:187], v249, s[20:23], s66 offen offset:1024 sc1
  v_pk_add_f32 v[196:197], v[196:197], v[10:11]
  v_pk_add_f32 v[198:199], v[198:199], v[10:11]
  v_pk_add_f32 v[200:201], v[200:201], v[10:11]
  v_pk_add_f32 v[202:203], v[202:203], v[10:11]
  v_rcp_f32 v196, v196
  v_rcp_f32 v197, v197
  v_rcp_f32 v198, v198
  v_rcp_f32 v199, v199
  v_rcp_f32 v200, v200
  v_rcp_f32 v201, v201
  v_rcp_f32 v202, v202
  v_rcp_f32 v203, v203
  buffer_load_dwordx4 a[188:191], v249, s[20:23], s67 offen offset:1024 sc1
  v_pk_mul_f32 v[104:105], v[104:105], v[196:197]
  v_pk_mul_f32 v[106:107], v[106:107], v[198:199]
  v_pk_mul_f32 v[108:109], v[108:109], v[200:201]
  v_pk_mul_f32 v[110:111], v[110:111], v[202:203]
  v_pk_add_f32 v[12:13], v[104:105], v[106:107]
  v_pk_mul_f32 v[14:15], v[104:105], v[104:105]
  v_pk_add_f32 v[12:13], v[12:13], v[108:109]
  v_pk_fma_f32 v[14:15], v[106:107], v[106:107], v[14:15]
  v_pk_add_f32 v[12:13], v[12:13], v[110:111]
  v_pk_fma_f32 v[14:15], v[108:109], v[108:109], v[14:15]
  v_add_f32 v206, v12, v13
  v_pk_fma_f32 v[14:15], v[110:111], v[110:111], v[14:15]
  v_add_f32 v210, v14, v15
  v_pk_fma_f32 v[112:113], v[188:189], v[174:175], v[112:113] op_sel:[0,1,0] op_sel_hi:[1,1,1]
  v_pk_fma_f32 v[114:115], v[190:191], v[174:175], v[114:115] op_sel:[0,1,0] op_sel_hi:[1,1,1]
  v_pk_fma_f32 v[116:117], v[192:193], v[174:175], v[116:117] op_sel:[0,1,0] op_sel_hi:[1,1,1]
  v_pk_fma_f32 v[118:119], v[194:195], v[174:175], v[118:119] op_sel:[0,1,0] op_sel_hi:[1,1,1]
  v_pk_mul_f32 v[112:113], v[112:113], v[174:175] op_sel_hi:[1,0]
  v_pk_mul_f32 v[114:115], v[114:115], v[174:175] op_sel_hi:[1,0]
  v_pk_mul_f32 v[116:117], v[116:117], v[174:175] op_sel_hi:[1,0]
  v_pk_mul_f32 v[118:119], v[118:119], v[174:175] op_sel_hi:[1,0]
  buffer_load_dwordx4 a[192:195], v249, s[20:23], s66 offen offset:2048 sc1
  v_pk_mul_f32 v[196:197], v[112:113], v[112:113]
  v_pk_mul_f32 v[198:199], v[114:115], v[114:115]
  v_pk_mul_f32 v[200:201], v[116:117], v[116:117]
  v_pk_mul_f32 v[202:203], v[118:119], v[118:119]
  v_pk_fma_f32 v[196:197], v[196:197], v[8:9], v[6:7]
  v_pk_fma_f32 v[198:199], v[198:199], v[8:9], v[6:7]
  v_pk_fma_f32 v[200:201], v[200:201], v[8:9], v[6:7]
  v_pk_fma_f32 v[202:203], v[202:203], v[8:9], v[6:7]
  v_pk_mul_f32 v[196:197], v[196:197], v[112:113]
  v_pk_mul_f32 v[198:199], v[198:199], v[114:115]
  v_pk_mul_f32 v[200:201], v[200:201], v[116:117]
  v_pk_mul_f32 v[202:203], v[202:203], v[118:119]
  buffer_load_dwordx4 a[196:199], v249, s[20:23], s67 offen offset:2048 sc1
  v_exp_f32 v196, v196
  v_exp_f32 v197, v197
  v_exp_f32 v198, v198
  v_exp_f32 v199, v199
  v_exp_f32 v200, v200
  v_exp_f32 v201, v201
  v_exp_f32 v202, v202
  v_exp_f32 v203, v203
  buffer_load_dwordx4 a[200:203], v249, s[20:23], s66 offen offset:3072 sc1
  v_pk_add_f32 v[196:197], v[196:197], v[10:11]
  v_pk_add_f32 v[198:199], v[198:199], v[10:11]
  v_pk_add_f32 v[200:201], v[200:201], v[10:11]
  v_pk_add_f32 v[202:203], v[202:203], v[10:11]
  v_rcp_f32 v196, v196
  v_rcp_f32 v197, v197
  v_rcp_f32 v198, v198
  v_rcp_f32 v199, v199
  v_rcp_f32 v200, v200
  v_rcp_f32 v201, v201
  v_rcp_f32 v202, v202
  v_rcp_f32 v203, v203
  buffer_load_dwordx4 a[204:207], v249, s[20:23], s67 offen offset:3072 sc1
  v_pk_mul_f32 v[112:113], v[112:113], v[196:197]
  v_pk_mul_f32 v[114:115], v[114:115], v[198:199]
  v_pk_mul_f32 v[116:117], v[116:117], v[200:201]
  v_pk_mul_f32 v[118:119], v[118:119], v[202:203]
  v_pk_add_f32 v[12:13], v[112:113], v[114:115]
  v_pk_mul_f32 v[14:15], v[112:113], v[112:113]
  v_pk_add_f32 v[12:13], v[12:13], v[116:117]
  v_pk_fma_f32 v[14:15], v[114:115], v[114:115], v[14:15]
  v_pk_add_f32 v[12:13], v[12:13], v[118:119]
  v_pk_fma_f32 v[14:15], v[116:117], v[116:117], v[14:15]
  v_add_f32 v207, v12, v13
  v_pk_fma_f32 v[14:15], v[118:119], v[118:119], v[14:15]
  v_add_f32 v211, v14, v15
  v_pk_fma_f32 v[120:121], v[188:189], v[176:177], v[120:121] op_sel:[0,1,0] op_sel_hi:[1,1,1]
  v_pk_fma_f32 v[122:123], v[190:191], v[176:177], v[122:123] op_sel:[0,1,0] op_sel_hi:[1,1,1]
  v_pk_fma_f32 v[124:125], v[192:193], v[176:177], v[124:125] op_sel:[0,1,0] op_sel_hi:[1,1,1]
  v_pk_fma_f32 v[126:127], v[194:195], v[176:177], v[126:127] op_sel:[0,1,0] op_sel_hi:[1,1,1]
  v_pk_mul_f32 v[120:121], v[120:121], v[176:177] op_sel_hi:[1,0]
  v_pk_mul_f32 v[122:123], v[122:123], v[176:177] op_sel_hi:[1,0]
  v_pk_mul_f32 v[124:125], v[124:125], v[176:177] op_sel_hi:[1,0]
  v_pk_mul_f32 v[126:127], v[126:127], v[176:177] op_sel_hi:[1,0]
  v_add_u32 v249, 4096, v249
  buffer_load_dwordx4 a[208:211], v249, s[20:23], s66 offen offset:0 sc1
  v_pk_mul_f32 v[196:197], v[120:121], v[120:121]
  v_pk_mul_f32 v[198:199], v[122:123], v[122:123]
  v_pk_mul_f32 v[200:201], v[124:125], v[124:125]
  v_pk_mul_f32 v[202:203], v[126:127], v[126:127]
  v_pk_fma_f32 v[196:197], v[196:197], v[8:9], v[6:7]
  v_pk_fma_f32 v[198:199], v[198:199], v[8:9], v[6:7]
  v_pk_fma_f32 v[200:201], v[200:201], v[8:9], v[6:7]
  v_pk_fma_f32 v[202:203], v[202:203], v[8:9], v[6:7]
  v_pk_mul_f32 v[196:197], v[196:197], v[120:121]
  v_pk_mul_f32 v[198:199], v[198:199], v[122:123]
  v_pk_mul_f32 v[200:201], v[200:201], v[124:125]
  v_pk_mul_f32 v[202:203], v[202:203], v[126:127]
  buffer_load_dwordx4 a[212:215], v249, s[20:23], s67 offen offset:0 sc1
  v_exp_f32 v196, v196
  v_exp_f32 v197, v197
  v_exp_f32 v198, v198
  v_exp_f32 v199, v199
  v_exp_f32 v200, v200
  v_exp_f32 v201, v201
  v_exp_f32 v202, v202
  v_exp_f32 v203, v203
  buffer_load_dwordx4 a[216:219], v249, s[20:23], s66 offen offset:1024 sc1
  v_pk_add_f32 v[196:197], v[196:197], v[10:11]
  v_pk_add_f32 v[198:199], v[198:199], v[10:11]
  v_pk_add_f32 v[200:201], v[200:201], v[10:11]
  v_pk_add_f32 v[202:203], v[202:203], v[10:11]
  v_rcp_f32 v196, v196
  v_rcp_f32 v197, v197
  v_rcp_f32 v198, v198
  v_rcp_f32 v199, v199
  v_rcp_f32 v200, v200
  v_rcp_f32 v201, v201
  v_rcp_f32 v202, v202
  v_rcp_f32 v203, v203
  s_add_u32 m0, s60, 139264
  s_nop 0
  buffer_load_dwordx4 v248, s[20:23], s62 offen sc1 lds
  v_pk_mul_f32 v[120:121], v[120:121], v[196:197]
  v_pk_mul_f32 v[122:123], v[122:123], v[198:199]
  v_pk_mul_f32 v[124:125], v[124:125], v[200:201]
  v_pk_mul_f32 v[126:127], v[126:127], v[202:203]
  v_pk_add_f32 v[12:13], v[120:121], v[122:123]
  v_pk_mul_f32 v[14:15], v[120:121], v[120:121]
  v_pk_add_f32 v[12:13], v[12:13], v[124:125]
  v_pk_fma_f32 v[14:15], v[122:123], v[122:123], v[14:15]
  v_pk_add_f32 v[12:13], v[12:13], v[126:127]
  v_pk_fma_f32 v[14:15], v[124:125], v[124:125], v[14:15]
  v_add_f32 v212, v12, v13
  v_pk_fma_f32 v[14:15], v[126:127], v[126:127], v[14:15]
  v_add_f32 v216, v14, v15
  v_pk_fma_f32 v[128:129], v[188:189], v[178:179], v[128:129] op_sel:[0,1,0] op_sel_hi:[1,1,1]
  v_pk_fma_f32 v[130:131], v[190:191], v[178:179], v[130:131] op_sel:[0,1,0] op_sel_hi:[1,1,1]
  v_pk_fma_f32 v[132:133], v[192:193], v[178:179], v[132:133] op_sel:[0,1,0] op_sel_hi:[1,1,1]
  v_pk_fma_f32 v[134:135], v[194:195], v[178:179], v[134:135] op_sel:[0,1,0] op_sel_hi:[1,1,1]
  v_pk_mul_f32 v[128:129], v[128:129], v[178:179] op_sel_hi:[1,0]
  v_pk_mul_f32 v[130:131], v[130:131], v[178:179] op_sel_hi:[1,0]
  v_pk_mul_f32 v[132:133], v[132:133], v[178:179] op_sel_hi:[1,0]
  v_pk_mul_f32 v[134:135], v[134:135], v[178:179] op_sel_hi:[1,0]
  s_add_u32 m0, s60, 140288
  s_nop 0
  buffer_load_dwordx4 v248, s[20:23], s63 offen sc1 lds
  v_pk_mul_f32 v[196:197], v[128:129], v[128:129]
  v_pk_mul_f32 v[198:199], v[130:131], v[130:131]
  v_pk_mul_f32 v[200:201], v[132:133], v[132:133]
  v_pk_mul_f32 v[202:203], v[134:135], v[134:135]
  v_pk_fma_f32 v[196:197], v[196:197], v[8:9], v[6:7]
  v_pk_fma_f32 v[198:199], v[198:199], v[8:9], v[6:7]
  v_pk_fma_f32 v[200:201], v[200:201], v[8:9], v[6:7]
  v_pk_fma_f32 v[202:203], v[202:203], v[8:9], v[6:7]
  v_pk_mul_f32 v[196:197], v[196:197], v[128:129]
  v_pk_mul_f32 v[198:199], v[198:199], v[130:131]
  v_pk_mul_f32 v[200:201], v[200:201], v[132:133]
  v_pk_mul_f32 v[202:203], v[202:203], v[134:135]
  s_add_u32 m0, s60, 141312
  s_nop 0
  buffer_load_dwordx4 v248, s[20:23], s64 offen sc1 lds
  v_exp_f32 v196, v196
  v_exp_f32 v197, v197
  v_exp_f32 v198, v198
  v_exp_f32 v199, v199
  v_exp_f32 v200, v200
  v_exp_f32 v201, v201
  v_exp_f32 v202, v202
  v_exp_f32 v203, v203
  s_add_u32 m0, s60, 142336
  s_nop 0
  buffer_load_dwordx4 v248, s[20:23], s65 offen sc1 lds
  v_pk_add_f32 v[196:197], v[196:197], v[10:11]
  v_pk_add_f32 v[198:199], v[198:199], v[10:11]
  v_pk_add_f32 v[200:201], v[200:201], v[10:11]
  v_pk_add_f32 v[202:203], v[202:203], v[10:11]
  v_rcp_f32 v196, v196
  v_rcp_f32 v197, v197
  v_rcp_f32 v198, v198
  v_rcp_f32 v199, v199
  v_rcp_f32 v200, v200
  v_rcp_f32 v201, v201
  v_rcp_f32 v202, v202
  v_rcp_f32 v203, v203
  v_add_u32 v248, 2048, v248
  s_add_u32 m0, s60, 73728
  s_nop 0
  buffer_load_dwordx4 v248, s[20:23], s62 offen sc1 lds
  v_pk_mul_f32 v[128:129], v[128:129], v[196:197]
  v_pk_mul_f32 v[130:131], v[130:131], v[198:199]
  v_pk_mul_f32 v[132:133], v[132:133], v[200:201]
  v_pk_mul_f32 v[134:135], v[134:135], v[202:203]
  v_pk_add_f32 v[12:13], v[128:129], v[130:131]
  v_pk_mul_f32 v[14:15], v[128:129], v[128:129]
  v_pk_add_f32 v[12:13], v[12:13], v[132:133]
  v_pk_fma_f32 v[14:15], v[130:131], v[130:131], v[14:15]
  v_pk_add_f32 v[12:13], v[12:13], v[134:135]
  v_pk_fma_f32 v[14:15], v[132:133], v[132:133], v[14:15]
  v_add_f32 v213, v12, v13
  v_pk_fma_f32 v[14:15], v[134:135], v[134:135], v[14:15]
  v_add_f32 v217, v14, v15
  v_pk_fma_f32 v[136:137], v[188:189], v[180:181], v[136:137] op_sel:[0,1,0] op_sel_hi:[1,1,1]
  v_pk_fma_f32 v[138:139], v[190:191], v[180:181], v[138:139] op_sel:[0,1,0] op_sel_hi:[1,1,1]
  v_pk_fma_f32 v[140:141], v[192:193], v[180:181], v[140:141] op_sel:[0,1,0] op_sel_hi:[1,1,1]
  v_pk_fma_f32 v[142:143], v[194:195], v[180:181], v[142:143] op_sel:[0,1,0] op_sel_hi:[1,1,1]
  v_pk_mul_f32 v[136:137], v[136:137], v[180:181] op_sel_hi:[1,0]
  v_pk_mul_f32 v[138:139], v[138:139], v[180:181] op_sel_hi:[1,0]
  v_pk_mul_f32 v[140:141], v[140:141], v[180:181] op_sel_hi:[1,0]
  v_pk_mul_f32 v[142:143], v[142:143], v[180:181] op_sel_hi:[1,0]
  s_add_u32 m0, s60, 74752
  s_nop 0
  buffer_load_dwordx4 v248, s[20:23], s63 offen sc1 lds
  v_pk_mul_f32 v[196:197], v[136:137], v[136:137]
  v_pk_mul_f32 v[198:199], v[138:139], v[138:139]
  v_pk_mul_f32 v[200:201], v[140:141], v[140:141]
  v_pk_mul_f32 v[202:203], v[142:143], v[142:143]
  v_pk_fma_f32 v[196:197], v[196:197], v[8:9], v[6:7]
  v_pk_fma_f32 v[198:199], v[198:199], v[8:9], v[6:7]
  v_pk_fma_f32 v[200:201], v[200:201], v[8:9], v[6:7]
  v_pk_fma_f32 v[202:203], v[202:203], v[8:9], v[6:7]
  v_pk_mul_f32 v[196:197], v[196:197], v[136:137]
  v_pk_mul_f32 v[198:199], v[198:199], v[138:139]
  v_pk_mul_f32 v[200:201], v[200:201], v[140:141]
  v_pk_mul_f32 v[202:203], v[202:203], v[142:143]
  s_add_u32 m0, s60, 75776
  s_nop 0
  buffer_load_dwordx4 v248, s[20:23], s64 offen sc1 lds
  v_exp_f32 v196, v196
  v_exp_f32 v197, v197
  v_exp_f32 v198, v198
  v_exp_f32 v199, v199
  v_exp_f32 v200, v200
  v_exp_f32 v201, v201
  v_exp_f32 v202, v202
  v_exp_f32 v203, v203
  s_add_u32 m0, s60, 76800
  s_nop 0
  buffer_load_dwordx4 v248, s[20:23], s65 offen sc1 lds
  v_pk_add_f32 v[196:197], v[196:197], v[10:11]
  v_pk_add_f32 v[198:199], v[198:199], v[10:11]
  v_pk_add_f32 v[200:201], v[200:201], v[10:11]
  v_pk_add_f32 v[202:203], v[202:203], v[10:11]
  v_rcp_f32 v196, v196
  v_rcp_f32 v197, v197
  v_rcp_f32 v198, v198
  v_rcp_f32 v199, v199
  v_rcp_f32 v200, v200
  v_rcp_f32 v201, v201
  v_rcp_f32 v202, v202
  v_rcp_f32 v203, v203
  v_add_u32 v248, 2048, v248
  s_add_u32 m0, s60, 90112
  s_nop 0
  buffer_load_dwordx4 v248, s[20:23], s62 offen sc1 lds
  v_pk_mul_f32 v[136:137], v[136:137], v[196:197]
  v_pk_mul_f32 v[138:139], v[138:139], v[198:199]
  v_pk_mul_f32 v[140:141], v[140:141], v[200:201]
  v_pk_mul_f32 v[142:143], v[142:143], v[202:203]
  v_pk_add_f32 v[12:13], v[136:137], v[138:139]
  v_pk_mul_f32 v[14:15], v[136:137], v[136:137]
  v_pk_add_f32 v[12:13], v[12:13], v[140:141]
  v_pk_fma_f32 v[14:15], v[138:139], v[138:139], v[14:15]
  v_pk_add_f32 v[12:13], v[12:13], v[142:143]
  v_pk_fma_f32 v[14:15], v[140:141], v[140:141], v[14:15]
  v_add_f32 v214, v12, v13
  v_pk_fma_f32 v[14:15], v[142:143], v[142:143], v[14:15]
  v_add_f32 v218, v14, v15
  v_pk_fma_f32 v[144:145], v[188:189], v[182:183], v[144:145] op_sel:[0,1,0] op_sel_hi:[1,1,1]
  v_pk_fma_f32 v[146:147], v[190:191], v[182:183], v[146:147] op_sel:[0,1,0] op_sel_hi:[1,1,1]
  v_pk_fma_f32 v[148:149], v[192:193], v[182:183], v[148:149] op_sel:[0,1,0] op_sel_hi:[1,1,1]
  v_pk_fma_f32 v[150:151], v[194:195], v[182:183], v[150:151] op_sel:[0,1,0] op_sel_hi:[1,1,1]
  v_pk_mul_f32 v[144:145], v[144:145], v[182:183] op_sel_hi:[1,0]
  v_pk_mul_f32 v[146:147], v[146:147], v[182:183] op_sel_hi:[1,0]
  v_pk_mul_f32 v[148:149], v[148:149], v[182:183] op_sel_hi:[1,0]
  v_pk_mul_f32 v[150:151], v[150:151], v[182:183] op_sel_hi:[1,0]
  s_add_u32 m0, s60, 91136
  s_nop 0
  buffer_load_dwordx4 v248, s[20:23], s63 offen sc1 lds
  v_pk_mul_f32 v[196:197], v[144:145], v[144:145]
  v_pk_mul_f32 v[198:199], v[146:147], v[146:147]
  v_pk_mul_f32 v[200:201], v[148:149], v[148:149]
  v_pk_mul_f32 v[202:203], v[150:151], v[150:151]
  v_pk_fma_f32 v[196:197], v[196:197], v[8:9], v[6:7]
  v_pk_fma_f32 v[198:199], v[198:199], v[8:9], v[6:7]
  v_pk_fma_f32 v[200:201], v[200:201], v[8:9], v[6:7]
  v_pk_fma_f32 v[202:203], v[202:203], v[8:9], v[6:7]
  v_pk_mul_f32 v[196:197], v[196:197], v[144:145]
  v_pk_mul_f32 v[198:199], v[198:199], v[146:147]
  v_pk_mul_f32 v[200:201], v[200:201], v[148:149]
  v_pk_mul_f32 v[202:203], v[202:203], v[150:151]
  s_add_u32 m0, s60, 92160
  s_nop 0
  buffer_load_dwordx4 v248, s[20:23], s64 offen sc1 lds
  v_exp_f32 v196, v196
  v_exp_f32 v197, v197
  v_exp_f32 v198, v198
  v_exp_f32 v199, v199
  v_exp_f32 v200, v200
  v_exp_f32 v201, v201
  v_exp_f32 v202, v202
  v_exp_f32 v203, v203
  s_add_u32 m0, s60, 93184
  s_nop 0
  buffer_load_dwordx4 v248, s[20:23], s65 offen sc1 lds
  v_pk_add_f32 v[196:197], v[196:197], v[10:11]
  v_pk_add_f32 v[198:199], v[198:199], v[10:11]
  v_pk_add_f32 v[200:201], v[200:201], v[10:11]
  v_pk_add_f32 v[202:203], v[202:203], v[10:11]
  v_rcp_f32 v196, v196
  v_rcp_f32 v197, v197
  v_rcp_f32 v198, v198
  v_rcp_f32 v199, v199
  v_rcp_f32 v200, v200
  v_rcp_f32 v201, v201
  v_rcp_f32 v202, v202
  v_rcp_f32 v203, v203
  v_add_u32 v248, 2048, v248
  buffer_load_dwordx4 a[220:223], v249, s[20:23], s67 offen offset:1024 sc1
  v_pk_mul_f32 v[144:145], v[144:145], v[196:197]
  v_pk_mul_f32 v[146:147], v[146:147], v[198:199]
  v_pk_mul_f32 v[148:149], v[148:149], v[200:201]
  v_pk_mul_f32 v[150:151], v[150:151], v[202:203]
  v_pk_add_f32 v[12:13], v[144:145], v[146:147]
  v_pk_mul_f32 v[14:15], v[144:145], v[144:145]
  v_pk_add_f32 v[12:13], v[12:13], v[148:149]
  v_pk_fma_f32 v[14:15], v[146:147], v[146:147], v[14:15]
  v_pk_add_f32 v[12:13], v[12:13], v[150:151]
  v_pk_fma_f32 v[14:15], v[148:149], v[148:149], v[14:15]
  v_add_f32 v215, v12, v13
  v_pk_fma_f32 v[14:15], v[150:151], v[150:151], v[14:15]
  v_add_f32 v219, v14, v15
  v_pk_fma_f32 v[152:153], v[188:189], v[184:185], v[152:153] op_sel:[0,1,0] op_sel_hi:[1,1,1]
  v_pk_fma_f32 v[154:155], v[190:191], v[184:185], v[154:155] op_sel:[0,1,0] op_sel_hi:[1,1,1]
  v_pk_fma_f32 v[156:157], v[192:193], v[184:185], v[156:157] op_sel:[0,1,0] op_sel_hi:[1,1,1]
  v_pk_fma_f32 v[158:159], v[194:195], v[184:185], v[158:159] op_sel:[0,1,0] op_sel_hi:[1,1,1]
  v_pk_mul_f32 v[152:153], v[152:153], v[184:185] op_sel_hi:[1,0]
  v_pk_mul_f32 v[154:155], v[154:155], v[184:185] op_sel_hi:[1,0]
  v_pk_mul_f32 v[156:157], v[156:157], v[184:185] op_sel_hi:[1,0]
  v_pk_mul_f32 v[158:159], v[158:159], v[184:185] op_sel_hi:[1,0]
  buffer_load_dwordx4 a[224:227], v249, s[20:23], s66 offen offset:2048 sc1
  v_pk_mul_f32 v[196:197], v[152:153], v[152:153]
  v_pk_mul_f32 v[198:199], v[154:155], v[154:155]
  v_pk_mul_f32 v[200:201], v[156:157], v[156:157]
  v_pk_mul_f32 v[202:203], v[158:159], v[158:159]
  v_pk_fma_f32 v[196:197], v[196:197], v[8:9], v[6:7]
  v_pk_fma_f32 v[198:199], v[198:199], v[8:9], v[6:7]
  v_pk_fma_f32 v[200:201], v[200:201], v[8:9], v[6:7]
  v_pk_fma_f32 v[202:203], v[202:203], v[8:9], v[6:7]
  v_pk_mul_f32 v[196:197], v[196:197], v[152:153]
  v_pk_mul_f32 v[198:199], v[198:199], v[154:155]
  v_pk_mul_f32 v[200:201], v[200:201], v[156:157]
  v_pk_mul_f32 v[202:203], v[202:203], v[158:159]
  buffer_load_dwordx4 a[228:231], v249, s[20:23], s67 offen offset:2048 sc1
  v_exp_f32 v196, v196
  v_exp_f32 v197, v197
  v_exp_f32 v198, v198
  v_exp_f32 v199, v199
  v_exp_f32 v200, v200
  v_exp_f32 v201, v201
  v_exp_f32 v202, v202
  v_exp_f32 v203, v203
  buffer_load_dwordx4 a[232:235], v249, s[20:23], s66 offen offset:3072 sc1
  v_pk_add_f32 v[196:197], v[196:197], v[10:11]
  v_pk_add_f32 v[198:199], v[198:199], v[10:11]
  v_pk_add_f32 v[200:201], v[200:201], v[10:11]
  v_pk_add_f32 v[202:203], v[202:203], v[10:11]
  v_rcp_f32 v196, v196
  v_rcp_f32 v197, v197
  v_rcp_f32 v198, v198
  v_rcp_f32 v199, v199
  v_rcp_f32 v200, v200
  v_rcp_f32 v201, v201
  v_rcp_f32 v202, v202
  v_rcp_f32 v203, v203
  buffer_load_dwordx4 a[236:239], v249, s[20:23], s67 offen offset:3072 sc1
  v_pk_mul_f32 v[152:153], v[152:153], v[196:197]
  v_pk_mul_f32 v[154:155], v[154:155], v[198:199]
  v_pk_mul_f32 v[156:157], v[156:157], v[200:201]
  v_pk_mul_f32 v[158:159], v[158:159], v[202:203]
  v_pk_add_f32 v[12:13], v[152:153], v[154:155]
  v_pk_mul_f32 v[14:15], v[152:153], v[152:153]
  v_pk_add_f32 v[12:13], v[12:13], v[156:157]
  v_pk_fma_f32 v[14:15], v[154:155], v[154:155], v[14:15]
  v_pk_add_f32 v[12:13], v[12:13], v[158:159]
  v_pk_fma_f32 v[14:15], v[156:157], v[156:157], v[14:15]
  v_add_f32 v220, v12, v13
  v_pk_fma_f32 v[14:15], v[158:159], v[158:159], v[14:15]
  v_add_f32 v224, v14, v15
  v_pk_fma_f32 v[160:161], v[188:189], v[186:187], v[160:161] op_sel:[0,1,0] op_sel_hi:[1,1,1]
  v_pk_fma_f32 v[162:163], v[190:191], v[186:187], v[162:163] op_sel:[0,1,0] op_sel_hi:[1,1,1]
  v_pk_fma_f32 v[164:165], v[192:193], v[186:187], v[164:165] op_sel:[0,1,0] op_sel_hi:[1,1,1]
  v_pk_fma_f32 v[166:167], v[194:195], v[186:187], v[166:167] op_sel:[0,1,0] op_sel_hi:[1,1,1]
  v_pk_mul_f32 v[160:161], v[160:161], v[186:187] op_sel_hi:[1,0]
  v_pk_mul_f32 v[162:163], v[162:163], v[186:187] op_sel_hi:[1,0]
  v_pk_mul_f32 v[164:165], v[164:165], v[186:187] op_sel_hi:[1,0]
  v_pk_mul_f32 v[166:167], v[166:167], v[186:187] op_sel_hi:[1,0]
  v_add_u32 v249, 4096, v249
  v_pk_mul_f32 v[196:197], v[160:161], v[160:161]
  v_pk_mul_f32 v[198:199], v[162:163], v[162:163]
  v_pk_mul_f32 v[200:201], v[164:165], v[164:165]
  v_pk_mul_f32 v[202:203], v[166:167], v[166:167]
  v_pk_fma_f32 v[196:197], v[196:197], v[8:9], v[6:7]
  v_pk_fma_f32 v[198:199], v[198:199], v[8:9], v[6:7]
  v_pk_fma_f32 v[200:201], v[200:201], v[8:9], v[6:7]
  v_pk_fma_f32 v[202:203], v[202:203], v[8:9], v[6:7]
  v_pk_mul_f32 v[196:197], v[196:197], v[160:161]
  v_pk_mul_f32 v[198:199], v[198:199], v[162:163]
  v_pk_mul_f32 v[200:201], v[200:201], v[164:165]
  v_pk_mul_f32 v[202:203], v[202:203], v[166:167]
  v_exp_f32 v196, v196
  v_exp_f32 v197, v197
  v_exp_f32 v198, v198
  v_exp_f32 v199, v199
  v_exp_f32 v200, v200
  v_exp_f32 v201, v201
  v_exp_f32 v202, v202
  v_exp_f32 v203, v203
  v_pk_add_f32 v[196:197], v[196:197], v[10:11]
  v_pk_add_f32 v[198:199], v[198:199], v[10:11]
  v_pk_add_f32 v[200:201], v[200:201], v[10:11]
  v_pk_add_f32 v[202:203], v[202:203], v[10:11]
  v_rcp_f32 v196, v196
  v_rcp_f32 v197, v197
  v_rcp_f32 v198, v198
  v_rcp_f32 v199, v199
  v_rcp_f32 v200, v200
  v_rcp_f32 v201, v201
  v_rcp_f32 v202, v202
  v_rcp_f32 v203, v203
  v_pk_mul_f32 v[160:161], v[160:161], v[196:197]
  v_pk_mul_f32 v[162:163], v[162:163], v[198:199]
  v_pk_mul_f32 v[164:165], v[164:165], v[200:201]
  v_pk_mul_f32 v[166:167], v[166:167], v[202:203]
  v_pk_add_f32 v[12:13], v[160:161], v[162:163]
  v_pk_mul_f32 v[14:15], v[160:161], v[160:161]
  v_pk_add_f32 v[12:13], v[12:13], v[164:165]
  v_pk_fma_f32 v[14:15], v[162:163], v[162:163], v[14:15]
  v_pk_add_f32 v[12:13], v[12:13], v[166:167]
  v_pk_fma_f32 v[14:15], v[164:165], v[164:165], v[14:15]
  v_add_f32 v221, v12, v13
  v_pk_fma_f32 v[14:15], v[166:167], v[166:167], v[14:15]
  v_add_f32 v225, v14, v15
  s_lshl_b32 s33, s28, 4
  s_add_u32 s33, s33, s31
  s_mul_i32 s33, s33, 1536
  s_add_u32 s33, s33, 88342528
  v_lshlrev_b32 v12, 3, v0
  v_permlane32_swap_b32 v204, v206
  v_permlane32_swap_b32 v205, v207
  v_add_f32 v204, v204, v206
  v_add_f32 v205, v205, v207
  s_nop 1
  v_permlane16_swap_b32 v204, v205
  v_add_f32 v204, v204, v205
  v_permlane32_swap_b32 v208, v210
  v_permlane32_swap_b32 v209, v211
  v_add_f32 v208, v208, v210
  v_add_f32 v209, v209, v211
  s_nop 1
  v_permlane16_swap_b32 v208, v209
  v_add_f32 v208, v208, v209
  v_mov_b32 v205, v208
  buffer_store_dwordx2 v[204:205], v12, s[20:23], s33 offen offset:0 sc1
  v_permlane32_swap_b32 v212, v214
  v_permlane32_swap_b32 v213, v215
  v_add_f32 v212, v212, v214
  v_add_f32 v213, v213, v215
  s_nop 1
  v_permlane16_swap_b32 v212, v213
  v_add_f32 v212, v212, v213
  v_permlane32_swap_b32 v216, v218
  v_permlane32_swap_b32 v217, v219
  v_add_f32 v216, v216, v218
  v_add_f32 v217, v217, v219
  s_nop 1
  v_permlane16_swap_b32 v216, v217
  v_add_f32 v216, v216, v217
  v_mov_b32 v213, v216
  buffer_store_dwordx2 v[212:213], v12, s[20:23], s33 offen offset:512 sc1
  v_permlane32_swap_b32 v220, v222
  v_permlane32_swap_b32 v221, v223
  v_add_f32 v220, v220, v222
  v_add_f32 v221, v221, v223
  s_nop 1
  v_permlane16_swap_b32 v220, v221
  v_add_f32 v220, v220, v221
  v_permlane32_swap_b32 v224, v226
  v_permlane32_swap_b32 v225, v227
  v_add_f32 v224, v224, v226
  v_add_f32 v225, v225, v227
  s_nop 1
  v_permlane16_swap_b32 v224, v225
  v_add_f32 v224, v224, v225
  v_mov_b32 v221, v224
  buffer_store_dwordx2 v[220:221], v12, s[20:23], s33 offen offset:1024 sc1
  v_pk_fma_f32 v[24:25], v[16:17], v[170:171], v[24:25] op_sel:[0,1,0] op_sel_hi:[1,1,1]
  v_pk_fma_f32 v[26:27], v[18:19], v[170:171], v[26:27] op_sel:[0,1,0] op_sel_hi:[1,1,1]
  v_pk_fma_f32 v[28:29], v[20:21], v[170:171], v[28:29] op_sel:[0,1,0] op_sel_hi:[1,1,1]
  v_pk_fma_f32 v[30:31], v[22:23], v[170:171], v[30:31] op_sel:[0,1,0] op_sel_hi:[1,1,1]
  v_pk_mul_f32 v[24:25], v[24:25], v[170:171] op_sel_hi:[1,0]
  v_pk_mul_f32 v[26:27], v[26:27], v[170:171] op_sel_hi:[1,0]
  v_pk_mul_f32 v[28:29], v[28:29], v[170:171] op_sel_hi:[1,0]
  v_pk_mul_f32 v[30:31], v[30:31], v[170:171] op_sel_hi:[1,0]
  v_pk_fma_f32 v[32:33], v[16:17], v[172:173], v[32:33] op_sel:[0,1,0] op_sel_hi:[1,1,1]
  v_pk_fma_f32 v[34:35], v[18:19], v[172:173], v[34:35] op_sel:[0,1,0] op_sel_hi:[1,1,1]
  v_pk_fma_f32 v[36:37], v[20:21], v[172:173], v[36:37] op_sel:[0,1,0] op_sel_hi:[1,1,1]
  v_pk_fma_f32 v[38:39], v[22:23], v[172:173], v[38:39] op_sel:[0,1,0] op_sel_hi:[1,1,1]
  v_pk_mul_f32 v[32:33], v[32:33], v[172:173] op_sel_hi:[1,0]
  v_pk_mul_f32 v[34:35], v[34:35], v[172:173] op_sel_hi:[1,0]
  v_pk_mul_f32 v[36:37], v[36:37], v[172:173] op_sel_hi:[1,0]
  v_pk_mul_f32 v[38:39], v[38:39], v[172:173] op_sel_hi:[1,0]
  v_pk_fma_f32 v[40:41], v[16:17], v[174:175], v[40:41] op_sel:[0,1,0] op_sel_hi:[1,1,1]
  v_pk_fma_f32 v[42:43], v[18:19], v[174:175], v[42:43] op_sel:[0,1,0] op_sel_hi:[1,1,1]
  v_pk_fma_f32 v[44:45], v[20:21], v[174:175], v[44:45] op_sel:[0,1,0] op_sel_hi:[1,1,1]
  v_pk_fma_f32 v[46:47], v[22:23], v[174:175], v[46:47] op_sel:[0,1,0] op_sel_hi:[1,1,1]
  v_pk_mul_f32 v[40:41], v[40:41], v[174:175] op_sel_hi:[1,0]
  v_pk_mul_f32 v[42:43], v[42:43], v[174:175] op_sel_hi:[1,0]
  v_pk_mul_f32 v[44:45], v[44:45], v[174:175] op_sel_hi:[1,0]
  v_pk_mul_f32 v[46:47], v[46:47], v[174:175] op_sel_hi:[1,0]
  v_pk_fma_f32 v[48:49], v[16:17], v[176:177], v[48:49] op_sel:[0,1,0] op_sel_hi:[1,1,1]
  v_pk_fma_f32 v[50:51], v[18:19], v[176:177], v[50:51] op_sel:[0,1,0] op_sel_hi:[1,1,1]
  v_pk_fma_f32 v[52:53], v[20:21], v[176:177], v[52:53] op_sel:[0,1,0] op_sel_hi:[1,1,1]
  v_pk_fma_f32 v[54:55], v[22:23], v[176:177], v[54:55] op_sel:[0,1,0] op_sel_hi:[1,1,1]
  v_pk_mul_f32 v[48:49], v[48:49], v[176:177] op_sel_hi:[1,0]
  v_pk_mul_f32 v[50:51], v[50:51], v[176:177] op_sel_hi:[1,0]
  v_pk_mul_f32 v[52:53], v[52:53], v[176:177] op_sel_hi:[1,0]
  v_pk_mul_f32 v[54:55], v[54:55], v[176:177] op_sel_hi:[1,0]
  v_pk_fma_f32 v[56:57], v[16:17], v[178:179], v[56:57] op_sel:[0,1,0] op_sel_hi:[1,1,1]
  v_pk_fma_f32 v[58:59], v[18:19], v[178:179], v[58:59] op_sel:[0,1,0] op_sel_hi:[1,1,1]
  v_pk_fma_f32 v[60:61], v[20:21], v[178:179], v[60:61] op_sel:[0,1,0] op_sel_hi:[1,1,1]
  v_pk_fma_f32 v[62:63], v[22:23], v[178:179], v[62:63] op_sel:[0,1,0] op_sel_hi:[1,1,1]
  v_pk_mul_f32 v[56:57], v[56:57], v[178:179] op_sel_hi:[1,0]
  v_pk_mul_f32 v[58:59], v[58:59], v[178:179] op_sel_hi:[1,0]
  v_pk_mul_f32 v[60:61], v[60:61], v[178:179] op_sel_hi:[1,0]
  v_pk_mul_f32 v[62:63], v[62:63], v[178:179] op_sel_hi:[1,0]
  v_pk_fma_f32 v[64:65], v[16:17], v[180:181], v[64:65] op_sel:[0,1,0] op_sel_hi:[1,1,1]
  v_pk_fma_f32 v[66:67], v[18:19], v[180:181], v[66:67] op_sel:[0,1,0] op_sel_hi:[1,1,1]
  v_pk_fma_f32 v[68:69], v[20:21], v[180:181], v[68:69] op_sel:[0,1,0] op_sel_hi:[1,1,1]
  v_pk_fma_f32 v[70:71], v[22:23], v[180:181], v[70:71] op_sel:[0,1,0] op_sel_hi:[1,1,1]
  v_pk_mul_f32 v[64:65], v[64:65], v[180:181] op_sel_hi:[1,0]
  v_pk_mul_f32 v[66:67], v[66:67], v[180:181] op_sel_hi:[1,0]
  v_pk_mul_f32 v[68:69], v[68:69], v[180:181] op_sel_hi:[1,0]
  v_pk_mul_f32 v[70:71], v[70:71], v[180:181] op_sel_hi:[1,0]
  v_pk_fma_f32 v[72:73], v[16:17], v[182:183], v[72:73] op_sel:[0,1,0] op_sel_hi:[1,1,1]
  v_pk_fma_f32 v[74:75], v[18:19], v[182:183], v[74:75] op_sel:[0,1,0] op_sel_hi:[1,1,1]
  v_pk_fma_f32 v[76:77], v[20:21], v[182:183], v[76:77] op_sel:[0,1,0] op_sel_hi:[1,1,1]
  v_pk_fma_f32 v[78:79], v[22:23], v[182:183], v[78:79] op_sel:[0,1,0] op_sel_hi:[1,1,1]
  v_pk_mul_f32 v[72:73], v[72:73], v[182:183] op_sel_hi:[1,0]
  v_pk_mul_f32 v[74:75], v[74:75], v[182:183] op_sel_hi:[1,0]
  v_pk_mul_f32 v[76:77], v[76:77], v[182:183] op_sel_hi:[1,0]
  v_pk_mul_f32 v[78:79], v[78:79], v[182:183] op_sel_hi:[1,0]
  v_pk_fma_f32 v[80:81], v[16:17], v[184:185], v[80:81] op_sel:[0,1,0] op_sel_hi:[1,1,1]
  v_pk_fma_f32 v[82:83], v[18:19], v[184:185], v[82:83] op_sel:[0,1,0] op_sel_hi:[1,1,1]
  v_pk_fma_f32 v[84:85], v[20:21], v[184:185], v[84:85] op_sel:[0,1,0] op_sel_hi:[1,1,1]
  v_pk_fma_f32 v[86:87], v[22:23], v[184:185], v[86:87] op_sel:[0,1,0] op_sel_hi:[1,1,1]
  v_pk_mul_f32 v[80:81], v[80:81], v[184:185] op_sel_hi:[1,0]
  v_pk_mul_f32 v[82:83], v[82:83], v[184:185] op_sel_hi:[1,0]
  v_pk_mul_f32 v[84:85], v[84:85], v[184:185] op_sel_hi:[1,0]
  v_pk_mul_f32 v[86:87], v[86:87], v[184:185] op_sel_hi:[1,0]
  s_lshl_b32 s33, s3, 6
  v_add_u32 v14, s33, v0
  v_lshlrev_b32 v15, 3, v14
  s_lshl_b32 s33, s28, 7
  s_sub_u32 s33, s33, 16
  v_add_u32 v14, s33, v14
  s_mul_i32 s7, s28, 24576
  s_add_u32 s7, s7, 88342528
  s_waitcnt vmcnt(35)
  s_barrier
  ds_read_b128 a[0:3], v250 offset:40960
  ds_read_b128 a[4:7], v250 offset:43008
  ds_read_b128 a[8:11], v250 offset:45056
  ds_read_b128 a[12:15], v250 offset:47104
  ds_read_b128 a[16:19], v250 offset:49152
  ds_read_b128 a[20:23], v250 offset:51200
  ds_read_b128 a[24:27], v250 offset:53248
  ds_read_b128 a[28:31], v250 offset:55296
  s_waitcnt lgkmcnt(4)
  v_mfma_f32_16x16x32_bf16 v[168:171], a[112:115], a[0:3], 0
  ds_read_b128 a[32:35], v250 offset:41984
  v_mfma_f32_16x16x32_bf16 v[172:175], a[116:119], a[0:3], 0
  ds_read_b128 a[36:39], v250 offset:44032
  v_mfma_f32_16x16x32_bf16 v[176:179], a[112:115], a[4:7], 0
  v_mfma_f32_16x16x32_bf16 v[180:183], a[116:119], a[4:7], 0
  ds_read_b128 a[40:43], v250 offset:46080
  v_mfma_f32_16x16x32_bf16 v[184:187], a[112:115], a[8:11], 0
  v_mfma_f32_16x16x32_bf16 v[188:191], a[116:119], a[8:11], 0
  ds_read_b128 a[44:47], v250 offset:48128
  v_mfma_f32_16x16x32_bf16 v[192:195], a[112:115], a[12:15], 0
  v_mfma_f32_16x16x32_bf16 v[196:199], a[116:119], a[12:15], 0
  ds_read_b128 a[48:51], v250 offset:50176
  s_waitcnt lgkmcnt(5)
  v_mfma_f32_16x16x32_bf16 v[200:203], a[112:115], a[16:19], 0
  ds_read_b128 a[52:55], v250 offset:52224
  v_mfma_f32_16x16x32_bf16 v[204:207], a[116:119], a[16:19], 0
  v_mfma_f32_16x16x32_bf16 v[208:211], a[112:115], a[20:23], 0
  ds_read_b128 a[56:59], v250 offset:54272
  v_mfma_f32_16x16x32_bf16 v[212:215], a[116:119], a[20:23], 0
  v_mfma_f32_16x16x32_bf16 v[216:219], a[112:115], a[24:27], 0
  ds_read_b128 a[60:63], v250 offset:56320
  v_mfma_f32_16x16x32_bf16 v[220:223], a[116:119], a[24:27], 0
  v_mfma_f32_16x16x32_bf16 v[224:227], a[112:115], a[28:31], 0
  v_mfma_f32_16x16x32_bf16 v[228:231], a[116:119], a[28:31], 0
  s_waitcnt vmcnt(31) lgkmcnt(0)
  s_barrier
  v_mfma_f32_16x16x32_bf16 v[168:171], a[120:123], a[32:35], v[168:171]
  ds_read_b128 a[0:3], v250 offset:57344
  s_add_u32 m0, s60, 106496
  v_mfma_f32_16x16x32_bf16 v[172:175], a[124:127], a[32:35], v[172:175]
  ds_read_b128 a[4:7], v250 offset:59392
  v_mfma_f32_16x16x32_bf16 v[176:179], a[120:123], a[36:39], v[176:179]
  buffer_load_dwordx4 v248, s[20:23], s62 offen sc1 lds
  s_add_u32 m0, s60, 107520
  v_mfma_f32_16x16x32_bf16 v[180:183], a[124:127], a[36:39], v[180:183]
  ds_read_b128 a[8:11], v250 offset:61440
  v_mfma_f32_16x16x32_bf16 v[184:187], a[120:123], a[40:43], v[184:187]
  v_mfma_f32_16x16x32_bf16 v[188:191], a[124:127], a[40:43], v[188:191]
  ds_read_b128 a[12:15], v250 offset:63488
  v_mfma_f32_16x16x32_bf16 v[192:195], a[120:123], a[44:47], v[192:195]
  buffer_load_dwordx4 v248, s[20:23], s63 offen sc1 lds
  s_add_u32 m0, s60, 108544
  v_mfma_f32_16x16x32_bf16 v[196:199], a[124:127], a[44:47], v[196:199]
  ds_read_b128 a[16:19], v251 offset:0
  v_mfma_f32_16x16x32_bf16 v[200:203], a[120:123], a[48:51], v[200:203]
  ds_read_b128 a[20:23], v251 offset:2048
  v_mfma_f32_16x16x32_bf16 v[204:207], a[124:127], a[48:51], v[204:207]
  v_mfma_f32_16x16x32_bf16 v[208:211], a[120:123], a[52:55], v[208:211]
  ds_read_b128 a[24:27], v251 offset:4096
  v_mfma_f32_16x16x32_bf16 v[212:215], a[124:127], a[52:55], v[212:215]
  buffer_load_dwordx4 v248, s[20:23], s64 offen sc1 lds
  s_add_u32 m0, s60, 109568
  v_mfma_f32_16x16x32_bf16 v[216:219], a[120:123], a[56:59], v[216:219]
  ds_read_b128 a[28:31], v251 offset:6144
  v_mfma_f32_16x16x32_bf16 v[220:223], a[124:127], a[56:59], v[220:223]
  v_mfma_f32_16x16x32_bf16 v[224:227], a[120:123], a[60:63], v[224:227]
  v_mfma_f32_16x16x32_bf16 v[228:231], a[124:127], a[60:63], v[228:231]
  buffer_load_dwordx4 v248, s[20:23], s65 offen sc1 lds
  s_waitcnt lgkmcnt(4)
  v_mfma_f32_16x16x32_bf16 v[168:171], a[128:131], a[0:3], v[168:171]
  ds_read_b128 a[32:35], v250 offset:58368
  v_add_u32 v248, 2048, v248
  v_mfma_f32_16x16x32_bf16 v[172:175], a[132:135], a[0:3], v[172:175]
  ds_read_b128 a[36:39], v250 offset:60416
  v_mfma_f32_16x16x32_bf16 v[176:179], a[128:131], a[4:7], v[176:179]
  v_mfma_f32_16x16x32_bf16 v[180:183], a[132:135], a[4:7], v[180:183]
  ds_read_b128 a[40:43], v250 offset:62464
  v_mfma_f32_16x16x32_bf16 v[184:187], a[128:131], a[8:11], v[184:187]
  v_mfma_f32_16x16x32_bf16 v[188:191], a[132:135], a[8:11], v[188:191]
  ds_read_b128 a[44:47], v250 offset:64512
  v_mfma_f32_16x16x32_bf16 v[192:195], a[128:131], a[12:15], v[192:195]
  v_mfma_f32_16x16x32_bf16 v[196:199], a[132:135], a[12:15], v[196:199]
  ds_read_b128 a[48:51], v251 offset:1024
  s_waitcnt lgkmcnt(5)
  v_mfma_f32_16x16x32_bf16 v[200:203], a[128:131], a[16:19], v[200:203]
  ds_read_b128 a[52:55], v251 offset:3072
  v_mfma_f32_16x16x32_bf16 v[204:207], a[132:135], a[16:19], v[204:207]
  v_mfma_f32_16x16x32_bf16 v[208:211], a[128:131], a[20:23], v[208:211]
  ds_read_b128 a[56:59], v251 offset:5120
  v_mfma_f32_16x16x32_bf16 v[212:215], a[132:135], a[20:23], v[212:215]
  v_mfma_f32_16x16x32_bf16 v[216:219], a[128:131], a[24:27], v[216:219]
  ds_read_b128 a[60:63], v251 offset:7168
  v_mfma_f32_16x16x32_bf16 v[220:223], a[132:135], a[24:27], v[220:223]
  v_mfma_f32_16x16x32_bf16 v[224:227], a[128:131], a[28:31], v[224:227]
  v_mfma_f32_16x16x32_bf16 v[228:231], a[132:135], a[28:31], v[228:231]
  s_waitcnt vmcnt(20) lgkmcnt(0)
  s_barrier
  v_mfma_f32_16x16x32_bf16 v[168:171], a[136:139], a[32:35], v[168:171]
  ds_read_b128 a[0:3], v251 offset:8192
  v_mfma_f32_16x16x32_bf16 v[172:175], a[140:143], a[32:35], v[172:175]
  ds_read_b128 a[4:7], v251 offset:10240
  v_mfma_f32_16x16x32_bf16 v[176:179], a[136:139], a[36:39], v[176:179]
  v_mov_b32 v12, 1
  s_add_u32 s26, s24, 0
  s_waitcnt vmcnt(4)
  s_mov_b64 exec, 1
  buffer_atomic_add v12, off, s[20:23], s26 sc1
  s_mov_b64 exec, -1
  s_add_u32 m0, s60, 122880
  v_mfma_f32_16x16x32_bf16 v[180:183], a[140:143], a[36:39], v[180:183]
  ds_read_b128 a[8:11], v251 offset:12288
  v_mfma_f32_16x16x32_bf16 v[184:187], a[136:139], a[40:43], v[184:187]
  v_mfma_f32_16x16x32_bf16 v[188:191], a[140:143], a[40:43], v[188:191]
  ds_read_b128 a[12:15], v251 offset:14336
  v_mfma_f32_16x16x32_bf16 v[192:195], a[136:139], a[44:47], v[192:195]
  buffer_load_dwordx4 v248, s[20:23], s62 offen sc1 lds
  s_add_u32 m0, s60, 123904
  v_mfma_f32_16x16x32_bf16 v[196:199], a[140:143], a[44:47], v[196:199]
  ds_read_b128 a[16:19], v251 offset:16384
  v_mfma_f32_16x16x32_bf16 v[200:203], a[136:139], a[48:51], v[200:203]
  ds_read_b128 a[20:23], v251 offset:18432
  v_mfma_f32_16x16x32_bf16 v[204:207], a[140:143], a[48:51], v[204:207]
  v_mfma_f32_16x16x32_bf16 v[208:211], a[136:139], a[52:55], v[208:211]
  ds_read_b128 a[24:27], v251 offset:20480
  v_mfma_f32_16x16x32_bf16 v[212:215], a[140:143], a[52:55], v[212:215]
  buffer_load_dwordx4 v248, s[20:23], s63 offen sc1 lds
  s_add_u32 m0, s60, 124928
  v_mfma_f32_16x16x32_bf16 v[216:219], a[136:139], a[56:59], v[216:219]
  ds_read_b128 a[28:31], v251 offset:22528
  v_mfma_f32_16x16x32_bf16 v[220:223], a[140:143], a[56:59], v[220:223]
  v_mfma_f32_16x16x32_bf16 v[224:227], a[136:139], a[60:63], v[224:227]
  v_mfma_f32_16x16x32_bf16 v[228:231], a[140:143], a[60:63], v[228:231]
  buffer_load_dwordx4 v248, s[20:23], s64 offen sc1 lds
  s_waitcnt lgkmcnt(4)
  v_mfma_f32_16x16x32_bf16 v[168:171], a[144:147], a[0:3], v[168:171]
  ds_read_b128 a[32:35], v251 offset:9216
  s_add_u32 m0, s60, 125952
  v_mfma_f32_16x16x32_bf16 v[172:175], a[148:151], a[0:3], v[172:175]
  ds_read_b128 a[36:39], v251 offset:11264
  v_mfma_f32_16x16x32_bf16 v[176:179], a[144:147], a[4:7], v[176:179]
  v_mfma_f32_16x16x32_bf16 v[180:183], a[148:151], a[4:7], v[180:183]
  ds_read_b128 a[40:43], v251 offset:13312
  v_mfma_f32_16x16x32_bf16 v[184:187], a[144:147], a[8:11], v[184:187]
  buffer_load_dwordx4 v248, s[20:23], s65 offen sc1 lds
  v_add_u32 v248, 2048, v248
  v_mfma_f32_16x16x32_bf16 v[188:191], a[148:151], a[8:11], v[188:191]
  ds_read_b128 a[44:47], v251 offset:15360
  v_mfma_f32_16x16x32_bf16 v[192:195], a[144:147], a[12:15], v[192:195]
  v_mfma_f32_16x16x32_bf16 v[196:199], a[148:151], a[12:15], v[196:199]
  ds_read_b128 a[48:51], v251 offset:17408
  s_waitcnt lgkmcnt(5)
  v_mfma_f32_16x16x32_bf16 v[200:203], a[144:147], a[16:19], v[200:203]
  ds_read_b128 a[52:55], v251 offset:19456
  v_mfma_f32_16x16x32_bf16 v[204:207], a[148:151], a[16:19], v[204:207]
  v_mfma_f32_16x16x32_bf16 v[208:211], a[144:147], a[20:23], v[208:211]
  ds_read_b128 a[56:59], v251 offset:21504
  v_mfma_f32_16x16x32_bf16 v[212:215], a[148:151], a[20:23], v[212:215]
  v_mfma_f32_16x16x32_bf16 v[216:219], a[144:147], a[24:27], v[216:219]
  ds_read_b128 a[60:63], v251 offset:23552
  v_mfma_f32_16x16x32_bf16 v[220:223], a[148:151], a[24:27], v[220:223]
  v_mfma_f32_16x16x32_bf16 v[224:227], a[144:147], a[28:31], v[224:227]
  v_mfma_f32_16x16x32_bf16 v[228:231], a[148:151], a[28:31], v[228:231]
  s_waitcnt lgkmcnt(0)
  s_barrier
  v_mfma_f32_16x16x32_bf16 v[168:171], a[152:155], a[32:35], v[168:171]
  ds_read_b128 a[0:3], v250 offset:8192
  s_add_u32 m0, s60, 139264
  v_mfma_f32_16x16x32_bf16 v[172:175], a[156:159], a[32:35], v[172:175]
  ds_read_b128 a[4:7], v250 offset:10240
  v_mfma_f32_16x16x32_bf16 v[176:179], a[152:155], a[36:39], v[176:179]
  buffer_load_dwordx4 v248, s[20:23], s62 offen sc1 lds
  s_add_u32 m0, s60, 140288
  v_mfma_f32_16x16x32_bf16 v[180:183], a[156:159], a[36:39], v[180:183]
  ds_read_b128 a[8:11], v250 offset:12288
  v_mfma_f32_16x16x32_bf16 v[184:187], a[152:155], a[40:43], v[184:187]
  v_mfma_f32_16x16x32_bf16 v[188:191], a[156:159], a[40:43], v[188:191]
  ds_read_b128 a[12:15], v250 offset:14336
  v_mfma_f32_16x16x32_bf16 v[192:195], a[152:155], a[44:47], v[192:195]
  buffer_load_dwordx4 v248, s[20:23], s63 offen sc1 lds
  s_add_u32 m0, s60, 141312
  v_mfma_f32_16x16x32_bf16 v[196:199], a[156:159], a[44:47], v[196:199]
  ds_read_b128 a[16:19], v250 offset:16384
  v_mfma_f32_16x16x32_bf16 v[200:203], a[152:155], a[48:51], v[200:203]
  ds_read_b128 a[20:23], v250 offset:18432
  v_mfma_f32_16x16x32_bf16 v[204:207], a[156:159], a[48:51], v[204:207]
  v_mfma_f32_16x16x32_bf16 v[208:211], a[152:155], a[52:55], v[208:211]
  ds_read_b128 a[24:27], v250 offset:20480
  v_mfma_f32_16x16x32_bf16 v[212:215], a[156:159], a[52:55], v[212:215]
  buffer_load_dwordx4 v248, s[20:23], s64 offen sc1 lds
  s_add_u32 m0, s60, 142336
  v_mfma_f32_16x16x32_bf16 v[216:219], a[152:155], a[56:59], v[216:219]
  ds_read_b128 a[28:31], v250 offset:22528
  v_mfma_f32_16x16x32_bf16 v[220:223], a[156:159], a[56:59], v[220:223]
  v_mfma_f32_16x16x32_bf16 v[224:227], a[152:155], a[60:63], v[224:227]
  v_mfma_f32_16x16x32_bf16 v[228:231], a[156:159], a[60:63], v[228:231]
  buffer_load_dwordx4 v248, s[20:23], s65 offen sc1 lds
  s_waitcnt lgkmcnt(4)
  v_mfma_f32_16x16x32_bf16 v[168:171], a[160:163], a[0:3], v[168:171]
  ds_read_b128 a[32:35], v250 offset:9216
  v_add_u32 v248, 2048, v248
  v_mfma_f32_16x16x32_bf16 v[172:175], a[164:167], a[0:3], v[172:175]
  ds_read_b128 a[36:39], v250 offset:11264
  s_add_u32 m0, s36, 0
  v_mfma_f32_16x16x32_bf16 v[176:179], a[160:163], a[4:7], v[176:179]
  v_mfma_f32_16x16x32_bf16 v[180:183], a[164:167], a[4:7], v[180:183]
  ds_read_b128 a[40:43], v250 offset:13312
  v_mfma_f32_16x16x32_bf16 v[184:187], a[160:163], a[8:11], v[184:187]
  buffer_load_dwordx4 v232, s[44:47], s38 offen lds
  s_add_u32 s38, s38, 12288
  v_mfma_f32_16x16x32_bf16 v[188:191], a[164:167], a[8:11], v[188:191]
  ds_read_b128 a[44:47], v250 offset:15360
  s_add_u32 m0, s36, 1024
  v_mfma_f32_16x16x32_bf16 v[192:195], a[160:163], a[12:15], v[192:195]
  v_mfma_f32_16x16x32_bf16 v[196:199], a[164:167], a[12:15], v[196:199]
  ds_read_b128 a[48:51], v250 offset:17408
  s_waitcnt lgkmcnt(5)
  v_mfma_f32_16x16x32_bf16 v[200:203], a[160:163], a[16:19], v[200:203]
  ds_read_b128 a[52:55], v250 offset:19456
  v_mfma_f32_16x16x32_bf16 v[204:207], a[164:167], a[16:19], v[204:207]
  buffer_load_dwordx4 v233, s[44:47], s38 offen lds
  s_add_u32 s38, s38, 12288
  v_mfma_f32_16x16x32_bf16 v[208:211], a[160:163], a[20:23], v[208:211]
  ds_read_b128 a[56:59], v250 offset:21504
  s_add_u32 m0, s36, 2048
  v_mfma_f32_16x16x32_bf16 v[212:215], a[164:167], a[20:23], v[212:215]
  v_mfma_f32_16x16x32_bf16 v[216:219], a[160:163], a[24:27], v[216:219]
  ds_read_b128 a[60:63], v250 offset:23552
  v_mfma_f32_16x16x32_bf16 v[220:223], a[164:167], a[24:27], v[220:223]
  buffer_load_dwordx4 v234, s[44:47], s38 offen lds
  s_add_u32 s38, s38, 12288
  v_mfma_f32_16x16x32_bf16 v[224:227], a[160:163], a[28:31], v[224:227]
  s_add_u32 m0, s36, 3072
  v_mfma_f32_16x16x32_bf16 v[228:231], a[164:167], a[28:31], v[228:231]
  s_waitcnt lgkmcnt(0)
  s_barrier
  v_mfma_f32_16x16x32_bf16 v[168:171], a[168:171], a[32:35], v[168:171]
  ds_read_b128 a[0:3], v250 offset:24576
  v_mfma_f32_16x16x32_bf16 v[172:175], a[172:175], a[32:35], v[172:175]
  ds_read_b128 a[4:7], v250 offset:26624
  v_mfma_f32_16x16x32_bf16 v[176:179], a[168:171], a[36:39], v[176:179]
  buffer_load_dwordx4 v235, s[44:47], s38 offen lds
  s_add_u32 s38, s38, 356352
  v_mfma_f32_16x16x32_bf16 v[180:183], a[172:175], a[36:39], v[180:183]
  ds_read_b128 a[8:11], v250 offset:28672
  s_add_u32 m0, s36, 4096
  v_mfma_f32_16x16x32_bf16 v[184:187], a[168:171], a[40:43], v[184:187]
  v_mfma_f32_16x16x32_bf16 v[188:191], a[172:175], a[40:43], v[188:191]
  ds_read_b128 a[12:15], v250 offset:30720
  v_mfma_f32_16x16x32_bf16 v[192:195], a[168:171], a[44:47], v[192:195]
  buffer_load_dwordx4 v232, s[44:47], s38 offen lds
  s_add_u32 s38, s38, 12288
  v_mfma_f32_16x16x32_bf16 v[196:199], a[172:175], a[44:47], v[196:199]
  ds_read_b128 a[16:19], v250 offset:32768
  v_mfma_f32_16x16x32_bf16 v[200:203], a[168:171], a[48:51], v[200:203]
  ds_read_b128 a[20:23], v250 offset:34816
  s_add_u32 m0, s36, 5120
  v_mfma_f32_16x16x32_bf16 v[204:207], a[172:175], a[48:51], v[204:207]
  v_mfma_f32_16x16x32_bf16 v[208:211], a[168:171], a[52:55], v[208:211]
  ds_read_b128 a[24:27], v250 offset:36864
  v_mfma_f32_16x16x32_bf16 v[212:215], a[172:175], a[52:55], v[212:215]
  buffer_load_dwordx4 v233, s[44:47], s38 offen lds
  s_add_u32 s38, s38, 12288
  v_mfma_f32_16x16x32_bf16 v[216:219], a[168:171], a[56:59], v[216:219]
  ds_read_b128 a[28:31], v250 offset:38912
  s_add_u32 m0, s36, 6144
  v_mfma_f32_16x16x32_bf16 v[220:223], a[172:175], a[56:59], v[220:223]
  v_mfma_f32_16x16x32_bf16 v[224:227], a[168:171], a[60:63], v[224:227]
  v_mfma_f32_16x16x32_bf16 v[228:231], a[172:175], a[60:63], v[228:231]
  buffer_load_dwordx4 v234, s[44:47], s38 offen lds
  s_waitcnt lgkmcnt(4)
  v_mfma_f32_16x16x32_bf16 v[168:171], a[176:179], a[0:3], v[168:171]
  ds_read_b128 a[32:35], v250 offset:25600
  s_add_u32 s38, s38, 12288
  v_mfma_f32_16x16x32_bf16 v[172:175], a[180:183], a[0:3], v[172:175]
  ds_read_b128 a[36:39], v250 offset:27648
  s_add_u32 m0, s36, 7168
  v_mfma_f32_16x16x32_bf16 v[176:179], a[176:179], a[4:7], v[176:179]
  v_mfma_f32_16x16x32_bf16 v[180:183], a[180:183], a[4:7], v[180:183]
  ds_read_b128 a[40:43], v250 offset:29696
  v_mfma_f32_16x16x32_bf16 v[184:187], a[176:179], a[8:11], v[184:187]
  buffer_load_dwordx4 v235, s[44:47], s38 offen lds
  s_add_u32 s38, s38, 12288
  v_mfma_f32_16x16x32_bf16 v[188:191], a[180:183], a[8:11], v[188:191]
  ds_read_b128 a[44:47], v250 offset:31744
  s_add_u32 m0, s36, 8192
  v_mfma_f32_16x16x32_bf16 v[192:195], a[176:179], a[12:15], v[192:195]
  v_mfma_f32_16x16x32_bf16 v[196:199], a[180:183], a[12:15], v[196:199]
  ds_read_b128 a[48:51], v250 offset:33792
  s_waitcnt lgkmcnt(5)
  v_mfma_f32_16x16x32_bf16 v[200:203], a[176:179], a[16:19], v[200:203]
  ds_read_b128 a[52:55], v250 offset:35840
  v_mfma_f32_16x16x32_bf16 v[204:207], a[180:183], a[16:19], v[204:207]
  buffer_load_dwordx4 v236, s[40:43], s39 offen lds
  s_add_u32 s39, s39, 16384
  v_mfma_f32_16x16x32_bf16 v[208:211], a[176:179], a[20:23], v[208:211]
  ds_read_b128 a[56:59], v250 offset:37888
  s_add_u32 m0, s36, 9216
  v_mfma_f32_16x16x32_bf16 v[212:215], a[180:183], a[20:23], v[212:215]
  v_mfma_f32_16x16x32_bf16 v[216:219], a[176:179], a[24:27], v[216:219]
  ds_read_b128 a[60:63], v250 offset:39936
  v_mfma_f32_16x16x32_bf16 v[220:223], a[180:183], a[24:27], v[220:223]
  buffer_load_dwordx4 v236, s[40:43], s39 offen lds
  s_add_u32 s39, s39, 16384
  v_mfma_f32_16x16x32_bf16 v[224:227], a[176:179], a[28:31], v[224:227]
  s_add_u32 m0, s36, 10240
  v_mfma_f32_16x16x32_bf16 v[228:231], a[180:183], a[28:31], v[228:231]
  s_waitcnt vmcnt(19) lgkmcnt(0)
  s_barrier
  v_mfma_f32_16x16x32_bf16 v[168:171], a[184:187], a[32:35], v[168:171]
  ds_read_b128 a[0:3], v250 offset:40960
  v_mfma_f32_16x16x32_bf16 v[172:175], a[188:191], a[32:35], v[172:175]
  ds_read_b128 a[4:7], v250 offset:43008
  v_mfma_f32_16x16x32_bf16 v[176:179], a[184:187], a[36:39], v[176:179]
  s_add_u32 s27, s24, 0
  buffer_load_dword v13, off, s[20:23], s27 sc1
  v_mfma_f32_16x16x32_bf16 v[180:183], a[188:191], a[36:39], v[180:183]
  ds_read_b128 a[8:11], v250 offset:45056
  v_mfma_f32_16x16x32_bf16 v[184:187], a[184:187], a[40:43], v[184:187]
  v_mfma_f32_16x16x32_bf16 v[188:191], a[188:191], a[40:43], v[188:191]
  ds_read_b128 a[12:15], v250 offset:47104
  v_mfma_f32_16x16x32_bf16 v[192:195], a[184:187], a[44:47], v[192:195]
  buffer_load_dwordx4 v236, s[40:43], s39 offen lds
  s_add_u32 s39, s39, 16384
  v_mfma_f32_16x16x32_bf16 v[196:199], a[188:191], a[44:47], v[196:199]
  ds_read_b128 a[16:19], v250 offset:49152
  v_mfma_f32_16x16x32_bf16 v[200:203], a[184:187], a[48:51], v[200:203]
  ds_read_b128 a[20:23], v250 offset:51200
  s_add_u32 m0, s36, 11264
  v_mfma_f32_16x16x32_bf16 v[204:207], a[188:191], a[48:51], v[204:207]
  v_mfma_f32_16x16x32_bf16 v[208:211], a[184:187], a[52:55], v[208:211]
  ds_read_b128 a[24:27], v250 offset:53248
  v_mfma_f32_16x16x32_bf16 v[212:215], a[188:191], a[52:55], v[212:215]
  buffer_load_dwordx4 v236, s[40:43], s39 offen lds
  s_add_u32 s39, s39, 16384
  v_mfma_f32_16x16x32_bf16 v[216:219], a[184:187], a[56:59], v[216:219]
  ds_read_b128 a[28:31], v250 offset:55296
  s_add_u32 m0, s36, 12288
  v_mfma_f32_16x16x32_bf16 v[220:223], a[188:191], a[56:59], v[220:223]
  v_mfma_f32_16x16x32_bf16 v[224:227], a[184:187], a[60:63], v[224:227]
  v_mfma_f32_16x16x32_bf16 v[228:231], a[188:191], a[60:63], v[228:231]
  buffer_load_dwordx4 v236, s[40:43], s39 offen lds
  s_waitcnt lgkmcnt(4)
  v_mfma_f32_16x16x32_bf16 v[168:171], a[192:195], a[0:3], v[168:171]
  ds_read_b128 a[32:35], v250 offset:41984
  s_add_u32 s39, s39, 16384
  v_mfma_f32_16x16x32_bf16 v[172:175], a[196:199], a[0:3], v[172:175]
  ds_read_b128 a[36:39], v250 offset:44032
  s_add_u32 m0, s36, 13312
  v_mfma_f32_16x16x32_bf16 v[176:179], a[192:195], a[4:7], v[176:179]
  v_mfma_f32_16x16x32_bf16 v[180:183], a[196:199], a[4:7], v[180:183]
  ds_read_b128 a[40:43], v250 offset:46080
  v_mfma_f32_16x16x32_bf16 v[184:187], a[192:195], a[8:11], v[184:187]
  buffer_load_dwordx4 v236, s[40:43], s39 offen lds
  s_add_u32 s39, s39, 16384
  v_mfma_f32_16x16x32_bf16 v[188:191], a[196:199], a[8:11], v[188:191]
  ds_read_b128 a[44:47], v250 offset:48128
  s_add_u32 m0, s36, 14336
  v_mfma_f32_16x16x32_bf16 v[192:195], a[192:195], a[12:15], v[192:195]
  v_mfma_f32_16x16x32_bf16 v[196:199], a[196:199], a[12:15], v[196:199]
  ds_read_b128 a[48:51], v250 offset:50176
  s_waitcnt lgkmcnt(5)
  v_mfma_f32_16x16x32_bf16 v[200:203], a[192:195], a[16:19], v[200:203]
  ds_read_b128 a[52:55], v250 offset:52224
  v_mfma_f32_16x16x32_bf16 v[204:207], a[196:199], a[16:19], v[204:207]
  buffer_load_dwordx4 v236, s[40:43], s39 offen lds
  s_add_u32 s39, s39, 16384
  v_mfma_f32_16x16x32_bf16 v[208:211], a[192:195], a[20:23], v[208:211]
  ds_read_b128 a[56:59], v250 offset:54272
  s_add_u32 m0, s36, 15360
  v_mfma_f32_16x16x32_bf16 v[212:215], a[196:199], a[20:23], v[212:215]
  v_mfma_f32_16x16x32_bf16 v[216:219], a[192:195], a[24:27], v[216:219]
  ds_read_b128 a[60:63], v250 offset:56320
  v_mfma_f32_16x16x32_bf16 v[220:223], a[196:199], a[24:27], v[220:223]
  buffer_load_dwordx4 v236, s[40:43], s39 offen lds
  s_add_u32 s39, s39, 16384
  v_mfma_f32_16x16x32_bf16 v[224:227], a[192:195], a[28:31], v[224:227]
  s_add_u32 m0, s35, 65536
  v_mfma_f32_16x16x32_bf16 v[228:231], a[196:199], a[28:31], v[228:231]
  s_waitcnt vmcnt(21) lgkmcnt(0)
  s_barrier
  v_mfma_f32_16x16x32_bf16 v[168:171], a[200:203], a[32:35], v[168:171]
  ds_read_b128 a[0:3], v250 offset:57344
  v_mfma_f32_16x16x32_bf16 v[172:175], a[204:207], a[32:35], v[172:175]
  ds_read_b128 a[4:7], v250 offset:59392
  v_mfma_f32_16x16x32_bf16 v[176:179], a[200:203], a[36:39], v[176:179]
  s_waitcnt vmcnt(6)
PLP_8:
  v_cmp_le_u32 vcc, 16, v13
  s_cmp_eq_u64 vcc, -1
  s_cbranch_scc1 POK_7
  s_sleep 1
  buffer_load_dword v13, off, s[20:23], s27 sc1
  s_sub_u32 s25, s25, 1
  s_waitcnt vmcnt(0)
  s_cbranch_scc0 PLP_8
  s_endpgm
POK_7:
  v_mfma_f32_16x16x32_bf16 v[180:183], a[204:207], a[36:39], v[180:183]
  ds_read_b128 a[8:11], v250 offset:61440
  v_mfma_f32_16x16x32_bf16 v[184:187], a[200:203], a[40:43], v[184:187]
  v_mfma_f32_16x16x32_bf16 v[188:191], a[204:207], a[40:43], v[188:191]
  ds_read_b128 a[12:15], v250 offset:63488
  v_mfma_f32_16x16x32_bf16 v[192:195], a[200:203], a[44:47], v[192:195]
  buffer_load_dwordx2 a[64:65], v15, s[20:23], s7 offen offset:0 sc1
  buffer_load_dwordx2 a[66:67], v15, s[20:23], s7 offen offset:1536 sc1
  s_add_u32 s7, s7, 3072
  v_mfma_f32_16x16x32_bf16 v[196:199], a[204:207], a[44:47], v[196:199]
  ds_read_b128 a[16:19], v251 offset:0
  v_mfma_f32_16x16x32_bf16 v[200:203], a[200:203], a[48:51], v[200:203]
  ds_read_b128 a[20:23], v251 offset:2048
  v_mfma_f32_16x16x32_bf16 v[204:207], a[204:207], a[48:51], v[204:207]
  v_mfma_f32_16x16x32_bf16 v[208:211], a[200:203], a[52:55], v[208:211]
  ds_read_b128 a[24:27], v251 offset:4096
  v_mfma_f32_16x16x32_bf16 v[212:215], a[204:207], a[52:55], v[212:215]
  buffer_load_dwordx2 a[68:69], v15, s[20:23], s7 offen offset:0 sc1
  buffer_load_dwordx2 a[70:71], v15, s[20:23], s7 offen offset:1536 sc1
  s_add_u32 s7, s7, 3072
  v_mfma_f32_16x16x32_bf16 v[216:219], a[200:203], a[56:59], v[216:219]
  ds_read_b128 a[28:31], v251 offset:6144
  v_mfma_f32_16x16x32_bf16 v[220:223], a[204:207], a[56:59], v[220:223]
  v_mfma_f32_16x16x32_bf16 v[224:227], a[200:203], a[60:63], v[224:227]
  v_mfma_f32_16x16x32_bf16 v[228:231], a[204:207], a[60:63], v[228:231]
  buffer_load_dwordx2 a[72:73], v15, s[20:23], s7 offen offset:0 sc1
  buffer_load_dwordx2 a[74:75], v15, s[20:23], s7 offen offset:1536 sc1
  s_add_u32 s7, s7, 3072
  s_waitcnt lgkmcnt(4)
  v_mfma_f32_16x16x32_bf16 v[168:171], a[208:211], a[0:3], v[168:171]
  ds_read_b128 a[32:35], v250 offset:58368
  v_mfma_f32_16x16x32_bf16 v[172:175], a[212:215], a[0:3], v[172:175]
  ds_read_b128 a[36:39], v250 offset:60416
  v_mfma_f32_16x16x32_bf16 v[176:179], a[208:211], a[4:7], v[176:179]
  v_mfma_f32_16x16x32_bf16 v[180:183], a[212:215], a[4:7], v[180:183]
  ds_read_b128 a[40:43], v250 offset:62464
  v_mfma_f32_16x16x32_bf16 v[184:187], a[208:211], a[8:11], v[184:187]
  buffer_load_dwordx2 a[76:77], v15, s[20:23], s7 offen offset:0 sc1
  buffer_load_dwordx2 a[78:79], v15, s[20:23], s7 offen offset:1536 sc1
  s_add_u32 s7, s7, 3072
  v_mfma_f32_16x16x32_bf16 v[188:191], a[212:215], a[8:11], v[188:191]
  ds_read_b128 a[44:47], v250 offset:64512
  v_mfma_f32_16x16x32_bf16 v[192:195], a[208:211], a[12:15], v[192:195]
  v_mfma_f32_16x16x32_bf16 v[196:199], a[212:215], a[12:15], v[196:199]
  ds_read_b128 a[48:51], v251 offset:1024
  s_waitcnt lgkmcnt(5)
  v_mfma_f32_16x16x32_bf16 v[200:203], a[208:211], a[16:19], v[200:203]
  ds_read_b128 a[52:55], v251 offset:3072
  v_mfma_f32_16x16x32_bf16 v[204:207], a[212:215], a[16:19], v[204:207]
  buffer_load_dwordx2 a[80:81], v15, s[20:23], s7 offen offset:0 sc1
  buffer_load_dwordx2 a[82:83], v15, s[20:23], s7 offen offset:1536 sc1
  s_add_u32 s7, s7, 3072
  v_mfma_f32_16x16x32_bf16 v[208:211], a[208:211], a[20:23], v[208:211]
  ds_read_b128 a[56:59], v251 offset:5120
  v_mfma_f32_16x16x32_bf16 v[212:215], a[212:215], a[20:23], v[212:215]
  v_mfma_f32_16x16x32_bf16 v[216:219], a[208:211], a[24:27], v[216:219]
  ds_read_b128 a[60:63], v251 offset:7168
  v_mfma_f32_16x16x32_bf16 v[220:223], a[212:215], a[24:27], v[220:223]
  buffer_load_dwordx2 a[84:85], v15, s[20:23], s7 offen offset:0 sc1
  buffer_load_dwordx2 a[86:87], v15, s[20:23], s7 offen offset:1536 sc1
  s_add_u32 s7, s7, 3072
  v_mfma_f32_16x16x32_bf16 v[224:227], a[208:211], a[28:31], v[224:227]
  v_mfma_f32_16x16x32_bf16 v[228:231], a[212:215], a[28:31], v[228:231]
  s_waitcnt lgkmcnt(0)
  s_barrier
  v_mfma_f32_16x16x32_bf16 v[168:171], a[216:219], a[32:35], v[168:171]
  ds_read_b128 a[0:3], v251 offset:8192
  v_mfma_f32_16x16x32_bf16 v[172:175], a[220:223], a[32:35], v[172:175]
  ds_read_b128 a[4:7], v251 offset:10240
  v_mfma_f32_16x16x32_bf16 v[176:179], a[216:219], a[36:39], v[176:179]
  buffer_load_dwordx2 a[88:89], v15, s[20:23], s7 offen offset:0 sc1
  buffer_load_dwordx2 a[90:91], v15, s[20:23], s7 offen offset:1536 sc1
  s_add_u32 s7, s7, 3072
  v_mfma_f32_16x16x32_bf16 v[180:183], a[220:223], a[36:39], v[180:183]
  ds_read_b128 a[8:11], v251 offset:12288
  v_mfma_f32_16x16x32_bf16 v[184:187], a[216:219], a[40:43], v[184:187]
  v_mfma_f32_16x16x32_bf16 v[188:191], a[220:223], a[40:43], v[188:191]
  ds_read_b128 a[12:15], v251 offset:14336
  v_mfma_f32_16x16x32_bf16 v[192:195], a[216:219], a[44:47], v[192:195]
  buffer_load_dwordx2 a[92:93], v15, s[20:23], s7 offen offset:0 sc1
  buffer_load_dwordx2 a[94:95], v15, s[20:23], s7 offen offset:1536 sc1
  s_add_u32 s7, s7, 3072
  v_mfma_f32_16x16x32_bf16 v[196:199], a[220:223], a[44:47], v[196:199]
  ds_read_b128 a[16:19], v251 offset:16384
  v_mfma_f32_16x16x32_bf16 v[200:203], a[216:219], a[48:51], v[200:203]
  ds_read_b128 a[20:23], v251 offset:18432
  v_mfma_f32_16x16x32_bf16 v[204:207], a[220:223], a[48:51], v[204:207]
  v_mfma_f32_16x16x32_bf16 v[208:211], a[216:219], a[52:55], v[208:211]
  ds_read_b128 a[24:27], v251 offset:20480
  v_mfma_f32_16x16x32_bf16 v[212:215], a[220:223], a[52:55], v[212:215]
  buffer_load_dwordx4 v237, s[52:55], s37 offen lds
  s_add_u32 m0, s35, 69632
  v_mfma_f32_16x16x32_bf16 v[216:219], a[216:219], a[56:59], v[216:219]
  ds_read_b128 a[28:31], v251 offset:22528
  v_mfma_f32_16x16x32_bf16 v[220:223], a[220:223], a[56:59], v[220:223]
  v_mfma_f32_16x16x32_bf16 v[224:227], a[216:219], a[60:63], v[224:227]
  v_mfma_f32_16x16x32_bf16 v[228:231], a[220:223], a[60:63], v[228:231]
  buffer_load_dwordx4 v237, s[56:59], s37 offen lds
  s_waitcnt lgkmcnt(4)
  v_mfma_f32_16x16x32_bf16 v[168:171], a[224:227], a[0:3], v[168:171]
  ds_read_b128 a[32:35], v251 offset:9216
  v_mfma_f32_16x16x32_bf16 v[172:175], a[228:231], a[0:3], v[172:175]
  ds_read_b128 a[36:39], v251 offset:11264
  v_mfma_f32_16x16x32_bf16 v[176:179], a[224:227], a[4:7], v[176:179]
  v_mfma_f32_16x16x32_bf16 v[180:183], a[228:231], a[4:7], v[180:183]
  ds_read_b128 a[40:43], v251 offset:13312
  v_mfma_f32_16x16x32_bf16 v[184:187], a[224:227], a[8:11], v[184:187]
  v_mfma_f32_16x16x32_bf16 v[188:191], a[228:231], a[8:11], v[188:191]
  ds_read_b128 a[44:47], v251 offset:15360
  v_mfma_f32_16x16x32_bf16 v[192:195], a[224:227], a[12:15], v[192:195]
  v_mfma_f32_16x16x32_bf16 v[196:199], a[228:231], a[12:15], v[196:199]
  ds_read_b128 a[48:51], v251 offset:17408
  s_waitcnt lgkmcnt(5)
  v_mfma_f32_16x16x32_bf16 v[200:203], a[224:227], a[16:19], v[200:203]
  ds_read_b128 a[52:55], v251 offset:19456
  v_mfma_f32_16x16x32_bf16 v[204:207], a[228:231], a[16:19], v[204:207]
  v_mfma_f32_16x16x32_bf16 v[208:211], a[224:227], a[20:23], v[208:211]
  ds_read_b128 a[56:59], v251 offset:21504
  v_mfma_f32_16x16x32_bf16 v[212:215], a[228:231], a[20:23], v[212:215]
  v_mfma_f32_16x16x32_bf16 v[216:219], a[224:227], a[24:27], v[216:219]
  ds_read_b128 a[60:63], v251 offset:23552
  v_mfma_f32_16x16x32_bf16 v[220:223], a[228:231], a[24:27], v[220:223]
  v_mfma_f32_16x16x32_bf16 v[224:227], a[224:227], a[28:31], v[224:227]
  v_mfma_f32_16x16x32_bf16 v[228:231], a[228:231], a[28:31], v[228:231]
  s_waitcnt lgkmcnt(4)
  v_mfma_f32_16x16x32_bf16 v[168:171], a[232:235], a[32:35], v[168:171]
  v_mfma_f32_16x16x32_bf16 v[172:175], a[236:239], a[32:35], v[172:175]
  v_mfma_f32_16x16x32_bf16 v[176:179], a[232:235], a[36:39], v[176:179]
  v_mfma_f32_16x16x32_bf16 v[180:183], a[236:239], a[36:39], v[180:183]
  v_mfma_f32_16x16x32_bf16 v[184:187], a[232:235], a[40:43], v[184:187]
  v_mfma_f32_16x16x32_bf16 v[188:191], a[236:239], a[40:43], v[188:191]
  v_mfma_f32_16x16x32_bf16 v[192:195], a[232:235], a[44:47], v[192:195]
  v_mfma_f32_16x16x32_bf16 v[196:199], a[236:239], a[44:47], v[196:199]
  s_waitcnt lgkmcnt(0)
  v_mfma_f32_16x16x32_bf16 v[200:203], a[232:235], a[48:51], v[200:203]
  v_mfma_f32_16x16x32_bf16 v[204:207], a[236:239], a[48:51], v[204:207]
  v_mfma_f32_16x16x32_bf16 v[208:211], a[232:235], a[52:55], v[208:211]
  v_mfma_f32_16x16x32_bf16 v[212:215], a[236:239], a[52:55], v[212:215]
  v_mfma_f32_16x16x32_bf16 v[216:219], a[232:235], a[56:59], v[216:219]
  v_mfma_f32_16x16x32_bf16 v[220:223], a[236:239], a[56:59], v[220:223]
  v_mfma_f32_16x16x32_bf16 v[224:227], a[232:235], a[60:63], v[224:227]
  v_mfma_f32_16x16x32_bf16 v[228:231], a[236:239], a[60:63], v[228:231]
  s_lshl_b32 s48, s28, 17
  s_lshl_b32 s33, s31, 10
  s_add_u32 s48, s48, s33
  s_add_u32 s33, s48, 25427968
  v_cvt_pk_bf16_f32 v168, v168, v169
  v_cvt_pk_bf16_f32 v169, v170, v171
  v_cvt_pk_bf16_f32 v170, v172, v173
  v_cvt_pk_bf16_f32 v171, v174, v175
  v_cvt_pk_bf16_f32 v176, v176, v177
  v_cvt_pk_bf16_f32 v177, v178, v179
  v_cvt_pk_bf16_f32 v178, v180, v181
  v_cvt_pk_bf16_f32 v179, v182, v183
  v_cvt_pk_bf16_f32 v184, v184, v185
  v_cvt_pk_bf16_f32 v185, v186, v187
  v_cvt_pk_bf16_f32 v186, v188, v189
  v_cvt_pk_bf16_f32 v187, v190, v191
  v_cvt_pk_bf16_f32 v192, v192, v193
  v_cvt_pk_bf16_f32 v193, v194, v195
  v_cvt_pk_bf16_f32 v194, v196, v197
  v_cvt_pk_bf16_f32 v195, v198, v199
  v_cvt_pk_bf16_f32 v200, v200, v201
  v_cvt_pk_bf16_f32 v201, v202, v203
  v_cvt_pk_bf16_f32 v202, v204, v205
  v_cvt_pk_bf16_f32 v203, v206, v207
  v_cvt_pk_bf16_f32 v208, v208, v209
  v_cvt_pk_bf16_f32 v209, v210, v211
  v_cvt_pk_bf16_f32 v210, v212, v213
  v_cvt_pk_bf16_f32 v211, v214, v215
  v_cvt_pk_bf16_f32 v216, v216, v217
  v_cvt_pk_bf16_f32 v217, v218, v219
  v_cvt_pk_bf16_f32 v218, v220, v221
  v_cvt_pk_bf16_f32 v219, v222, v223
  v_cvt_pk_bf16_f32 v224, v224, v225
  v_cvt_pk_bf16_f32 v225, v226, v227
  v_cvt_pk_bf16_f32 v226, v228, v229
  v_cvt_pk_bf16_f32 v227, v230, v231
  v_pk_mul_f32 v[240:241], v[24:25], v[24:25]
  v_pk_mul_f32 v[242:243], v[26:27], v[26:27]
  v_pk_mul_f32 v[244:245], v[28:29], v[28:29]
  v_pk_mul_f32 v[246:247], v[30:31], v[30:31]
  v_pk_fma_f32 v[240:241], v[240:241], v[8:9], v[6:7]
  v_pk_fma_f32 v[242:243], v[242:243], v[8:9], v[6:7]
  v_pk_fma_f32 v[244:245], v[244:245], v[8:9], v[6:7]
  v_pk_fma_f32 v[246:247], v[246:247], v[8:9], v[6:7]
  v_pk_mul_f32 v[240:241], v[240:241], v[24:25]
  v_pk_mul_f32 v[242:243], v[242:243], v[26:27]
  v_pk_mul_f32 v[244:245], v[244:245], v[28:29]
  v_pk_mul_f32 v[246:247], v[246:247], v[30:31]
  buffer_store_dwordx4 v[168:171], v1, s[20:23], s33 offen sc1
  v_exp_f32 v240, v240
  v_exp_f32 v241, v241
  v_exp_f32 v242, v242
  v_exp_f32 v243, v243
  v_exp_f32 v244, v244
  v_exp_f32 v245, v245
  v_exp_f32 v246, v246
  v_exp_f32 v247, v247
  s_add_u32 s33, s33, 16384
  buffer_store_dwordx4 v[176:179], v1, s[20:23], s33 offen sc1
  v_pk_add_f32 v[240:241], v[240:241], v[10:11]
  v_pk_add_f32 v[242:243], v[242:243], v[10:11]
  v_pk_add_f32 v[244:245], v[244:245], v[10:11]
  v_pk_add_f32 v[246:247], v[246:247], v[10:11]
  v_rcp_f32 v240, v240
  v_rcp_f32 v241, v241
  v_rcp_f32 v242, v242
  v_rcp_f32 v243, v243
  v_rcp_f32 v244, v244
  v_rcp_f32 v245, v245
  v_rcp_f32 v246, v246
  v_rcp_f32 v247, v247
  s_add_u32 s33, s33, 16384
  buffer_store_dwordx4 v[184:187], v1, s[20:23], s33 offen sc1
  v_pk_mul_f32 v[24:25], v[24:25], v[240:241]
  v_pk_mul_f32 v[26:27], v[26:27], v[242:243]
  v_pk_mul_f32 v[28:29], v[28:29], v[244:245]
  v_pk_mul_f32 v[30:31], v[30:31], v[246:247]
  v_cvt_pk_bf16_f32 v16, v24, v25
  v_cvt_pk_bf16_f32 v17, v26, v27
  v_cvt_pk_bf16_f32 v18, v28, v29
  v_cvt_pk_bf16_f32 v19, v30, v31
  v_pk_mul_f32 v[240:241], v[32:33], v[32:33]
  v_pk_mul_f32 v[242:243], v[34:35], v[34:35]
  v_pk_mul_f32 v[244:245], v[36:37], v[36:37]
  v_pk_mul_f32 v[246:247], v[38:39], v[38:39]
  v_pk_fma_f32 v[240:241], v[240:241], v[8:9], v[6:7]
  v_pk_fma_f32 v[242:243], v[242:243], v[8:9], v[6:7]
  v_pk_fma_f32 v[244:245], v[244:245], v[8:9], v[6:7]
  v_pk_fma_f32 v[246:247], v[246:247], v[8:9], v[6:7]
  v_pk_mul_f32 v[240:241], v[240:241], v[32:33]
  v_pk_mul_f32 v[242:243], v[242:243], v[34:35]
  v_pk_mul_f32 v[244:245], v[244:245], v[36:37]
  v_pk_mul_f32 v[246:247], v[246:247], v[38:39]
  s_add_u32 s33, s33, 16384
  buffer_store_dwordx4 v[192:195], v1, s[20:23], s33 offen sc1
  v_exp_f32 v240, v240
  v_exp_f32 v241, v241
  v_exp_f32 v242, v242
  v_exp_f32 v243, v243
  v_exp_f32 v244, v244
  v_exp_f32 v245, v245
  v_exp_f32 v246, v246
  v_exp_f32 v247, v247
  s_add_u32 s33, s33, 16384
  buffer_store_dwordx4 v[200:203], v1, s[20:23], s33 offen sc1
  v_pk_add_f32 v[240:241], v[240:241], v[10:11]
  v_pk_add_f32 v[242:243], v[242:243], v[10:11]
  v_pk_add_f32 v[244:245], v[244:245], v[10:11]
  v_pk_add_f32 v[246:247], v[246:247], v[10:11]
  v_rcp_f32 v240, v240
  v_rcp_f32 v241, v241
  v_rcp_f32 v242, v242
  v_rcp_f32 v243, v243
  v_rcp_f32 v244, v244
  v_rcp_f32 v245, v245
  v_rcp_f32 v246, v246
  v_rcp_f32 v247, v247
  s_add_u32 s33, s33, 16384
  buffer_store_dwordx4 v[208:211], v1, s[20:23], s33 offen sc1
  v_pk_mul_f32 v[32:33], v[32:33], v[240:241]
  v_pk_mul_f32 v[34:35], v[34:35], v[242:243]
  v_pk_mul_f32 v[36:37], v[36:37], v[244:245]
  v_pk_mul_f32 v[38:39], v[38:39], v[246:247]
  v_cvt_pk_bf16_f32 v20, v32, v33
  v_cvt_pk_bf16_f32 v21, v34, v35
  v_cvt_pk_bf16_f32 v22, v36, v37
  v_cvt_pk_bf16_f32 v23, v38, v39
  v_pk_mul_f32 v[240:241], v[40:41], v[40:41]
  v_pk_mul_f32 v[242:243], v[42:43], v[42:43]
  v_pk_mul_f32 v[244:245], v[44:45], v[44:45]
  v_pk_mul_f32 v[246:247], v[46:47], v[46:47]
  v_pk_fma_f32 v[240:241], v[240:241], v[8:9], v[6:7]
  v_pk_fma_f32 v[242:243], v[242:243], v[8:9], v[6:7]
  v_pk_fma_f32 v[244:245], v[244:245], v[8:9], v[6:7]
  v_pk_fma_f32 v[246:247], v[246:247], v[8:9], v[6:7]
  v_pk_mul_f32 v[240:241], v[240:241], v[40:41]
  v_pk_mul_f32 v[242:243], v[242:243], v[42:43]
  v_pk_mul_f32 v[244:245], v[244:245], v[44:45]
  v_pk_mul_f32 v[246:247], v[246:247], v[46:47]
  s_add_u32 s33, s33, 16384
  buffer_store_dwordx4 v[216:219], v1, s[20:23], s33 offen sc1
  v_exp_f32 v240, v240
  v_exp_f32 v241, v241
  v_exp_f32 v242, v242
  v_exp_f32 v243, v243
  v_exp_f32 v244, v244
  v_exp_f32 v245, v245
  v_exp_f32 v246, v246
  v_exp_f32 v247, v247
  s_add_u32 s33, s33, 16384
  buffer_store_dwordx4 v[224:227], v1, s[20:23], s33 offen sc1
  v_pk_add_f32 v[240:241], v[240:241], v[10:11]
  v_pk_add_f32 v[242:243], v[242:243], v[10:11]
  v_pk_add_f32 v[244:245], v[244:245], v[10:11]
  v_pk_add_f32 v[246:247], v[246:247], v[10:11]
  v_rcp_f32 v240, v240
  v_rcp_f32 v241, v241
  v_rcp_f32 v242, v242
  v_rcp_f32 v243, v243
  v_rcp_f32 v244, v244
  v_rcp_f32 v245, v245
  v_rcp_f32 v246, v246
  v_rcp_f32 v247, v247
  s_add_u32 s33, s33, 16384
  v_pk_mul_f32 v[40:41], v[40:41], v[240:241]
  v_pk_mul_f32 v[42:43], v[42:43], v[242:243]
  v_pk_mul_f32 v[44:45], v[44:45], v[244:245]
  v_pk_mul_f32 v[46:47], v[46:47], v[246:247]
  v_cvt_pk_bf16_f32 v24, v40, v41
  v_cvt_pk_bf16_f32 v25, v42, v43
  v_cvt_pk_bf16_f32 v26, v44, v45
  v_cvt_pk_bf16_f32 v27, v46, v47
  v_pk_mul_f32 v[240:241], v[48:49], v[48:49]
  v_pk_mul_f32 v[242:243], v[50:51], v[50:51]
  v_pk_mul_f32 v[244:245], v[52:53], v[52:53]
  v_pk_mul_f32 v[246:247], v[54:55], v[54:55]
  v_pk_fma_f32 v[240:241], v[240:241], v[8:9], v[6:7]
  v_pk_fma_f32 v[242:243], v[242:243], v[8:9], v[6:7]
  v_pk_fma_f32 v[244:245], v[244:245], v[8:9], v[6:7]
  v_pk_fma_f32 v[246:247], v[246:247], v[8:9], v[6:7]
  v_pk_mul_f32 v[240:241], v[240:241], v[48:49]
  v_pk_mul_f32 v[242:243], v[242:243], v[50:51]
  v_pk_mul_f32 v[244:245], v[244:245], v[52:53]
  v_pk_mul_f32 v[246:247], v[246:247], v[54:55]
  v_exp_f32 v240, v240
  v_exp_f32 v241, v241
  v_exp_f32 v242, v242
  v_exp_f32 v243, v243
  v_exp_f32 v244, v244
  v_exp_f32 v245, v245
  v_exp_f32 v246, v246
  v_exp_f32 v247, v247
  v_pk_add_f32 v[240:241], v[240:241], v[10:11]
  v_pk_add_f32 v[242:243], v[242:243], v[10:11]
  v_pk_add_f32 v[244:245], v[244:245], v[10:11]
  v_pk_add_f32 v[246:247], v[246:247], v[10:11]
  v_rcp_f32 v240, v240
  v_rcp_f32 v241, v241
  v_rcp_f32 v242, v242
  v_rcp_f32 v243, v243
  v_rcp_f32 v244, v244
  v_rcp_f32 v245, v245
  v_rcp_f32 v246, v246
  v_rcp_f32 v247, v247
  v_pk_mul_f32 v[48:49], v[48:49], v[240:241]
  v_pk_mul_f32 v[50:51], v[50:51], v[242:243]
  v_pk_mul_f32 v[52:53], v[52:53], v[244:245]
  v_pk_mul_f32 v[54:55], v[54:55], v[246:247]
  v_cvt_pk_bf16_f32 v28, v48, v49
  v_cvt_pk_bf16_f32 v29, v50, v51
  v_cvt_pk_bf16_f32 v30, v52, v53
  v_cvt_pk_bf16_f32 v31, v54, v55
  v_pk_mul_f32 v[240:241], v[56:57], v[56:57]
  v_pk_mul_f32 v[242:243], v[58:59], v[58:59]
  v_pk_mul_f32 v[244:245], v[60:61], v[60:61]
  v_pk_mul_f32 v[246:247], v[62:63], v[62:63]
  v_pk_fma_f32 v[240:241], v[240:241], v[8:9], v[6:7]
  v_pk_fma_f32 v[242:243], v[242:243], v[8:9], v[6:7]
  v_pk_fma_f32 v[244:245], v[244:245], v[8:9], v[6:7]
  v_pk_fma_f32 v[246:247], v[246:247], v[8:9], v[6:7]
  v_pk_mul_f32 v[240:241], v[240:241], v[56:57]
  v_pk_mul_f32 v[242:243], v[242:243], v[58:59]
  v_pk_mul_f32 v[244:245], v[244:245], v[60:61]
  v_pk_mul_f32 v[246:247], v[246:247], v[62:63]
  v_exp_f32 v240, v240
  v_exp_f32 v241, v241
  v_exp_f32 v242, v242
  v_exp_f32 v243, v243
  v_exp_f32 v244, v244
  v_exp_f32 v245, v245
  v_exp_f32 v246, v246
  v_exp_f32 v247, v247
  v_pk_add_f32 v[240:241], v[240:241], v[10:11]
  v_pk_add_f32 v[242:243], v[242:243], v[10:11]
  v_pk_add_f32 v[244:245], v[244:245], v[10:11]
  v_pk_add_f32 v[246:247], v[246:247], v[10:11]
  v_rcp_f32 v240, v240
  v_rcp_f32 v241, v241
  v_rcp_f32 v242, v242
  v_rcp_f32 v243, v243
  v_rcp_f32 v244, v244
  v_rcp_f32 v245, v245
  v_rcp_f32 v246, v246
  v_rcp_f32 v247, v247
  v_pk_mul_f32 v[56:57], v[56:57], v[240:241]
  v_pk_mul_f32 v[58:59], v[58:59], v[242:243]
  v_pk_mul_f32 v[60:61], v[60:61], v[244:245]
  v_pk_mul_f32 v[62:63], v[62:63], v[246:247]
  v_cvt_pk_bf16_f32 v32, v56, v57
  v_cvt_pk_bf16_f32 v33, v58, v59
  v_cvt_pk_bf16_f32 v34, v60, v61
  v_cvt_pk_bf16_f32 v35, v62, v63
  v_pk_mul_f32 v[240:241], v[64:65], v[64:65]
  v_pk_mul_f32 v[242:243], v[66:67], v[66:67]
  v_pk_mul_f32 v[244:245], v[68:69], v[68:69]
  v_pk_mul_f32 v[246:247], v[70:71], v[70:71]
  v_pk_fma_f32 v[240:241], v[240:241], v[8:9], v[6:7]
  v_pk_fma_f32 v[242:243], v[242:243], v[8:9], v[6:7]
  v_pk_fma_f32 v[244:245], v[244:245], v[8:9], v[6:7]
  v_pk_fma_f32 v[246:247], v[246:247], v[8:9], v[6:7]
  v_pk_mul_f32 v[240:241], v[240:241], v[64:65]
  v_pk_mul_f32 v[242:243], v[242:243], v[66:67]
  v_pk_mul_f32 v[244:245], v[244:245], v[68:69]
  v_pk_mul_f32 v[246:247], v[246:247], v[70:71]
  v_exp_f32 v240, v240
  v_exp_f32 v241, v241
  v_exp_f32 v242, v242
  v_exp_f32 v243, v243
  v_exp_f32 v244, v244
  v_exp_f32 v245, v245
  v_exp_f32 v246, v246
  v_exp_f32 v247, v247
  v_pk_add_f32 v[240:241], v[240:241], v[10:11]
  v_pk_add_f32 v[242:243], v[242:243], v[10:11]
  v_pk_add_f32 v[244:245], v[244:245], v[10:11]
  v_pk_add_f32 v[246:247], v[246:247], v[10:11]
  v_rcp_f32 v240, v240
  v_rcp_f32 v241, v241
  v_rcp_f32 v242, v242
  v_rcp_f32 v243, v243
  v_rcp_f32 v244, v244
  v_rcp_f32 v245, v245
  v_rcp_f32 v246, v246
  v_rcp_f32 v247, v247
  v_pk_mul_f32 v[64:65], v[64:65], v[240:241]
  v_pk_mul_f32 v[66:67], v[66:67], v[242:243]
  v_pk_mul_f32 v[68:69], v[68:69], v[244:245]
  v_pk_mul_f32 v[70:71], v[70:71], v[246:247]
  v_cvt_pk_bf16_f32 v36, v64, v65
  v_cvt_pk_bf16_f32 v37, v66, v67
  v_cvt_pk_bf16_f32 v38, v68, v69
  v_cvt_pk_bf16_f32 v39, v70, v71
  v_pk_mul_f32 v[240:241], v[72:73], v[72:73]
  v_pk_mul_f32 v[242:243], v[74:75], v[74:75]
  v_pk_mul_f32 v[244:245], v[76:77], v[76:77]
  v_pk_mul_f32 v[246:247], v[78:79], v[78:79]
  v_pk_fma_f32 v[240:241], v[240:241], v[8:9], v[6:7]
  v_pk_fma_f32 v[242:243], v[242:243], v[8:9], v[6:7]
  v_pk_fma_f32 v[244:245], v[244:245], v[8:9], v[6:7]
  v_pk_fma_f32 v[246:247], v[246:247], v[8:9], v[6:7]
  v_pk_mul_f32 v[240:241], v[240:241], v[72:73]
  v_pk_mul_f32 v[242:243], v[242:243], v[74:75]
  v_pk_mul_f32 v[244:245], v[244:245], v[76:77]
  v_pk_mul_f32 v[246:247], v[246:247], v[78:79]
  v_exp_f32 v240, v240
  v_exp_f32 v241, v241
  v_exp_f32 v242, v242
  v_exp_f32 v243, v243
  v_exp_f32 v244, v244
  v_exp_f32 v245, v245
  v_exp_f32 v246, v246
  v_exp_f32 v247, v247
  v_pk_add_f32 v[240:241], v[240:241], v[10:11]
  v_pk_add_f32 v[242:243], v[242:243], v[10:11]
  v_pk_add_f32 v[244:245], v[244:245], v[10:11]
  v_pk_add_f32 v[246:247], v[246:247], v[10:11]
  v_rcp_f32 v240, v240
  v_rcp_f32 v241, v241
  v_rcp_f32 v242, v242
  v_rcp_f32 v243, v243
  v_rcp_f32 v244, v244
  v_rcp_f32 v245, v245
  v_rcp_f32 v246, v246
  v_rcp_f32 v247, v247
  v_pk_mul_f32 v[72:73], v[72:73], v[240:241]
  v_pk_mul_f32 v[74:75], v[74:75], v[242:243]
  v_pk_mul_f32 v[76:77], v[76:77], v[244:245]
  v_pk_mul_f32 v[78:79], v[78:79], v[246:247]
  v_cvt_pk_bf16_f32 v40, v72, v73
  v_cvt_pk_bf16_f32 v41, v74, v75
  v_cvt_pk_bf16_f32 v42, v76, v77
  v_cvt_pk_bf16_f32 v43, v78, v79
  v_pk_mul_f32 v[240:241], v[80:81], v[80:81]
  v_pk_mul_f32 v[242:243], v[82:83], v[82:83]
  v_pk_mul_f32 v[244:245], v[84:85], v[84:85]
  v_pk_mul_f32 v[246:247], v[86:87], v[86:87]
  v_pk_fma_f32 v[240:241], v[240:241], v[8:9], v[6:7]
  v_pk_fma_f32 v[242:243], v[242:243], v[8:9], v[6:7]
  v_pk_fma_f32 v[244:245], v[244:245], v[8:9], v[6:7]
  v_pk_fma_f32 v[246:247], v[246:247], v[8:9], v[6:7]
  v_pk_mul_f32 v[240:241], v[240:241], v[80:81]
  v_pk_mul_f32 v[242:243], v[242:243], v[82:83]
  v_pk_mul_f32 v[244:245], v[244:245], v[84:85]
  v_pk_mul_f32 v[246:247], v[246:247], v[86:87]
  v_exp_f32 v240, v240
  v_exp_f32 v241, v241
  v_exp_f32 v242, v242
  v_exp_f32 v243, v243
  v_exp_f32 v244, v244
  v_exp_f32 v245, v245
  v_exp_f32 v246, v246
  v_exp_f32 v247, v247
  v_pk_add_f32 v[240:241], v[240:241], v[10:11]
  v_pk_add_f32 v[242:243], v[242:243], v[10:11]
  v_pk_add_f32 v[244:245], v[244:245], v[10:11]
  v_pk_add_f32 v[246:247], v[246:247], v[10:11]
  v_rcp_f32 v240, v240
  v_rcp_f32 v241, v241
  v_rcp_f32 v242, v242
  v_rcp_f32 v243, v243
  v_rcp_f32 v244, v244
  v_rcp_f32 v245, v245
  v_rcp_f32 v246, v246
  v_rcp_f32 v247, v247
  v_pk_mul_f32 v[80:81], v[80:81], v[240:241]
  v_pk_mul_f32 v[82:83], v[82:83], v[242:243]
  v_pk_mul_f32 v[84:85], v[84:85], v[244:245]
  v_pk_mul_f32 v[86:87], v[86:87], v[246:247]
  v_cvt_pk_bf16_f32 v44, v80, v81
  v_cvt_pk_bf16_f32 v45, v82, v83
  v_cvt_pk_bf16_f32 v46, v84, v85
  v_cvt_pk_bf16_f32 v47, v86, v87
  buffer_load_dwordx4 a[176:179], v1, s[20:23], s68 offen offset:0 sc1
  buffer_load_dwordx4 a[180:183], v1, s[20:23], s68 offen offset:1024 sc1
  buffer_load_dwordx4 a[184:187], v1, s[20:23], s68 offen offset:2048 sc1
  buffer_load_dwordx4 a[188:191], v1, s[20:23], s68 offen offset:3072 sc1
  buffer_load_dwordx4 a[192:195], v1, s[20:23], s69 offen offset:0 sc1
  buffer_load_dwordx4 a[196:199], v1, s[20:23], s69 offen offset:1024 sc1
  buffer_load_dwordx4 a[200:203], v1, s[20:23], s69 offen offset:2048 sc1
  buffer_load_dwordx4 a[204:207], v1, s[20:23], s69 offen offset:3072 sc1
  buffer_load_dwordx4 a[208:211], v1, s[20:23], s70 offen offset:0 sc1
  buffer_load_dwordx4 a[212:215], v1, s[20:23], s70 offen offset:1024 sc1
  v_and_b32 v12, 4095, v14
  s_movk_i32 s32, 4000
  s_movk_i32 s33, 8192
  v_cmp_gt_u32 vcc, s32, v12
  v_cmp_gt_u32 s[34:35], s33, v14
  s_and_b64 vcc, vcc, s[34:35]
  v_add_u32 v15, 155648, v15
  s_waitcnt vmcnt(20)
  v_accvgpr_read_b32 v48, a64
  v_accvgpr_read_b32 v49, a65
  v_accvgpr_read_b32 v50, a66
  v_accvgpr_read_b32 v51, a67
  v_accvgpr_read_b32 v52, a68
  v_accvgpr_read_b32 v53, a69
  v_accvgpr_read_b32 v54, a70
  v_accvgpr_read_b32 v55, a71
  v_accvgpr_read_b32 v56, a72
  v_accvgpr_read_b32 v57, a73
  v_accvgpr_read_b32 v58, a74
  v_accvgpr_read_b32 v59, a75
  v_accvgpr_read_b32 v60, a76
  v_accvgpr_read_b32 v61, a77
  v_accvgpr_read_b32 v62, a78
  v_accvgpr_read_b32 v63, a79
  v_accvgpr_read_b32 v64, a80
  v_accvgpr_read_b32 v65, a81
  v_accvgpr_read_b32 v66, a82
  v_accvgpr_read_b32 v67, a83
  v_accvgpr_read_b32 v68, a84
  v_accvgpr_read_b32 v69, a85
  v_accvgpr_read_b32 v70, a86
  v_accvgpr_read_b32 v71, a87
  v_accvgpr_read_b32 v72, a88
  v_accvgpr_read_b32 v73, a89
  v_accvgpr_read_b32 v74, a90
  v_accvgpr_read_b32 v75, a91
  v_accvgpr_read_b32 v76, a92
  v_accvgpr_read_b32 v77, a93
  v_accvgpr_read_b32 v78, a94
  v_accvgpr_read_b32 v79, a95
  v_pk_add_f32 v[48:49], v[48:49], v[50:51]
  v_pk_add_f32 v[48:49], v[48:49], v[52:53]
  v_pk_add_f32 v[48:49], v[48:49], v[54:55]
  v_pk_add_f32 v[48:49], v[48:49], v[56:57]
  v_pk_add_f32 v[48:49], v[48:49], v[58:59]
  v_pk_add_f32 v[48:49], v[48:49], v[60:61]
  v_pk_add_f32 v[48:49], v[48:49], v[62:63]
  v_pk_add_f32 v[48:49], v[48:49], v[64:65]
  v_pk_add_f32 v[48:49], v[48:49], v[66:67]
  v_pk_add_f32 v[48:49], v[48:49], v[68:69]
  v_pk_add_f32 v[48:49], v[48:49], v[70:71]
  v_pk_add_f32 v[48:49], v[48:49], v[72:73]
  v_pk_add_f32 v[48:49], v[48:49], v[74:75]
  v_pk_add_f32 v[48:49], v[48:49], v[76:77]
  v_pk_add_f32 v[48:49], v[48:49], v[78:79]
  v_mul_f32 v48, 0x3b000000, v48
  v_mul_f32 v49, 0x3b000000, v49
  v_fma_f32 v49, -v48, v48, v49
  v_max_f32 v49, 0, v49
  v_add_f32 v49, 0x3727c5ac, v49
  v_rsq_f32 v50, v49
  s_nop 0
  v_mul_f32 v51, v48, v50
  v_sub_f32 v51, 0, v51
  v_cndmask_b32 v50, 0, v50, vcc
  v_cndmask_b32 v51, 0, v51, vcc
  ds_write_b64 v15, v[50:51]
  v_mov_b32 v12, 1
  s_add_u32 s26, s24, 8192
  s_waitcnt vmcnt(10)
  s_mov_b64 exec, 1
  buffer_atomic_add v12, off, s[20:23], s26 sc1
  s_mov_b64 exec, -1
  v_and_b32 v237, 7, v0
  v_bfe_u32 v236, v0, 3, 1
  v_lshl_add_u32 v236, v236, 4, v237
  v_lshrrev_b32 v238, 4, v0
  v_xor_b32 v237, v237, v238
  v_lshlrev_b32 v237, 4, v237
  v_lshl_add_u32 v237, v236, 8, v237
  s_lshl_b32 s36, s3, 14
  v_add_u32 v232, s36, v237
  v_xor_b32 v233, 64, v232
  v_xor_b32 v234, 128, v232
  v_xor_b32 v235, 192, v232
  v_bfe_u32 v236, v0, 2, 2
  v_lshl_add_u32 v236, v238, 3, v236
  v_and_b32 v237, 3, v0
  v_lshlrev_b32 v237, 4, v237
  v_lshl_add_u32 v238, v236, 6, v237
  v_add_u32 v238, s36, v238
  s_lshr_b32 s34, s3, 1
  s_lshl_b32 s34, s34, 6
  s_and_b32 s33, s3, 1
  s_lshl_b32 s33, s33, 3
  s_add_u32 s34, s34, s33
  s_add_u32 s34, s34, 65536
  v_lshl_add_u32 v239, v236, 7, v237
  v_add_u32 v239, s34, v239
  ds_read_b128 v[168:171], v232 offset:0
  ds_read_b64_tr_b16 v[200:201], v238 offset:8192
  ds_read_b64_tr_b16 v[202:203], v238 offset:8448
  ds_read_b128 v[184:187], v234 offset:2048
  ds_read_b64_tr_b16 v[216:217], v238 offset:8200
  ds_read_b64_tr_b16 v[218:219], v238 offset:8456
  ds_read_b128 v[172:175], v233 offset:0
  ds_read_b64_tr_b16 v[204:205], v238 offset:10240
  ds_read_b64_tr_b16 v[206:207], v238 offset:10496
  ds_read_b128 v[188:191], v235 offset:2048
  ds_read_b64_tr_b16 v[220:221], v238 offset:10248
  ds_read_b64_tr_b16 v[222:223], v238 offset:10504
  s_mul_i32 s45, s3, 10752
  s_add_u32 s45, s45, 65536
  v_and_b32 v80, 15, v0
  v_mul_u32_u24 v80, 336, v80
  v_lshrrev_b32 v81, 4, v0
  v_lshl_add_u32 v80, v81, 3, v80
  v_add_u32 v80, s45, v80
  v_lshrrev_b32 v81, 2, v0
  v_mul_u32_u24 v81, 336, v81
  v_add_u32 v81, s45, v81
  v_and_b32 v83, 3, v0
  v_lshl_add_u32 v82, v83, 3, v81
  v_lshl_add_u32 v81, v83, 6, v81
  s_mul_i32 s45, s3, 10240
  s_add_u32 s45, s45, 108544
  v_add_u32 v84, s45, v1
  v_lshrrev_b32 v85, 2, v0
  v_lshlrev_b32 v85, 4, v85
  v_and_b32 v14, 3, v0
  v_lshl_add_u32 v85, v14, 8, v85
  v_add_u32 v85, s45, v85
  s_waitcnt lgkmcnt(0)
  ds_read_b128 v[176:179], v234 offset:0
  ds_read_b64_tr_b16 v[208:209], v238 offset:12288
  ds_read_b64_tr_b16 v[210:211], v238 offset:12544
  ds_read_b128 v[192:195], v232 offset:2048
  ds_read_b64_tr_b16 v[224:225], v238 offset:12296
  ds_read_b64_tr_b16 v[226:227], v238 offset:12552
  ds_read_b128 v[180:183], v235 offset:0
  ds_read_b64_tr_b16 v[212:213], v238 offset:14336
  ds_read_b64_tr_b16 v[214:215], v238 offset:14592
  ds_read_b128 v[196:199], v233 offset:2048
  ds_read_b64_tr_b16 v[228:229], v238 offset:14344
  ds_read_b64_tr_b16 v[230:231], v238 offset:14600
  s_lshr_b32 s32, s28, 5
  s_mul_i32 s33, s30, 31
  s_cmp_lg_u32 s30, 0
  s_addc_u32 s33, s33, 0
  s_lshl_b32 s34, s32, 7
  s_add_u32 s33, s33, s34
  s_lshl_b32 s46, s33, 15
  s_add_u32 s46, s46, 65536
  s_lshl_b32 s47, s3, 12
  s_and_b32 s35, s3, 1
  s_lshl_b32 s35, s35, 7
  v_xor_b32 v2, s35, v1
  v_add_u32 v2, s47, v2
  v_add_u32 v3, 16384, v2
  v_and_b32 v14, 15, v0
  v_lshlrev_b32 v14, 3, v14
  v_add_u32 v14, 155648, v14
  s_lshl_b32 s36, s28, 2
  s_add_u32 s36, s36, s3
  s_lshl_b32 s36, s36, 15
  s_add_u32 s36, s36, 25427968
  s_add_u32 s37, s36, 16384
  v_mov_b32 v4, v1
  v_xor_b32 v5, 128, v1
  s_waitcnt lgkmcnt(0)
  v_mfma_f32_16x16x32_bf16 v[240:243], v[168:171], v[200:203], 0
  v_mfma_f32_16x16x32_bf16 v[248:251], v[168:171], v[216:219], 0
  v_mfma_f32_16x16x32_bf16 v[244:247], v[184:187], v[200:203], 0
  v_mfma_f32_16x16x32_bf16 v[252:255], v[184:187], v[216:219], 0
  v_mfma_f32_16x16x32_bf16 v[240:243], v[172:175], v[204:207], v[240:243]
  v_mfma_f32_16x16x32_bf16 v[248:251], v[172:175], v[220:223], v[248:251]
  v_mfma_f32_16x16x32_bf16 v[244:247], v[188:191], v[204:207], v[244:247]
  v_mfma_f32_16x16x32_bf16 v[252:255], v[188:191], v[220:223], v[252:255]
  v_mfma_f32_16x16x32_bf16 v[240:243], v[176:179], v[208:211], v[240:243]
  v_mfma_f32_16x16x32_bf16 v[248:251], v[176:179], v[224:227], v[248:251]
  v_mfma_f32_16x16x32_bf16 v[244:247], v[192:195], v[208:211], v[244:247]
  v_mfma_f32_16x16x32_bf16 v[252:255], v[192:195], v[224:227], v[252:255]
  v_mfma_f32_16x16x32_bf16 v[240:243], v[180:183], v[212:215], v[240:243]
  v_mfma_f32_16x16x32_bf16 v[248:251], v[180:183], v[228:231], v[248:251]
  v_mfma_f32_16x16x32_bf16 v[244:247], v[196:199], v[212:215], v[244:247]
  v_mfma_f32_16x16x32_bf16 v[252:255], v[196:199], v[228:231], v[252:255]
  s_lshl_b32 s33, s3, 14
  s_add_u32 s33, s33, 0
  v_add_u32 v232, s33, v1
  s_and_b32 s33, s3, 1
  s_lshl_b32 s33, s33, 11
  s_add_u32 s33, s33, 0
  v_add_u32 v233, s33, v1
  ds_write_b128 v232, v[240:243] offset:0
  ds_write_b128 v232, v[244:247] offset:1024
  ds_write_b128 v232, v[248:251] offset:2048
  ds_write_b128 v232, v[252:255] offset:3072
  s_waitcnt lgkmcnt(0)
  s_barrier
  ds_read_b128 v[168:171], v233 offset:0
  ds_read_b128 v[172:175], v233 offset:1024
  ds_read_b128 v[176:179], v233 offset:16384
  ds_read_b128 v[180:183], v233 offset:17408
  ds_read_b128 v[184:187], v233 offset:32768
  ds_read_b128 v[188:191], v233 offset:33792
  ds_read_b128 v[192:195], v233 offset:49152
  ds_read_b128 v[196:199], v233 offset:50176
  ds_read_b64_tr_b16 v[208:209], v239 offset:0
  ds_read_b64_tr_b16 v[210:211], v239 offset:512
  ds_read_b64_tr_b16 v[212:213], v239 offset:4096
  ds_read_b64_tr_b16 v[214:215], v239 offset:4608
  s_lshr_b32 s33, s2, 4
  s_lshl_b32 s33, s33, 1
  s_and_b32 s34, s3, 1
  s_add_u32 s33, s33, s34
  s_lshl_b32 s33, s33, 14
  s_and_b32 s34, s2, 15
  s_lshl_b32 s34, s34, 10
  s_add_u32 s33, s33, s34
  s_add_u32 s33, s33, 85721088
  s_waitcnt lgkmcnt(0)
  v_pk_add_f32 v[168:169], v[168:169], v[176:177]
  v_pk_add_f32 v[170:171], v[170:171], v[178:179]
  v_pk_add_f32 v[172:173], v[172:173], v[180:181]
  v_pk_add_f32 v[174:175], v[174:175], v[182:183]
  v_pk_add_f32 v[168:169], v[168:169], v[184:185]
  v_pk_add_f32 v[170:171], v[170:171], v[186:187]
  v_pk_add_f32 v[172:173], v[172:173], v[188:189]
  v_pk_add_f32 v[174:175], v[174:175], v[190:191]
  v_pk_add_f32 v[168:169], v[168:169], v[192:193]
  v_pk_add_f32 v[170:171], v[170:171], v[194:195]
  v_pk_add_f32 v[172:173], v[172:173], v[196:197]
  v_pk_add_f32 v[174:175], v[174:175], v[198:199]
  v_cvt_pk_bf16_f32 v200, v168, v169
  v_cvt_pk_bf16_f32 v201, v170, v171
  v_cvt_pk_bf16_f32 v202, v172, v173
  v_cvt_pk_bf16_f32 v203, v174, v175
  buffer_store_dwordx4 v[200:203], v1, s[20:23], s33 offen sc1
  s_and_b32 s35, s2, 7
  s_lshl_b32 s35, s35, 2
  s_add_u32 s35, s35, s3
  s_lshr_b32 s33, s2, 3
  s_lshl_b32 s33, s33, 10
  s_lshl_b32 s32, s35, 15
  s_add_u32 s32, s32, s33
  s_add_u32 s32, s32, 86769664
  buffer_store_dwordx4 v[208:211], v1, s[20:23], s32 offen sc1
  s_lshl_b32 s32, s35, 14
  s_add_u32 s32, s32, s33
  s_add_u32 s32, s32, 86245376
  s_cmp_lt_u32 s2, 128
  s_cselect_b32 s32, s32, 2130706432
  buffer_store_dwordx4 v[212:215], v1, s[20:23], s32 offen sc1
  ds_read_b64 v[232:233], v14 offset:0
  ds_read_b64 v[234:235], v14 offset:128
  ds_read_b64 v[236:237], v14 offset:256
  ds_read_b64 v[238:239], v14 offset:384
  ds_read_b64 v[240:241], v14 offset:512
  ds_read_b64 v[242:243], v14 offset:640
  ds_read_b64 v[244:245], v14 offset:768
  ds_read_b64 v[246:247], v14 offset:896
  ds_read_b64 v[248:249], v14 offset:1024
  ds_read_b64 v[250:251], v14 offset:1152
  s_add_u32 s27, s24, 8192
  buffer_load_dword v13, off, s[20:23], s27 sc1
  s_barrier
  s_waitcnt lgkmcnt(9)
  v_pk_fma_f32 v[88:89], v[88:89], v[232:233], v[232:233] op_sel:[0,0,1] op_sel_hi:[1,0,1]
  v_pk_fma_f32 v[90:91], v[90:91], v[232:233], v[232:233] op_sel:[0,0,1] op_sel_hi:[1,0,1]
  v_pk_fma_f32 v[92:93], v[92:93], v[232:233], v[232:233] op_sel:[0,0,1] op_sel_hi:[1,0,1]
  v_pk_fma_f32 v[94:95], v[94:95], v[232:233], v[232:233] op_sel:[0,0,1] op_sel_hi:[1,0,1]
  s_mov_b32 m0, s47
  s_nop 0
  buffer_load_dwordx4 v2, s[20:23], s46 offen offset:0 sc1 lds
  v_cvt_pk_bf16_f32 v88, v88, v89
  v_cvt_pk_bf16_f32 v89, v90, v91
  v_cvt_pk_bf16_f32 v90, v92, v93
  v_cvt_pk_bf16_f32 v91, v94, v95
  ds_write_b128 v84, v[88:91] offset:0
  ds_read_b64_tr_b16 v[168:169], v85 offset:0
  ds_read_b64_tr_b16 v[170:171], v85 offset:8
  buffer_load_dwordx4 v2, s[20:23], s46 offen offset:1024 sc1 lds
  s_waitcnt lgkmcnt(11)
  v_pk_fma_f32 v[96:97], v[96:97], v[234:235], v[234:235] op_sel:[0,0,1] op_sel_hi:[1,0,1]
  v_pk_fma_f32 v[98:99], v[98:99], v[234:235], v[234:235] op_sel:[0,0,1] op_sel_hi:[1,0,1]
  v_pk_fma_f32 v[100:101], v[100:101], v[234:235], v[234:235] op_sel:[0,0,1] op_sel_hi:[1,0,1]
  v_pk_fma_f32 v[102:103], v[102:103], v[234:235], v[234:235] op_sel:[0,0,1] op_sel_hi:[1,0,1]
  buffer_load_dwordx4 v2, s[20:23], s46 offen offset:2048 sc1 lds
  v_cvt_pk_bf16_f32 v96, v96, v97
  v_cvt_pk_bf16_f32 v97, v98, v99
  v_cvt_pk_bf16_f32 v98, v100, v101
  v_cvt_pk_bf16_f32 v99, v102, v103
  ds_write_b128 v84, v[96:99] offset:1024
  ds_read_b64_tr_b16 v[172:173], v85 offset:1024
  ds_read_b64_tr_b16 v[174:175], v85 offset:1032
  buffer_load_dwordx4 v2, s[20:23], s46 offen offset:3072 sc1 lds
  s_waitcnt lgkmcnt(3)
  ds_write_b64 v80, v[168:169] offset:0
  ds_write_b64 v80, v[170:171] offset:5376
  v_pk_fma_f32 v[104:105], v[104:105], v[236:237], v[236:237] op_sel:[0,0,1] op_sel_hi:[1,0,1]
  v_pk_fma_f32 v[106:107], v[106:107], v[236:237], v[236:237] op_sel:[0,0,1] op_sel_hi:[1,0,1]
  v_pk_fma_f32 v[108:109], v[108:109], v[236:237], v[236:237] op_sel:[0,0,1] op_sel_hi:[1,0,1]
  v_pk_fma_f32 v[110:111], v[110:111], v[236:237], v[236:237] op_sel:[0,0,1] op_sel_hi:[1,0,1]
  s_add_u32 m0, s47, 16384
  s_nop 0
  buffer_load_dwordx4 v3, s[20:23], s46 offen offset:0 sc1 lds
  v_cvt_pk_bf16_f32 v104, v104, v105
  v_cvt_pk_bf16_f32 v105, v106, v107
  v_cvt_pk_bf16_f32 v106, v108, v109
  v_cvt_pk_bf16_f32 v107, v110, v111
  ds_write_b128 v84, v[104:107] offset:2048
  ds_read_b64_tr_b16 v[176:177], v85 offset:2048
  ds_read_b64_tr_b16 v[178:179], v85 offset:2056
  buffer_load_dwordx4 v3, s[20:23], s46 offen offset:1024 sc1 lds
  s_waitcnt lgkmcnt(5)
  ds_write_b64 v80, v[172:173] offset:32
  ds_write_b64 v80, v[174:175] offset:5408
  v_pk_fma_f32 v[112:113], v[112:113], v[238:239], v[238:239] op_sel:[0,0,1] op_sel_hi:[1,0,1]
  v_pk_fma_f32 v[114:115], v[114:115], v[238:239], v[238:239] op_sel:[0,0,1] op_sel_hi:[1,0,1]
  v_pk_fma_f32 v[116:117], v[116:117], v[238:239], v[238:239] op_sel:[0,0,1] op_sel_hi:[1,0,1]
  v_pk_fma_f32 v[118:119], v[118:119], v[238:239], v[238:239] op_sel:[0,0,1] op_sel_hi:[1,0,1]
  buffer_load_dwordx4 v3, s[20:23], s46 offen offset:2048 sc1 lds
  v_cvt_pk_bf16_f32 v112, v112, v113
  v_cvt_pk_bf16_f32 v113, v114, v115
  v_cvt_pk_bf16_f32 v114, v116, v117
  v_cvt_pk_bf16_f32 v115, v118, v119
  ds_write_b128 v84, v[112:115] offset:3072
  ds_read_b64_tr_b16 v[180:181], v85 offset:3072
  ds_read_b64_tr_b16 v[182:183], v85 offset:3080
  buffer_load_dwordx4 v3, s[20:23], s46 offen offset:3072 sc1 lds
  s_add_u32 s46, s46, 32768
  s_add_u32 s47, s47, 32768
  s_and_b32 s47, s47, 0x1ffff
  s_waitcnt lgkmcnt(5)
  ds_write_b64 v80, v[176:177] offset:64
  ds_write_b64 v80, v[178:179] offset:5440
  v_pk_fma_f32 v[120:121], v[120:121], v[240:241], v[240:241] op_sel:[0,0,1] op_sel_hi:[1,0,1]
  v_pk_fma_f32 v[122:123], v[122:123], v[240:241], v[240:241] op_sel:[0,0,1] op_sel_hi:[1,0,1]
  v_pk_fma_f32 v[124:125], v[124:125], v[240:241], v[240:241] op_sel:[0,0,1] op_sel_hi:[1,0,1]
  v_pk_fma_f32 v[126:127], v[126:127], v[240:241], v[240:241] op_sel:[0,0,1] op_sel_hi:[1,0,1]
  s_waitcnt vmcnt(8)
PLP_10:
  v_cmp_le_u32 vcc, 16, v13
  s_cmp_eq_u64 vcc, -1
  s_cbranch_scc1 POK_9
  s_sleep 1
  buffer_load_dword v13, off, s[20:23], s27 sc1
  s_sub_u32 s25, s25, 1
  s_waitcnt vmcnt(0)
  s_cbranch_scc0 PLP_10
  s_endpgm
POK_9:
  buffer_load_dwordx4 a[0:3], v1, s[20:23], s36 offen offset:0 sc1
  v_cvt_pk_bf16_f32 v120, v120, v121
  v_cvt_pk_bf16_f32 v121, v122, v123
  v_cvt_pk_bf16_f32 v122, v124, v125
  v_cvt_pk_bf16_f32 v123, v126, v127
  ds_write_b128 v84, v[120:123] offset:4096
  ds_read_b64_tr_b16 v[184:185], v85 offset:4096
  ds_read_b64_tr_b16 v[186:187], v85 offset:4104
  buffer_load_dwordx4 a[64:67], v1, s[20:23], s37 offen offset:0 sc1
  s_waitcnt lgkmcnt(5)
  ds_write_b64 v80, v[180:181] offset:96
  ds_write_b64 v80, v[182:183] offset:5472
  v_pk_fma_f32 v[128:129], v[128:129], v[242:243], v[242:243] op_sel:[0,0,1] op_sel_hi:[1,0,1]
  v_pk_fma_f32 v[130:131], v[130:131], v[242:243], v[242:243] op_sel:[0,0,1] op_sel_hi:[1,0,1]
  v_pk_fma_f32 v[132:133], v[132:133], v[242:243], v[242:243] op_sel:[0,0,1] op_sel_hi:[1,0,1]
  v_pk_fma_f32 v[134:135], v[134:135], v[242:243], v[242:243] op_sel:[0,0,1] op_sel_hi:[1,0,1]
  buffer_load_dwordx4 a[4:7], v1, s[20:23], s36 offen offset:1024 sc1
  v_cvt_pk_bf16_f32 v128, v128, v129
  v_cvt_pk_bf16_f32 v129, v130, v131
  v_cvt_pk_bf16_f32 v130, v132, v133
  v_cvt_pk_bf16_f32 v131, v134, v135
  ds_write_b128 v84, v[128:131] offset:5120
  ds_read_b64_tr_b16 v[188:189], v85 offset:5120
  ds_read_b64_tr_b16 v[190:191], v85 offset:5128
  buffer_load_dwordx4 a[68:71], v1, s[20:23], s37 offen offset:1024 sc1
  s_waitcnt lgkmcnt(5)
  ds_write_b64 v80, v[184:185] offset:128
  ds_write_b64 v80, v[186:187] offset:5504
  v_pk_fma_f32 v[136:137], v[136:137], v[244:245], v[244:245] op_sel:[0,0,1] op_sel_hi:[1,0,1]
  v_pk_fma_f32 v[138:139], v[138:139], v[244:245], v[244:245] op_sel:[0,0,1] op_sel_hi:[1,0,1]
  v_pk_fma_f32 v[140:141], v[140:141], v[244:245], v[244:245] op_sel:[0,0,1] op_sel_hi:[1,0,1]
  v_pk_fma_f32 v[142:143], v[142:143], v[244:245], v[244:245] op_sel:[0,0,1] op_sel_hi:[1,0,1]
  buffer_load_dwordx4 a[8:11], v1, s[20:23], s36 offen offset:2048 sc1
  v_cvt_pk_bf16_f32 v136, v136, v137
  v_cvt_pk_bf16_f32 v137, v138, v139
  v_cvt_pk_bf16_f32 v138, v140, v141
  v_cvt_pk_bf16_f32 v139, v142, v143
  ds_write_b128 v84, v[136:139] offset:6144
  ds_read_b64_tr_b16 v[192:193], v85 offset:6144
  ds_read_b64_tr_b16 v[194:195], v85 offset:6152
  buffer_load_dwordx4 a[72:75], v1, s[20:23], s37 offen offset:2048 sc1
  s_waitcnt lgkmcnt(5)
  ds_write_b64 v80, v[188:189] offset:160
  ds_write_b64 v80, v[190:191] offset:5536
  v_pk_fma_f32 v[144:145], v[144:145], v[246:247], v[246:247] op_sel:[0,0,1] op_sel_hi:[1,0,1]
  v_pk_fma_f32 v[146:147], v[146:147], v[246:247], v[246:247] op_sel:[0,0,1] op_sel_hi:[1,0,1]
  v_pk_fma_f32 v[148:149], v[148:149], v[246:247], v[246:247] op_sel:[0,0,1] op_sel_hi:[1,0,1]
  v_pk_fma_f32 v[150:151], v[150:151], v[246:247], v[246:247] op_sel:[0,0,1] op_sel_hi:[1,0,1]
  buffer_load_dwordx4 a[12:15], v1, s[20:23], s36 offen offset:3072 sc1
  v_cvt_pk_bf16_f32 v144, v144, v145
  v_cvt_pk_bf16_f32 v145, v146, v147
  v_cvt_pk_bf16_f32 v146, v148, v149
  v_cvt_pk_bf16_f32 v147, v150, v151
  ds_write_b128 v84, v[144:147] offset:7168
  ds_read_b64_tr_b16 v[196:197], v85 offset:7168
  ds_read_b64_tr_b16 v[198:199], v85 offset:7176
  buffer_load_dwordx4 a[76:79], v1, s[20:23], s37 offen offset:3072 sc1
  s_add_u32 s36, s36, 4096
  s_add_u32 s37, s37, 4096
  s_waitcnt lgkmcnt(5)
  ds_write_b64 v80, v[192:193] offset:192
  ds_write_b64 v80, v[194:195] offset:5568
  v_pk_fma_f32 v[152:153], v[152:153], v[248:249], v[248:249] op_sel:[0,0,1] op_sel_hi:[1,0,1]
  v_pk_fma_f32 v[154:155], v[154:155], v[248:249], v[248:249] op_sel:[0,0,1] op_sel_hi:[1,0,1]
  v_pk_fma_f32 v[156:157], v[156:157], v[248:249], v[248:249] op_sel:[0,0,1] op_sel_hi:[1,0,1]
  v_pk_fma_f32 v[158:159], v[158:159], v[248:249], v[248:249] op_sel:[0,0,1] op_sel_hi:[1,0,1]
  buffer_load_dwordx4 a[16:19], v1, s[20:23], s36 offen offset:0 sc1
  v_cvt_pk_bf16_f32 v152, v152, v153
  v_cvt_pk_bf16_f32 v153, v154, v155
  v_cvt_pk_bf16_f32 v154, v156, v157
  v_cvt_pk_bf16_f32 v155, v158, v159
  ds_write_b128 v84, v[152:155] offset:8192
  ds_read_b64_tr_b16 v[200:201], v85 offset:8192
  ds_read_b64_tr_b16 v[202:203], v85 offset:8200
  buffer_load_dwordx4 a[80:83], v1, s[20:23], s37 offen offset:0 sc1
  s_waitcnt lgkmcnt(5)
  ds_write_b64 v80, v[196:197] offset:224
  ds_write_b64 v80, v[198:199] offset:5600
  v_pk_fma_f32 v[160:161], v[160:161], v[250:251], v[250:251] op_sel:[0,0,1] op_sel_hi:[1,0,1]
  v_pk_fma_f32 v[162:163], v[162:163], v[250:251], v[250:251] op_sel:[0,0,1] op_sel_hi:[1,0,1]
  v_pk_fma_f32 v[164:165], v[164:165], v[250:251], v[250:251] op_sel:[0,0,1] op_sel_hi:[1,0,1]
  v_pk_fma_f32 v[166:167], v[166:167], v[250:251], v[250:251] op_sel:[0,0,1] op_sel_hi:[1,0,1]
  buffer_load_dwordx4 a[20:23], v1, s[20:23], s36 offen offset:1024 sc1
  v_cvt_pk_bf16_f32 v160, v160, v161
  v_cvt_pk_bf16_f32 v161, v162, v163
  v_cvt_pk_bf16_f32 v162, v164, v165
  v_cvt_pk_bf16_f32 v163, v166, v167
  ds_write_b128 v84, v[160:163] offset:9216
  ds_read_b64_tr_b16 v[204:205], v85 offset:9216
  ds_read_b64_tr_b16 v[206:207], v85 offset:9224
  buffer_load_dwordx4 a[84:87], v1, s[20:23], s37 offen offset:1024 sc1
  s_waitcnt lgkmcnt(5)
  ds_write_b64 v80, v[200:201] offset:256
  ds_write_b64 v80, v[202:203] offset:5632
  s_waitcnt lgkmcnt(2)
  ds_write_b64 v80, v[204:205] offset:288
  ds_write_b64 v80, v[206:207] offset:5664
  ds_read_b128 v[168:171], v81 offset:0
  ds_read_b128 v[172:175], v81 offset:16
  ds_read_b128 v[176:179], v81 offset:32
  ds_read_b128 v[180:183], v81 offset:48
  ds_read_b128 v[184:187], v81 offset:64
  ds_read_b128 v[188:191], v81 offset:80
  ds_read_b128 v[192:195], v81 offset:96
  ds_read_b128 v[196:199], v81 offset:112
  s_waitcnt lgkmcnt(4)
  ds_read_b128 v[200:203], v81 offset:5376
  ds_read_b128 v[204:207], v81 offset:5392
  ds_read_b128 v[208:211], v81 offset:5408
  ds_read_b128 v[212:215], v81 offset:5424
  ds_read_b128 v[216:219], v81 offset:5440
  ds_read_b128 v[220:223], v81 offset:5456
  ds_read_b128 v[224:227], v81 offset:5472
  ds_read_b128 v[228:231], v81 offset:5488
  v_mfma_f32_4x4x4_16b_bf16 v[88:91], a[176:177], v[168:169], 0
  v_mfma_f32_4x4x4_16b_bf16 v[92:95], a[176:177], v[170:171], 0
  v_mfma_f32_4x4x4_16b_bf16 v[96:99], a[176:177], v[172:173], 0
  v_mfma_f32_4x4x4_16b_bf16 v[100:103], a[176:177], v[174:175], 0
  v_mfma_f32_4x4x4_16b_bf16 v[104:107], a[176:177], v[176:177], 0
  v_mfma_f32_4x4x4_16b_bf16 v[108:111], a[176:177], v[178:179], 0
  v_mfma_f32_4x4x4_16b_bf16 v[112:115], a[176:177], v[180:181], 0
  v_mfma_f32_4x4x4_16b_bf16 v[116:119], a[176:177], v[182:183], 0
  buffer_load_dwordx4 a[24:27], v1, s[20:23], s36 offen offset:2048 sc1
  s_waitcnt lgkmcnt(11)
  v_mfma_f32_4x4x4_16b_bf16 v[88:91], a[178:179], v[170:171], v[88:91]
  v_mfma_f32_4x4x4_16b_bf16 v[92:95], a[178:179], v[172:173], v[92:95]
  v_mfma_f32_4x4x4_16b_bf16 v[96:99], a[178:179], v[174:175], v[96:99]
  v_mfma_f32_4x4x4_16b_bf16 v[100:103], a[178:179], v[176:177], v[100:103]
  v_mfma_f32_4x4x4_16b_bf16 v[104:107], a[178:179], v[178:179], v[104:107]
  v_mfma_f32_4x4x4_16b_bf16 v[108:111], a[178:179], v[180:181], v[108:111]
  v_mfma_f32_4x4x4_16b_bf16 v[112:115], a[178:179], v[182:183], v[112:115]
  v_mfma_f32_4x4x4_16b_bf16 v[116:119], a[178:179], v[184:185], v[116:119]
  buffer_load_dwordx4 a[88:91], v1, s[20:23], s37 offen offset:2048 sc1
  v_mfma_f32_4x4x4_16b_bf16 v[88:91], a[180:181], v[172:173], v[88:91]
  v_mfma_f32_4x4x4_16b_bf16 v[92:95], a[180:181], v[174:175], v[92:95]
  v_mfma_f32_4x4x4_16b_bf16 v[96:99], a[180:181], v[176:177], v[96:99]
  v_mfma_f32_4x4x4_16b_bf16 v[100:103], a[180:181], v[178:179], v[100:103]
  v_mfma_f32_4x4x4_16b_bf16 v[104:107], a[180:181], v[180:181], v[104:107]
  v_mfma_f32_4x4x4_16b_bf16 v[108:111], a[180:181], v[182:183], v[108:111]
  v_mfma_f32_4x4x4_16b_bf16 v[112:115], a[180:181], v[184:185], v[112:115]
  v_mfma_f32_4x4x4_16b_bf16 v[116:119], a[180:181], v[186:187], v[116:119]
  buffer_load_dwordx4 a[28:31], v1, s[20:23], s36 offen offset:3072 sc1
  s_waitcnt lgkmcnt(10)
  v_mfma_f32_4x4x4_16b_bf16 v[88:91], a[182:183], v[174:175], v[88:91]
  v_mfma_f32_4x4x4_16b_bf16 v[92:95], a[182:183], v[176:177], v[92:95]
  v_mfma_f32_4x4x4_16b_bf16 v[96:99], a[182:183], v[178:179], v[96:99]
  v_mfma_f32_4x4x4_16b_bf16 v[100:103], a[182:183], v[180:181], v[100:103]
  v_mfma_f32_4x4x4_16b_bf16 v[104:107], a[182:183], v[182:183], v[104:107]
  v_mfma_f32_4x4x4_16b_bf16 v[108:111], a[182:183], v[184:185], v[108:111]
  v_mfma_f32_4x4x4_16b_bf16 v[112:115], a[182:183], v[186:187], v[112:115]
  v_mfma_f32_4x4x4_16b_bf16 v[116:119], a[182:183], v[188:189], v[116:119]
  buffer_load_dwordx4 a[92:95], v1, s[20:23], s37 offen offset:3072 sc1
  s_add_u32 s36, s36, 4096
  s_add_u32 s37, s37, 4096
  v_mfma_f32_4x4x4_16b_bf16 v[88:91], a[184:185], v[176:177], v[88:91]
  v_mfma_f32_4x4x4_16b_bf16 v[92:95], a[184:185], v[178:179], v[92:95]
  v_mfma_f32_4x4x4_16b_bf16 v[96:99], a[184:185], v[180:181], v[96:99]
  v_mfma_f32_4x4x4_16b_bf16 v[100:103], a[184:185], v[182:183], v[100:103]
  v_mfma_f32_4x4x4_16b_bf16 v[104:107], a[184:185], v[184:185], v[104:107]
  v_mfma_f32_4x4x4_16b_bf16 v[108:111], a[184:185], v[186:187], v[108:111]
  v_mfma_f32_4x4x4_16b_bf16 v[112:115], a[184:185], v[188:189], v[112:115]
  v_mfma_f32_4x4x4_16b_bf16 v[116:119], a[184:185], v[190:191], v[116:119]
  buffer_load_dwordx4 a[32:35], v1, s[20:23], s36 offen offset:0 sc1
  s_waitcnt lgkmcnt(9)
  v_mfma_f32_4x4x4_16b_bf16 v[88:91], a[186:187], v[178:179], v[88:91]
  v_mfma_f32_4x4x4_16b_bf16 v[92:95], a[186:187], v[180:181], v[92:95]
  v_mfma_f32_4x4x4_16b_bf16 v[96:99], a[186:187], v[182:183], v[96:99]
  v_mfma_f32_4x4x4_16b_bf16 v[100:103], a[186:187], v[184:185], v[100:103]
  v_mfma_f32_4x4x4_16b_bf16 v[104:107], a[186:187], v[186:187], v[104:107]
  v_mfma_f32_4x4x4_16b_bf16 v[108:111], a[186:187], v[188:189], v[108:111]
  v_mfma_f32_4x4x4_16b_bf16 v[112:115], a[186:187], v[190:191], v[112:115]
  v_mfma_f32_4x4x4_16b_bf16 v[116:119], a[186:187], v[192:193], v[116:119]
  buffer_load_dwordx4 a[96:99], v1, s[20:23], s37 offen offset:0 sc1
  v_mfma_f32_4x4x4_16b_bf16 v[88:91], a[188:189], v[180:181], v[88:91]
  v_mfma_f32_4x4x4_16b_bf16 v[92:95], a[188:189], v[182:183], v[92:95]
  v_mfma_f32_4x4x4_16b_bf16 v[96:99], a[188:189], v[184:185], v[96:99]
  v_mfma_f32_4x4x4_16b_bf16 v[100:103], a[188:189], v[186:187], v[100:103]
  v_mfma_f32_4x4x4_16b_bf16 v[104:107], a[188:189], v[188:189], v[104:107]
  v_mfma_f32_4x4x4_16b_bf16 v[108:111], a[188:189], v[190:191], v[108:111]
  v_mfma_f32_4x4x4_16b_bf16 v[112:115], a[188:189], v[192:193], v[112:115]
  v_mfma_f32_4x4x4_16b_bf16 v[116:119], a[188:189], v[194:195], v[116:119]
  buffer_load_dwordx4 a[36:39], v1, s[20:23], s36 offen offset:1024 sc1
  s_waitcnt lgkmcnt(8)
  v_mfma_f32_4x4x4_16b_bf16 v[88:91], a[190:191], v[182:183], v[88:91]
  v_mfma_f32_4x4x4_16b_bf16 v[92:95], a[190:191], v[184:185], v[92:95]
  v_mfma_f32_4x4x4_16b_bf16 v[96:99], a[190:191], v[186:187], v[96:99]
  v_mfma_f32_4x4x4_16b_bf16 v[100:103], a[190:191], v[188:189], v[100:103]
  v_mfma_f32_4x4x4_16b_bf16 v[104:107], a[190:191], v[190:191], v[104:107]
  v_mfma_f32_4x4x4_16b_bf16 v[108:111], a[190:191], v[192:193], v[108:111]
  v_mfma_f32_4x4x4_16b_bf16 v[112:115], a[190:191], v[194:195], v[112:115]
  v_mfma_f32_4x4x4_16b_bf16 v[116:119], a[190:191], v[196:197], v[116:119]
  buffer_load_dwordx4 a[100:103], v1, s[20:23], s37 offen offset:1024 sc1
  v_mfma_f32_4x4x4_16b_bf16 v[88:91], a[192:193], v[184:185], v[88:91]
  v_mfma_f32_4x4x4_16b_bf16 v[92:95], a[192:193], v[186:187], v[92:95]
  v_mfma_f32_4x4x4_16b_bf16 v[96:99], a[192:193], v[188:189], v[96:99]
  v_mfma_f32_4x4x4_16b_bf16 v[100:103], a[192:193], v[190:191], v[100:103]
  v_mfma_f32_4x4x4_16b_bf16 v[104:107], a[192:193], v[192:193], v[104:107]
  v_mfma_f32_4x4x4_16b_bf16 v[108:111], a[192:193], v[194:195], v[108:111]
  v_mfma_f32_4x4x4_16b_bf16 v[112:115], a[192:193], v[196:197], v[112:115]
  v_mfma_f32_4x4x4_16b_bf16 v[116:119], a[192:193], v[198:199], v[116:119]
  buffer_load_dwordx4 a[40:43], v1, s[20:23], s36 offen offset:2048 sc1
  s_waitcnt lgkmcnt(4)
  v_mfma_f32_4x4x4_16b_bf16 v[120:123], a[196:197], v[200:201], 0
  v_mfma_f32_4x4x4_16b_bf16 v[124:127], a[196:197], v[202:203], 0
  v_mfma_f32_4x4x4_16b_bf16 v[128:131], a[196:197], v[204:205], 0
  v_mfma_f32_4x4x4_16b_bf16 v[132:135], a[196:197], v[206:207], 0
  v_mfma_f32_4x4x4_16b_bf16 v[136:139], a[196:197], v[208:209], 0
  v_mfma_f32_4x4x4_16b_bf16 v[140:143], a[196:197], v[210:211], 0
  v_mfma_f32_4x4x4_16b_bf16 v[144:147], a[196:197], v[212:213], 0
  v_mfma_f32_4x4x4_16b_bf16 v[148:151], a[196:197], v[214:215], 0
  buffer_load_dwordx4 a[104:107], v1, s[20:23], s37 offen offset:2048 sc1
  s_waitcnt lgkmcnt(3)
  v_mfma_f32_4x4x4_16b_bf16 v[120:123], a[198:199], v[202:203], v[120:123]
  v_cvt_pk_bf16_f32 v168, v88, v89
  v_mfma_f32_4x4x4_16b_bf16 v[124:127], a[198:199], v[204:205], v[124:127]
  v_mfma_f32_4x4x4_16b_bf16 v[128:131], a[198:199], v[206:207], v[128:131]
  v_cvt_pk_bf16_f32 v169, v90, v91
  v_mfma_f32_4x4x4_16b_bf16 v[132:135], a[198:199], v[208:209], v[132:135]
  v_mfma_f32_4x4x4_16b_bf16 v[136:139], a[198:199], v[210:211], v[136:139]
  v_cvt_pk_bf16_f32 v170, v92, v93
  v_mfma_f32_4x4x4_16b_bf16 v[140:143], a[198:199], v[212:213], v[140:143]
  v_mfma_f32_4x4x4_16b_bf16 v[144:147], a[198:199], v[214:215], v[144:147]
  v_cvt_pk_bf16_f32 v171, v94, v95
  v_mfma_f32_4x4x4_16b_bf16 v[148:151], a[198:199], v[216:217], v[148:151]
  buffer_load_dwordx4 a[44:47], v1, s[20:23], s36 offen offset:3072 sc1
  v_mfma_f32_4x4x4_16b_bf16 v[120:123], a[200:201], v[204:205], v[120:123]
  v_cvt_pk_bf16_f32 v172, v96, v97
  v_mfma_f32_4x4x4_16b_bf16 v[124:127], a[200:201], v[206:207], v[124:127]
  v_mfma_f32_4x4x4_16b_bf16 v[128:131], a[200:201], v[208:209], v[128:131]
  v_cvt_pk_bf16_f32 v173, v98, v99
  v_mfma_f32_4x4x4_16b_bf16 v[132:135], a[200:201], v[210:211], v[132:135]
  v_mfma_f32_4x4x4_16b_bf16 v[136:139], a[200:201], v[212:213], v[136:139]
  v_cvt_pk_bf16_f32 v174, v100, v101
  v_mfma_f32_4x4x4_16b_bf16 v[140:143], a[200:201], v[214:215], v[140:143]
  v_mfma_f32_4x4x4_16b_bf16 v[144:147], a[200:201], v[216:217], v[144:147]
  v_cvt_pk_bf16_f32 v175, v102, v103
  v_mfma_f32_4x4x4_16b_bf16 v[148:151], a[200:201], v[218:219], v[148:151]
  buffer_load_dwordx4 a[108:111], v1, s[20:23], s37 offen offset:3072 sc1
  s_add_u32 s36, s36, 4096
  s_add_u32 s37, s37, 4096
  s_waitcnt lgkmcnt(2)
  v_mfma_f32_4x4x4_16b_bf16 v[120:123], a[202:203], v[206:207], v[120:123]
  v_cvt_pk_bf16_f32 v176, v104, v105
  v_mfma_f32_4x4x4_16b_bf16 v[124:127], a[202:203], v[208:209], v[124:127]
  v_mfma_f32_4x4x4_16b_bf16 v[128:131], a[202:203], v[210:211], v[128:131]
  v_cvt_pk_bf16_f32 v177, v106, v107
  v_mfma_f32_4x4x4_16b_bf16 v[132:135], a[202:203], v[212:213], v[132:135]
  v_mfma_f32_4x4x4_16b_bf16 v[136:139], a[202:203], v[214:215], v[136:139]
  v_cvt_pk_bf16_f32 v178, v108, v109
  v_mfma_f32_4x4x4_16b_bf16 v[140:143], a[202:203], v[216:217], v[140:143]
  v_mfma_f32_4x4x4_16b_bf16 v[144:147], a[202:203], v[218:219], v[144:147]
  v_cvt_pk_bf16_f32 v179, v110, v111
  v_mfma_f32_4x4x4_16b_bf16 v[148:151], a[202:203], v[220:221], v[148:151]
  buffer_load_dwordx4 a[48:51], v1, s[20:23], s36 offen offset:0 sc1
  v_mfma_f32_4x4x4_16b_bf16 v[120:123], a[204:205], v[208:209], v[120:123]
  v_cvt_pk_bf16_f32 v180, v112, v113
  v_mfma_f32_4x4x4_16b_bf16 v[124:127], a[204:205], v[210:211], v[124:127]
  v_mfma_f32_4x4x4_16b_bf16 v[128:131], a[204:205], v[212:213], v[128:131]
  v_cvt_pk_bf16_f32 v181, v114, v115
  v_mfma_f32_4x4x4_16b_bf16 v[132:135], a[204:205], v[214:215], v[132:135]
  v_mfma_f32_4x4x4_16b_bf16 v[136:139], a[204:205], v[216:217], v[136:139]
  v_cvt_pk_bf16_f32 v182, v116, v117
  v_mfma_f32_4x4x4_16b_bf16 v[140:143], a[204:205], v[218:219], v[140:143]
  v_mfma_f32_4x4x4_16b_bf16 v[144:147], a[204:205], v[220:221], v[144:147]
  v_cvt_pk_bf16_f32 v183, v118, v119
  v_mfma_f32_4x4x4_16b_bf16 v[148:151], a[204:205], v[222:223], v[148:151]
  buffer_load_dwordx4 a[112:115], v1, s[20:23], s37 offen offset:0 sc1
  s_waitcnt lgkmcnt(1)
  v_mfma_f32_4x4x4_16b_bf16 v[120:123], a[206:207], v[210:211], v[120:123]
  v_mfma_f32_4x4x4_16b_bf16 v[124:127], a[206:207], v[212:213], v[124:127]
  v_mfma_f32_4x4x4_16b_bf16 v[128:131], a[206:207], v[214:215], v[128:131]
  v_mfma_f32_4x4x4_16b_bf16 v[132:135], a[206:207], v[216:217], v[132:135]
  v_mfma_f32_4x4x4_16b_bf16 v[136:139], a[206:207], v[218:219], v[136:139]
  v_mfma_f32_4x4x4_16b_bf16 v[140:143], a[206:207], v[220:221], v[140:143]
  v_mfma_f32_4x4x4_16b_bf16 v[144:147], a[206:207], v[222:223], v[144:147]
  v_mfma_f32_4x4x4_16b_bf16 v[148:151], a[206:207], v[224:225], v[148:151]
  buffer_load_dwordx4 a[52:55], v1, s[20:23], s36 offen offset:1024 sc1
  ds_write_b128 v81, v[168:171] offset:0
  ds_write_b128 v81, v[172:175] offset:16
  ds_write_b128 v81, v[176:179] offset:32
  ds_write_b128 v81, v[180:183] offset:48
  v_mfma_f32_4x4x4_16b_bf16 v[120:123], a[208:209], v[212:213], v[120:123]
  v_mfma_f32_4x4x4_16b_bf16 v[124:127], a[208:209], v[214:215], v[124:127]
  v_mfma_f32_4x4x4_16b_bf16 v[128:131], a[208:209], v[216:217], v[128:131]
  v_mfma_f32_4x4x4_16b_bf16 v[132:135], a[208:209], v[218:219], v[132:135]
  v_mfma_f32_4x4x4_16b_bf16 v[136:139], a[208:209], v[220:221], v[136:139]
  v_mfma_f32_4x4x4_16b_bf16 v[140:143], a[208:209], v[222:223], v[140:143]
  v_mfma_f32_4x4x4_16b_bf16 v[144:147], a[208:209], v[224:225], v[144:147]
  v_mfma_f32_4x4x4_16b_bf16 v[148:151], a[208:209], v[226:227], v[148:151]
  buffer_load_dwordx4 a[116:119], v1, s[20:23], s37 offen offset:1024 sc1
  s_waitcnt lgkmcnt(4)
  v_mfma_f32_4x4x4_16b_bf16 v[120:123], a[210:211], v[214:215], v[120:123]
  v_mfma_f32_4x4x4_16b_bf16 v[124:127], a[210:211], v[216:217], v[124:127]
  v_mfma_f32_4x4x4_16b_bf16 v[128:131], a[210:211], v[218:219], v[128:131]
  v_mfma_f32_4x4x4_16b_bf16 v[132:135], a[210:211], v[220:221], v[132:135]
  v_mfma_f32_4x4x4_16b_bf16 v[136:139], a[210:211], v[222:223], v[136:139]
  v_mfma_f32_4x4x4_16b_bf16 v[140:143], a[210:211], v[224:225], v[140:143]
  v_mfma_f32_4x4x4_16b_bf16 v[144:147], a[210:211], v[226:227], v[144:147]
  v_mfma_f32_4x4x4_16b_bf16 v[148:151], a[210:211], v[228:229], v[148:151]
  buffer_load_dwordx4 a[56:59], v1, s[20:23], s36 offen offset:2048 sc1
  v_mfma_f32_4x4x4_16b_bf16 v[120:123], a[212:213], v[216:217], v[120:123]
  v_mfma_f32_4x4x4_16b_bf16 v[124:127], a[212:213], v[218:219], v[124:127]
  v_mfma_f32_4x4x4_16b_bf16 v[128:131], a[212:213], v[220:221], v[128:131]
  v_mfma_f32_4x4x4_16b_bf16 v[132:135], a[212:213], v[222:223], v[132:135]
  v_mfma_f32_4x4x4_16b_bf16 v[136:139], a[212:213], v[224:225], v[136:139]
  v_mfma_f32_4x4x4_16b_bf16 v[140:143], a[212:213], v[226:227], v[140:143]
  v_mfma_f32_4x4x4_16b_bf16 v[144:147], a[212:213], v[228:229], v[144:147]
  v_mfma_f32_4x4x4_16b_bf16 v[148:151], a[212:213], v[230:231], v[148:151]
  buffer_load_dwordx4 a[120:123], v1, s[20:23], s37 offen offset:2048 sc1
  v_cvt_pk_bf16_f32 v200, v120, v121
  v_cvt_pk_bf16_f32 v201, v122, v123
  v_cvt_pk_bf16_f32 v202, v124, v125
  v_cvt_pk_bf16_f32 v203, v126, v127
  v_cvt_pk_bf16_f32 v204, v128, v129
  v_cvt_pk_bf16_f32 v205, v130, v131
  v_cvt_pk_bf16_f32 v206, v132, v133
  v_cvt_pk_bf16_f32 v207, v134, v135
  v_cvt_pk_bf16_f32 v208, v136, v137
  v_cvt_pk_bf16_f32 v209, v138, v139
  v_cvt_pk_bf16_f32 v210, v140, v141
  v_cvt_pk_bf16_f32 v211, v142, v143
  v_cvt_pk_bf16_f32 v212, v144, v145
  v_cvt_pk_bf16_f32 v213, v146, v147
  v_cvt_pk_bf16_f32 v214, v148, v149
  v_cvt_pk_bf16_f32 v215, v150, v151
  ds_write_b128 v81, v[200:203] offset:5376
  ds_write_b128 v81, v[204:207] offset:5392
  ds_write_b128 v81, v[208:211] offset:5408
  ds_write_b128 v81, v[212:215] offset:5424
  ds_read_b64_tr_b16 v[48:49], v82 offset:0
  ds_read_b64_tr_b16 v[50:51], v82 offset:5376
  ds_read_b64_tr_b16 v[52:53], v82 offset:32
  ds_read_b64_tr_b16 v[54:55], v82 offset:5408
  ds_read_b64_tr_b16 v[56:57], v82 offset:64
  ds_read_b64_tr_b16 v[58:59], v82 offset:5440
  ds_read_b64_tr_b16 v[60:61], v82 offset:96
  ds_read_b64_tr_b16 v[62:63], v82 offset:5472
  s_waitcnt lgkmcnt(4)
  ds_read_b64_tr_b16 v[64:65], v82 offset:128
  ds_read_b64_tr_b16 v[66:67], v82 offset:5504
  ds_read_b64_tr_b16 v[68:69], v82 offset:160
  ds_read_b64_tr_b16 v[70:71], v82 offset:5536
  ds_read_b64_tr_b16 v[72:73], v82 offset:192
  ds_read_b64_tr_b16 v[74:75], v82 offset:5568
  ds_read_b64_tr_b16 v[76:77], v82 offset:224
  ds_read_b64_tr_b16 v[78:79], v82 offset:5600
  s_add_u32 s41, s48, 8519680
  buffer_load_dwordx4 a[60:63], v1, s[20:23], s36 offen offset:3072 sc1
  buffer_load_dwordx4 a[124:127], v1, s[20:23], s37 offen offset:3072 sc1
  s_add_u32 s36, s36, 4096
  s_add_u32 s37, s37, 4096
  v_lshlrev_b32 v88, 16, v48
  v_and_b32 v89, s49, v48
  v_lshlrev_b32 v96, 16, v16
  v_and_b32 v97, s49, v16
  v_lshlrev_b32 v90, 16, v49
  v_and_b32 v91, s49, v49
  v_lshlrev_b32 v98, 16, v17
  v_and_b32 v99, s49, v17
  v_lshlrev_b32 v92, 16, v50
  v_and_b32 v93, s49, v50
  v_lshlrev_b32 v100, 16, v18
  v_and_b32 v101, s49, v18
  v_lshlrev_b32 v94, 16, v51
  v_and_b32 v95, s49, v51
  v_lshlrev_b32 v102, 16, v19
  v_and_b32 v103, s49, v19
  v_pk_mul_f32 v[88:89], v[88:89], v[96:97]
  v_pk_mul_f32 v[90:91], v[90:91], v[98:99]
  v_pk_mul_f32 v[92:93], v[92:93], v[100:101]
  v_pk_mul_f32 v[94:95], v[94:95], v[102:103]
  v_cvt_pk_bf16_f32 v128, v88, v89
  v_cvt_pk_bf16_f32 v129, v90, v91
  v_cvt_pk_bf16_f32 v130, v92, v93
  v_cvt_pk_bf16_f32 v131, v94, v95
  s_mov_b32 m0, s47
  s_nop 0
  buffer_load_dwordx4 v2, s[20:23], s46 offen offset:0 sc1 lds
  buffer_load_dwordx4 v2, s[20:23], s46 offen offset:1024 sc1 lds
  v_lshlrev_b32 v104, 16, v52
  v_and_b32 v105, s49, v52
  v_lshlrev_b32 v112, 16, v20
  v_and_b32 v113, s49, v20
  v_lshlrev_b32 v106, 16, v53
  v_and_b32 v107, s49, v53
  v_lshlrev_b32 v114, 16, v21
  v_and_b32 v115, s49, v21
  v_lshlrev_b32 v108, 16, v54
  v_and_b32 v109, s49, v54
  v_lshlrev_b32 v116, 16, v22
  v_and_b32 v117, s49, v22
  v_lshlrev_b32 v110, 16, v55
  v_and_b32 v111, s49, v55
  v_lshlrev_b32 v118, 16, v23
  v_and_b32 v119, s49, v23
  v_pk_mul_f32 v[104:105], v[104:105], v[112:113]
  v_pk_mul_f32 v[106:107], v[106:107], v[114:115]
  v_pk_mul_f32 v[108:109], v[108:109], v[116:117]
  v_pk_mul_f32 v[110:111], v[110:111], v[118:119]
  v_cvt_pk_bf16_f32 v132, v104, v105
  v_cvt_pk_bf16_f32 v133, v106, v107
  v_cvt_pk_bf16_f32 v134, v108, v109
  v_cvt_pk_bf16_f32 v135, v110, v111
  s_waitcnt lgkmcnt(10)
  buffer_load_dwordx4 v2, s[20:23], s46 offen offset:2048 sc1 lds
  buffer_load_dwordx4 v2, s[20:23], s46 offen offset:3072 sc1 lds
  v_lshlrev_b32 v88, 16, v56
  v_and_b32 v89, s49, v56
  v_lshlrev_b32 v96, 16, v24
  v_and_b32 v97, s49, v24
  v_lshlrev_b32 v90, 16, v57
  v_and_b32 v91, s49, v57
  v_lshlrev_b32 v98, 16, v25
  v_and_b32 v99, s49, v25
  v_lshlrev_b32 v92, 16, v58
  v_and_b32 v93, s49, v58
  v_lshlrev_b32 v100, 16, v26
  v_and_b32 v101, s49, v26
  v_lshlrev_b32 v94, 16, v59
  v_and_b32 v95, s49, v59
  v_lshlrev_b32 v102, 16, v27
  v_and_b32 v103, s49, v27
  v_pk_mul_f32 v[88:89], v[88:89], v[96:97]
  v_pk_mul_f32 v[90:91], v[90:91], v[98:99]
  v_pk_mul_f32 v[92:93], v[92:93], v[100:101]
  v_pk_mul_f32 v[94:95], v[94:95], v[102:103]
  v_cvt_pk_bf16_f32 v136, v88, v89
  v_cvt_pk_bf16_f32 v137, v90, v91
  v_cvt_pk_bf16_f32 v138, v92, v93
  v_cvt_pk_bf16_f32 v139, v94, v95
  s_waitcnt lgkmcnt(8)
  s_add_u32 m0, s47, 16384
  s_nop 0
  buffer_load_dwordx4 v3, s[20:23], s46 offen offset:0 sc1 lds
  buffer_load_dwordx4 v3, s[20:23], s46 offen offset:1024 sc1 lds
  v_lshlrev_b32 v104, 16, v60
  v_and_b32 v105, s49, v60
  v_lshlrev_b32 v112, 16, v28
  v_and_b32 v113, s49, v28
  v_lshlrev_b32 v106, 16, v61
  v_and_b32 v107, s49, v61
  v_lshlrev_b32 v114, 16, v29
  v_and_b32 v115, s49, v29
  v_lshlrev_b32 v108, 16, v62
  v_and_b32 v109, s49, v62
  v_lshlrev_b32 v116, 16, v30
  v_and_b32 v117, s49, v30
  v_lshlrev_b32 v110, 16, v63
  v_and_b32 v111, s49, v63
  v_lshlrev_b32 v118, 16, v31
  v_and_b32 v119, s49, v31
  v_pk_mul_f32 v[104:105], v[104:105], v[112:113]
  v_pk_mul_f32 v[106:107], v[106:107], v[114:115]
  v_pk_mul_f32 v[108:109], v[108:109], v[116:117]
  v_pk_mul_f32 v[110:111], v[110:111], v[118:119]
  v_cvt_pk_bf16_f32 v140, v104, v105
  v_cvt_pk_bf16_f32 v141, v106, v107
  v_cvt_pk_bf16_f32 v142, v108, v109
  v_cvt_pk_bf16_f32 v143, v110, v111
  s_waitcnt lgkmcnt(6)
  buffer_load_dwordx4 v3, s[20:23], s46 offen offset:2048 sc1 lds
  buffer_load_dwordx4 v3, s[20:23], s46 offen offset:3072 sc1 lds
  s_add_u32 s46, s46, 32768
  s_add_u32 s47, s47, 32768
  s_and_b32 s47, s47, 0x1ffff
  v_lshlrev_b32 v88, 16, v64
  v_and_b32 v89, s49, v64
  v_lshlrev_b32 v96, 16, v32
  v_and_b32 v97, s49, v32
  v_lshlrev_b32 v90, 16, v65
  v_and_b32 v91, s49, v65
  v_lshlrev_b32 v98, 16, v33
  v_and_b32 v99, s49, v33
  v_lshlrev_b32 v92, 16, v66
  v_and_b32 v93, s49, v66
  v_lshlrev_b32 v100, 16, v34
  v_and_b32 v101, s49, v34
  v_lshlrev_b32 v94, 16, v67
  v_and_b32 v95, s49, v67
  v_lshlrev_b32 v102, 16, v35
  v_and_b32 v103, s49, v35
  v_pk_mul_f32 v[88:89], v[88:89], v[96:97]
  v_pk_mul_f32 v[90:91], v[90:91], v[98:99]
  v_pk_mul_f32 v[92:93], v[92:93], v[100:101]
  v_pk_mul_f32 v[94:95], v[94:95], v[102:103]
  v_cvt_pk_bf16_f32 v144, v88, v89
  v_cvt_pk_bf16_f32 v145, v90, v91
  v_cvt_pk_bf16_f32 v146, v92, v93
  v_cvt_pk_bf16_f32 v147, v94, v95
  s_waitcnt lgkmcnt(4)
  v_lshlrev_b32 v104, 16, v68
  v_and_b32 v105, s49, v68
  v_lshlrev_b32 v112, 16, v36
  v_and_b32 v113, s49, v36
  v_lshlrev_b32 v106, 16, v69
  v_and_b32 v107, s49, v69
  v_lshlrev_b32 v114, 16, v37
  v_and_b32 v115, s49, v37
  v_lshlrev_b32 v108, 16, v70
  v_and_b32 v109, s49, v70
  v_lshlrev_b32 v116, 16, v38
  v_and_b32 v117, s49, v38
  v_lshlrev_b32 v110, 16, v71
  v_and_b32 v111, s49, v71
  v_lshlrev_b32 v118, 16, v39
  v_and_b32 v119, s49, v39
  v_pk_mul_f32 v[104:105], v[104:105], v[112:113]
  v_pk_mul_f32 v[106:107], v[106:107], v[114:115]
  v_pk_mul_f32 v[108:109], v[108:109], v[116:117]
  v_pk_mul_f32 v[110:111], v[110:111], v[118:119]
  v_cvt_pk_bf16_f32 v148, v104, v105
  v_cvt_pk_bf16_f32 v149, v106, v107
  v_cvt_pk_bf16_f32 v150, v108, v109
  v_cvt_pk_bf16_f32 v151, v110, v111
  s_waitcnt lgkmcnt(2)
  v_lshlrev_b32 v88, 16, v72
  v_and_b32 v89, s49, v72
  v_lshlrev_b32 v96, 16, v40
  v_and_b32 v97, s49, v40
  v_lshlrev_b32 v90, 16, v73
  v_and_b32 v91, s49, v73
  v_lshlrev_b32 v98, 16, v41
  v_and_b32 v99, s49, v41
  v_lshlrev_b32 v92, 16, v74
  v_and_b32 v93, s49, v74
  v_lshlrev_b32 v100, 16, v42
  v_and_b32 v101, s49, v42
  v_lshlrev_b32 v94, 16, v75
  v_and_b32 v95, s49, v75
  v_lshlrev_b32 v102, 16, v43
  v_and_b32 v103, s49, v43
  v_pk_mul_f32 v[88:89], v[88:89], v[96:97]
  v_pk_mul_f32 v[90:91], v[90:91], v[98:99]
  v_pk_mul_f32 v[92:93], v[92:93], v[100:101]
  v_pk_mul_f32 v[94:95], v[94:95], v[102:103]
  v_cvt_pk_bf16_f32 v152, v88, v89
  v_cvt_pk_bf16_f32 v153, v90, v91
  v_cvt_pk_bf16_f32 v154, v92, v93
  v_cvt_pk_bf16_f32 v155, v94, v95
  s_waitcnt lgkmcnt(0)
  v_lshlrev_b32 v104, 16, v76
  v_and_b32 v105, s49, v76
  v_lshlrev_b32 v112, 16, v44
  v_and_b32 v113, s49, v44
  v_lshlrev_b32 v106, 16, v77
  v_and_b32 v107, s49, v77
  v_lshlrev_b32 v114, 16, v45
  v_and_b32 v115, s49, v45
  v_lshlrev_b32 v108, 16, v78
  v_and_b32 v109, s49, v78
  v_lshlrev_b32 v116, 16, v46
  v_and_b32 v117, s49, v46
  v_lshlrev_b32 v110, 16, v79
  v_and_b32 v111, s49, v79
  v_lshlrev_b32 v118, 16, v47
  v_and_b32 v119, s49, v47
  v_pk_mul_f32 v[104:105], v[104:105], v[112:113]
  v_pk_mul_f32 v[106:107], v[106:107], v[114:115]
  v_pk_mul_f32 v[108:109], v[108:109], v[116:117]
  v_pk_mul_f32 v[110:111], v[110:111], v[118:119]
  v_cvt_pk_bf16_f32 v156, v104, v105
  v_cvt_pk_bf16_f32 v157, v106, v107
  v_cvt_pk_bf16_f32 v158, v108, v109
  v_cvt_pk_bf16_f32 v159, v110, v111
  v_mov_b32 v124, 0
  s_lshl_b32 s33, s3, 8
  s_add_u32 s33, s33, 162816
  v_lshlrev_b32 v125, 2, v0
  v_add_u32 v125, s33, v125
  v_and_b32 v126, 3, v0
  v_lshlrev_b32 v126, 8, v126
  v_add_u32 v126, 162816, v126
  ds_write_b32 v125, v124
  s_waitcnt vmcnt(40)
  s_waitcnt lgkmcnt(0)
  s_barrier
  ds_read_b128 v[68:71], v4 offset:0
  ds_read_b128 v[72:75], v4 offset:16384
  ds_read_b128 v[76:79], v4 offset:1024
  ds_read_b128 v[80:83], v4 offset:17408
  ds_read_b128 v[84:87], v4 offset:2048
  ds_read_b128 v[88:91], v4 offset:18432
  ds_read_b128 v[92:95], v4 offset:3072
  ds_read_b128 v[96:99], v4 offset:19456
  v_mov_b32 v120, s4
  s_lshr_b32 s26, s2, 3
  s_lshl_b32 s26, s26, 7
  s_and_b32 s5, s2, 7
  s_lshl_b32 s5, s5, 2
  s_add_u32 s26, s26, s5
  s_add_u32 s26, s26, 90378240
  s_cmp_eq_u32 s3, 0
  s_cselect_b32 s26, s26, 2130706432
  s_mov_b64 exec, 1
  buffer_store_dword v120, off, s[20:23], s26 sc1
  s_mov_b64 exec, -1
  s_waitcnt vmcnt(39) lgkmcnt(6)
  v_mfma_f32_16x16x32_bf16 v[36:39], v[68:71], a[0:3], 0
  s_cmp_eq_u32 s30, 0
  s_addc_u32 s44, 31, 0
  v_mfma_f32_16x16x32_bf16 v[40:43], v[68:71], a[64:67], 0
  ds_read_b128 v[68:71], v5 offset:4096
  v_mfma_f32_16x16x32_bf16 v[44:47], v[72:75], a[0:3], 0
  s_mov_b32 m0, s47
  s_nop 0
  buffer_load_dwordx4 v2, s[20:23], s46 offen offset:0 sc1 lds
  v_mfma_f32_16x16x32_bf16 v[48:51], v[72:75], a[64:67], 0
  ds_read_b128 v[72:75], v5 offset:20480
  s_waitcnt vmcnt(38) lgkmcnt(6)
  v_mfma_f32_16x16x32_bf16 v[36:39], v[76:79], a[4:7], v[36:39]
  s_mov_b32 s45, 0x4e800000
  v_lshrrev_b32 v12, 2, v0
  v_mfma_f32_16x16x32_bf16 v[40:43], v[76:79], a[68:71], v[40:43]
  ds_read_b128 v[76:79], v5 offset:5120
  v_mfma_f32_16x16x32_bf16 v[44:47], v[80:83], a[4:7], v[44:47]
  buffer_load_dwordx4 v2, s[20:23], s46 offen offset:1024 sc1 lds
  v_mfma_f32_16x16x32_bf16 v[48:51], v[80:83], a[68:71], v[48:51]
  ds_read_b128 v[80:83], v5 offset:21504
  s_waitcnt vmcnt(37) lgkmcnt(6)
  v_mfma_f32_16x16x32_bf16 v[36:39], v[84:87], a[8:11], v[36:39]
  v_bfe_u32 v13, v0, 1, 1
  v_lshlrev_b32 v14, 3, v13
  v_mfma_f32_16x16x32_bf16 v[40:43], v[84:87], a[72:75], v[40:43]
  ds_read_b128 v[84:87], v5 offset:6144
  v_mfma_f32_16x16x32_bf16 v[44:47], v[88:91], a[8:11], v[44:47]
  buffer_load_dwordx4 v2, s[20:23], s46 offen offset:2048 sc1 lds
  v_mfma_f32_16x16x32_bf16 v[48:51], v[88:91], a[72:75], v[48:51]
  ds_read_b128 v[88:91], v5 offset:22528
  s_waitcnt vmcnt(36) lgkmcnt(6)
  v_mfma_f32_16x16x32_bf16 v[36:39], v[92:95], a[12:15], v[36:39]
  v_xor_b32 v12, v12, v14
  v_lshlrev_b32 v12, 4, v12
  v_mfma_f32_16x16x32_bf16 v[40:43], v[92:95], a[76:79], v[40:43]
  ds_read_b128 v[92:95], v5 offset:7168
  v_mfma_f32_16x16x32_bf16 v[44:47], v[96:99], a[12:15], v[44:47]
  buffer_load_dwordx4 v2, s[20:23], s46 offen offset:3072 sc1 lds
  v_mfma_f32_16x16x32_bf16 v[48:51], v[96:99], a[76:79], v[48:51]
  ds_read_b128 v[96:99], v5 offset:23552
  s_waitcnt vmcnt(35) lgkmcnt(6)
  v_mfma_f32_16x16x32_bf16 v[36:39], v[68:71], a[16:19], v[36:39]
  v_lshl_add_u32 v12, v13, 12, v12
  v_and_b32 v13, 1, v0
  v_mfma_f32_16x16x32_bf16 v[40:43], v[68:71], a[80:83], v[40:43]
  ds_read_b128 v[68:71], v4 offset:8192
  v_mfma_f32_16x16x32_bf16 v[44:47], v[72:75], a[16:19], v[44:47]
  s_add_u32 m0, s47, 16384
  s_nop 0
  buffer_load_dwordx4 v3, s[20:23], s46 offen offset:0 sc1 lds
  v_mfma_f32_16x16x32_bf16 v[48:51], v[72:75], a[80:83], v[48:51]
  ds_read_b128 v[72:75], v4 offset:24576
  s_waitcnt vmcnt(34) lgkmcnt(6)
  v_mfma_f32_16x16x32_bf16 v[36:39], v[76:79], a[20:23], v[36:39]
  v_lshl_add_u32 v6, v13, 3, v12
  v_xor_b32 v6, 0x10000, v6
  v_mfma_f32_16x16x32_bf16 v[40:43], v[76:79], a[84:87], v[40:43]
  ds_read_b128 v[76:79], v4 offset:9216
  v_mfma_f32_16x16x32_bf16 v[44:47], v[80:83], a[20:23], v[44:47]
  buffer_load_dwordx4 v3, s[20:23], s46 offen offset:1024 sc1 lds
  v_mfma_f32_16x16x32_bf16 v[48:51], v[80:83], a[84:87], v[48:51]
  ds_read_b128 v[80:83], v4 offset:25600
  s_waitcnt vmcnt(33) lgkmcnt(6)
  v_mfma_f32_16x16x32_bf16 v[36:39], v[84:87], a[24:27], v[36:39]
  v_mov_b32 v7, 0
  v_mov_b32 v8, 0
  v_mfma_f32_16x16x32_bf16 v[40:43], v[84:87], a[88:91], v[40:43]
  ds_read_b128 v[84:87], v4 offset:10240
  v_mfma_f32_16x16x32_bf16 v[44:47], v[88:91], a[24:27], v[44:47]
  buffer_load_dwordx4 v3, s[20:23], s46 offen offset:2048 sc1 lds
  v_mfma_f32_16x16x32_bf16 v[48:51], v[88:91], a[88:91], v[48:51]
  ds_read_b128 v[88:91], v4 offset:26624
  s_waitcnt vmcnt(32) lgkmcnt(6)
  v_mfma_f32_16x16x32_bf16 v[36:39], v[92:95], a[28:31], v[36:39]
  s_lshl_b32 s60, s31, 15
  s_add_u32 s60, s60, 86245376
  v_mfma_f32_16x16x32_bf16 v[40:43], v[92:95], a[92:95], v[40:43]
  ds_read_b128 v[92:95], v4 offset:11264
  v_mfma_f32_16x16x32_bf16 v[44:47], v[96:99], a[28:31], v[44:47]
  buffer_store_dwordx4 v[128:131], v1, s[20:23], s41 offen sc1
  s_add_u32 s41, s41, 16384
  v_mfma_f32_16x16x32_bf16 v[48:51], v[96:99], a[92:95], v[48:51]
  ds_read_b128 v[96:99], v4 offset:27648
  s_waitcnt vmcnt(31) lgkmcnt(6)
  v_mfma_f32_16x16x32_bf16 v[36:39], v[68:71], a[32:35], v[36:39]
  s_add_u32 s61, s60, 16384
  v_mov_b32 v117, v1
  v_mfma_f32_16x16x32_bf16 v[40:43], v[68:71], a[96:99], v[40:43]
  ds_read_b128 v[68:71], v5 offset:12288
  v_mfma_f32_16x16x32_bf16 v[44:47], v[72:75], a[32:35], v[44:47]
  buffer_store_dwordx4 v[132:135], v1, s[20:23], s41 offen sc1
  s_add_u32 s41, s41, 16384
  v_mfma_f32_16x16x32_bf16 v[48:51], v[72:75], a[96:99], v[48:51]
  ds_read_b128 v[72:75], v5 offset:28672
  s_waitcnt vmcnt(30) lgkmcnt(6)
  v_mfma_f32_16x16x32_bf16 v[36:39], v[76:79], a[36:39], v[36:39]
  v_mfma_f32_16x16x32_bf16 v[40:43], v[76:79], a[100:103], v[40:43]
  ds_read_b128 v[76:79], v5 offset:13312
  v_mfma_f32_16x16x32_bf16 v[44:47], v[80:83], a[36:39], v[44:47]
  buffer_store_dwordx4 v[136:139], v1, s[20:23], s41 offen sc1
  s_add_u32 s41, s41, 16384
  v_mfma_f32_16x16x32_bf16 v[48:51], v[80:83], a[100:103], v[48:51]
  ds_read_b128 v[80:83], v5 offset:29696
  s_waitcnt vmcnt(29) lgkmcnt(6)
  v_mfma_f32_16x16x32_bf16 v[36:39], v[84:87], a[40:43], v[36:39]
  v_mfma_f32_16x16x32_bf16 v[40:43], v[84:87], a[104:107], v[40:43]
  ds_read_b128 v[84:87], v5 offset:14336
  v_mfma_f32_16x16x32_bf16 v[44:47], v[88:91], a[40:43], v[44:47]
  buffer_store_dwordx4 v[140:143], v1, s[20:23], s41 offen sc1
  s_add_u32 s41, s41, 16384
  v_mfma_f32_16x16x32_bf16 v[48:51], v[88:91], a[104:107], v[48:51]
  ds_read_b128 v[88:91], v5 offset:30720
  s_waitcnt vmcnt(28) lgkmcnt(6)
  v_mfma_f32_16x16x32_bf16 v[36:39], v[92:95], a[44:47], v[36:39]
  v_mfma_f32_16x16x32_bf16 v[40:43], v[92:95], a[108:111], v[40:43]
  ds_read_b128 v[92:95], v5 offset:15360
  v_mfma_f32_16x16x32_bf16 v[44:47], v[96:99], a[44:47], v[44:47]
  buffer_store_dwordx4 v[144:147], v1, s[20:23], s41 offen sc1
  s_add_u32 s41, s41, 16384
  v_mfma_f32_16x16x32_bf16 v[48:51], v[96:99], a[108:111], v[48:51]
  ds_read_b128 v[96:99], v5 offset:31744
  s_waitcnt vmcnt(27) lgkmcnt(6)
  v_mfma_f32_16x16x32_bf16 v[36:39], v[68:71], a[48:51], v[36:39]
  v_mfma_f32_16x16x32_bf16 v[40:43], v[68:71], a[112:115], v[40:43]
  s_waitcnt vmcnt(13)
  s_barrier
  ds_read_b128 v[68:71], v4 offset:32768
  v_mfma_f32_16x16x32_bf16 v[44:47], v[72:75], a[48:51], v[44:47]
  buffer_store_dwordx4 v[148:151], v1, s[20:23], s41 offen sc1
  s_add_u32 s41, s41, 16384
  v_mfma_f32_16x16x32_bf16 v[48:51], v[72:75], a[112:115], v[48:51]
  ds_read_b128 v[72:75], v4 offset:49152
  s_waitcnt lgkmcnt(6)
  v_mfma_f32_16x16x32_bf16 v[36:39], v[76:79], a[52:55], v[36:39]
  v_mfma_f32_16x16x32_bf16 v[40:43], v[76:79], a[116:119], v[40:43]
  ds_read_b128 v[76:79], v4 offset:33792
  v_mfma_f32_16x16x32_bf16 v[44:47], v[80:83], a[52:55], v[44:47]
  buffer_store_dwordx4 v[152:155], v1, s[20:23], s41 offen sc1
  s_add_u32 s41, s41, 16384
  v_mfma_f32_16x16x32_bf16 v[48:51], v[80:83], a[116:119], v[48:51]
  ds_read_b128 v[80:83], v4 offset:50176
  s_waitcnt lgkmcnt(6)
  v_mfma_f32_16x16x32_bf16 v[36:39], v[84:87], a[56:59], v[36:39]
  v_mfma_f32_16x16x32_bf16 v[40:43], v[84:87], a[120:123], v[40:43]
  ds_read_b128 v[84:87], v4 offset:34816
  v_mfma_f32_16x16x32_bf16 v[44:47], v[88:91], a[56:59], v[44:47]
  buffer_store_dwordx4 v[156:159], v1, s[20:23], s41 offen sc1
  s_add_u32 s41, s41, 16384
  v_mfma_f32_16x16x32_bf16 v[48:51], v[88:91], a[120:123], v[48:51]
  ds_read_b128 v[88:91], v4 offset:51200
  s_waitcnt lgkmcnt(6)
  v_mfma_f32_16x16x32_bf16 v[36:39], v[92:95], a[60:63], v[36:39]
  v_mfma_f32_16x16x32_bf16 v[40:43], v[92:95], a[124:127], v[40:43]
  ds_read_b128 v[92:95], v4 offset:35840
  v_mfma_f32_16x16x32_bf16 v[44:47], v[96:99], a[60:63], v[44:47]
  v_mfma_f32_16x16x32_bf16 v[48:51], v[96:99], a[124:127], v[48:51]
  ds_read_b128 v[96:99], v4 offset:52224
  s_nop 2
  v_max3_f32 v12, v36, v37, v38
  s_nop 1
  v_max3_f32 v12, v12, v39, v44
  v_max3_f32 v12, v12, v45, v46
  v_max_f32 v12, v12, v47
  v_mov_b32 v14, v12
  s_nop 1
  v_permlane16_swap_b32 v12, v14
  v_max_f32 v12, v12, v14
  v_mov_b32 v14, v12
  s_nop 1
  v_permlane32_swap_b32 v12, v14
  v_max_f32 v12, v12, v14
  v_sub_f32 v36, v36, v12
  v_sub_f32 v37, v37, v12
  v_sub_f32 v38, v38, v12
  v_sub_f32 v39, v39, v12
  v_sub_f32 v44, v44, v12
  v_sub_f32 v45, v45, v12
  v_sub_f32 v46, v46, v12
  v_sub_f32 v47, v47, v12
  v_sub_f32 v20, 0, v12
  v_sub_f32 v21, 0, v12
  v_sub_f32 v22, 0, v12
  v_sub_f32 v23, 0, v12
  v_max3_f32 v13, v40, v41, v42
  v_max3_f32 v13, v13, v43, v48
  v_max3_f32 v13, v13, v49, v50
  v_max_f32 v13, v13, v51
  v_mov_b32 v14, v13
  s_nop 1
  v_permlane16_swap_b32 v13, v14
  v_max_f32 v13, v13, v14
  v_mov_b32 v14, v13
  s_nop 1
  v_permlane32_swap_b32 v13, v14
  v_max_f32 v13, v13, v14
  v_sub_f32 v40, v40, v13
  v_sub_f32 v41, v41, v13
  v_sub_f32 v42, v42, v13
  v_sub_f32 v43, v43, v13
  v_sub_f32 v48, v48, v13
  v_sub_f32 v49, v49, v13
  v_sub_f32 v50, v50, v13
  v_sub_f32 v51, v51, v13
  v_sub_f32 v24, 0, v13
  v_sub_f32 v25, 0, v13
  v_sub_f32 v26, 0, v13
  v_sub_f32 v27, 0, v13
  s_waitcnt lgkmcnt(6)
  v_mfma_f32_16x16x32_bf16 v[52:55], v[68:71], a[0:3], v[20:23]
  buffer_load_dwordx4 v3, s[20:23], s46 offen offset:3072 sc1 lds
  s_add_u32 s46, s46, 32768
  v_mfma_f32_16x16x32_bf16 v[56:59], v[68:71], a[64:67], v[24:27]
  ds_read_b128 v[68:71], v5 offset:36864
  v_xor_b32 v6, 0x10000, v6
  v_mfma_f32_16x16x32_bf16 v[60:63], v[72:75], a[0:3], v[20:23]
  v_exp_f32 v12, v36
  v_mfma_f32_16x16x32_bf16 v[64:67], v[72:75], a[64:67], v[24:27]
  ds_read_b128 v[72:75], v5 offset:53248
  s_waitcnt lgkmcnt(6)
  v_mfma_f32_16x16x32_bf16 v[52:55], v[76:79], a[4:7], v[52:55]
  v_exp_f32 v13, v37
  v_mfma_f32_16x16x32_bf16 v[56:59], v[76:79], a[68:71], v[56:59]
  ds_read_b128 v[76:79], v5 offset:37888
  v_mfma_f32_16x16x32_bf16 v[60:63], v[80:83], a[4:7], v[60:63]
  v_exp_f32 v14, v38
  v_mfma_f32_16x16x32_bf16 v[64:67], v[80:83], a[68:71], v[64:67]
  ds_read_b128 v[80:83], v5 offset:54272
  s_waitcnt lgkmcnt(6)
  v_mfma_f32_16x16x32_bf16 v[52:55], v[84:87], a[8:11], v[52:55]
  v_exp_f32 v15, v39
  v_mfma_f32_16x16x32_bf16 v[56:59], v[84:87], a[72:75], v[56:59]
  ds_read_b128 v[84:87], v5 offset:38912
  v_add_f32 v9, v12, v13
  v_mfma_f32_16x16x32_bf16 v[60:63], v[88:91], a[8:11], v[60:63]
  v_exp_f32 v16, v44
  v_mfma_f32_16x16x32_bf16 v[64:67], v[88:91], a[72:75], v[64:67]
  ds_read_b128 v[88:91], v5 offset:55296
  s_waitcnt lgkmcnt(6)
  v_mfma_f32_16x16x32_bf16 v[52:55], v[92:95], a[12:15], v[52:55]
  v_exp_f32 v17, v45
  v_mfma_f32_16x16x32_bf16 v[56:59], v[92:95], a[76:79], v[56:59]
  ds_read_b128 v[92:95], v5 offset:39936
  v_cvt_pk_bf16_f32 v28, v12, v13
  v_mfma_f32_16x16x32_bf16 v[60:63], v[96:99], a[12:15], v[60:63]
  v_exp_f32 v18, v46
  v_mfma_f32_16x16x32_bf16 v[64:67], v[96:99], a[76:79], v[64:67]
  ds_read_b128 v[96:99], v5 offset:56320
  s_waitcnt lgkmcnt(6)
  v_mfma_f32_16x16x32_bf16 v[52:55], v[68:71], a[16:19], v[52:55]
  v_exp_f32 v19, v47
  v_mfma_f32_16x16x32_bf16 v[56:59], v[68:71], a[80:83], v[56:59]
  ds_read_b128 v[68:71], v4 offset:40960
  v_add_f32 v9, v9, v14
  v_mfma_f32_16x16x32_bf16 v[60:63], v[72:75], a[16:19], v[60:63]
  v_add_f32 v9, v9, v15
  v_cvt_pk_bf16_f32 v29, v14, v15
  v_mfma_f32_16x16x32_bf16 v[64:67], v[72:75], a[80:83], v[64:67]
  ds_read_b128 v[72:75], v4 offset:57344
  s_waitcnt lgkmcnt(6)
  v_mfma_f32_16x16x32_bf16 v[52:55], v[76:79], a[20:23], v[52:55]
  v_exp_f32 v12, v40
  v_mfma_f32_16x16x32_bf16 v[56:59], v[76:79], a[84:87], v[56:59]
  ds_read_b128 v[76:79], v4 offset:41984
  v_add_f32 v9, v9, v16
  v_mfma_f32_16x16x32_bf16 v[60:63], v[80:83], a[20:23], v[60:63]
  v_exp_f32 v13, v41
  v_mfma_f32_16x16x32_bf16 v[64:67], v[80:83], a[84:87], v[64:67]
  ds_read_b128 v[80:83], v4 offset:58368
  s_waitcnt lgkmcnt(6)
  v_mfma_f32_16x16x32_bf16 v[52:55], v[84:87], a[24:27], v[52:55]
  v_exp_f32 v14, v42
  v_mfma_f32_16x16x32_bf16 v[56:59], v[84:87], a[88:91], v[56:59]
  ds_read_b128 v[84:87], v4 offset:43008
  v_add_f32 v9, v9, v17
  v_mfma_f32_16x16x32_bf16 v[60:63], v[88:91], a[24:27], v[60:63]
  v_exp_f32 v15, v43
  v_mfma_f32_16x16x32_bf16 v[64:67], v[88:91], a[88:91], v[64:67]
  ds_read_b128 v[88:91], v4 offset:59392
  s_waitcnt lgkmcnt(6)
  v_mfma_f32_16x16x32_bf16 v[52:55], v[92:95], a[28:31], v[52:55]
  v_cvt_pk_bf16_f32 v30, v16, v17
  v_add_f32 v9, v9, v18
  v_mfma_f32_16x16x32_bf16 v[56:59], v[92:95], a[92:95], v[56:59]
  ds_read_b128 v[92:95], v4 offset:44032
  v_add_f32 v9, v9, v19
  v_mfma_f32_16x16x32_bf16 v[60:63], v[96:99], a[28:31], v[60:63]
  v_cvt_pk_bf16_f32 v31, v18, v19
  v_add_f32 v10, v12, v13
  v_mfma_f32_16x16x32_bf16 v[64:67], v[96:99], a[92:95], v[64:67]
  ds_read_b128 v[96:99], v4 offset:60416
  s_waitcnt lgkmcnt(6)
  v_mfma_f32_16x16x32_bf16 v[52:55], v[68:71], a[32:35], v[52:55]
  v_exp_f32 v16, v48
  v_mfma_f32_16x16x32_bf16 v[56:59], v[68:71], a[96:99], v[56:59]
  ds_read_b128 v[68:71], v5 offset:45056
  v_cvt_pk_bf16_f32 v32, v12, v13
  v_mfma_f32_16x16x32_bf16 v[60:63], v[72:75], a[32:35], v[60:63]
  v_exp_f32 v17, v49
  v_mfma_f32_16x16x32_bf16 v[64:67], v[72:75], a[96:99], v[64:67]
  ds_read_b128 v[72:75], v5 offset:61440
  s_waitcnt lgkmcnt(6)
  v_mfma_f32_16x16x32_bf16 v[52:55], v[76:79], a[36:39], v[52:55]
  v_exp_f32 v18, v50
  v_mfma_f32_16x16x32_bf16 v[56:59], v[76:79], a[100:103], v[56:59]
  ds_read_b128 v[76:79], v5 offset:46080
  v_add_f32 v10, v10, v14
  v_mfma_f32_16x16x32_bf16 v[60:63], v[80:83], a[36:39], v[60:63]
  v_exp_f32 v19, v51
  v_mfma_f32_16x16x32_bf16 v[64:67], v[80:83], a[100:103], v[64:67]
  ds_read_b128 v[80:83], v5 offset:62464
  s_waitcnt lgkmcnt(6)
  v_mfma_f32_16x16x32_bf16 v[52:55], v[84:87], a[40:43], v[52:55]
  v_add_f32 v10, v10, v15
  v_cvt_pk_bf16_f32 v33, v14, v15
  v_mfma_f32_16x16x32_bf16 v[56:59], v[84:87], a[104:107], v[56:59]
  ds_read_b128 v[84:87], v5 offset:47104
  v_add_f32 v10, v10, v16
  v_mfma_f32_16x16x32_bf16 v[60:63], v[88:91], a[40:43], v[60:63]
  v_add_f32 v10, v10, v17
  v_cvt_pk_bf16_f32 v34, v16, v17
  v_mfma_f32_16x16x32_bf16 v[64:67], v[88:91], a[104:107], v[64:67]
  ds_read_b128 v[88:91], v5 offset:63488
  s_waitcnt lgkmcnt(6)
  v_mfma_f32_16x16x32_bf16 v[52:55], v[92:95], a[44:47], v[52:55]
  v_add_f32 v10, v10, v18
  v_add_f32 v10, v10, v19
  v_mfma_f32_16x16x32_bf16 v[56:59], v[92:95], a[108:111], v[56:59]
  ds_read_b128 v[92:95], v5 offset:48128
  v_cvt_pk_bf16_f32 v35, v18, v19
  v_mfma_f32_16x16x32_bf16 v[60:63], v[96:99], a[44:47], v[60:63]
  v_max_f32 v11, v9, v10
  v_cmp_lt_f32 vcc, s45, v11
  v_mfma_f32_16x16x32_bf16 v[64:67], v[96:99], a[108:111], v[64:67]
  ds_read_b128 v[96:99], v5 offset:64512
  s_waitcnt lgkmcnt(6)
  v_mfma_f32_16x16x32_bf16 v[52:55], v[68:71], a[48:51], v[52:55]
  v_mfma_f32_16x16x32_bf16 v[56:59], v[68:71], a[112:115], v[56:59]
  ds_read_b64_tr_b16 v[68:69], v6 offset:0
  v_mfma_f32_16x16x32_bf16 v[60:63], v[72:75], a[48:51], v[60:63]
  ds_read_b64_tr_b16 v[70:71], v6 offset:16384
  v_mfma_f32_16x16x32_bf16 v[64:67], v[72:75], a[112:115], v[64:67]
  ds_read_b64_tr_b16 v[72:73], v6 offset:256
  s_waitcnt lgkmcnt(7)
  v_mfma_f32_16x16x32_bf16 v[52:55], v[76:79], a[52:55], v[52:55]
  ds_read_b64_tr_b16 v[74:75], v6 offset:16640
  v_mfma_f32_16x16x32_bf16 v[56:59], v[76:79], a[116:119], v[56:59]
  ds_read_b64_tr_b16 v[76:77], v6 offset:512
  v_mfma_f32_16x16x32_bf16 v[60:63], v[80:83], a[52:55], v[60:63]
  ds_read_b64_tr_b16 v[78:79], v6 offset:16896
  v_mfma_f32_16x16x32_bf16 v[64:67], v[80:83], a[116:119], v[64:67]
  ds_read_b64_tr_b16 v[80:81], v6 offset:768
  s_waitcnt lgkmcnt(9)
  v_mfma_f32_16x16x32_bf16 v[52:55], v[84:87], a[56:59], v[52:55]
  ds_read_b64_tr_b16 v[82:83], v6 offset:17152
  v_mfma_f32_16x16x32_bf16 v[56:59], v[84:87], a[120:123], v[56:59]
  ds_read_b64_tr_b16 v[84:85], v6 offset:1024
  v_mfma_f32_16x16x32_bf16 v[60:63], v[88:91], a[56:59], v[60:63]
  ds_read_b64_tr_b16 v[86:87], v6 offset:17408
  v_mfma_f32_16x16x32_bf16 v[64:67], v[88:91], a[120:123], v[64:67]
  ds_read_b64_tr_b16 v[88:89], v6 offset:1280
  s_waitcnt lgkmcnt(11)
  v_mfma_f32_16x16x32_bf16 v[52:55], v[92:95], a[60:63], v[52:55]
  ds_read_b64_tr_b16 v[90:91], v6 offset:17664
  v_mfma_f32_16x16x32_bf16 v[56:59], v[92:95], a[124:127], v[56:59]
  ds_read_b64_tr_b16 v[92:93], v6 offset:1536
  v_mfma_f32_16x16x32_bf16 v[60:63], v[96:99], a[60:63], v[60:63]
  ds_read_b64_tr_b16 v[94:95], v6 offset:17920
  v_mfma_f32_16x16x32_bf16 v[64:67], v[96:99], a[124:127], v[64:67]
  ds_read_b64_tr_b16 v[96:97], v6 offset:1792
  s_waitcnt lgkmcnt(11)
  v_mfma_f32_16x16x32_bf16 v[128:131], v[68:71], v[28:31], 0
  ds_read_b64_tr_b16 v[98:99], v6 offset:18176
  v_add_f32 v7, v7, v9
  v_mfma_f32_16x16x32_bf16 v[132:135], v[68:71], v[32:35], 0
  ds_read_b64_tr_b16 v[68:69], v6 offset:2048
  v_add_f32 v8, v8, v10
  v_mfma_f32_16x16x32_bf16 v[136:139], v[72:75], v[28:31], 0
  ds_read_b64_tr_b16 v[70:71], v6 offset:18432
  s_add_u32 s47, s47, 32768
  v_mfma_f32_16x16x32_bf16 v[140:143], v[72:75], v[32:35], 0
  ds_read_b64_tr_b16 v[72:73], v6 offset:2304
  s_waitcnt lgkmcnt(11)
  v_mfma_f32_16x16x32_bf16 v[144:147], v[76:79], v[28:31], 0
  ds_read_b64_tr_b16 v[74:75], v6 offset:18688
  s_and_b32 s47, s47, 0x1ffff
  v_mfma_f32_16x16x32_bf16 v[148:151], v[76:79], v[32:35], 0
  ds_read_b64_tr_b16 v[76:77], v6 offset:2560
  v_xor_b32 v4, 0x10000, v4
  v_mfma_f32_16x16x32_bf16 v[152:155], v[80:83], v[28:31], 0
  ds_read_b64_tr_b16 v[78:79], v6 offset:18944
  v_xor_b32 v5, 0x10000, v5
  v_mfma_f32_16x16x32_bf16 v[156:159], v[80:83], v[32:35], 0
  ds_read_b64_tr_b16 v[80:81], v6 offset:2816
  s_waitcnt lgkmcnt(11)
  v_mfma_f32_16x16x32_bf16 v[160:163], v[84:87], v[28:31], 0
  ds_read_b64_tr_b16 v[82:83], v6 offset:19200
  v_add_u32 v124, 1, v124
  v_mfma_f32_16x16x32_bf16 v[164:167], v[84:87], v[32:35], 0
  ds_read_b64_tr_b16 v[84:85], v6 offset:3072
  v_mfma_f32_16x16x32_bf16 v[168:171], v[88:91], v[28:31], 0
  ds_read_b64_tr_b16 v[86:87], v6 offset:19456
  v_mfma_f32_16x16x32_bf16 v[172:175], v[88:91], v[32:35], 0
  ds_read_b64_tr_b16 v[88:89], v6 offset:3328
  s_waitcnt vmcnt(0) lgkmcnt(11)
  v_mfma_f32_16x16x32_bf16 v[176:179], v[92:95], v[28:31], 0
  ds_read_b64_tr_b16 v[90:91], v6 offset:19712
  ds_write_b32 v125, v124
  v_mfma_f32_16x16x32_bf16 v[180:183], v[92:95], v[32:35], 0
  ds_read_b64_tr_b16 v[92:93], v6 offset:3584
  v_mov_b32 v120, 1
  s_add_u32 s26, s24, 16384
  s_mov_b64 exec, 1
  buffer_atomic_add v120, off, s[20:23], s26 sc1
  s_mov_b64 exec, -1
  v_mfma_f32_16x16x32_bf16 v[184:187], v[96:99], v[28:31], 0
  ds_read_b64_tr_b16 v[94:95], v6 offset:19968
  v_mfma_f32_16x16x32_bf16 v[188:191], v[96:99], v[32:35], 0
  ds_read_b64_tr_b16 v[96:97], v6 offset:3840
  s_waitcnt lgkmcnt(12)
  v_mfma_f32_16x16x32_bf16 v[192:195], v[68:71], v[28:31], 0
  ds_read_b64_tr_b16 v[98:99], v6 offset:20224
  v_mfma_f32_16x16x32_bf16 v[196:199], v[68:71], v[32:35], 0
  ds_read_b64_tr_b16 v[68:69], v6 offset:8192
  v_mfma_f32_16x16x32_bf16 v[200:203], v[72:75], v[28:31], 0
  ds_read_b64_tr_b16 v[70:71], v6 offset:24576
  v_mfma_f32_16x16x32_bf16 v[204:207], v[72:75], v[32:35], 0
  ds_read_b64_tr_b16 v[72:73], v6 offset:8448
  s_waitcnt lgkmcnt(12)
  v_mfma_f32_16x16x32_bf16 v[208:211], v[76:79], v[28:31], 0
  ds_read_b64_tr_b16 v[74:75], v6 offset:24832
  v_mfma_f32_16x16x32_bf16 v[212:215], v[76:79], v[32:35], 0
  ds_read_b64_tr_b16 v[76:77], v6 offset:8704
  v_mfma_f32_16x16x32_bf16 v[216:219], v[80:83], v[28:31], 0
  ds_read_b64_tr_b16 v[78:79], v6 offset:25088
  v_mfma_f32_16x16x32_bf16 v[220:223], v[80:83], v[32:35], 0
  ds_read_b64_tr_b16 v[80:81], v6 offset:8960
  s_waitcnt lgkmcnt(12)
  v_mfma_f32_16x16x32_bf16 v[224:227], v[84:87], v[28:31], 0
  ds_read_b64_tr_b16 v[82:83], v6 offset:25344
  v_mfma_f32_16x16x32_bf16 v[228:231], v[84:87], v[32:35], 0
  ds_read_b64_tr_b16 v[84:85], v6 offset:9216
  v_mfma_f32_16x16x32_bf16 v[232:235], v[88:91], v[28:31], 0
  ds_read_b64_tr_b16 v[86:87], v6 offset:25600
  v_mfma_f32_16x16x32_bf16 v[236:239], v[88:91], v[32:35], 0
  ds_read_b64_tr_b16 v[88:89], v6 offset:9472
  s_waitcnt lgkmcnt(11)
  v_mfma_f32_16x16x32_bf16 v[240:243], v[92:95], v[28:31], 0
  ds_read_b64_tr_b16 v[90:91], v6 offset:25856
  v_mfma_f32_16x16x32_bf16 v[244:247], v[92:95], v[32:35], 0
  ds_read_b64_tr_b16 v[92:93], v6 offset:9728
  v_mfma_f32_16x16x32_bf16 v[248:251], v[96:99], v[28:31], 0
  ds_read_b64_tr_b16 v[94:95], v6 offset:26112
  ds_read_b32 v127, v126
  v_mfma_f32_16x16x32_bf16 v[252:255], v[96:99], v[32:35], 0
  ds_read_b64_tr_b16 v[96:97], v6 offset:9984
  s_waitcnt lgkmcnt(12)
  v_mfma_f32_16x16x32_bf16 a[128:131], v[68:71], v[28:31], 0
  ds_read_b64_tr_b16 v[98:99], v6 offset:26368
  v_mfma_f32_16x16x32_bf16 a[132:135], v[68:71], v[32:35], 0
  ds_read_b64_tr_b16 v[68:69], v6 offset:10240
  v_mfma_f32_16x16x32_bf16 a[136:139], v[72:75], v[28:31], 0
  ds_read_b64_tr_b16 v[70:71], v6 offset:26624
  v_mfma_f32_16x16x32_bf16 a[140:143], v[72:75], v[32:35], 0
  ds_read_b64_tr_b16 v[72:73], v6 offset:10496
  s_waitcnt lgkmcnt(12)
  v_mfma_f32_16x16x32_bf16 a[144:147], v[76:79], v[28:31], 0
  ds_read_b64_tr_b16 v[74:75], v6 offset:26880
  v_mfma_f32_16x16x32_bf16 a[148:151], v[76:79], v[32:35], 0
  ds_read_b64_tr_b16 v[76:77], v6 offset:10752
  v_mfma_f32_16x16x32_bf16 a[152:155], v[80:83], v[28:31], 0
  ds_read_b64_tr_b16 v[78:79], v6 offset:27136
  v_mfma_f32_16x16x32_bf16 a[156:159], v[80:83], v[32:35], 0
  ds_read_b64_tr_b16 v[80:81], v6 offset:11008
  s_waitcnt lgkmcnt(12)
  v_mfma_f32_16x16x32_bf16 a[160:163], v[84:87], v[28:31], 0
  ds_read_b64_tr_b16 v[82:83], v6 offset:27392
  v_mfma_f32_16x16x32_bf16 a[164:167], v[84:87], v[32:35], 0
  ds_read_b64_tr_b16 v[84:85], v6 offset:11264
  v_mfma_f32_16x16x32_bf16 a[168:171], v[88:91], v[28:31], 0
  ds_read_b64_tr_b16 v[86:87], v6 offset:27648
  v_mfma_f32_16x16x32_bf16 a[172:175], v[88:91], v[32:35], 0
  ds_read_b64_tr_b16 v[88:89], v6 offset:11520
  s_waitcnt lgkmcnt(11)
  v_mfma_f32_16x16x32_bf16 a[176:179], v[92:95], v[28:31], 0
  ds_read_b64_tr_b16 v[90:91], v6 offset:27904
  v_mfma_f32_16x16x32_bf16 a[180:183], v[92:95], v[32:35], 0
  ds_read_b64_tr_b16 v[92:93], v6 offset:11776
  v_mfma_f32_16x16x32_bf16 a[184:187], v[96:99], v[28:31], 0
  ds_read_b64_tr_b16 v[94:95], v6 offset:28160
  v_cmp_gt_u32 vcc, v124, v127
  v_mfma_f32_16x16x32_bf16 a[188:191], v[96:99], v[32:35], 0
  ds_read_b64_tr_b16 v[96:97], v6 offset:12032
  s_waitcnt lgkmcnt(11)
  v_mfma_f32_16x16x32_bf16 a[192:195], v[68:71], v[28:31], 0
  ds_read_b64_tr_b16 v[98:99], v6 offset:28416
  s_cbranch_vccnz SPINF0
SRETF0:
  v_mfma_f32_16x16x32_bf16 a[196:199], v[68:71], v[32:35], 0
  ds_read_b128 v[68:71], v4 offset:0
  s_mov_b32 m0, s47
  v_mfma_f32_16x16x32_bf16 a[200:203], v[72:75], v[28:31], 0
  buffer_load_dwordx4 v2, s[20:23], s46 offen offset:0 sc1 lds
  v_mfma_f32_16x16x32_bf16 a[204:207], v[72:75], v[32:35], 0
  ds_read_b128 v[72:75], v4 offset:16384
  s_waitcnt lgkmcnt(10)
  v_mfma_f32_16x16x32_bf16 a[208:211], v[76:79], v[28:31], 0
  buffer_load_dwordx4 v2, s[20:23], s46 offen offset:1024 sc1 lds
  v_mfma_f32_16x16x32_bf16 a[212:215], v[76:79], v[32:35], 0
  ds_read_b128 v[76:79], v4 offset:1024
  v_mfma_f32_16x16x32_bf16 a[216:219], v[80:83], v[28:31], 0
  buffer_load_dwordx4 v2, s[20:23], s46 offen offset:2048 sc1 lds
  v_mfma_f32_16x16x32_bf16 a[220:223], v[80:83], v[32:35], 0
  ds_read_b128 v[80:83], v4 offset:17408
  s_waitcnt lgkmcnt(8)
  v_mfma_f32_16x16x32_bf16 a[224:227], v[84:87], v[28:31], 0
  buffer_load_dwordx4 v2, s[20:23], s46 offen offset:3072 sc1 lds
  v_mfma_f32_16x16x32_bf16 a[228:231], v[84:87], v[32:35], 0
  ds_read_b128 v[84:87], v4 offset:2048
  s_add_u32 m0, s47, 16384
  v_mfma_f32_16x16x32_bf16 a[232:235], v[88:91], v[28:31], 0
  buffer_load_dwordx4 v3, s[20:23], s46 offen offset:0 sc1 lds
  s_sub_u32 s44, s44, 1
  v_mfma_f32_16x16x32_bf16 a[236:239], v[88:91], v[32:35], 0
  ds_read_b128 v[88:91], v4 offset:18432
  s_waitcnt lgkmcnt(6)
  v_mfma_f32_16x16x32_bf16 a[240:243], v[92:95], v[28:31], 0
  buffer_load_dwordx4 v3, s[20:23], s46 offen offset:1024 sc1 lds
  s_cmp_eq_u32 s44, 2
  v_mfma_f32_16x16x32_bf16 a[244:247], v[92:95], v[32:35], 0
  ds_read_b128 v[92:95], v4 offset:3072
  v_mfma_f32_16x16x32_bf16 a[248:251], v[96:99], v[28:31], 0
  buffer_load_dwordx4 v3, s[20:23], s46 offen offset:2048 sc1 lds
  s_waitcnt lgkmcnt(5)
  v_mfma_f32_16x16x32_bf16 a[252:255], v[96:99], v[32:35], 0
  ds_read_b128 v[96:99], v4 offset:19456
  s_branch LOOP1
.p2align 6
LOOP:
  v_mfma_f32_16x16x32_bf16 v[52:55], v[68:71], a[0:3], v[20:23]
  buffer_load_dwordx4 v3, s[20:23], s46 offen offset:3072 sc1 lds
  s_add_u32 s46, s46, 32768
  v_mfma_f32_16x16x32_bf16 v[56:59], v[68:71], a[64:67], v[24:27]
  ds_read_b128 v[68:71], v5 offset:36864
  v_xor_b32 v6, 0x10000, v6
  v_mfma_f32_16x16x32_bf16 v[60:63], v[72:75], a[0:3], v[20:23]
  v_exp_f32 v12, v36
  v_mfma_f32_16x16x32_bf16 v[64:67], v[72:75], a[64:67], v[24:27]
  ds_read_b128 v[72:75], v5 offset:53248
  s_waitcnt lgkmcnt(6)
  v_mfma_f32_16x16x32_bf16 v[52:55], v[76:79], a[4:7], v[52:55]
  v_exp_f32 v13, v37
  v_mfma_f32_16x16x32_bf16 v[56:59], v[76:79], a[68:71], v[56:59]
  ds_read_b128 v[76:79], v5 offset:37888
  v_mfma_f32_16x16x32_bf16 v[60:63], v[80:83], a[4:7], v[60:63]
  v_exp_f32 v14, v38
  v_mfma_f32_16x16x32_bf16 v[64:67], v[80:83], a[68:71], v[64:67]
  ds_read_b128 v[80:83], v5 offset:54272
  s_waitcnt lgkmcnt(6)
  v_mfma_f32_16x16x32_bf16 v[52:55], v[84:87], a[8:11], v[52:55]
  v_exp_f32 v15, v39
  v_mfma_f32_16x16x32_bf16 v[56:59], v[84:87], a[72:75], v[56:59]
  ds_read_b128 v[84:87], v5 offset:38912
  v_add_f32 v9, v12, v13
  v_mfma_f32_16x16x32_bf16 v[60:63], v[88:91], a[8:11], v[60:63]
  v_exp_f32 v16, v44
  v_mfma_f32_16x16x32_bf16 v[64:67], v[88:91], a[72:75], v[64:67]
  ds_read_b128 v[88:91], v5 offset:55296
  s_waitcnt lgkmcnt(6)
  v_mfma_f32_16x16x32_bf16 v[52:55], v[92:95], a[12:15], v[52:55]
  v_exp_f32 v17, v45
  v_mfma_f32_16x16x32_bf16 v[56:59], v[92:95], a[76:79], v[56:59]
  ds_read_b128 v[92:95], v5 offset:39936
  v_cvt_pk_bf16_f32 v28, v12, v13
  v_mfma_f32_16x16x32_bf16 v[60:63], v[96:99], a[12:15], v[60:63]
  v_exp_f32 v18, v46
  v_mfma_f32_16x16x32_bf16 v[64:67], v[96:99], a[76:79], v[64:67]
  ds_read_b128 v[96:99], v5 offset:56320
  s_waitcnt lgkmcnt(6)
  v_mfma_f32_16x16x32_bf16 v[52:55], v[68:71], a[16:19], v[52:55]
  v_exp_f32 v19, v47
  v_mfma_f32_16x16x32_bf16 v[56:59], v[68:71], a[80:83], v[56:59]
  ds_read_b128 v[68:71], v4 offset:40960
  v_add_f32 v9, v9, v14
  v_mfma_f32_16x16x32_bf16 v[60:63], v[72:75], a[16:19], v[60:63]
  v_add_f32 v9, v9, v15
  v_cvt_pk_bf16_f32 v29, v14, v15
  v_mfma_f32_16x16x32_bf16 v[64:67], v[72:75], a[80:83], v[64:67]
  ds_read_b128 v[72:75], v4 offset:57344
  s_waitcnt lgkmcnt(6)
  v_mfma_f32_16x16x32_bf16 v[52:55], v[76:79], a[20:23], v[52:55]
  v_exp_f32 v12, v40
  v_mfma_f32_16x16x32_bf16 v[56:59], v[76:79], a[84:87], v[56:59]
  ds_read_b128 v[76:79], v4 offset:41984
  v_add_f32 v9, v9, v16
  v_mfma_f32_16x16x32_bf16 v[60:63], v[80:83], a[20:23], v[60:63]
  v_exp_f32 v13, v41
  v_mfma_f32_16x16x32_bf16 v[64:67], v[80:83], a[84:87], v[64:67]
  ds_read_b128 v[80:83], v4 offset:58368
  s_waitcnt lgkmcnt(6)
  v_mfma_f32_16x16x32_bf16 v[52:55], v[84:87], a[24:27], v[52:55]
  v_exp_f32 v14, v42
  v_mfma_f32_16x16x32_bf16 v[56:59], v[84:87], a[88:91], v[56:59]
  ds_read_b128 v[84:87], v4 offset:43008
  v_add_f32 v9, v9, v17
  v_mfma_f32_16x16x32_bf16 v[60:63], v[88:91], a[24:27], v[60:63]
  v_exp_f32 v15, v43
  v_mfma_f32_16x16x32_bf16 v[64:67], v[88:91], a[88:91], v[64:67]
  ds_read_b128 v[88:91], v4 offset:59392
  s_waitcnt lgkmcnt(6)
  v_mfma_f32_16x16x32_bf16 v[52:55], v[92:95], a[28:31], v[52:55]
  v_cvt_pk_bf16_f32 v30, v16, v17
  v_add_f32 v9, v9, v18
  v_mfma_f32_16x16x32_bf16 v[56:59], v[92:95], a[92:95], v[56:59]
  ds_read_b128 v[92:95], v4 offset:44032
  v_add_f32 v9, v9, v19
  v_mfma_f32_16x16x32_bf16 v[60:63], v[96:99], a[28:31], v[60:63]
  v_cvt_pk_bf16_f32 v31, v18, v19
  v_add_f32 v10, v12, v13
  v_mfma_f32_16x16x32_bf16 v[64:67], v[96:99], a[92:95], v[64:67]
  ds_read_b128 v[96:99], v4 offset:60416
  s_waitcnt lgkmcnt(6)
  v_mfma_f32_16x16x32_bf16 v[52:55], v[68:71], a[32:35], v[52:55]
  v_exp_f32 v16, v48
  v_mfma_f32_16x16x32_bf16 v[56:59], v[68:71], a[96:99], v[56:59]
  ds_read_b128 v[68:71], v5 offset:45056
  v_cvt_pk_bf16_f32 v32, v12, v13
  v_mfma_f32_16x16x32_bf16 v[60:63], v[72:75], a[32:35], v[60:63]
  v_exp_f32 v17, v49
  v_mfma_f32_16x16x32_bf16 v[64:67], v[72:75], a[96:99], v[64:67]
  ds_read_b128 v[72:75], v5 offset:61440
  s_waitcnt lgkmcnt(6)
  v_mfma_f32_16x16x32_bf16 v[52:55], v[76:79], a[36:39], v[52:55]
  v_exp_f32 v18, v50
  v_mfma_f32_16x16x32_bf16 v[56:59], v[76:79], a[100:103], v[56:59]
  ds_read_b128 v[76:79], v5 offset:46080
  v_add_f32 v10, v10, v14
  v_mfma_f32_16x16x32_bf16 v[60:63], v[80:83], a[36:39], v[60:63]
  v_exp_f32 v19, v51
  v_mfma_f32_16x16x32_bf16 v[64:67], v[80:83], a[100:103], v[64:67]
  ds_read_b128 v[80:83], v5 offset:62464
  s_waitcnt lgkmcnt(6)
  v_mfma_f32_16x16x32_bf16 v[52:55], v[84:87], a[40:43], v[52:55]
  v_add_f32 v10, v10, v15
  v_cvt_pk_bf16_f32 v33, v14, v15
  v_mfma_f32_16x16x32_bf16 v[56:59], v[84:87], a[104:107], v[56:59]
  ds_read_b128 v[84:87], v5 offset:47104
  v_add_f32 v10, v10, v16
  v_mfma_f32_16x16x32_bf16 v[60:63], v[88:91], a[40:43], v[60:63]
  v_add_f32 v10, v10, v17
  v_cvt_pk_bf16_f32 v34, v16, v17
  v_mfma_f32_16x16x32_bf16 v[64:67], v[88:91], a[104:107], v[64:67]
  ds_read_b128 v[88:91], v5 offset:63488
  s_waitcnt lgkmcnt(6)
  v_mfma_f32_16x16x32_bf16 v[52:55], v[92:95], a[44:47], v[52:55]
  v_add_f32 v10, v10, v18
  v_add_f32 v10, v10, v19
  v_mfma_f32_16x16x32_bf16 v[56:59], v[92:95], a[108:111], v[56:59]
  ds_read_b128 v[92:95], v5 offset:48128
  v_cvt_pk_bf16_f32 v35, v18, v19
  v_mfma_f32_16x16x32_bf16 v[60:63], v[96:99], a[44:47], v[60:63]
  v_max_f32 v11, v9, v10
  v_cmp_lt_f32 vcc, s45, v11
  v_mfma_f32_16x16x32_bf16 v[64:67], v[96:99], a[108:111], v[64:67]
  ds_read_b128 v[96:99], v5 offset:64512
  s_waitcnt lgkmcnt(6)
  v_mfma_f32_16x16x32_bf16 v[52:55], v[68:71], a[48:51], v[52:55]
  s_cbranch_vccnz RARE0
RETL0:
  v_mfma_f32_16x16x32_bf16 v[56:59], v[68:71], a[112:115], v[56:59]
  ds_read_b64_tr_b16 v[68:69], v6 offset:0
  v_mfma_f32_16x16x32_bf16 v[60:63], v[72:75], a[48:51], v[60:63]
  ds_read_b64_tr_b16 v[70:71], v6 offset:16384
  v_mfma_f32_16x16x32_bf16 v[64:67], v[72:75], a[112:115], v[64:67]
  ds_read_b64_tr_b16 v[72:73], v6 offset:256
  s_waitcnt lgkmcnt(7)
  v_mfma_f32_16x16x32_bf16 v[52:55], v[76:79], a[52:55], v[52:55]
  ds_read_b64_tr_b16 v[74:75], v6 offset:16640
  v_mfma_f32_16x16x32_bf16 v[56:59], v[76:79], a[116:119], v[56:59]
  ds_read_b64_tr_b16 v[76:77], v6 offset:512
  v_mfma_f32_16x16x32_bf16 v[60:63], v[80:83], a[52:55], v[60:63]
  ds_read_b64_tr_b16 v[78:79], v6 offset:16896
  v_mfma_f32_16x16x32_bf16 v[64:67], v[80:83], a[116:119], v[64:67]
  ds_read_b64_tr_b16 v[80:81], v6 offset:768
  s_waitcnt lgkmcnt(9)
  v_mfma_f32_16x16x32_bf16 v[52:55], v[84:87], a[56:59], v[52:55]
  ds_read_b64_tr_b16 v[82:83], v6 offset:17152
  v_mfma_f32_16x16x32_bf16 v[56:59], v[84:87], a[120:123], v[56:59]
  ds_read_b64_tr_b16 v[84:85], v6 offset:1024
  v_mfma_f32_16x16x32_bf16 v[60:63], v[88:91], a[56:59], v[60:63]
  ds_read_b64_tr_b16 v[86:87], v6 offset:17408
  v_mfma_f32_16x16x32_bf16 v[64:67], v[88:91], a[120:123], v[64:67]
  ds_read_b64_tr_b16 v[88:89], v6 offset:1280
  s_waitcnt lgkmcnt(11)
  v_mfma_f32_16x16x32_bf16 v[52:55], v[92:95], a[60:63], v[52:55]
  ds_read_b64_tr_b16 v[90:91], v6 offset:17664
  v_mfma_f32_16x16x32_bf16 v[56:59], v[92:95], a[124:127], v[56:59]
  ds_read_b64_tr_b16 v[92:93], v6 offset:1536
  v_mfma_f32_16x16x32_bf16 v[60:63], v[96:99], a[60:63], v[60:63]
  ds_read_b64_tr_b16 v[94:95], v6 offset:17920
  v_mfma_f32_16x16x32_bf16 v[64:67], v[96:99], a[124:127], v[64:67]
  ds_read_b64_tr_b16 v[96:97], v6 offset:1792
  s_waitcnt lgkmcnt(11)
  v_mfma_f32_16x16x32_bf16 v[128:131], v[68:71], v[28:31], v[128:131]
  ds_read_b64_tr_b16 v[98:99], v6 offset:18176
  v_add_f32 v7, v7, v9
  v_mfma_f32_16x16x32_bf16 v[132:135], v[68:71], v[32:35], v[132:135]
  ds_read_b64_tr_b16 v[68:69], v6 offset:2048
  v_add_f32 v8, v8, v10
  v_mfma_f32_16x16x32_bf16 v[136:139], v[72:75], v[28:31], v[136:139]
  ds_read_b64_tr_b16 v[70:71], v6 offset:18432
  s_add_u32 s47, s47, 32768
  v_mfma_f32_16x16x32_bf16 v[140:143], v[72:75], v[32:35], v[140:143]
  ds_read_b64_tr_b16 v[72:73], v6 offset:2304
  s_waitcnt lgkmcnt(11)
  v_mfma_f32_16x16x32_bf16 v[144:147], v[76:79], v[28:31], v[144:147]
  ds_read_b64_tr_b16 v[74:75], v6 offset:18688
  s_and_b32 s47, s47, 0x1ffff
  v_mfma_f32_16x16x32_bf16 v[148:151], v[76:79], v[32:35], v[148:151]
  ds_read_b64_tr_b16 v[76:77], v6 offset:2560
  v_xor_b32 v4, 0x10000, v4
  v_mfma_f32_16x16x32_bf16 v[152:155], v[80:83], v[28:31], v[152:155]
  ds_read_b64_tr_b16 v[78:79], v6 offset:18944
  v_xor_b32 v5, 0x10000, v5
  v_mfma_f32_16x16x32_bf16 v[156:159], v[80:83], v[32:35], v[156:159]
  ds_read_b64_tr_b16 v[80:81], v6 offset:2816
  s_waitcnt lgkmcnt(11)
  v_mfma_f32_16x16x32_bf16 v[160:163], v[84:87], v[28:31], v[160:163]
  ds_read_b64_tr_b16 v[82:83], v6 offset:19200
  v_add_u32 v124, 1, v124
  v_mfma_f32_16x16x32_bf16 v[164:167], v[84:87], v[32:35], v[164:167]
  ds_read_b64_tr_b16 v[84:85], v6 offset:3072
  v_mfma_f32_16x16x32_bf16 v[168:171], v[88:91], v[28:31], v[168:171]
  ds_read_b64_tr_b16 v[86:87], v6 offset:19456
  v_mfma_f32_16x16x32_bf16 v[172:175], v[88:91], v[32:35], v[172:175]
  ds_read_b64_tr_b16 v[88:89], v6 offset:3328
  s_waitcnt vmcnt(0) lgkmcnt(11)
  v_mfma_f32_16x16x32_bf16 v[176:179], v[92:95], v[28:31], v[176:179]
  ds_read_b64_tr_b16 v[90:91], v6 offset:19712
  ds_write_b32 v125, v124
  v_mfma_f32_16x16x32_bf16 v[180:183], v[92:95], v[32:35], v[180:183]
  ds_read_b64_tr_b16 v[92:93], v6 offset:3584
  s_cmp_le_u32 s44, 13
  v_mfma_f32_16x16x32_bf16 v[184:187], v[96:99], v[28:31], v[184:187]
  ds_read_b64_tr_b16 v[94:95], v6 offset:19968
  s_cbranch_scc1 HOOKL0
HRETL0:
  v_mfma_f32_16x16x32_bf16 v[188:191], v[96:99], v[32:35], v[188:191]
  ds_read_b64_tr_b16 v[96:97], v6 offset:3840
  s_waitcnt lgkmcnt(12)
  v_mfma_f32_16x16x32_bf16 v[192:195], v[68:71], v[28:31], v[192:195]
  ds_read_b64_tr_b16 v[98:99], v6 offset:20224
  v_mfma_f32_16x16x32_bf16 v[196:199], v[68:71], v[32:35], v[196:199]
  ds_read_b64_tr_b16 v[68:69], v6 offset:8192
  v_mfma_f32_16x16x32_bf16 v[200:203], v[72:75], v[28:31], v[200:203]
  ds_read_b64_tr_b16 v[70:71], v6 offset:24576
  v_mfma_f32_16x16x32_bf16 v[204:207], v[72:75], v[32:35], v[204:207]
  ds_read_b64_tr_b16 v[72:73], v6 offset:8448
  s_waitcnt lgkmcnt(12)
  v_mfma_f32_16x16x32_bf16 v[208:211], v[76:79], v[28:31], v[208:211]
  ds_read_b64_tr_b16 v[74:75], v6 offset:24832
  v_mfma_f32_16x16x32_bf16 v[212:215], v[76:79], v[32:35], v[212:215]
  ds_read_b64_tr_b16 v[76:77], v6 offset:8704
  v_mfma_f32_16x16x32_bf16 v[216:219], v[80:83], v[28:31], v[216:219]
  ds_read_b64_tr_b16 v[78:79], v6 offset:25088
  v_mfma_f32_16x16x32_bf16 v[220:223], v[80:83], v[32:35], v[220:223]
  ds_read_b64_tr_b16 v[80:81], v6 offset:8960
  s_waitcnt lgkmcnt(12)
  v_mfma_f32_16x16x32_bf16 v[224:227], v[84:87], v[28:31], v[224:227]
  ds_read_b64_tr_b16 v[82:83], v6 offset:25344
  v_mfma_f32_16x16x32_bf16 v[228:231], v[84:87], v[32:35], v[228:231]
  ds_read_b64_tr_b16 v[84:85], v6 offset:9216
  v_mfma_f32_16x16x32_bf16 v[232:235], v[88:91], v[28:31], v[232:235]
  ds_read_b64_tr_b16 v[86:87], v6 offset:25600
  v_mfma_f32_16x16x32_bf16 v[236:239], v[88:91], v[32:35], v[236:239]
  ds_read_b64_tr_b16 v[88:89], v6 offset:9472
  s_waitcnt lgkmcnt(11)
  v_mfma_f32_16x16x32_bf16 v[240:243], v[92:95], v[28:31], v[240:243]
  ds_read_b64_tr_b16 v[90:91], v6 offset:25856
  v_mfma_f32_16x16x32_bf16 v[244:247], v[92:95], v[32:35], v[244:247]
  ds_read_b64_tr_b16 v[92:93], v6 offset:9728
  v_mfma_f32_16x16x32_bf16 v[248:251], v[96:99], v[28:31], v[248:251]
  ds_read_b64_tr_b16 v[94:95], v6 offset:26112
  ds_read_b32 v127, v126
  v_mfma_f32_16x16x32_bf16 v[252:255], v[96:99], v[32:35], v[252:255]
  ds_read_b64_tr_b16 v[96:97], v6 offset:9984
  s_waitcnt lgkmcnt(12)
  v_mfma_f32_16x16x32_bf16 a[128:131], v[68:71], v[28:31], a[128:131]
  ds_read_b64_tr_b16 v[98:99], v6 offset:26368
  v_mfma_f32_16x16x32_bf16 a[132:135], v[68:71], v[32:35], a[132:135]
  ds_read_b64_tr_b16 v[68:69], v6 offset:10240
  v_mfma_f32_16x16x32_bf16 a[136:139], v[72:75], v[28:31], a[136:139]
  ds_read_b64_tr_b16 v[70:71], v6 offset:26624
  v_mfma_f32_16x16x32_bf16 a[140:143], v[72:75], v[32:35], a[140:143]
  ds_read_b64_tr_b16 v[72:73], v6 offset:10496
  s_waitcnt lgkmcnt(12)
  v_mfma_f32_16x16x32_bf16 a[144:147], v[76:79], v[28:31], a[144:147]
  ds_read_b64_tr_b16 v[74:75], v6 offset:26880
  v_mfma_f32_16x16x32_bf16 a[148:151], v[76:79], v[32:35], a[148:151]
  ds_read_b64_tr_b16 v[76:77], v6 offset:10752
  v_mfma_f32_16x16x32_bf16 a[152:155], v[80:83], v[28:31], a[152:155]
  ds_read_b64_tr_b16 v[78:79], v6 offset:27136
  v_mfma_f32_16x16x32_bf16 a[156:159], v[80:83], v[32:35], a[156:159]
  ds_read_b64_tr_b16 v[80:81], v6 offset:11008
  s_waitcnt lgkmcnt(12)
  v_mfma_f32_16x16x32_bf16 a[160:163], v[84:87], v[28:31], a[160:163]
  ds_read_b64_tr_b16 v[82:83], v6 offset:27392
  v_mfma_f32_16x16x32_bf16 a[164:167], v[84:87], v[32:35], a[164:167]
  ds_read_b64_tr_b16 v[84:85], v6 offset:11264
  v_mfma_f32_16x16x32_bf16 a[168:171], v[88:91], v[28:31], a[168:171]
  ds_read_b64_tr_b16 v[86:87], v6 offset:27648
  v_mfma_f32_16x16x32_bf16 a[172:175], v[88:91], v[32:35], a[172:175]
  ds_read_b64_tr_b16 v[88:89], v6 offset:11520
  s_waitcnt lgkmcnt(11)
  v_mfma_f32_16x16x32_bf16 a[176:179], v[92:95], v[28:31], a[176:179]
  ds_read_b64_tr_b16 v[90:91], v6 offset:27904
  v_mfma_f32_16x16x32_bf16 a[180:183], v[92:95], v[32:35], a[180:183]
  ds_read_b64_tr_b16 v[92:93], v6 offset:11776
  v_mfma_f32_16x16x32_bf16 a[184:187], v[96:99], v[28:31], a[184:187]
  ds_read_b64_tr_b16 v[94:95], v6 offset:28160
  v_cmp_gt_u32 vcc, v124, v127
  v_mfma_f32_16x16x32_bf16 a[188:191], v[96:99], v[32:35], a[188:191]
  ds_read_b64_tr_b16 v[96:97], v6 offset:12032
  s_waitcnt lgkmcnt(11)
  v_mfma_f32_16x16x32_bf16 a[192:195], v[68:71], v[28:31], a[192:195]
  ds_read_b64_tr_b16 v[98:99], v6 offset:28416
  s_cbranch_vccnz SPINL0
SRETL0:
  v_mfma_f32_16x16x32_bf16 a[196:199], v[68:71], v[32:35], a[196:199]
  ds_read_b128 v[68:71], v4 offset:0
  s_mov_b32 m0, s47
  v_mfma_f32_16x16x32_bf16 a[200:203], v[72:75], v[28:31], a[200:203]
  buffer_load_dwordx4 v2, s[20:23], s46 offen offset:0 sc1 lds
  v_mfma_f32_16x16x32_bf16 a[204:207], v[72:75], v[32:35], a[204:207]
  ds_read_b128 v[72:75], v4 offset:16384
  s_waitcnt lgkmcnt(10)
  v_mfma_f32_16x16x32_bf16 a[208:211], v[76:79], v[28:31], a[208:211]
  buffer_load_dwordx4 v2, s[20:23], s46 offen offset:1024 sc1 lds
  v_mfma_f32_16x16x32_bf16 a[212:215], v[76:79], v[32:35], a[212:215]
  ds_read_b128 v[76:79], v4 offset:1024
  v_mfma_f32_16x16x32_bf16 a[216:219], v[80:83], v[28:31], a[216:219]
  buffer_load_dwordx4 v2, s[20:23], s46 offen offset:2048 sc1 lds
  v_mfma_f32_16x16x32_bf16 a[220:223], v[80:83], v[32:35], a[220:223]
  ds_read_b128 v[80:83], v4 offset:17408
  s_waitcnt lgkmcnt(8)
  v_mfma_f32_16x16x32_bf16 a[224:227], v[84:87], v[28:31], a[224:227]
  buffer_load_dwordx4 v2, s[20:23], s46 offen offset:3072 sc1 lds
  v_mfma_f32_16x16x32_bf16 a[228:231], v[84:87], v[32:35], a[228:231]
  ds_read_b128 v[84:87], v4 offset:2048
  s_add_u32 m0, s47, 16384
  v_mfma_f32_16x16x32_bf16 a[232:235], v[88:91], v[28:31], a[232:235]
  buffer_load_dwordx4 v3, s[20:23], s46 offen offset:0 sc1 lds
  s_sub_u32 s44, s44, 1
  v_mfma_f32_16x16x32_bf16 a[236:239], v[88:91], v[32:35], a[236:239]
  ds_read_b128 v[88:91], v4 offset:18432
  s_waitcnt lgkmcnt(6)
  v_mfma_f32_16x16x32_bf16 a[240:243], v[92:95], v[28:31], a[240:243]
  buffer_load_dwordx4 v3, s[20:23], s46 offen offset:1024 sc1 lds
  s_cmp_eq_u32 s44, 2
  v_mfma_f32_16x16x32_bf16 a[244:247], v[92:95], v[32:35], a[244:247]
  ds_read_b128 v[92:95], v4 offset:3072
  v_mfma_f32_16x16x32_bf16 a[248:251], v[96:99], v[28:31], a[248:251]
  buffer_load_dwordx4 v3, s[20:23], s46 offen offset:2048 sc1 lds
  s_waitcnt lgkmcnt(5)
  v_mfma_f32_16x16x32_bf16 a[252:255], v[96:99], v[32:35], a[252:255]
  ds_read_b128 v[96:99], v4 offset:19456
  s_cbranch_scc1 PRE1
LOOP1:
  v_mfma_f32_16x16x32_bf16 v[36:39], v[68:71], a[0:3], v[20:23]
  buffer_load_dwordx4 v3, s[20:23], s46 offen offset:3072 sc1 lds
  s_add_u32 s46, s46, 32768
  v_mfma_f32_16x16x32_bf16 v[40:43], v[68:71], a[64:67], v[24:27]
  ds_read_b128 v[68:71], v5 offset:4096
  v_mfma_f32_16x16x32_bf16 v[44:47], v[72:75], a[0:3], v[20:23]
  v_exp_f32 v12, v52
  v_mfma_f32_16x16x32_bf16 v[48:51], v[72:75], a[64:67], v[24:27]
  ds_read_b128 v[72:75], v5 offset:20480
  s_waitcnt lgkmcnt(6)
  v_mfma_f32_16x16x32_bf16 v[36:39], v[76:79], a[4:7], v[36:39]
  v_exp_f32 v13, v53
  v_mfma_f32_16x16x32_bf16 v[40:43], v[76:79], a[68:71], v[40:43]
  ds_read_b128 v[76:79], v5 offset:5120
  v_mfma_f32_16x16x32_bf16 v[44:47], v[80:83], a[4:7], v[44:47]
  v_exp_f32 v14, v54
  v_mfma_f32_16x16x32_bf16 v[48:51], v[80:83], a[68:71], v[48:51]
  ds_read_b128 v[80:83], v5 offset:21504
  s_waitcnt lgkmcnt(6)
  v_mfma_f32_16x16x32_bf16 v[36:39], v[84:87], a[8:11], v[36:39]
  v_exp_f32 v15, v55
  v_mfma_f32_16x16x32_bf16 v[40:43], v[84:87], a[72:75], v[40:43]
  ds_read_b128 v[84:87], v5 offset:6144
  v_add_f32 v9, v12, v13
  v_mfma_f32_16x16x32_bf16 v[44:47], v[88:91], a[8:11], v[44:47]
  v_exp_f32 v16, v60
  v_mfma_f32_16x16x32_bf16 v[48:51], v[88:91], a[72:75], v[48:51]
  ds_read_b128 v[88:91], v5 offset:22528
  s_waitcnt lgkmcnt(6)
  v_mfma_f32_16x16x32_bf16 v[36:39], v[92:95], a[12:15], v[36:39]
  v_exp_f32 v17, v61
  v_mfma_f32_16x16x32_bf16 v[40:43], v[92:95], a[76:79], v[40:43]
  ds_read_b128 v[92:95], v5 offset:7168
  v_cvt_pk_bf16_f32 v28, v12, v13
  v_mfma_f32_16x16x32_bf16 v[44:47], v[96:99], a[12:15], v[44:47]
  v_exp_f32 v18, v62
  v_mfma_f32_16x16x32_bf16 v[48:51], v[96:99], a[76:79], v[48:51]
  ds_read_b128 v[96:99], v5 offset:23552
  s_waitcnt lgkmcnt(6)
  v_mfma_f32_16x16x32_bf16 v[36:39], v[68:71], a[16:19], v[36:39]
  v_exp_f32 v19, v63
  v_mfma_f32_16x16x32_bf16 v[40:43], v[68:71], a[80:83], v[40:43]
  ds_read_b128 v[68:71], v4 offset:8192
  v_add_f32 v9, v9, v14
  v_mfma_f32_16x16x32_bf16 v[44:47], v[72:75], a[16:19], v[44:47]
  v_add_f32 v9, v9, v15
  v_cvt_pk_bf16_f32 v29, v14, v15
  v_mfma_f32_16x16x32_bf16 v[48:51], v[72:75], a[80:83], v[48:51]
  ds_read_b128 v[72:75], v4 offset:24576
  s_waitcnt lgkmcnt(6)
  v_mfma_f32_16x16x32_bf16 v[36:39], v[76:79], a[20:23], v[36:39]
  v_exp_f32 v12, v56
  v_mfma_f32_16x16x32_bf16 v[40:43], v[76:79], a[84:87], v[40:43]
  ds_read_b128 v[76:79], v4 offset:9216
  v_add_f32 v9, v9, v16
  v_mfma_f32_16x16x32_bf16 v[44:47], v[80:83], a[20:23], v[44:47]
  v_exp_f32 v13, v57
  v_mfma_f32_16x16x32_bf16 v[48:51], v[80:83], a[84:87], v[48:51]
  ds_read_b128 v[80:83], v4 offset:25600
  s_waitcnt lgkmcnt(6)
  v_mfma_f32_16x16x32_bf16 v[36:39], v[84:87], a[24:27], v[36:39]
  v_exp_f32 v14, v58
  v_mfma_f32_16x16x32_bf16 v[40:43], v[84:87], a[88:91], v[40:43]
  ds_read_b128 v[84:87], v4 offset:10240
  v_add_f32 v9, v9, v17
  v_mfma_f32_16x16x32_bf16 v[44:47], v[88:91], a[24:27], v[44:47]
  v_exp_f32 v15, v59
  v_mfma_f32_16x16x32_bf16 v[48:51], v[88:91], a[88:91], v[48:51]
  ds_read_b128 v[88:91], v4 offset:26624
  s_waitcnt lgkmcnt(6)
  v_mfma_f32_16x16x32_bf16 v[36:39], v[92:95], a[28:31], v[36:39]
  v_cvt_pk_bf16_f32 v30, v16, v17
  v_add_f32 v9, v9, v18
  v_mfma_f32_16x16x32_bf16 v[40:43], v[92:95], a[92:95], v[40:43]
  ds_read_b128 v[92:95], v4 offset:11264
  v_add_f32 v9, v9, v19
  v_mfma_f32_16x16x32_bf16 v[44:47], v[96:99], a[28:31], v[44:47]
  v_cvt_pk_bf16_f32 v31, v18, v19
  v_add_f32 v10, v12, v13
  v_mfma_f32_16x16x32_bf16 v[48:51], v[96:99], a[92:95], v[48:51]
  ds_read_b128 v[96:99], v4 offset:27648
  s_waitcnt lgkmcnt(6)
  v_mfma_f32_16x16x32_bf16 v[36:39], v[68:71], a[32:35], v[36:39]
  v_exp_f32 v16, v64
  v_mfma_f32_16x16x32_bf16 v[40:43], v[68:71], a[96:99], v[40:43]
  ds_read_b128 v[68:71], v5 offset:12288
  v_cvt_pk_bf16_f32 v32, v12, v13
  v_mfma_f32_16x16x32_bf16 v[44:47], v[72:75], a[32:35], v[44:47]
  v_exp_f32 v17, v65
  v_mfma_f32_16x16x32_bf16 v[48:51], v[72:75], a[96:99], v[48:51]
  ds_read_b128 v[72:75], v5 offset:28672
  s_waitcnt lgkmcnt(6)
  v_mfma_f32_16x16x32_bf16 v[36:39], v[76:79], a[36:39], v[36:39]
  v_exp_f32 v18, v66
  v_mfma_f32_16x16x32_bf16 v[40:43], v[76:79], a[100:103], v[40:43]
  ds_read_b128 v[76:79], v5 offset:13312
  v_add_f32 v10, v10, v14
  v_mfma_f32_16x16x32_bf16 v[44:47], v[80:83], a[36:39], v[44:47]
  v_exp_f32 v19, v67
  v_mfma_f32_16x16x32_bf16 v[48:51], v[80:83], a[100:103], v[48:51]
  ds_read_b128 v[80:83], v5 offset:29696
  s_waitcnt lgkmcnt(6)
  v_mfma_f32_16x16x32_bf16 v[36:39], v[84:87], a[40:43], v[36:39]
  v_add_f32 v10, v10, v15
  v_cvt_pk_bf16_f32 v33, v14, v15
  v_mfma_f32_16x16x32_bf16 v[40:43], v[84:87], a[104:107], v[40:43]
  ds_read_b128 v[84:87], v5 offset:14336
  v_add_f32 v10, v10, v16
  v_mfma_f32_16x16x32_bf16 v[44:47], v[88:91], a[40:43], v[44:47]
  v_add_f32 v10, v10, v17
  v_cvt_pk_bf16_f32 v34, v16, v17
  v_mfma_f32_16x16x32_bf16 v[48:51], v[88:91], a[104:107], v[48:51]
  ds_read_b128 v[88:91], v5 offset:30720
  s_waitcnt lgkmcnt(6)
  v_mfma_f32_16x16x32_bf16 v[36:39], v[92:95], a[44:47], v[36:39]
  v_add_f32 v10, v10, v18
  v_add_f32 v10, v10, v19
  v_mfma_f32_16x16x32_bf16 v[40:43], v[92:95], a[108:111], v[40:43]
  ds_read_b128 v[92:95], v5 offset:15360
  v_cvt_pk_bf16_f32 v35, v18, v19
  v_mfma_f32_16x16x32_bf16 v[44:47], v[96:99], a[44:47], v[44:47]
  v_max_f32 v11, v9, v10
  v_cmp_lt_f32 vcc, s45, v11
  v_mfma_f32_16x16x32_bf16 v[48:51], v[96:99], a[108:111], v[48:51]
  ds_read_b128 v[96:99], v5 offset:31744
  s_waitcnt lgkmcnt(6)
  v_mfma_f32_16x16x32_bf16 v[36:39], v[68:71], a[48:51], v[36:39]
  s_cbranch_vccnz RARE1
RETL1:
  v_mfma_f32_16x16x32_bf16 v[40:43], v[68:71], a[112:115], v[40:43]
  ds_read_b64_tr_b16 v[68:69], v6 offset:32768
  v_mfma_f32_16x16x32_bf16 v[44:47], v[72:75], a[48:51], v[44:47]
  ds_read_b64_tr_b16 v[70:71], v6 offset:49152
  v_mfma_f32_16x16x32_bf16 v[48:51], v[72:75], a[112:115], v[48:51]
  ds_read_b64_tr_b16 v[72:73], v6 offset:33024
  s_waitcnt lgkmcnt(7)
  v_mfma_f32_16x16x32_bf16 v[36:39], v[76:79], a[52:55], v[36:39]
  ds_read_b64_tr_b16 v[74:75], v6 offset:49408
  v_mfma_f32_16x16x32_bf16 v[40:43], v[76:79], a[116:119], v[40:43]
  ds_read_b64_tr_b16 v[76:77], v6 offset:33280
  v_mfma_f32_16x16x32_bf16 v[44:47], v[80:83], a[52:55], v[44:47]
  ds_read_b64_tr_b16 v[78:79], v6 offset:49664
  v_mfma_f32_16x16x32_bf16 v[48:51], v[80:83], a[116:119], v[48:51]
  ds_read_b64_tr_b16 v[80:81], v6 offset:33536
  s_waitcnt lgkmcnt(9)
  v_mfma_f32_16x16x32_bf16 v[36:39], v[84:87], a[56:59], v[36:39]
  ds_read_b64_tr_b16 v[82:83], v6 offset:49920
  v_mfma_f32_16x16x32_bf16 v[40:43], v[84:87], a[120:123], v[40:43]
  ds_read_b64_tr_b16 v[84:85], v6 offset:33792
  v_mfma_f32_16x16x32_bf16 v[44:47], v[88:91], a[56:59], v[44:47]
  ds_read_b64_tr_b16 v[86:87], v6 offset:50176
  v_mfma_f32_16x16x32_bf16 v[48:51], v[88:91], a[120:123], v[48:51]
  ds_read_b64_tr_b16 v[88:89], v6 offset:34048
  s_waitcnt lgkmcnt(11)
  v_mfma_f32_16x16x32_bf16 v[36:39], v[92:95], a[60:63], v[36:39]
  ds_read_b64_tr_b16 v[90:91], v6 offset:50432
  v_mfma_f32_16x16x32_bf16 v[40:43], v[92:95], a[124:127], v[40:43]
  ds_read_b64_tr_b16 v[92:93], v6 offset:34304
  v_mfma_f32_16x16x32_bf16 v[44:47], v[96:99], a[60:63], v[44:47]
  ds_read_b64_tr_b16 v[94:95], v6 offset:50688
  v_mfma_f32_16x16x32_bf16 v[48:51], v[96:99], a[124:127], v[48:51]
  ds_read_b64_tr_b16 v[96:97], v6 offset:34560
  s_waitcnt lgkmcnt(11)
  v_mfma_f32_16x16x32_bf16 v[128:131], v[68:71], v[28:31], v[128:131]
  ds_read_b64_tr_b16 v[98:99], v6 offset:50944
  v_add_f32 v7, v7, v9
  v_mfma_f32_16x16x32_bf16 v[132:135], v[68:71], v[32:35], v[132:135]
  ds_read_b64_tr_b16 v[68:69], v6 offset:34816
  v_add_f32 v8, v8, v10
  v_mfma_f32_16x16x32_bf16 v[136:139], v[72:75], v[28:31], v[136:139]
  ds_read_b64_tr_b16 v[70:71], v6 offset:51200
  s_add_u32 s47, s47, 32768
  v_mfma_f32_16x16x32_bf16 v[140:143], v[72:75], v[32:35], v[140:143]
  ds_read_b64_tr_b16 v[72:73], v6 offset:35072
  s_waitcnt lgkmcnt(11)
  v_mfma_f32_16x16x32_bf16 v[144:147], v[76:79], v[28:31], v[144:147]
  ds_read_b64_tr_b16 v[74:75], v6 offset:51456
  s_and_b32 s47, s47, 0x1ffff
  v_mfma_f32_16x16x32_bf16 v[148:151], v[76:79], v[32:35], v[148:151]
  ds_read_b64_tr_b16 v[76:77], v6 offset:35328
  v_add_u32 v124, 1, v124
  v_mfma_f32_16x16x32_bf16 v[152:155], v[80:83], v[28:31], v[152:155]
  ds_read_b64_tr_b16 v[78:79], v6 offset:51712
  v_mfma_f32_16x16x32_bf16 v[156:159], v[80:83], v[32:35], v[156:159]
  ds_read_b64_tr_b16 v[80:81], v6 offset:35584
  s_waitcnt lgkmcnt(11)
  v_mfma_f32_16x16x32_bf16 v[160:163], v[84:87], v[28:31], v[160:163]
  ds_read_b64_tr_b16 v[82:83], v6 offset:51968
  v_mfma_f32_16x16x32_bf16 v[164:167], v[84:87], v[32:35], v[164:167]
  ds_read_b64_tr_b16 v[84:85], v6 offset:35840
  v_mfma_f32_16x16x32_bf16 v[168:171], v[88:91], v[28:31], v[168:171]
  ds_read_b64_tr_b16 v[86:87], v6 offset:52224
  v_mfma_f32_16x16x32_bf16 v[172:175], v[88:91], v[32:35], v[172:175]
  ds_read_b64_tr_b16 v[88:89], v6 offset:36096
  s_waitcnt vmcnt(0) lgkmcnt(11)
  v_mfma_f32_16x16x32_bf16 v[176:179], v[92:95], v[28:31], v[176:179]
  ds_read_b64_tr_b16 v[90:91], v6 offset:52480
  ds_write_b32 v125, v124
  v_mfma_f32_16x16x32_bf16 v[180:183], v[92:95], v[32:35], v[180:183]
  ds_read_b64_tr_b16 v[92:93], v6 offset:36352
  s_cmp_le_u32 s44, 13
  v_mfma_f32_16x16x32_bf16 v[184:187], v[96:99], v[28:31], v[184:187]
  ds_read_b64_tr_b16 v[94:95], v6 offset:52736
  s_cbranch_scc1 HOOKL1
HRETL1:
  v_mfma_f32_16x16x32_bf16 v[188:191], v[96:99], v[32:35], v[188:191]
  ds_read_b64_tr_b16 v[96:97], v6 offset:36608
  s_waitcnt lgkmcnt(12)
  v_mfma_f32_16x16x32_bf16 v[192:195], v[68:71], v[28:31], v[192:195]
  ds_read_b64_tr_b16 v[98:99], v6 offset:52992
  v_mfma_f32_16x16x32_bf16 v[196:199], v[68:71], v[32:35], v[196:199]
  ds_read_b64_tr_b16 v[68:69], v6 offset:40960
  v_mfma_f32_16x16x32_bf16 v[200:203], v[72:75], v[28:31], v[200:203]
  ds_read_b64_tr_b16 v[70:71], v6 offset:57344
  v_mfma_f32_16x16x32_bf16 v[204:207], v[72:75], v[32:35], v[204:207]
  ds_read_b64_tr_b16 v[72:73], v6 offset:41216
  s_waitcnt lgkmcnt(12)
  v_mfma_f32_16x16x32_bf16 v[208:211], v[76:79], v[28:31], v[208:211]
  ds_read_b64_tr_b16 v[74:75], v6 offset:57600
  v_mfma_f32_16x16x32_bf16 v[212:215], v[76:79], v[32:35], v[212:215]
  ds_read_b64_tr_b16 v[76:77], v6 offset:41472
  v_mfma_f32_16x16x32_bf16 v[216:219], v[80:83], v[28:31], v[216:219]
  ds_read_b64_tr_b16 v[78:79], v6 offset:57856
  v_mfma_f32_16x16x32_bf16 v[220:223], v[80:83], v[32:35], v[220:223]
  ds_read_b64_tr_b16 v[80:81], v6 offset:41728
  s_waitcnt lgkmcnt(12)
  v_mfma_f32_16x16x32_bf16 v[224:227], v[84:87], v[28:31], v[224:227]
  ds_read_b64_tr_b16 v[82:83], v6 offset:58112
  v_mfma_f32_16x16x32_bf16 v[228:231], v[84:87], v[32:35], v[228:231]
  ds_read_b64_tr_b16 v[84:85], v6 offset:41984
  v_mfma_f32_16x16x32_bf16 v[232:235], v[88:91], v[28:31], v[232:235]
  ds_read_b64_tr_b16 v[86:87], v6 offset:58368
  v_mfma_f32_16x16x32_bf16 v[236:239], v[88:91], v[32:35], v[236:239]
  ds_read_b64_tr_b16 v[88:89], v6 offset:42240
  s_waitcnt lgkmcnt(11)
  v_mfma_f32_16x16x32_bf16 v[240:243], v[92:95], v[28:31], v[240:243]
  ds_read_b64_tr_b16 v[90:91], v6 offset:58624
  v_mfma_f32_16x16x32_bf16 v[244:247], v[92:95], v[32:35], v[244:247]
  ds_read_b64_tr_b16 v[92:93], v6 offset:42496
  v_mfma_f32_16x16x32_bf16 v[248:251], v[96:99], v[28:31], v[248:251]
  ds_read_b64_tr_b16 v[94:95], v6 offset:58880
  ds_read_b32 v127, v126
  v_mfma_f32_16x16x32_bf16 v[252:255], v[96:99], v[32:35], v[252:255]
  ds_read_b64_tr_b16 v[96:97], v6 offset:42752
  s_waitcnt lgkmcnt(12)
  v_mfma_f32_16x16x32_bf16 a[128:131], v[68:71], v[28:31], a[128:131]
  ds_read_b64_tr_b16 v[98:99], v6 offset:59136
  v_mfma_f32_16x16x32_bf16 a[132:135], v[68:71], v[32:35], a[132:135]
  ds_read_b64_tr_b16 v[68:69], v6 offset:43008
  v_mfma_f32_16x16x32_bf16 a[136:139], v[72:75], v[28:31], a[136:139]
  ds_read_b64_tr_b16 v[70:71], v6 offset:59392
  v_mfma_f32_16x16x32_bf16 a[140:143], v[72:75], v[32:35], a[140:143]
  ds_read_b64_tr_b16 v[72:73], v6 offset:43264
  s_waitcnt lgkmcnt(12)
  v_mfma_f32_16x16x32_bf16 a[144:147], v[76:79], v[28:31], a[144:147]
  ds_read_b64_tr_b16 v[74:75], v6 offset:59648
  v_mfma_f32_16x16x32_bf16 a[148:151], v[76:79], v[32:35], a[148:151]
  ds_read_b64_tr_b16 v[76:77], v6 offset:43520
  v_mfma_f32_16x16x32_bf16 a[152:155], v[80:83], v[28:31], a[152:155]
  ds_read_b64_tr_b16 v[78:79], v6 offset:59904
  v_mfma_f32_16x16x32_bf16 a[156:159], v[80:83], v[32:35], a[156:159]
  ds_read_b64_tr_b16 v[80:81], v6 offset:43776
  s_waitcnt lgkmcnt(12)
  v_mfma_f32_16x16x32_bf16 a[160:163], v[84:87], v[28:31], a[160:163]
  ds_read_b64_tr_b16 v[82:83], v6 offset:60160
  v_mfma_f32_16x16x32_bf16 a[164:167], v[84:87], v[32:35], a[164:167]
  ds_read_b64_tr_b16 v[84:85], v6 offset:44032
  v_mfma_f32_16x16x32_bf16 a[168:171], v[88:91], v[28:31], a[168:171]
  ds_read_b64_tr_b16 v[86:87], v6 offset:60416
  v_mfma_f32_16x16x32_bf16 a[172:175], v[88:91], v[32:35], a[172:175]
  ds_read_b64_tr_b16 v[88:89], v6 offset:44288
  s_waitcnt lgkmcnt(11)
  v_mfma_f32_16x16x32_bf16 a[176:179], v[92:95], v[28:31], a[176:179]
  ds_read_b64_tr_b16 v[90:91], v6 offset:60672
  v_mfma_f32_16x16x32_bf16 a[180:183], v[92:95], v[32:35], a[180:183]
  ds_read_b64_tr_b16 v[92:93], v6 offset:44544
  v_mfma_f32_16x16x32_bf16 a[184:187], v[96:99], v[28:31], a[184:187]
  ds_read_b64_tr_b16 v[94:95], v6 offset:60928
  v_cmp_gt_u32 vcc, v124, v127
  v_mfma_f32_16x16x32_bf16 a[188:191], v[96:99], v[32:35], a[188:191]
  ds_read_b64_tr_b16 v[96:97], v6 offset:44800
  s_waitcnt lgkmcnt(11)
  v_mfma_f32_16x16x32_bf16 a[192:195], v[68:71], v[28:31], a[192:195]
  ds_read_b64_tr_b16 v[98:99], v6 offset:61184
  s_cbranch_vccnz SPINL1
SRETL1:
  v_mfma_f32_16x16x32_bf16 a[196:199], v[68:71], v[32:35], a[196:199]
  ds_read_b128 v[68:71], v4 offset:32768
  s_mov_b32 m0, s47
  v_mfma_f32_16x16x32_bf16 a[200:203], v[72:75], v[28:31], a[200:203]
  buffer_load_dwordx4 v2, s[20:23], s46 offen offset:0 sc1 lds
  v_mfma_f32_16x16x32_bf16 a[204:207], v[72:75], v[32:35], a[204:207]
  ds_read_b128 v[72:75], v4 offset:49152
  s_waitcnt lgkmcnt(10)
  v_mfma_f32_16x16x32_bf16 a[208:211], v[76:79], v[28:31], a[208:211]
  buffer_load_dwordx4 v2, s[20:23], s46 offen offset:1024 sc1 lds
  v_mfma_f32_16x16x32_bf16 a[212:215], v[76:79], v[32:35], a[212:215]
  ds_read_b128 v[76:79], v4 offset:33792
  v_mfma_f32_16x16x32_bf16 a[216:219], v[80:83], v[28:31], a[216:219]
  buffer_load_dwordx4 v2, s[20:23], s46 offen offset:2048 sc1 lds
  v_mfma_f32_16x16x32_bf16 a[220:223], v[80:83], v[32:35], a[220:223]
  ds_read_b128 v[80:83], v4 offset:50176
  s_waitcnt lgkmcnt(8)
  v_mfma_f32_16x16x32_bf16 a[224:227], v[84:87], v[28:31], a[224:227]
  buffer_load_dwordx4 v2, s[20:23], s46 offen offset:3072 sc1 lds
  v_mfma_f32_16x16x32_bf16 a[228:231], v[84:87], v[32:35], a[228:231]
  ds_read_b128 v[84:87], v4 offset:34816
  s_add_u32 m0, s47, 16384
  v_mfma_f32_16x16x32_bf16 a[232:235], v[88:91], v[28:31], a[232:235]
  buffer_load_dwordx4 v3, s[20:23], s46 offen offset:0 sc1 lds
  s_sub_u32 s44, s44, 1
  v_mfma_f32_16x16x32_bf16 a[236:239], v[88:91], v[32:35], a[236:239]
  ds_read_b128 v[88:91], v4 offset:51200
  s_waitcnt lgkmcnt(6)
  v_mfma_f32_16x16x32_bf16 a[240:243], v[92:95], v[28:31], a[240:243]
  buffer_load_dwordx4 v3, s[20:23], s46 offen offset:1024 sc1 lds
  s_cmp_lg_u32 s44, 2
  v_mfma_f32_16x16x32_bf16 a[244:247], v[92:95], v[32:35], a[244:247]
  ds_read_b128 v[92:95], v4 offset:35840
  v_mfma_f32_16x16x32_bf16 a[248:251], v[96:99], v[28:31], a[248:251]
  buffer_load_dwordx4 v3, s[20:23], s46 offen offset:2048 sc1 lds
  s_waitcnt lgkmcnt(5)
  v_mfma_f32_16x16x32_bf16 a[252:255], v[96:99], v[32:35], a[252:255]
  ds_read_b128 v[96:99], v4 offset:52224
  s_cbranch_scc1 LOOP
  v_mfma_f32_16x16x32_bf16 v[52:55], v[68:71], a[0:3], v[20:23]
  buffer_load_dwordx4 v3, s[20:23], s46 offen offset:3072 sc1 lds
  s_add_u32 s46, s46, 32768
  v_mfma_f32_16x16x32_bf16 v[56:59], v[68:71], a[64:67], v[24:27]
  ds_read_b128 v[68:71], v5 offset:36864
  v_xor_b32 v6, 0x10000, v6
  s_add_u32 s47, s47, 32768
  s_and_b32 s47, s47, 0x1ffff
  s_barrier
  v_mfma_f32_16x16x32_bf16 v[60:63], v[72:75], a[0:3], v[20:23]
  v_exp_f32 v12, v36
  s_mov_b32 m0, s47
  v_mfma_f32_16x16x32_bf16 v[64:67], v[72:75], a[64:67], v[24:27]
  ds_read_b128 v[72:75], v5 offset:53248
  buffer_load_dwordx4 v2, s[20:23], s46 offen offset:0 sc1 lds
  s_waitcnt lgkmcnt(6)
  v_mfma_f32_16x16x32_bf16 v[52:55], v[76:79], a[4:7], v[52:55]
  v_exp_f32 v13, v37
  v_mfma_f32_16x16x32_bf16 v[56:59], v[76:79], a[68:71], v[56:59]
  ds_read_b128 v[76:79], v5 offset:37888
  v_mfma_f32_16x16x32_bf16 v[60:63], v[80:83], a[4:7], v[60:63]
  v_exp_f32 v14, v38
  v_mfma_f32_16x16x32_bf16 v[64:67], v[80:83], a[68:71], v[64:67]
  ds_read_b128 v[80:83], v5 offset:54272
  buffer_load_dwordx4 v2, s[20:23], s46 offen offset:1024 sc1 lds
  s_waitcnt lgkmcnt(6)
  v_mfma_f32_16x16x32_bf16 v[52:55], v[84:87], a[8:11], v[52:55]
  v_exp_f32 v15, v39
  v_mfma_f32_16x16x32_bf16 v[56:59], v[84:87], a[72:75], v[56:59]
  ds_read_b128 v[84:87], v5 offset:38912
  v_add_f32 v9, v12, v13
  v_mfma_f32_16x16x32_bf16 v[60:63], v[88:91], a[8:11], v[60:63]
  v_exp_f32 v16, v44
  v_mfma_f32_16x16x32_bf16 v[64:67], v[88:91], a[72:75], v[64:67]
  ds_read_b128 v[88:91], v5 offset:55296
  buffer_load_dwordx4 v2, s[20:23], s46 offen offset:2048 sc1 lds
  s_waitcnt lgkmcnt(6)
  v_mfma_f32_16x16x32_bf16 v[52:55], v[92:95], a[12:15], v[52:55]
  v_exp_f32 v17, v45
  v_mfma_f32_16x16x32_bf16 v[56:59], v[92:95], a[76:79], v[56:59]
  ds_read_b128 v[92:95], v5 offset:39936
  v_cvt_pk_bf16_f32 v28, v12, v13
  v_mfma_f32_16x16x32_bf16 v[60:63], v[96:99], a[12:15], v[60:63]
  v_exp_f32 v18, v46
  v_mfma_f32_16x16x32_bf16 v[64:67], v[96:99], a[76:79], v[64:67]
  ds_read_b128 v[96:99], v5 offset:56320
  buffer_load_dwordx4 v2, s[20:23], s46 offen offset:3072 sc1 lds
  s_waitcnt lgkmcnt(6)
  v_mfma_f32_16x16x32_bf16 v[52:55], v[68:71], a[16:19], v[52:55]
  v_exp_f32 v19, v47
  v_mfma_f32_16x16x32_bf16 v[56:59], v[68:71], a[80:83], v[56:59]
  ds_read_b128 v[68:71], v4 offset:40960
  v_add_f32 v9, v9, v14
  v_mfma_f32_16x16x32_bf16 v[60:63], v[72:75], a[16:19], v[60:63]
  v_add_f32 v9, v9, v15
  v_cvt_pk_bf16_f32 v29, v14, v15
  s_add_u32 m0, s47, 16384
  v_mfma_f32_16x16x32_bf16 v[64:67], v[72:75], a[80:83], v[64:67]
  ds_read_b128 v[72:75], v4 offset:57344
  buffer_load_dwordx4 v3, s[20:23], s46 offen offset:0 sc1 lds
  s_waitcnt lgkmcnt(6)
  v_mfma_f32_16x16x32_bf16 v[52:55], v[76:79], a[20:23], v[52:55]
  v_exp_f32 v12, v40
  v_mfma_f32_16x16x32_bf16 v[56:59], v[76:79], a[84:87], v[56:59]
  ds_read_b128 v[76:79], v4 offset:41984
  v_add_f32 v9, v9, v16
  v_mfma_f32_16x16x32_bf16 v[60:63], v[80:83], a[20:23], v[60:63]
  v_exp_f32 v13, v41
  v_mfma_f32_16x16x32_bf16 v[64:67], v[80:83], a[84:87], v[64:67]
  ds_read_b128 v[80:83], v4 offset:58368
  buffer_load_dwordx4 v3, s[20:23], s46 offen offset:1024 sc1 lds
  s_waitcnt lgkmcnt(6)
  v_mfma_f32_16x16x32_bf16 v[52:55], v[84:87], a[24:27], v[52:55]
  v_exp_f32 v14, v42
  v_mfma_f32_16x16x32_bf16 v[56:59], v[84:87], a[88:91], v[56:59]
  ds_read_b128 v[84:87], v4 offset:43008
  v_add_f32 v9, v9, v17
  v_mfma_f32_16x16x32_bf16 v[60:63], v[88:91], a[24:27], v[60:63]
  v_exp_f32 v15, v43
  v_mfma_f32_16x16x32_bf16 v[64:67], v[88:91], a[88:91], v[64:67]
  ds_read_b128 v[88:91], v4 offset:59392
  buffer_load_dwordx4 v3, s[20:23], s46 offen offset:2048 sc1 lds
  s_waitcnt lgkmcnt(6)
  v_mfma_f32_16x16x32_bf16 v[52:55], v[92:95], a[28:31], v[52:55]
  v_cvt_pk_bf16_f32 v30, v16, v17
  v_add_f32 v9, v9, v18
  v_mfma_f32_16x16x32_bf16 v[56:59], v[92:95], a[92:95], v[56:59]
  ds_read_b128 v[92:95], v4 offset:44032
  v_add_f32 v9, v9, v19
  v_mfma_f32_16x16x32_bf16 v[60:63], v[96:99], a[28:31], v[60:63]
  v_cvt_pk_bf16_f32 v31, v18, v19
  v_add_f32 v10, v12, v13
  v_mfma_f32_16x16x32_bf16 v[64:67], v[96:99], a[92:95], v[64:67]
  ds_read_b128 v[96:99], v4 offset:60416
  buffer_load_dwordx4 v3, s[20:23], s46 offen offset:3072 sc1 lds
  s_waitcnt lgkmcnt(6)
  v_mfma_f32_16x16x32_bf16 v[52:55], v[68:71], a[32:35], v[52:55]
  v_exp_f32 v16, v48
  v_mfma_f32_16x16x32_bf16 v[56:59], v[68:71], a[96:99], v[56:59]
  ds_read_b128 v[68:71], v5 offset:45056
  v_cvt_pk_bf16_f32 v32, v12, v13
  v_mfma_f32_16x16x32_bf16 v[60:63], v[72:75], a[32:35], v[60:63]
  v_exp_f32 v17, v49
  s_add_u32 s46, s46, 32768
  s_add_u32 s47, s47, 32768
  s_and_b32 s47, s47, 0x1ffff
  s_lshl_b32 s33, s3, 12
  s_add_u32 s32, s46, 32768
  s_add_u32 m0, s33, 131072
  v_mfma_f32_16x16x32_bf16 v[64:67], v[72:75], a[96:99], v[64:67]
  ds_read_b128 v[72:75], v5 offset:61440
  buffer_load_dwordx4 v2, s[20:23], s32 offen offset:0 sc1 lds
  s_waitcnt lgkmcnt(6)
  v_mfma_f32_16x16x32_bf16 v[52:55], v[76:79], a[36:39], v[52:55]
  v_exp_f32 v18, v50
  v_mfma_f32_16x16x32_bf16 v[56:59], v[76:79], a[100:103], v[56:59]
  ds_read_b128 v[76:79], v5 offset:46080
  v_add_f32 v10, v10, v14
  v_mfma_f32_16x16x32_bf16 v[60:63], v[80:83], a[36:39], v[60:63]
  v_exp_f32 v19, v51
  v_mfma_f32_16x16x32_bf16 v[64:67], v[80:83], a[100:103], v[64:67]
  ds_read_b128 v[80:83], v5 offset:62464
  buffer_load_dwordx4 v2, s[20:23], s32 offen offset:1024 sc1 lds
  s_waitcnt lgkmcnt(6)
  v_mfma_f32_16x16x32_bf16 v[52:55], v[84:87], a[40:43], v[52:55]
  v_add_f32 v10, v10, v15
  v_cvt_pk_bf16_f32 v33, v14, v15
  v_mfma_f32_16x16x32_bf16 v[56:59], v[84:87], a[104:107], v[56:59]
  ds_read_b128 v[84:87], v5 offset:47104
  v_add_f32 v10, v10, v16
  v_mfma_f32_16x16x32_bf16 v[60:63], v[88:91], a[40:43], v[60:63]
  v_add_f32 v10, v10, v17
  v_cvt_pk_bf16_f32 v34, v16, v17
  v_mfma_f32_16x16x32_bf16 v[64:67], v[88:91], a[104:107], v[64:67]
  ds_read_b128 v[88:91], v5 offset:63488
  buffer_load_dwordx4 v2, s[20:23], s32 offen offset:2048 sc1 lds
  s_waitcnt lgkmcnt(6)
  v_mfma_f32_16x16x32_bf16 v[52:55], v[92:95], a[44:47], v[52:55]
  v_add_f32 v10, v10, v18
  v_add_f32 v10, v10, v19
  v_mfma_f32_16x16x32_bf16 v[56:59], v[92:95], a[108:111], v[56:59]
  ds_read_b128 v[92:95], v5 offset:48128
  v_cvt_pk_bf16_f32 v35, v18, v19
  v_mfma_f32_16x16x32_bf16 v[60:63], v[96:99], a[44:47], v[60:63]
  v_max_f32 v11, v9, v10
  v_cmp_lt_f32 vcc, s45, v11
  v_mfma_f32_16x16x32_bf16 v[64:67], v[96:99], a[108:111], v[64:67]
  ds_read_b128 v[96:99], v5 offset:64512
  buffer_load_dwordx4 v2, s[20:23], s32 offen offset:3072 sc1 lds
  s_waitcnt lgkmcnt(6)
  v_mfma_f32_16x16x32_bf16 v[52:55], v[68:71], a[48:51], v[52:55]
  s_cbranch_vccnz RARE0
RETP0:
  v_mfma_f32_16x16x32_bf16 v[56:59], v[68:71], a[112:115], v[56:59]
  ds_read_b64_tr_b16 v[68:69], v6 offset:0
  v_mfma_f32_16x16x32_bf16 v[60:63], v[72:75], a[48:51], v[60:63]
  ds_read_b64_tr_b16 v[70:71], v6 offset:16384
  s_add_u32 m0, s33, 147456
  v_mfma_f32_16x16x32_bf16 v[64:67], v[72:75], a[112:115], v[64:67]
  ds_read_b64_tr_b16 v[72:73], v6 offset:256
  buffer_load_dwordx4 v3, s[20:23], s32 offen offset:0 sc1 lds
  s_waitcnt lgkmcnt(7)
  v_mfma_f32_16x16x32_bf16 v[52:55], v[76:79], a[52:55], v[52:55]
  ds_read_b64_tr_b16 v[74:75], v6 offset:16640
  v_mfma_f32_16x16x32_bf16 v[56:59], v[76:79], a[116:119], v[56:59]
  ds_read_b64_tr_b16 v[76:77], v6 offset:512
  v_mfma_f32_16x16x32_bf16 v[60:63], v[80:83], a[52:55], v[60:63]
  ds_read_b64_tr_b16 v[78:79], v6 offset:16896
  v_mfma_f32_16x16x32_bf16 v[64:67], v[80:83], a[116:119], v[64:67]
  ds_read_b64_tr_b16 v[80:81], v6 offset:768
  buffer_load_dwordx4 v3, s[20:23], s32 offen offset:1024 sc1 lds
  s_waitcnt lgkmcnt(9)
  v_mfma_f32_16x16x32_bf16 v[52:55], v[84:87], a[56:59], v[52:55]
  ds_read_b64_tr_b16 v[82:83], v6 offset:17152
  v_mfma_f32_16x16x32_bf16 v[56:59], v[84:87], a[120:123], v[56:59]
  ds_read_b64_tr_b16 v[84:85], v6 offset:1024
  v_mfma_f32_16x16x32_bf16 v[60:63], v[88:91], a[56:59], v[60:63]
  ds_read_b64_tr_b16 v[86:87], v6 offset:17408
  v_mfma_f32_16x16x32_bf16 v[64:67], v[88:91], a[120:123], v[64:67]
  ds_read_b64_tr_b16 v[88:89], v6 offset:1280
  buffer_load_dwordx4 v3, s[20:23], s32 offen offset:2048 sc1 lds
  s_waitcnt lgkmcnt(11)
  v_mfma_f32_16x16x32_bf16 v[52:55], v[92:95], a[60:63], v[52:55]
  ds_read_b64_tr_b16 v[90:91], v6 offset:17664
  v_mfma_f32_16x16x32_bf16 v[56:59], v[92:95], a[124:127], v[56:59]
  ds_read_b64_tr_b16 v[92:93], v6 offset:1536
  v_mfma_f32_16x16x32_bf16 v[60:63], v[96:99], a[60:63], v[60:63]
  ds_read_b64_tr_b16 v[94:95], v6 offset:17920
  v_mfma_f32_16x16x32_bf16 v[64:67], v[96:99], a[124:127], v[64:67]
  ds_read_b64_tr_b16 v[96:97], v6 offset:1792
  buffer_load_dwordx4 v3, s[20:23], s32 offen offset:3072 sc1 lds
  s_waitcnt lgkmcnt(11)
  v_mfma_f32_16x16x32_bf16 v[128:131], v[68:71], v[28:31], v[128:131]
  ds_read_b64_tr_b16 v[98:99], v6 offset:18176
  v_add_f32 v7, v7, v9
  v_mfma_f32_16x16x32_bf16 v[132:135], v[68:71], v[32:35], v[132:135]
  ds_read_b64_tr_b16 v[68:69], v6 offset:2048
  v_add_f32 v8, v8, v10
  v_mfma_f32_16x16x32_bf16 v[136:139], v[72:75], v[28:31], v[136:139]
  ds_read_b64_tr_b16 v[70:71], v6 offset:18432
  buffer_load_dwordx4 a[0:3], v117, s[20:23], s60 offen offset:0 sc1
  v_mfma_f32_16x16x32_bf16 v[140:143], v[72:75], v[32:35], v[140:143]
  ds_read_b64_tr_b16 v[72:73], v6 offset:2304
  s_waitcnt lgkmcnt(11)
  v_mfma_f32_16x16x32_bf16 v[144:147], v[76:79], v[28:31], v[144:147]
  ds_read_b64_tr_b16 v[74:75], v6 offset:18688
  v_mfma_f32_16x16x32_bf16 v[148:151], v[76:79], v[32:35], v[148:151]
  ds_read_b64_tr_b16 v[76:77], v6 offset:2560
  v_mfma_f32_16x16x32_bf16 v[152:155], v[80:83], v[28:31], v[152:155]
  ds_read_b64_tr_b16 v[78:79], v6 offset:18944
  buffer_load_dwordx4 a[4:7], v117, s[20:23], s61 offen offset:0 sc1
  v_mfma_f32_16x16x32_bf16 v[156:159], v[80:83], v[32:35], v[156:159]
  ds_read_b64_tr_b16 v[80:81], v6 offset:2816
  s_waitcnt lgkmcnt(11)
  v_mfma_f32_16x16x32_bf16 v[160:163], v[84:87], v[28:31], v[160:163]
  ds_read_b64_tr_b16 v[82:83], v6 offset:19200
  v_mfma_f32_16x16x32_bf16 v[164:167], v[84:87], v[32:35], v[164:167]
  ds_read_b64_tr_b16 v[84:85], v6 offset:3072
  v_mfma_f32_16x16x32_bf16 v[168:171], v[88:91], v[28:31], v[168:171]
  ds_read_b64_tr_b16 v[86:87], v6 offset:19456
  buffer_load_dwordx4 a[8:11], v117, s[20:23], s60 offen offset:1024 sc1
  v_mfma_f32_16x16x32_bf16 v[172:175], v[88:91], v[32:35], v[172:175]
  ds_read_b64_tr_b16 v[88:89], v6 offset:3328
  s_waitcnt lgkmcnt(11)
  v_mfma_f32_16x16x32_bf16 v[176:179], v[92:95], v[28:31], v[176:179]
  ds_read_b64_tr_b16 v[90:91], v6 offset:19712
  v_mfma_f32_16x16x32_bf16 v[180:183], v[92:95], v[32:35], v[180:183]
  ds_read_b64_tr_b16 v[92:93], v6 offset:3584
  v_mfma_f32_16x16x32_bf16 v[184:187], v[96:99], v[28:31], v[184:187]
  ds_read_b64_tr_b16 v[94:95], v6 offset:19968
  buffer_load_dwordx4 a[12:15], v117, s[20:23], s61 offen offset:1024 sc1
  v_mfma_f32_16x16x32_bf16 v[188:191], v[96:99], v[32:35], v[188:191]
  ds_read_b64_tr_b16 v[96:97], v6 offset:3840
  s_waitcnt lgkmcnt(11)
  v_mfma_f32_16x16x32_bf16 v[192:195], v[68:71], v[28:31], v[192:195]
  ds_read_b64_tr_b16 v[98:99], v6 offset:20224
  v_mfma_f32_16x16x32_bf16 v[196:199], v[68:71], v[32:35], v[196:199]
  ds_read_b64_tr_b16 v[68:69], v6 offset:8192
  v_mfma_f32_16x16x32_bf16 v[200:203], v[72:75], v[28:31], v[200:203]
  ds_read_b64_tr_b16 v[70:71], v6 offset:24576
  buffer_load_dwordx4 a[16:19], v117, s[20:23], s60 offen offset:2048 sc1
  v_mfma_f32_16x16x32_bf16 v[204:207], v[72:75], v[32:35], v[204:207]
  ds_read_b64_tr_b16 v[72:73], v6 offset:8448
  s_waitcnt lgkmcnt(11)
  v_mfma_f32_16x16x32_bf16 v[208:211], v[76:79], v[28:31], v[208:211]
  ds_read_b64_tr_b16 v[74:75], v6 offset:24832
  v_mfma_f32_16x16x32_bf16 v[212:215], v[76:79], v[32:35], v[212:215]
  ds_read_b64_tr_b16 v[76:77], v6 offset:8704
  v_mfma_f32_16x16x32_bf16 v[216:219], v[80:83], v[28:31], v[216:219]
  ds_read_b64_tr_b16 v[78:79], v6 offset:25088
  buffer_load_dwordx4 a[20:23], v117, s[20:23], s61 offen offset:2048 sc1
  v_mfma_f32_16x16x32_bf16 v[220:223], v[80:83], v[32:35], v[220:223]
  ds_read_b64_tr_b16 v[80:81], v6 offset:8960
  s_waitcnt lgkmcnt(11)
  v_mfma_f32_16x16x32_bf16 v[224:227], v[84:87], v[28:31], v[224:227]
  ds_read_b64_tr_b16 v[82:83], v6 offset:25344
  v_mfma_f32_16x16x32_bf16 v[228:231], v[84:87], v[32:35], v[228:231]
  ds_read_b64_tr_b16 v[84:85], v6 offset:9216
  v_mfma_f32_16x16x32_bf16 v[232:235], v[88:91], v[28:31], v[232:235]
  ds_read_b64_tr_b16 v[86:87], v6 offset:25600
  buffer_load_dwordx4 a[24:27], v117, s[20:23], s60 offen offset:3072 sc1
  v_mfma_f32_16x16x32_bf16 v[236:239], v[88:91], v[32:35], v[236:239]
  ds_read_b64_tr_b16 v[88:89], v6 offset:9472
  s_waitcnt lgkmcnt(11)
  v_mfma_f32_16x16x32_bf16 v[240:243], v[92:95], v[28:31], v[240:243]
  ds_read_b64_tr_b16 v[90:91], v6 offset:25856
  v_mfma_f32_16x16x32_bf16 v[244:247], v[92:95], v[32:35], v[244:247]
  ds_read_b64_tr_b16 v[92:93], v6 offset:9728
  v_mfma_f32_16x16x32_bf16 v[248:251], v[96:99], v[28:31], v[248:251]
  ds_read_b64_tr_b16 v[94:95], v6 offset:26112
  buffer_load_dwordx4 a[28:31], v117, s[20:23], s61 offen offset:3072 sc1
  v_mfma_f32_16x16x32_bf16 v[252:255], v[96:99], v[32:35], v[252:255]
  ds_read_b64_tr_b16 v[96:97], v6 offset:9984
  s_waitcnt lgkmcnt(11)
  v_mfma_f32_16x16x32_bf16 a[128:131], v[68:71], v[28:31], a[128:131]
  ds_read_b64_tr_b16 v[98:99], v6 offset:26368
  v_mfma_f32_16x16x32_bf16 a[132:135], v[68:71], v[32:35], a[132:135]
  ds_read_b64_tr_b16 v[68:69], v6 offset:10240
  v_add_u32 v117, 4096, v117
  v_mfma_f32_16x16x32_bf16 a[136:139], v[72:75], v[28:31], a[136:139]
  ds_read_b64_tr_b16 v[70:71], v6 offset:26624
  buffer_load_dwordx4 a[32:35], v117, s[20:23], s60 offen offset:0 sc1
  v_mfma_f32_16x16x32_bf16 a[140:143], v[72:75], v[32:35], a[140:143]
  ds_read_b64_tr_b16 v[72:73], v6 offset:10496
  s_waitcnt lgkmcnt(11)
  v_mfma_f32_16x16x32_bf16 a[144:147], v[76:79], v[28:31], a[144:147]
  ds_read_b64_tr_b16 v[74:75], v6 offset:26880
  v_mfma_f32_16x16x32_bf16 a[148:151], v[76:79], v[32:35], a[148:151]
  ds_read_b64_tr_b16 v[76:77], v6 offset:10752
  v_mfma_f32_16x16x32_bf16 a[152:155], v[80:83], v[28:31], a[152:155]
  ds_read_b64_tr_b16 v[78:79], v6 offset:27136
  buffer_load_dwordx4 a[36:39], v117, s[20:23], s61 offen offset:0 sc1
  v_mfma_f32_16x16x32_bf16 a[156:159], v[80:83], v[32:35], a[156:159]
  ds_read_b64_tr_b16 v[80:81], v6 offset:11008
  s_waitcnt lgkmcnt(11)
  v_mfma_f32_16x16x32_bf16 a[160:163], v[84:87], v[28:31], a[160:163]
  ds_read_b64_tr_b16 v[82:83], v6 offset:27392
  v_mfma_f32_16x16x32_bf16 a[164:167], v[84:87], v[32:35], a[164:167]
  ds_read_b64_tr_b16 v[84:85], v6 offset:11264
  v_mfma_f32_16x16x32_bf16 a[168:171], v[88:91], v[28:31], a[168:171]
  ds_read_b64_tr_b16 v[86:87], v6 offset:27648
  buffer_load_dwordx4 a[40:43], v117, s[20:23], s60 offen offset:1024 sc1
  v_mfma_f32_16x16x32_bf16 a[172:175], v[88:91], v[32:35], a[172:175]
  ds_read_b64_tr_b16 v[88:89], v6 offset:11520
  s_waitcnt lgkmcnt(11)
  v_mfma_f32_16x16x32_bf16 a[176:179], v[92:95], v[28:31], a[176:179]
  ds_read_b64_tr_b16 v[90:91], v6 offset:27904
  v_mfma_f32_16x16x32_bf16 a[180:183], v[92:95], v[32:35], a[180:183]
  ds_read_b64_tr_b16 v[92:93], v6 offset:11776
  v_mfma_f32_16x16x32_bf16 a[184:187], v[96:99], v[28:31], a[184:187]
  ds_read_b64_tr_b16 v[94:95], v6 offset:28160
  buffer_load_dwordx4 a[44:47], v117, s[20:23], s61 offen offset:1024 sc1
  v_mfma_f32_16x16x32_bf16 a[188:191], v[96:99], v[32:35], a[188:191]
  ds_read_b64_tr_b16 v[96:97], v6 offset:12032
  s_waitcnt lgkmcnt(11)
  v_mfma_f32_16x16x32_bf16 a[192:195], v[68:71], v[28:31], a[192:195]
  ds_read_b64_tr_b16 v[98:99], v6 offset:28416
  v_mfma_f32_16x16x32_bf16 a[196:199], v[68:71], v[32:35], a[196:199]
  ds_read_b64_tr_b16 v[68:69], v6 offset:32768
  v_mfma_f32_16x16x32_bf16 a[200:203], v[72:75], v[28:31], a[200:203]
  ds_read_b64_tr_b16 v[70:71], v6 offset:49152
  buffer_load_dwordx4 a[48:51], v117, s[20:23], s60 offen offset:2048 sc1
  v_mfma_f32_16x16x32_bf16 a[204:207], v[72:75], v[32:35], a[204:207]
  ds_read_b64_tr_b16 v[72:73], v6 offset:33024
  s_waitcnt lgkmcnt(11)
  v_mfma_f32_16x16x32_bf16 a[208:211], v[76:79], v[28:31], a[208:211]
  ds_read_b64_tr_b16 v[74:75], v6 offset:49408
  v_mfma_f32_16x16x32_bf16 a[212:215], v[76:79], v[32:35], a[212:215]
  ds_read_b64_tr_b16 v[76:77], v6 offset:33280
  v_mfma_f32_16x16x32_bf16 a[216:219], v[80:83], v[28:31], a[216:219]
  ds_read_b64_tr_b16 v[78:79], v6 offset:49664
  buffer_load_dwordx4 a[52:55], v117, s[20:23], s61 offen offset:2048 sc1
  v_mfma_f32_16x16x32_bf16 a[220:223], v[80:83], v[32:35], a[220:223]
  ds_read_b64_tr_b16 v[80:81], v6 offset:33536
  s_waitcnt lgkmcnt(11)
  v_mfma_f32_16x16x32_bf16 a[224:227], v[84:87], v[28:31], a[224:227]
  ds_read_b64_tr_b16 v[82:83], v6 offset:49920
  v_mfma_f32_16x16x32_bf16 a[228:231], v[84:87], v[32:35], a[228:231]
  ds_read_b64_tr_b16 v[84:85], v6 offset:33792
  v_mfma_f32_16x16x32_bf16 a[232:235], v[88:91], v[28:31], a[232:235]
  ds_read_b64_tr_b16 v[86:87], v6 offset:50176
  buffer_load_dwordx4 a[56:59], v117, s[20:23], s60 offen offset:3072 sc1
  v_mfma_f32_16x16x32_bf16 a[236:239], v[88:91], v[32:35], a[236:239]
  ds_read_b64_tr_b16 v[88:89], v6 offset:34048
  s_waitcnt lgkmcnt(11)
  v_mfma_f32_16x16x32_bf16 a[240:243], v[92:95], v[28:31], a[240:243]
  ds_read_b64_tr_b16 v[90:91], v6 offset:50432
  v_mfma_f32_16x16x32_bf16 a[244:247], v[92:95], v[32:35], a[244:247]
  ds_read_b64_tr_b16 v[92:93], v6 offset:34304
  v_mfma_f32_16x16x32_bf16 a[248:251], v[96:99], v[28:31], a[248:251]
  ds_read_b64_tr_b16 v[94:95], v6 offset:50688
  v_mfma_f32_16x16x32_bf16 a[252:255], v[96:99], v[32:35], a[252:255]
  ds_read_b64_tr_b16 v[96:97], v6 offset:34560
  s_sub_u32 s44, s44, 1
  s_barrier
  v_exp_f32 v12, v52
  s_mov_b32 m0, s47
  s_nop 0
  buffer_load_dwordx4 v2, s[20:23], s46 offen offset:0 sc1 lds
  v_exp_f32 v13, v53
  v_exp_f32 v14, v54
  v_exp_f32 v15, v55
  v_add_f32 v9, v12, v13
  v_cvt_pk_bf16_f32 v28, v12, v13
  v_add_f32 v9, v9, v14
  buffer_load_dwordx4 v2, s[20:23], s46 offen offset:1024 sc1 lds
  v_add_f32 v9, v9, v15
  v_cvt_pk_bf16_f32 v29, v14, v15
  v_exp_f32 v16, v60
  v_exp_f32 v17, v61
  v_exp_f32 v18, v62
  v_exp_f32 v19, v63
  buffer_load_dwordx4 v2, s[20:23], s46 offen offset:2048 sc1 lds
  v_add_f32 v9, v9, v16
  v_add_f32 v9, v9, v17
  v_cvt_pk_bf16_f32 v30, v16, v17
  v_add_f32 v9, v9, v18
  v_add_f32 v9, v9, v19
  v_cvt_pk_bf16_f32 v31, v18, v19
  buffer_load_dwordx4 v2, s[20:23], s46 offen offset:3072 sc1 lds
  v_exp_f32 v12, v56
  v_exp_f32 v13, v57
  v_exp_f32 v14, v58
  v_exp_f32 v15, v59
  v_add_f32 v10, v12, v13
  v_cvt_pk_bf16_f32 v32, v12, v13
  s_add_u32 m0, s47, 16384
  s_nop 0
  buffer_load_dwordx4 v3, s[20:23], s46 offen offset:0 sc1 lds
  v_add_f32 v10, v10, v14
  v_add_f32 v10, v10, v15
  v_cvt_pk_bf16_f32 v33, v14, v15
  v_exp_f32 v16, v64
  v_exp_f32 v17, v65
  v_exp_f32 v18, v66
  buffer_load_dwordx4 v3, s[20:23], s46 offen offset:1024 sc1 lds
  v_exp_f32 v19, v67
  v_add_f32 v10, v10, v16
  v_add_f32 v10, v10, v17
  v_cvt_pk_bf16_f32 v34, v16, v17
  v_add_f32 v10, v10, v18
  v_add_f32 v10, v10, v19
  buffer_load_dwordx4 v3, s[20:23], s46 offen offset:2048 sc1 lds
  v_cvt_pk_bf16_f32 v35, v18, v19
  v_max_f32 v11, v9, v10
  v_cmp_lt_f32 vcc, s45, v11
  s_cbranch_vccnz RARE1
RETT1:
  s_waitcnt lgkmcnt(11)
  v_mfma_f32_16x16x32_bf16 v[128:131], v[68:71], v[28:31], v[128:131]
  ds_read_b64_tr_b16 v[98:99], v6 offset:50944
  v_add_f32 v7, v7, v9
  v_mfma_f32_16x16x32_bf16 v[132:135], v[68:71], v[32:35], v[132:135]
  ds_read_b64_tr_b16 v[68:69], v6 offset:34816
  buffer_load_dwordx4 v3, s[20:23], s46 offen offset:3072 sc1 lds
  v_add_f32 v8, v8, v10
  v_mfma_f32_16x16x32_bf16 v[136:139], v[72:75], v[28:31], v[136:139]
  ds_read_b64_tr_b16 v[70:71], v6 offset:51200
  v_mfma_f32_16x16x32_bf16 v[140:143], v[72:75], v[32:35], v[140:143]
  ds_read_b64_tr_b16 v[72:73], v6 offset:35072
  s_waitcnt lgkmcnt(11)
  v_mfma_f32_16x16x32_bf16 v[144:147], v[76:79], v[28:31], v[144:147]
  ds_read_b64_tr_b16 v[74:75], v6 offset:51456
  buffer_load_dwordx4 a[60:63], v117, s[20:23], s61 offen offset:3072 sc1
  v_mfma_f32_16x16x32_bf16 v[148:151], v[76:79], v[32:35], v[148:151]
  ds_read_b64_tr_b16 v[76:77], v6 offset:35328
  v_mfma_f32_16x16x32_bf16 v[152:155], v[80:83], v[28:31], v[152:155]
  ds_read_b64_tr_b16 v[78:79], v6 offset:51712
  v_add_u32 v117, 4096, v117
  v_mfma_f32_16x16x32_bf16 v[156:159], v[80:83], v[32:35], v[156:159]
  ds_read_b64_tr_b16 v[80:81], v6 offset:35584
  buffer_load_dwordx4 a[64:67], v117, s[20:23], s60 offen offset:0 sc1
  s_waitcnt lgkmcnt(11)
  v_mfma_f32_16x16x32_bf16 v[160:163], v[84:87], v[28:31], v[160:163]
  ds_read_b64_tr_b16 v[82:83], v6 offset:51968
  v_mfma_f32_16x16x32_bf16 v[164:167], v[84:87], v[32:35], v[164:167]
  ds_read_b64_tr_b16 v[84:85], v6 offset:35840
  v_mfma_f32_16x16x32_bf16 v[168:171], v[88:91], v[28:31], v[168:171]
  ds_read_b64_tr_b16 v[86:87], v6 offset:52224
  buffer_load_dwordx4 a[68:71], v117, s[20:23], s61 offen offset:0 sc1
  v_mfma_f32_16x16x32_bf16 v[172:175], v[88:91], v[32:35], v[172:175]
  ds_read_b64_tr_b16 v[88:89], v6 offset:36096
  s_waitcnt lgkmcnt(11)
  v_mfma_f32_16x16x32_bf16 v[176:179], v[92:95], v[28:31], v[176:179]
  ds_read_b64_tr_b16 v[90:91], v6 offset:52480
  v_mfma_f32_16x16x32_bf16 v[180:183], v[92:95], v[32:35], v[180:183]
  ds_read_b64_tr_b16 v[92:93], v6 offset:36352
  buffer_load_dwordx4 a[72:75], v117, s[20:23], s60 offen offset:1024 sc1
  v_mfma_f32_16x16x32_bf16 v[184:187], v[96:99], v[28:31], v[184:187]
  ds_read_b64_tr_b16 v[94:95], v6 offset:52736
  v_mfma_f32_16x16x32_bf16 v[188:191], v[96:99], v[32:35], v[188:191]
  ds_read_b64_tr_b16 v[96:97], v6 offset:36608
  s_waitcnt lgkmcnt(11)
  v_mfma_f32_16x16x32_bf16 v[192:195], v[68:71], v[28:31], v[192:195]
  ds_read_b64_tr_b16 v[98:99], v6 offset:52992
  buffer_load_dwordx4 a[76:79], v117, s[20:23], s61 offen offset:1024 sc1
  v_mfma_f32_16x16x32_bf16 v[196:199], v[68:71], v[32:35], v[196:199]
  ds_read_b64_tr_b16 v[68:69], v6 offset:40960
  v_mfma_f32_16x16x32_bf16 v[200:203], v[72:75], v[28:31], v[200:203]
  ds_read_b64_tr_b16 v[70:71], v6 offset:57344
  v_mfma_f32_16x16x32_bf16 v[204:207], v[72:75], v[32:35], v[204:207]
  ds_read_b64_tr_b16 v[72:73], v6 offset:41216
  buffer_load_dwordx4 a[80:83], v117, s[20:23], s60 offen offset:2048 sc1
  s_waitcnt lgkmcnt(11)
  v_mfma_f32_16x16x32_bf16 v[208:211], v[76:79], v[28:31], v[208:211]
  ds_read_b64_tr_b16 v[74:75], v6 offset:57600
  v_mfma_f32_16x16x32_bf16 v[212:215], v[76:79], v[32:35], v[212:215]
  ds_read_b64_tr_b16 v[76:77], v6 offset:41472
  v_mfma_f32_16x16x32_bf16 v[216:219], v[80:83], v[28:31], v[216:219]
  ds_read_b64_tr_b16 v[78:79], v6 offset:57856
  buffer_load_dwordx4 a[84:87], v117, s[20:23], s61 offen offset:2048 sc1
  v_mfma_f32_16x16x32_bf16 v[220:223], v[80:83], v[32:35], v[220:223]
  ds_read_b64_tr_b16 v[80:81], v6 offset:41728
  s_waitcnt lgkmcnt(11)
  v_mfma_f32_16x16x32_bf16 v[224:227], v[84:87], v[28:31], v[224:227]
  ds_read_b64_tr_b16 v[82:83], v6 offset:58112
  v_mfma_f32_16x16x32_bf16 v[228:231], v[84:87], v[32:35], v[228:231]
  ds_read_b64_tr_b16 v[84:85], v6 offset:41984
  buffer_load_dwordx4 a[88:91], v117, s[20:23], s60 offen offset:3072 sc1
  v_mfma_f32_16x16x32_bf16 v[232:235], v[88:91], v[28:31], v[232:235]
  ds_read_b64_tr_b16 v[86:87], v6 offset:58368
  v_mfma_f32_16x16x32_bf16 v[236:239], v[88:91], v[32:35], v[236:239]
  ds_read_b64_tr_b16 v[88:89], v6 offset:42240
  s_waitcnt lgkmcnt(11)
  v_mfma_f32_16x16x32_bf16 v[240:243], v[92:95], v[28:31], v[240:243]
  ds_read_b64_tr_b16 v[90:91], v6 offset:58624
  buffer_load_dwordx4 a[92:95], v117, s[20:23], s61 offen offset:3072 sc1
  v_mfma_f32_16x16x32_bf16 v[244:247], v[92:95], v[32:35], v[244:247]
  ds_read_b64_tr_b16 v[92:93], v6 offset:42496
  v_mfma_f32_16x16x32_bf16 v[248:251], v[96:99], v[28:31], v[248:251]
  ds_read_b64_tr_b16 v[94:95], v6 offset:58880
  v_add_u32 v117, 4096, v117
  v_mfma_f32_16x16x32_bf16 v[252:255], v[96:99], v[32:35], v[252:255]
  ds_read_b64_tr_b16 v[96:97], v6 offset:42752
  buffer_load_dwordx4 a[96:99], v117, s[20:23], s60 offen offset:0 sc1
  s_waitcnt lgkmcnt(11)
  v_mfma_f32_16x16x32_bf16 a[128:131], v[68:71], v[28:31], a[128:131]
  ds_read_b64_tr_b16 v[98:99], v6 offset:59136
  v_mfma_f32_16x16x32_bf16 a[132:135], v[68:71], v[32:35], a[132:135]
  ds_read_b64_tr_b16 v[68:69], v6 offset:43008
  v_mfma_f32_16x16x32_bf16 a[136:139], v[72:75], v[28:31], a[136:139]
  ds_read_b64_tr_b16 v[70:71], v6 offset:59392
  buffer_load_dwordx4 a[100:103], v117, s[20:23], s61 offen offset:0 sc1
  v_mfma_f32_16x16x32_bf16 a[140:143], v[72:75], v[32:35], a[140:143]
  ds_read_b64_tr_b16 v[72:73], v6 offset:43264
  s_waitcnt lgkmcnt(11)
  v_mfma_f32_16x16x32_bf16 a[144:147], v[76:79], v[28:31], a[144:147]
  ds_read_b64_tr_b16 v[74:75], v6 offset:59648
  v_mfma_f32_16x16x32_bf16 a[148:151], v[76:79], v[32:35], a[148:151]
  ds_read_b64_tr_b16 v[76:77], v6 offset:43520
  buffer_load_dwordx4 a[104:107], v117, s[20:23], s60 offen offset:1024 sc1
  v_mfma_f32_16x16x32_bf16 a[152:155], v[80:83], v[28:31], a[152:155]
  ds_read_b64_tr_b16 v[78:79], v6 offset:59904
  v_mfma_f32_16x16x32_bf16 a[156:159], v[80:83], v[32:35], a[156:159]
  ds_read_b64_tr_b16 v[80:81], v6 offset:43776
  s_waitcnt lgkmcnt(11)
  v_mfma_f32_16x16x32_bf16 a[160:163], v[84:87], v[28:31], a[160:163]
  ds_read_b64_tr_b16 v[82:83], v6 offset:60160
  buffer_load_dwordx4 a[108:111], v117, s[20:23], s61 offen offset:1024 sc1
  v_mfma_f32_16x16x32_bf16 a[164:167], v[84:87], v[32:35], a[164:167]
  ds_read_b64_tr_b16 v[84:85], v6 offset:44032
  v_mfma_f32_16x16x32_bf16 a[168:171], v[88:91], v[28:31], a[168:171]
  ds_read_b64_tr_b16 v[86:87], v6 offset:60416
  v_mfma_f32_16x16x32_bf16 a[172:175], v[88:91], v[32:35], a[172:175]
  ds_read_b64_tr_b16 v[88:89], v6 offset:44288
  buffer_load_dwordx4 a[112:115], v117, s[20:23], s60 offen offset:2048 sc1
  s_waitcnt lgkmcnt(11)
  v_mfma_f32_16x16x32_bf16 a[176:179], v[92:95], v[28:31], a[176:179]
  ds_read_b64_tr_b16 v[90:91], v6 offset:60672
  v_mfma_f32_16x16x32_bf16 a[180:183], v[92:95], v[32:35], a[180:183]
  ds_read_b64_tr_b16 v[92:93], v6 offset:44544
  v_mfma_f32_16x16x32_bf16 a[184:187], v[96:99], v[28:31], a[184:187]
  ds_read_b64_tr_b16 v[94:95], v6 offset:60928
  buffer_load_dwordx4 a[116:119], v117, s[20:23], s61 offen offset:2048 sc1
  v_mfma_f32_16x16x32_bf16 a[188:191], v[96:99], v[32:35], a[188:191]
  ds_read_b64_tr_b16 v[96:97], v6 offset:44800
  s_waitcnt lgkmcnt(11)
  v_mfma_f32_16x16x32_bf16 a[192:195], v[68:71], v[28:31], a[192:195]
  ds_read_b64_tr_b16 v[98:99], v6 offset:61184
  v_mfma_f32_16x16x32_bf16 a[196:199], v[68:71], v[32:35], a[196:199]
  buffer_load_dwordx4 a[120:123], v117, s[20:23], s60 offen offset:3072 sc1
  v_mfma_f32_16x16x32_bf16 a[200:203], v[72:75], v[28:31], a[200:203]
  v_mfma_f32_16x16x32_bf16 a[204:207], v[72:75], v[32:35], a[204:207]
  s_waitcnt lgkmcnt(8)
  v_mfma_f32_16x16x32_bf16 a[208:211], v[76:79], v[28:31], a[208:211]
  buffer_load_dwordx4 a[124:127], v117, s[20:23], s61 offen offset:3072 sc1
  v_mfma_f32_16x16x32_bf16 a[212:215], v[76:79], v[32:35], a[212:215]
  v_mfma_f32_16x16x32_bf16 a[216:219], v[80:83], v[28:31], a[216:219]
  v_mfma_f32_16x16x32_bf16 a[220:223], v[80:83], v[32:35], a[220:223]
  s_waitcnt lgkmcnt(4)
  v_mfma_f32_16x16x32_bf16 a[224:227], v[84:87], v[28:31], a[224:227]
  v_mfma_f32_16x16x32_bf16 a[228:231], v[84:87], v[32:35], a[228:231]
  v_mfma_f32_16x16x32_bf16 a[232:235], v[88:91], v[28:31], a[232:235]
  v_mfma_f32_16x16x32_bf16 a[236:239], v[88:91], v[32:35], a[236:239]
  s_waitcnt lgkmcnt(0)
  v_mfma_f32_16x16x32_bf16 a[240:243], v[92:95], v[28:31], a[240:243]
  v_mfma_f32_16x16x32_bf16 a[244:247], v[92:95], v[32:35], a[244:247]
  v_mfma_f32_16x16x32_bf16 a[248:251], v[96:99], v[28:31], a[248:251]
  v_mfma_f32_16x16x32_bf16 a[252:255], v[96:99], v[32:35], a[252:255]
  s_branch EPI
SPINF0:
  ds_read_b32 v127, v126
  s_waitcnt lgkmcnt(0)
  v_cmp_gt_u32 vcc, v124, v127
  s_cbranch_vccz SRETF0
  s_sub_u32 s25, s25, 1
  s_cbranch_scc0 SPINF0
  s_endpgm
SPINL0:
  ds_read_b32 v127, v126
  s_waitcnt lgkmcnt(0)
  v_cmp_gt_u32 vcc, v124, v127
  s_cbranch_vccz SRETL0
  s_sub_u32 s25, s25, 1
  s_cbranch_scc0 SPINL0
  s_endpgm
SPINL1:
  ds_read_b32 v127, v126
  s_waitcnt lgkmcnt(0)
  v_cmp_gt_u32 vcc, v124, v127
  s_cbranch_vccz SRETL1
  s_sub_u32 s25, s25, 1
  s_cbranch_scc0 SPINL1
  s_endpgm
HOOKL0:
  s_cmp_lg_u32 s44, 13
  s_cbranch_scc1 HK11L0
  s_mov_b32 s27, 90193920
  s_sub_u32 s26, s28, 1
  v_min_u32 v121, 2, v0
  v_add_u32 v121, s26, v121
  v_med3_i32 v121, v121, 0, 63
  v_lshlrev_b32 v121, 7, v121
  buffer_load_dword v120, v121, s[20:23], s27 offen sc1
  v_lshrrev_b32 v116, 1, v0
  v_lshlrev_b32 v116, 7, v116
  v_and_b32 v112, 1, v0
  v_lshl_add_u32 v116, v112, 4, v116
  s_mov_b32 s5, 90378240
  s_cmp_eq_u32 s3, 0
  s_cselect_b32 s5, s5, 2130706432
  buffer_load_dwordx4 v[112:115], v116, s[20:23], s5 offen sc1
  s_branch HRETL0
HK11L0:
  s_cmp_lg_u32 s44, 12
  s_cbranch_scc1 HK10L0
PLP_12:
  v_cmp_le_u32 vcc, 16, v120
  s_cmp_eq_u64 vcc, -1
  s_cbranch_scc1 POK_11
  s_sleep 1
  buffer_load_dword v120, v121, s[20:23], s27 offen sc1
  s_sub_u32 s25, s25, 1
  s_waitcnt vmcnt(0)
  s_cbranch_scc0 PLP_12
  s_endpgm
POK_11:
  s_cmp_lg_u32 s3, 0
  s_cbranch_scc1 GOK_13
GLP_14:
  v_xor_b32 v112, s4, v112
  v_xor_b32 v113, s4, v113
  v_xor_b32 v114, s4, v114
  v_xor_b32 v115, s4, v115
  v_or3_b32 v112, v112, v113, v114
  v_or_b32 v112, v112, v115
  v_cmp_ne_u32 vcc, 0, v112
  s_cbranch_vccz GOK_13
  s_sleep 1
  buffer_load_dwordx4 v[112:115], v116, s[20:23], s5 offen sc1
  s_sub_u32 s25, s25, 1
  s_waitcnt vmcnt(0)
  s_cbranch_scc0 GLP_14
  s_endpgm
GOK_13:
  s_lshr_b32 s58, s2, 3
  s_lshl_b32 s58, s58, 2
  s_add_u32 s58, s58, s3
  s_mul_i32 s58, s58, 20480
  s_add_u32 s58, s58, 85721088
  v_lshlrev_b32 v122, 6, v0
  s_branch HRETL0
HK10L0:
  s_cmp_eq_u32 s44, 11
  s_cbranch_scc1 HRETL0
  s_cmp_lt_u32 s44, 6
  s_cbranch_scc1 HK5L0
  s_branch HRETL0
HK5L0:
  s_cmp_lg_u32 s44, 5
  s_cbranch_scc1 HK4L0
  s_getpc_b64 s[96:97]
PCLOOP_15:
  s_add_u32 s96, s96, LOOP-PCLOOP_15
  s_addc_u32 s97, s97, (LOOP-PCLOOP_15)>>32
  s_and_b32 s97, s97, 0xffff
  s_mov_b32 s98, PF_END-LOOP
  s_mov_b32 s99, 0x20000
  s_lshr_b32 s100, s2, 3
  s_lshl_b32 s100, s100, 2
  s_add_u32 s100, s100, s3
  s_lshl_b32 s100, s100, 10
  v_and_b32 v120, 7, v0
  v_lshlrev_b32 v120, 7, v120
  buffer_load_dword v121, v120, s[96:99], s100 offen
  s_branch HRETL0
HK4L0:
  s_cmp_lg_u32 s44, 4
  s_cbranch_scc1 HK3L0
  s_branch HRETL0
HK3L0:
  s_lshl_b32 s46, s28, 17
  s_add_u32 s46, s46, 8519680
  s_and_b32 s59, s47, 0x18000
  s_branch HRETL0
HOOKL1:
  s_cmp_lg_u32 s44, 13
  s_cbranch_scc1 HK11L1
  s_mov_b32 s27, 90193920
  s_sub_u32 s26, s28, 1
  v_min_u32 v121, 2, v0
  v_add_u32 v121, s26, v121
  v_med3_i32 v121, v121, 0, 63
  v_lshlrev_b32 v121, 7, v121
  buffer_load_dword v120, v121, s[20:23], s27 offen sc1
  v_lshrrev_b32 v116, 1, v0
  v_lshlrev_b32 v116, 7, v116
  v_and_b32 v112, 1, v0
  v_lshl_add_u32 v116, v112, 4, v116
  s_mov_b32 s5, 90378240
  s_cmp_eq_u32 s3, 0
  s_cselect_b32 s5, s5, 2130706432
  buffer_load_dwordx4 v[112:115], v116, s[20:23], s5 offen sc1
  s_branch HRETL1
HK11L1:
  s_cmp_lg_u32 s44, 12
  s_cbranch_scc1 HK10L1
PLP_17:
  v_cmp_le_u32 vcc, 16, v120
  s_cmp_eq_u64 vcc, -1
  s_cbranch_scc1 POK_16
  s_sleep 1
  buffer_load_dword v120, v121, s[20:23], s27 offen sc1
  s_sub_u32 s25, s25, 1
  s_waitcnt vmcnt(0)
  s_cbranch_scc0 PLP_17
  s_endpgm
POK_16:
  s_cmp_lg_u32 s3, 0
  s_cbranch_scc1 GOK_18
GLP_19:
  v_xor_b32 v112, s4, v112
  v_xor_b32 v113, s4, v113
  v_xor_b32 v114, s4, v114
  v_xor_b32 v115, s4, v115
  v_or3_b32 v112, v112, v113, v114
  v_or_b32 v112, v112, v115
  v_cmp_ne_u32 vcc, 0, v112
  s_cbranch_vccz GOK_18
  s_sleep 1
  buffer_load_dwordx4 v[112:115], v116, s[20:23], s5 offen sc1
  s_sub_u32 s25, s25, 1
  s_waitcnt vmcnt(0)
  s_cbranch_scc0 GLP_19
  s_endpgm
GOK_18:
  s_lshr_b32 s58, s2, 3
  s_lshl_b32 s58, s58, 2
  s_add_u32 s58, s58, s3
  s_mul_i32 s58, s58, 20480
  s_add_u32 s58, s58, 85721088
  v_lshlrev_b32 v122, 6, v0
  s_branch HRETL1
HK10L1:
  s_cmp_eq_u32 s44, 11
  s_cbranch_scc1 HRETL1
  s_cmp_lt_u32 s44, 6
  s_cbranch_scc1 HK5L1
  s_branch HRETL1
HK5L1:
  s_cmp_lg_u32 s44, 5
  s_cbranch_scc1 HK4L1
  s_getpc_b64 s[96:97]
PCLOOP_20:
  s_add_u32 s96, s96, LOOP-PCLOOP_20
  s_addc_u32 s97, s97, (LOOP-PCLOOP_20)>>32
  s_and_b32 s97, s97, 0xffff
  s_mov_b32 s98, PF_END-LOOP
  s_mov_b32 s99, 0x20000
  s_lshr_b32 s100, s2, 3
  s_lshl_b32 s100, s100, 2
  s_add_u32 s100, s100, s3
  s_lshl_b32 s100, s100, 10
  v_and_b32 v120, 7, v0
  v_lshlrev_b32 v120, 7, v120
  buffer_load_dword v121, v120, s[96:99], s100 offen
  s_branch HRETL1
HK4L1:
  s_cmp_lg_u32 s44, 4
  s_cbranch_scc1 HK3L1
  s_branch HRETL1
HK3L1:
  s_lshl_b32 s46, s28, 17
  s_add_u32 s46, s46, 8519680
  s_and_b32 s59, s47, 0x18000
  s_branch HRETL1
PRE1:
  v_mfma_f32_16x16x32_bf16 v[36:39], v[68:71], a[0:3], v[20:23]
  buffer_load_dwordx4 v3, s[20:23], s46 offen offset:3072 sc1 lds
  s_add_u32 s46, s46, 32768
  v_mfma_f32_16x16x32_bf16 v[40:43], v[68:71], a[64:67], v[24:27]
  ds_read_b128 v[68:71], v5 offset:4096
  s_add_u32 s47, s47, 32768
  s_and_b32 s47, s47, 0x1ffff
  s_barrier
  v_mfma_f32_16x16x32_bf16 v[44:47], v[72:75], a[0:3], v[20:23]
  v_exp_f32 v12, v52
  s_mov_b32 m0, s47
  v_mfma_f32_16x16x32_bf16 v[48:51], v[72:75], a[64:67], v[24:27]
  ds_read_b128 v[72:75], v5 offset:20480
  buffer_load_dwordx4 v2, s[20:23], s46 offen offset:0 sc1 lds
  s_waitcnt lgkmcnt(6)
  v_mfma_f32_16x16x32_bf16 v[36:39], v[76:79], a[4:7], v[36:39]
  v_exp_f32 v13, v53
  v_mfma_f32_16x16x32_bf16 v[40:43], v[76:79], a[68:71], v[40:43]
  ds_read_b128 v[76:79], v5 offset:5120
  v_mfma_f32_16x16x32_bf16 v[44:47], v[80:83], a[4:7], v[44:47]
  v_exp_f32 v14, v54
  v_mfma_f32_16x16x32_bf16 v[48:51], v[80:83], a[68:71], v[48:51]
  ds_read_b128 v[80:83], v5 offset:21504
  buffer_load_dwordx4 v2, s[20:23], s46 offen offset:1024 sc1 lds
  s_waitcnt lgkmcnt(6)
  v_mfma_f32_16x16x32_bf16 v[36:39], v[84:87], a[8:11], v[36:39]
  v_exp_f32 v15, v55
  v_mfma_f32_16x16x32_bf16 v[40:43], v[84:87], a[72:75], v[40:43]
  ds_read_b128 v[84:87], v5 offset:6144
  v_add_f32 v9, v12, v13
  v_mfma_f32_16x16x32_bf16 v[44:47], v[88:91], a[8:11], v[44:47]
  v_exp_f32 v16, v60
  v_mfma_f32_16x16x32_bf16 v[48:51], v[88:91], a[72:75], v[48:51]
  ds_read_b128 v[88:91], v5 offset:22528
  buffer_load_dwordx4 v2, s[20:23], s46 offen offset:2048 sc1 lds
  s_waitcnt lgkmcnt(6)
  v_mfma_f32_16x16x32_bf16 v[36:39], v[92:95], a[12:15], v[36:39]
  v_exp_f32 v17, v61
  v_mfma_f32_16x16x32_bf16 v[40:43], v[92:95], a[76:79], v[40:43]
  ds_read_b128 v[92:95], v5 offset:7168
  v_cvt_pk_bf16_f32 v28, v12, v13
  v_mfma_f32_16x16x32_bf16 v[44:47], v[96:99], a[12:15], v[44:47]
  v_exp_f32 v18, v62
  v_mfma_f32_16x16x32_bf16 v[48:51], v[96:99], a[76:79], v[48:51]
  ds_read_b128 v[96:99], v5 offset:23552
  buffer_load_dwordx4 v2, s[20:23], s46 offen offset:3072 sc1 lds
  s_waitcnt lgkmcnt(6)
  v_mfma_f32_16x16x32_bf16 v[36:39], v[68:71], a[16:19], v[36:39]
  v_exp_f32 v19, v63
  v_mfma_f32_16x16x32_bf16 v[40:43], v[68:71], a[80:83], v[40:43]
  ds_read_b128 v[68:71], v4 offset:8192
  v_add_f32 v9, v9, v14
  v_mfma_f32_16x16x32_bf16 v[44:47], v[72:75], a[16:19], v[44:47]
  v_add_f32 v9, v9, v15
  v_cvt_pk_bf16_f32 v29, v14, v15
  s_add_u32 m0, s47, 16384
  v_mfma_f32_16x16x32_bf16 v[48:51], v[72:75], a[80:83], v[48:51]
  ds_read_b128 v[72:75], v4 offset:24576
  buffer_load_dwordx4 v3, s[20:23], s46 offen offset:0 sc1 lds
  s_waitcnt lgkmcnt(6)
  v_mfma_f32_16x16x32_bf16 v[36:39], v[76:79], a[20:23], v[36:39]
  v_exp_f32 v12, v56
  v_mfma_f32_16x16x32_bf16 v[40:43], v[76:79], a[84:87], v[40:43]
  ds_read_b128 v[76:79], v4 offset:9216
  v_add_f32 v9, v9, v16
  v_mfma_f32_16x16x32_bf16 v[44:47], v[80:83], a[20:23], v[44:47]
  v_exp_f32 v13, v57
  v_mfma_f32_16x16x32_bf16 v[48:51], v[80:83], a[84:87], v[48:51]
  ds_read_b128 v[80:83], v4 offset:25600
  buffer_load_dwordx4 v3, s[20:23], s46 offen offset:1024 sc1 lds
  s_waitcnt lgkmcnt(6)
  v_mfma_f32_16x16x32_bf16 v[36:39], v[84:87], a[24:27], v[36:39]
  v_exp_f32 v14, v58
  v_mfma_f32_16x16x32_bf16 v[40:43], v[84:87], a[88:91], v[40:43]
  ds_read_b128 v[84:87], v4 offset:10240
  v_add_f32 v9, v9, v17
  v_mfma_f32_16x16x32_bf16 v[44:47], v[88:91], a[24:27], v[44:47]
  v_exp_f32 v15, v59
  v_mfma_f32_16x16x32_bf16 v[48:51], v[88:91], a[88:91], v[48:51]
  ds_read_b128 v[88:91], v4 offset:26624
  buffer_load_dwordx4 v3, s[20:23], s46 offen offset:2048 sc1 lds
  s_waitcnt lgkmcnt(6)
  v_mfma_f32_16x16x32_bf16 v[36:39], v[92:95], a[28:31], v[36:39]
  v_cvt_pk_bf16_f32 v30, v16, v17
  v_add_f32 v9, v9, v18
  v_mfma_f32_16x16x32_bf16 v[40:43], v[92:95], a[92:95], v[40:43]
  ds_read_b128 v[92:95], v4 offset:11264
  v_add_f32 v9, v9, v19
  v_mfma_f32_16x16x32_bf16 v[44:47], v[96:99], a[28:31], v[44:47]
  v_cvt_pk_bf16_f32 v31, v18, v19
  v_add_f32 v10, v12, v13
  v_mfma_f32_16x16x32_bf16 v[48:51], v[96:99], a[92:95], v[48:51]
  ds_read_b128 v[96:99], v4 offset:27648
  buffer_load_dwordx4 v3, s[20:23], s46 offen offset:3072 sc1 lds
  s_waitcnt lgkmcnt(6)
  v_mfma_f32_16x16x32_bf16 v[36:39], v[68:71], a[32:35], v[36:39]
  v_exp_f32 v16, v64
  v_mfma_f32_16x16x32_bf16 v[40:43], v[68:71], a[96:99], v[40:43]
  ds_read_b128 v[68:71], v5 offset:12288
  v_cvt_pk_bf16_f32 v32, v12, v13
  v_mfma_f32_16x16x32_bf16 v[44:47], v[72:75], a[32:35], v[44:47]
  v_exp_f32 v17, v65
  s_add_u32 s46, s46, 32768
  s_add_u32 s47, s47, 32768
  s_and_b32 s47, s47, 0x1ffff
  s_lshl_b32 s33, s3, 12
  s_add_u32 s32, s46, 32768
  s_add_u32 m0, s33, 131072
  v_mfma_f32_16x16x32_bf16 v[48:51], v[72:75], a[96:99], v[48:51]
  ds_read_b128 v[72:75], v5 offset:28672
  buffer_load_dwordx4 v2, s[20:23], s32 offen offset:0 sc1 lds
  s_waitcnt lgkmcnt(6)
  v_mfma_f32_16x16x32_bf16 v[36:39], v[76:79], a[36:39], v[36:39]
  v_exp_f32 v18, v66
  v_mfma_f32_16x16x32_bf16 v[40:43], v[76:79], a[100:103], v[40:43]
  ds_read_b128 v[76:79], v5 offset:13312
  v_add_f32 v10, v10, v14
  v_mfma_f32_16x16x32_bf16 v[44:47], v[80:83], a[36:39], v[44:47]
  v_exp_f32 v19, v67
  v_mfma_f32_16x16x32_bf16 v[48:51], v[80:83], a[100:103], v[48:51]
  ds_read_b128 v[80:83], v5 offset:29696
  buffer_load_dwordx4 v2, s[20:23], s32 offen offset:1024 sc1 lds
  s_waitcnt lgkmcnt(6)
  v_mfma_f32_16x16x32_bf16 v[36:39], v[84:87], a[40:43], v[36:39]
  v_add_f32 v10, v10, v15
  v_cvt_pk_bf16_f32 v33, v14, v15
  v_mfma_f32_16x16x32_bf16 v[40:43], v[84:87], a[104:107], v[40:43]
  ds_read_b128 v[84:87], v5 offset:14336
  v_add_f32 v10, v10, v16
  v_mfma_f32_16x16x32_bf16 v[44:47], v[88:91], a[40:43], v[44:47]
  v_add_f32 v10, v10, v17
  v_cvt_pk_bf16_f32 v34, v16, v17
  v_mfma_f32_16x16x32_bf16 v[48:51], v[88:91], a[104:107], v[48:51]
  ds_read_b128 v[88:91], v5 offset:30720
  buffer_load_dwordx4 v2, s[20:23], s32 offen offset:2048 sc1 lds
  s_waitcnt lgkmcnt(6)
  v_mfma_f32_16x16x32_bf16 v[36:39], v[92:95], a[44:47], v[36:39]
  v_add_f32 v10, v10, v18
  v_add_f32 v10, v10, v19
  v_mfma_f32_16x16x32_bf16 v[40:43], v[92:95], a[108:111], v[40:43]
  ds_read_b128 v[92:95], v5 offset:15360
  v_cvt_pk_bf16_f32 v35, v18, v19
  v_mfma_f32_16x16x32_bf16 v[44:47], v[96:99], a[44:47], v[44:47]
  v_max_f32 v11, v9, v10
  v_cmp_lt_f32 vcc, s45, v11
  v_mfma_f32_16x16x32_bf16 v[48:51], v[96:99], a[108:111], v[48:51]
  ds_read_b128 v[96:99], v5 offset:31744
  buffer_load_dwordx4 v2, s[20:23], s32 offen offset:3072 sc1 lds
  s_waitcnt lgkmcnt(6)
  v_mfma_f32_16x16x32_bf16 v[36:39], v[68:71], a[48:51], v[36:39]
  s_cbranch_vccnz RARE1
RETP1:
  v_mfma_f32_16x16x32_bf16 v[40:43], v[68:71], a[112:115], v[40:43]
  ds_read_b64_tr_b16 v[68:69], v6 offset:32768
  v_mfma_f32_16x16x32_bf16 v[44:47], v[72:75], a[48:51], v[44:47]
  ds_read_b64_tr_b16 v[70:71], v6 offset:49152
  s_add_u32 m0, s33, 147456
  v_mfma_f32_16x16x32_bf16 v[48:51], v[72:75], a[112:115], v[48:51]
  ds_read_b64_tr_b16 v[72:73], v6 offset:33024
  buffer_load_dwordx4 v3, s[20:23], s32 offen offset:0 sc1 lds
  s_waitcnt lgkmcnt(7)
  v_mfma_f32_16x16x32_bf16 v[36:39], v[76:79], a[52:55], v[36:39]
  ds_read_b64_tr_b16 v[74:75], v6 offset:49408
  v_mfma_f32_16x16x32_bf16 v[40:43], v[76:79], a[116:119], v[40:43]
  ds_read_b64_tr_b16 v[76:77], v6 offset:33280
  v_mfma_f32_16x16x32_bf16 v[44:47], v[80:83], a[52:55], v[44:47]
  ds_read_b64_tr_b16 v[78:79], v6 offset:49664
  v_mfma_f32_16x16x32_bf16 v[48:51], v[80:83], a[116:119], v[48:51]
  ds_read_b64_tr_b16 v[80:81], v6 offset:33536
  buffer_load_dwordx4 v3, s[20:23], s32 offen offset:1024 sc1 lds
  s_waitcnt lgkmcnt(9)
  v_mfma_f32_16x16x32_bf16 v[36:39], v[84:87], a[56:59], v[36:39]
  ds_read_b64_tr_b16 v[82:83], v6 offset:49920
  v_mfma_f32_16x16x32_bf16 v[40:43], v[84:87], a[120:123], v[40:43]
  ds_read_b64_tr_b16 v[84:85], v6 offset:33792
  v_mfma_f32_16x16x32_bf16 v[44:47], v[88:91], a[56:59], v[44:47]
  ds_read_b64_tr_b16 v[86:87], v6 offset:50176
  v_mfma_f32_16x16x32_bf16 v[48:51], v[88:91], a[120:123], v[48:51]
  ds_read_b64_tr_b16 v[88:89], v6 offset:34048
  buffer_load_dwordx4 v3, s[20:23], s32 offen offset:2048 sc1 lds
  s_waitcnt lgkmcnt(11)
  v_mfma_f32_16x16x32_bf16 v[36:39], v[92:95], a[60:63], v[36:39]
  ds_read_b64_tr_b16 v[90:91], v6 offset:50432
  v_mfma_f32_16x16x32_bf16 v[40:43], v[92:95], a[124:127], v[40:43]
  ds_read_b64_tr_b16 v[92:93], v6 offset:34304
  v_mfma_f32_16x16x32_bf16 v[44:47], v[96:99], a[60:63], v[44:47]
  ds_read_b64_tr_b16 v[94:95], v6 offset:50688
  v_mfma_f32_16x16x32_bf16 v[48:51], v[96:99], a[124:127], v[48:51]
  ds_read_b64_tr_b16 v[96:97], v6 offset:34560
  buffer_load_dwordx4 v3, s[20:23], s32 offen offset:3072 sc1 lds
  s_waitcnt lgkmcnt(11)
  v_mfma_f32_16x16x32_bf16 v[128:131], v[68:71], v[28:31], v[128:131]
  ds_read_b64_tr_b16 v[98:99], v6 offset:50944
  v_add_f32 v7, v7, v9
  v_mfma_f32_16x16x32_bf16 v[132:135], v[68:71], v[32:35], v[132:135]
  ds_read_b64_tr_b16 v[68:69], v6 offset:34816
  v_add_f32 v8, v8, v10
  v_mfma_f32_16x16x32_bf16 v[136:139], v[72:75], v[28:31], v[136:139]
  ds_read_b64_tr_b16 v[70:71], v6 offset:51200
  buffer_load_dwordx4 a[0:3], v117, s[20:23], s60 offen offset:0 sc1
  v_mfma_f32_16x16x32_bf16 v[140:143], v[72:75], v[32:35], v[140:143]
  ds_read_b64_tr_b16 v[72:73], v6 offset:35072
  s_waitcnt lgkmcnt(11)
  v_mfma_f32_16x16x32_bf16 v[144:147], v[76:79], v[28:31], v[144:147]
  ds_read_b64_tr_b16 v[74:75], v6 offset:51456
  v_mfma_f32_16x16x32_bf16 v[148:151], v[76:79], v[32:35], v[148:151]
  ds_read_b64_tr_b16 v[76:77], v6 offset:35328
  v_mfma_f32_16x16x32_bf16 v[152:155], v[80:83], v[28:31], v[152:155]
  ds_read_b64_tr_b16 v[78:79], v6 offset:51712
  buffer_load_dwordx4 a[4:7], v117, s[20:23], s61 offen offset:0 sc1
  v_mfma_f32_16x16x32_bf16 v[156:159], v[80:83], v[32:35], v[156:159]
  ds_read_b64_tr_b16 v[80:81], v6 offset:35584
  s_waitcnt lgkmcnt(11)
  v_mfma_f32_16x16x32_bf16 v[160:163], v[84:87], v[28:31], v[160:163]
  ds_read_b64_tr_b16 v[82:83], v6 offset:51968
  v_mfma_f32_16x16x32_bf16 v[164:167], v[84:87], v[32:35], v[164:167]
  ds_read_b64_tr_b16 v[84:85], v6 offset:35840
  v_mfma_f32_16x16x32_bf16 v[168:171], v[88:91], v[28:31], v[168:171]
  ds_read_b64_tr_b16 v[86:87], v6 offset:52224
  buffer_load_dwordx4 a[8:11], v117, s[20:23], s60 offen offset:1024 sc1
  v_mfma_f32_16x16x32_bf16 v[172:175], v[88:91], v[32:35], v[172:175]
  ds_read_b64_tr_b16 v[88:89], v6 offset:36096
  s_waitcnt lgkmcnt(11)
  v_mfma_f32_16x16x32_bf16 v[176:179], v[92:95], v[28:31], v[176:179]
  ds_read_b64_tr_b16 v[90:91], v6 offset:52480
  v_mfma_f32_16x16x32_bf16 v[180:183], v[92:95], v[32:35], v[180:183]
  ds_read_b64_tr_b16 v[92:93], v6 offset:36352
  v_mfma_f32_16x16x32_bf16 v[184:187], v[96:99], v[28:31], v[184:187]
  ds_read_b64_tr_b16 v[94:95], v6 offset:52736
  buffer_load_dwordx4 a[12:15], v117, s[20:23], s61 offen offset:1024 sc1
  v_mfma_f32_16x16x32_bf16 v[188:191], v[96:99], v[32:35], v[188:191]
  ds_read_b64_tr_b16 v[96:97], v6 offset:36608
  s_waitcnt lgkmcnt(11)
  v_mfma_f32_16x16x32_bf16 v[192:195], v[68:71], v[28:31], v[192:195]
  ds_read_b64_tr_b16 v[98:99], v6 offset:52992
  v_mfma_f32_16x16x32_bf16 v[196:199], v[68:71], v[32:35], v[196:199]
  ds_read_b64_tr_b16 v[68:69], v6 offset:40960
  v_mfma_f32_16x16x32_bf16 v[200:203], v[72:75], v[28:31], v[200:203]
  ds_read_b64_tr_b16 v[70:71], v6 offset:57344
  buffer_load_dwordx4 a[16:19], v117, s[20:23], s60 offen offset:2048 sc1
  v_mfma_f32_16x16x32_bf16 v[204:207], v[72:75], v[32:35], v[204:207]
  ds_read_b64_tr_b16 v[72:73], v6 offset:41216
  s_waitcnt lgkmcnt(11)
  v_mfma_f32_16x16x32_bf16 v[208:211], v[76:79], v[28:31], v[208:211]
  ds_read_b64_tr_b16 v[74:75], v6 offset:57600
  v_mfma_f32_16x16x32_bf16 v[212:215], v[76:79], v[32:35], v[212:215]
  ds_read_b64_tr_b16 v[76:77], v6 offset:41472
  v_mfma_f32_16x16x32_bf16 v[216:219], v[80:83], v[28:31], v[216:219]
  ds_read_b64_tr_b16 v[78:79], v6 offset:57856
  buffer_load_dwordx4 a[20:23], v117, s[20:23], s61 offen offset:2048 sc1
  v_mfma_f32_16x16x32_bf16 v[220:223], v[80:83], v[32:35], v[220:223]
  ds_read_b64_tr_b16 v[80:81], v6 offset:41728
  s_waitcnt lgkmcnt(11)
  v_mfma_f32_16x16x32_bf16 v[224:227], v[84:87], v[28:31], v[224:227]
  ds_read_b64_tr_b16 v[82:83], v6 offset:58112
  v_mfma_f32_16x16x32_bf16 v[228:231], v[84:87], v[32:35], v[228:231]
  ds_read_b64_tr_b16 v[84:85], v6 offset:41984
  v_mfma_f32_16x16x32_bf16 v[232:235], v[88:91], v[28:31], v[232:235]
  ds_read_b64_tr_b16 v[86:87], v6 offset:58368
  buffer_load_dwordx4 a[24:27], v117, s[20:23], s60 offen offset:3072 sc1
  v_mfma_f32_16x16x32_bf16 v[236:239], v[88:91], v[32:35], v[236:239]
  ds_read_b64_tr_b16 v[88:89], v6 offset:42240
  s_waitcnt lgkmcnt(11)
  v_mfma_f32_16x16x32_bf16 v[240:243], v[92:95], v[28:31], v[240:243]
  ds_read_b64_tr_b16 v[90:91], v6 offset:58624
  v_mfma_f32_16x16x32_bf16 v[244:247], v[92:95], v[32:35], v[244:247]
  ds_read_b64_tr_b16 v[92:93], v6 offset:42496
  v_mfma_f32_16x16x32_bf16 v[248:251], v[96:99], v[28:31], v[248:251]
  ds_read_b64_tr_b16 v[94:95], v6 offset:58880
  buffer_load_dwordx4 a[28:31], v117, s[20:23], s61 offen offset:3072 sc1
  v_mfma_f32_16x16x32_bf16 v[252:255], v[96:99], v[32:35], v[252:255]
  ds_read_b64_tr_b16 v[96:97], v6 offset:42752
  s_waitcnt lgkmcnt(11)
  v_mfma_f32_16x16x32_bf16 a[128:131], v[68:71], v[28:31], a[128:131]
  ds_read_b64_tr_b16 v[98:99], v6 offset:59136
  v_mfma_f32_16x16x32_bf16 a[132:135], v[68:71], v[32:35], a[132:135]
  ds_read_b64_tr_b16 v[68:69], v6 offset:43008
  v_add_u32 v117, 4096, v117
  v_mfma_f32_16x16x32_bf16 a[136:139], v[72:75], v[28:31], a[136:139]
  ds_read_b64_tr_b16 v[70:71], v6 offset:59392
  buffer_load_dwordx4 a[32:35], v117, s[20:23], s60 offen offset:0 sc1
  v_mfma_f32_16x16x32_bf16 a[140:143], v[72:75], v[32:35], a[140:143]
  ds_read_b64_tr_b16 v[72:73], v6 offset:43264
  s_waitcnt lgkmcnt(11)
  v_mfma_f32_16x16x32_bf16 a[144:147], v[76:79], v[28:31], a[144:147]
  ds_read_b64_tr_b16 v[74:75], v6 offset:59648
  v_mfma_f32_16x16x32_bf16 a[148:151], v[76:79], v[32:35], a[148:151]
  ds_read_b64_tr_b16 v[76:77], v6 offset:43520
  v_mfma_f32_16x16x32_bf16 a[152:155], v[80:83], v[28:31], a[152:155]
  ds_read_b64_tr_b16 v[78:79], v6 offset:59904
  buffer_load_dwordx4 a[36:39], v117, s[20:23], s61 offen offset:0 sc1
  v_mfma_f32_16x16x32_bf16 a[156:159], v[80:83], v[32:35], a[156:159]
  ds_read_b64_tr_b16 v[80:81], v6 offset:43776
  s_waitcnt lgkmcnt(11)
  v_mfma_f32_16x16x32_bf16 a[160:163], v[84:87], v[28:31], a[160:163]
  ds_read_b64_tr_b16 v[82:83], v6 offset:60160
  v_mfma_f32_16x16x32_bf16 a[164:167], v[84:87], v[32:35], a[164:167]
  ds_read_b64_tr_b16 v[84:85], v6 offset:44032
  v_mfma_f32_16x16x32_bf16 a[168:171], v[88:91], v[28:31], a[168:171]
  ds_read_b64_tr_b16 v[86:87], v6 offset:60416
  buffer_load_dwordx4 a[40:43], v117, s[20:23], s60 offen offset:1024 sc1
  v_mfma_f32_16x16x32_bf16 a[172:175], v[88:91], v[32:35], a[172:175]
  ds_read_b64_tr_b16 v[88:89], v6 offset:44288
  s_waitcnt lgkmcnt(11)
  v_mfma_f32_16x16x32_bf16 a[176:179], v[92:95], v[28:31], a[176:179]
  ds_read_b64_tr_b16 v[90:91], v6 offset:60672
  v_mfma_f32_16x16x32_bf16 a[180:183], v[92:95], v[32:35], a[180:183]
  ds_read_b64_tr_b16 v[92:93], v6 offset:44544
  v_mfma_f32_16x16x32_bf16 a[184:187], v[96:99], v[28:31], a[184:187]
  ds_read_b64_tr_b16 v[94:95], v6 offset:60928
  buffer_load_dwordx4 a[44:47], v117, s[20:23], s61 offen offset:1024 sc1
  v_mfma_f32_16x16x32_bf16 a[188:191], v[96:99], v[32:35], a[188:191]
  ds_read_b64_tr_b16 v[96:97], v6 offset:44800
  s_waitcnt lgkmcnt(11)
  v_mfma_f32_16x16x32_bf16 a[192:195], v[68:71], v[28:31], a[192:195]
  ds_read_b64_tr_b16 v[98:99], v6 offset:61184
  v_xor_b32 v6, 0x10000, v6
  v_mfma_f32_16x16x32_bf16 a[196:199], v[68:71], v[32:35], a[196:199]
  ds_read_b64_tr_b16 v[68:69], v6 offset:0
  v_mfma_f32_16x16x32_bf16 a[200:203], v[72:75], v[28:31], a[200:203]
  ds_read_b64_tr_b16 v[70:71], v6 offset:16384
  buffer_load_dwordx4 a[48:51], v117, s[20:23], s60 offen offset:2048 sc1
  v_mfma_f32_16x16x32_bf16 a[204:207], v[72:75], v[32:35], a[204:207]
  ds_read_b64_tr_b16 v[72:73], v6 offset:256
  s_waitcnt lgkmcnt(11)
  v_mfma_f32_16x16x32_bf16 a[208:211], v[76:79], v[28:31], a[208:211]
  ds_read_b64_tr_b16 v[74:75], v6 offset:16640
  v_mfma_f32_16x16x32_bf16 a[212:215], v[76:79], v[32:35], a[212:215]
  ds_read_b64_tr_b16 v[76:77], v6 offset:512
  v_mfma_f32_16x16x32_bf16 a[216:219], v[80:83], v[28:31], a[216:219]
  ds_read_b64_tr_b16 v[78:79], v6 offset:16896
  buffer_load_dwordx4 a[52:55], v117, s[20:23], s61 offen offset:2048 sc1
  v_mfma_f32_16x16x32_bf16 a[220:223], v[80:83], v[32:35], a[220:223]
  ds_read_b64_tr_b16 v[80:81], v6 offset:768
  s_waitcnt lgkmcnt(11)
  v_mfma_f32_16x16x32_bf16 a[224:227], v[84:87], v[28:31], a[224:227]
  ds_read_b64_tr_b16 v[82:83], v6 offset:17152
  v_mfma_f32_16x16x32_bf16 a[228:231], v[84:87], v[32:35], a[228:231]
  ds_read_b64_tr_b16 v[84:85], v6 offset:1024
  v_mfma_f32_16x16x32_bf16 a[232:235], v[88:91], v[28:31], a[232:235]
  ds_read_b64_tr_b16 v[86:87], v6 offset:17408
  buffer_load_dwordx4 a[56:59], v117, s[20:23], s60 offen offset:3072 sc1
  v_mfma_f32_16x16x32_bf16 a[236:239], v[88:91], v[32:35], a[236:239]
  ds_read_b64_tr_b16 v[88:89], v6 offset:1280
  s_waitcnt lgkmcnt(11)
  v_mfma_f32_16x16x32_bf16 a[240:243], v[92:95], v[28:31], a[240:243]
  ds_read_b64_tr_b16 v[90:91], v6 offset:17664
  v_mfma_f32_16x16x32_bf16 a[244:247], v[92:95], v[32:35], a[244:247]
  ds_read_b64_tr_b16 v[92:93], v6 offset:1536
  v_mfma_f32_16x16x32_bf16 a[248:251], v[96:99], v[28:31], a[248:251]
  ds_read_b64_tr_b16 v[94:95], v6 offset:17920
  v_mfma_f32_16x16x32_bf16 a[252:255], v[96:99], v[32:35], a[252:255]
  ds_read_b64_tr_b16 v[96:97], v6 offset:1792
  s_sub_u32 s44, s44, 1
  s_barrier
  v_exp_f32 v12, v36
  s_mov_b32 m0, s47
  s_nop 0
  buffer_load_dwordx4 v2, s[20:23], s46 offen offset:0 sc1 lds
  v_exp_f32 v13, v37
  v_exp_f32 v14, v38
  v_exp_f32 v15, v39
  v_add_f32 v9, v12, v13
  v_cvt_pk_bf16_f32 v28, v12, v13
  v_add_f32 v9, v9, v14
  buffer_load_dwordx4 v2, s[20:23], s46 offen offset:1024 sc1 lds
  v_add_f32 v9, v9, v15
  v_cvt_pk_bf16_f32 v29, v14, v15
  v_exp_f32 v16, v44
  v_exp_f32 v17, v45
  v_exp_f32 v18, v46
  v_exp_f32 v19, v47
  buffer_load_dwordx4 v2, s[20:23], s46 offen offset:2048 sc1 lds
  v_add_f32 v9, v9, v16
  v_add_f32 v9, v9, v17
  v_cvt_pk_bf16_f32 v30, v16, v17
  v_add_f32 v9, v9, v18
  v_add_f32 v9, v9, v19
  v_cvt_pk_bf16_f32 v31, v18, v19
  buffer_load_dwordx4 v2, s[20:23], s46 offen offset:3072 sc1 lds
  v_exp_f32 v12, v40
  v_exp_f32 v13, v41
  v_exp_f32 v14, v42
  v_exp_f32 v15, v43
  v_add_f32 v10, v12, v13
  v_cvt_pk_bf16_f32 v32, v12, v13
  s_add_u32 m0, s47, 16384
  s_nop 0
  buffer_load_dwordx4 v3, s[20:23], s46 offen offset:0 sc1 lds
  v_add_f32 v10, v10, v14
  v_add_f32 v10, v10, v15
  v_cvt_pk_bf16_f32 v33, v14, v15
  v_exp_f32 v16, v48
  v_exp_f32 v17, v49
  v_exp_f32 v18, v50
  buffer_load_dwordx4 v3, s[20:23], s46 offen offset:1024 sc1 lds
  v_exp_f32 v19, v51
  v_add_f32 v10, v10, v16
  v_add_f32 v10, v10, v17
  v_cvt_pk_bf16_f32 v34, v16, v17
  v_add_f32 v10, v10, v18
  v_add_f32 v10, v10, v19
  buffer_load_dwordx4 v3, s[20:23], s46 offen offset:2048 sc1 lds
  v_cvt_pk_bf16_f32 v35, v18, v19
  v_max_f32 v11, v9, v10
  v_cmp_lt_f32 vcc, s45, v11
  s_cbranch_vccnz RARE0
RETT0:
  s_waitcnt lgkmcnt(11)
  v_mfma_f32_16x16x32_bf16 v[128:131], v[68:71], v[28:31], v[128:131]
  ds_read_b64_tr_b16 v[98:99], v6 offset:18176
  v_add_f32 v7, v7, v9
  v_mfma_f32_16x16x32_bf16 v[132:135], v[68:71], v[32:35], v[132:135]
  ds_read_b64_tr_b16 v[68:69], v6 offset:2048
  buffer_load_dwordx4 v3, s[20:23], s46 offen offset:3072 sc1 lds
  v_add_f32 v8, v8, v10
  v_mfma_f32_16x16x32_bf16 v[136:139], v[72:75], v[28:31], v[136:139]
  ds_read_b64_tr_b16 v[70:71], v6 offset:18432
  v_mfma_f32_16x16x32_bf16 v[140:143], v[72:75], v[32:35], v[140:143]
  ds_read_b64_tr_b16 v[72:73], v6 offset:2304
  s_waitcnt lgkmcnt(11)
  v_mfma_f32_16x16x32_bf16 v[144:147], v[76:79], v[28:31], v[144:147]
  ds_read_b64_tr_b16 v[74:75], v6 offset:18688
  buffer_load_dwordx4 a[60:63], v117, s[20:23], s61 offen offset:3072 sc1
  v_mfma_f32_16x16x32_bf16 v[148:151], v[76:79], v[32:35], v[148:151]
  ds_read_b64_tr_b16 v[76:77], v6 offset:2560
  v_mfma_f32_16x16x32_bf16 v[152:155], v[80:83], v[28:31], v[152:155]
  ds_read_b64_tr_b16 v[78:79], v6 offset:18944
  v_add_u32 v117, 4096, v117
  v_mfma_f32_16x16x32_bf16 v[156:159], v[80:83], v[32:35], v[156:159]
  ds_read_b64_tr_b16 v[80:81], v6 offset:2816
  buffer_load_dwordx4 a[64:67], v117, s[20:23], s60 offen offset:0 sc1
  s_waitcnt lgkmcnt(11)
  v_mfma_f32_16x16x32_bf16 v[160:163], v[84:87], v[28:31], v[160:163]
  ds_read_b64_tr_b16 v[82:83], v6 offset:19200
  v_mfma_f32_16x16x32_bf16 v[164:167], v[84:87], v[32:35], v[164:167]
  ds_read_b64_tr_b16 v[84:85], v6 offset:3072
  v_mfma_f32_16x16x32_bf16 v[168:171], v[88:91], v[28:31], v[168:171]
  ds_read_b64_tr_b16 v[86:87], v6 offset:19456
  buffer_load_dwordx4 a[68:71], v117, s[20:23], s61 offen offset:0 sc1
  v_mfma_f32_16x16x32_bf16 v[172:175], v[88:91], v[32:35], v[172:175]
  ds_read_b64_tr_b16 v[88:89], v6 offset:3328
  s_waitcnt lgkmcnt(11)
  v_mfma_f32_16x16x32_bf16 v[176:179], v[92:95], v[28:31], v[176:179]
  ds_read_b64_tr_b16 v[90:91], v6 offset:19712
  v_mfma_f32_16x16x32_bf16 v[180:183], v[92:95], v[32:35], v[180:183]
  ds_read_b64_tr_b16 v[92:93], v6 offset:3584
  buffer_load_dwordx4 a[72:75], v117, s[20:23], s60 offen offset:1024 sc1
  v_mfma_f32_16x16x32_bf16 v[184:187], v[96:99], v[28:31], v[184:187]
  ds_read_b64_tr_b16 v[94:95], v6 offset:19968
  v_mfma_f32_16x16x32_bf16 v[188:191], v[96:99], v[32:35], v[188:191]
  ds_read_b64_tr_b16 v[96:97], v6 offset:3840
  s_waitcnt lgkmcnt(11)
  v_mfma_f32_16x16x32_bf16 v[192:195], v[68:71], v[28:31], v[192:195]
  ds_read_b64_tr_b16 v[98:99], v6 offset:20224
  buffer_load_dwordx4 a[76:79], v117, s[20:23], s61 offen offset:1024 sc1
  v_mfma_f32_16x16x32_bf16 v[196:199], v[68:71], v[32:35], v[196:199]
  ds_read_b64_tr_b16 v[68:69], v6 offset:8192
  v_mfma_f32_16x16x32_bf16 v[200:203], v[72:75], v[28:31], v[200:203]
  ds_read_b64_tr_b16 v[70:71], v6 offset:24576
  v_mfma_f32_16x16x32_bf16 v[204:207], v[72:75], v[32:35], v[204:207]
  ds_read_b64_tr_b16 v[72:73], v6 offset:8448
  buffer_load_dwordx4 a[80:83], v117, s[20:23], s60 offen offset:2048 sc1
  s_waitcnt lgkmcnt(11)
  v_mfma_f32_16x16x32_bf16 v[208:211], v[76:79], v[28:31], v[208:211]
  ds_read_b64_tr_b16 v[74:75], v6 offset:24832
  v_mfma_f32_16x16x32_bf16 v[212:215], v[76:79], v[32:35], v[212:215]
  ds_read_b64_tr_b16 v[76:77], v6 offset:8704
  v_mfma_f32_16x16x32_bf16 v[216:219], v[80:83], v[28:31], v[216:219]
  ds_read_b64_tr_b16 v[78:79], v6 offset:25088
  buffer_load_dwordx4 a[84:87], v117, s[20:23], s61 offen offset:2048 sc1
  v_mfma_f32_16x16x32_bf16 v[220:223], v[80:83], v[32:35], v[220:223]
  ds_read_b64_tr_b16 v[80:81], v6 offset:8960
  s_waitcnt lgkmcnt(11)
  v_mfma_f32_16x16x32_bf16 v[224:227], v[84:87], v[28:31], v[224:227]
  ds_read_b64_tr_b16 v[82:83], v6 offset:25344
  v_mfma_f32_16x16x32_bf16 v[228:231], v[84:87], v[32:35], v[228:231]
  ds_read_b64_tr_b16 v[84:85], v6 offset:9216
  buffer_load_dwordx4 a[88:91], v117, s[20:23], s60 offen offset:3072 sc1
  v_mfma_f32_16x16x32_bf16 v[232:235], v[88:91], v[28:31], v[232:235]
  ds_read_b64_tr_b16 v[86:87], v6 offset:25600
  v_mfma_f32_16x16x32_bf16 v[236:239], v[88:91], v[32:35], v[236:239]
  ds_read_b64_tr_b16 v[88:89], v6 offset:9472
  s_waitcnt lgkmcnt(11)
  v_mfma_f32_16x16x32_bf16 v[240:243], v[92:95], v[28:31], v[240:243]
  ds_read_b64_tr_b16 v[90:91], v6 offset:25856
  buffer_load_dwordx4 a[92:95], v117, s[20:23], s61 offen offset:3072 sc1
  v_mfma_f32_16x16x32_bf16 v[244:247], v[92:95], v[32:35], v[244:247]
  ds_read_b64_tr_b16 v[92:93], v6 offset:9728
  v_mfma_f32_16x16x32_bf16 v[248:251], v[96:99], v[28:31], v[248:251]
  ds_read_b64_tr_b16 v[94:95], v6 offset:26112
  v_add_u32 v117, 4096, v117
  v_mfma_f32_16x16x32_bf16 v[252:255], v[96:99], v[32:35], v[252:255]
  ds_read_b64_tr_b16 v[96:97], v6 offset:9984
  buffer_load_dwordx4 a[96:99], v117, s[20:23], s60 offen offset:0 sc1
  s_waitcnt lgkmcnt(11)
  v_mfma_f32_16x16x32_bf16 a[128:131], v[68:71], v[28:31], a[128:131]
  ds_read_b64_tr_b16 v[98:99], v6 offset:26368
  v_mfma_f32_16x16x32_bf16 a[132:135], v[68:71], v[32:35], a[132:135]
  ds_read_b64_tr_b16 v[68:69], v6 offset:10240
  v_mfma_f32_16x16x32_bf16 a[136:139], v[72:75], v[28:31], a[136:139]
  ds_read_b64_tr_b16 v[70:71], v6 offset:26624
  buffer_load_dwordx4 a[100:103], v117, s[20:23], s61 offen offset:0 sc1
  v_mfma_f32_16x16x32_bf16 a[140:143], v[72:75], v[32:35], a[140:143]
  ds_read_b64_tr_b16 v[72:73], v6 offset:10496
  s_waitcnt lgkmcnt(11)
  v_mfma_f32_16x16x32_bf16 a[144:147], v[76:79], v[28:31], a[144:147]
  ds_read_b64_tr_b16 v[74:75], v6 offset:26880
  v_mfma_f32_16x16x32_bf16 a[148:151], v[76:79], v[32:35], a[148:151]
  ds_read_b64_tr_b16 v[76:77], v6 offset:10752
  buffer_load_dwordx4 a[104:107], v117, s[20:23], s60 offen offset:1024 sc1
  v_mfma_f32_16x16x32_bf16 a[152:155], v[80:83], v[28:31], a[152:155]
  ds_read_b64_tr_b16 v[78:79], v6 offset:27136
  v_mfma_f32_16x16x32_bf16 a[156:159], v[80:83], v[32:35], a[156:159]
  ds_read_b64_tr_b16 v[80:81], v6 offset:11008
  s_waitcnt lgkmcnt(11)
  v_mfma_f32_16x16x32_bf16 a[160:163], v[84:87], v[28:31], a[160:163]
  ds_read_b64_tr_b16 v[82:83], v6 offset:27392
  buffer_load_dwordx4 a[108:111], v117, s[20:23], s61 offen offset:1024 sc1
  v_mfma_f32_16x16x32_bf16 a[164:167], v[84:87], v[32:35], a[164:167]
  ds_read_b64_tr_b16 v[84:85], v6 offset:11264
  v_mfma_f32_16x16x32_bf16 a[168:171], v[88:91], v[28:31], a[168:171]
  ds_read_b64_tr_b16 v[86:87], v6 offset:27648
  v_mfma_f32_16x16x32_bf16 a[172:175], v[88:91], v[32:35], a[172:175]
  ds_read_b64_tr_b16 v[88:89], v6 offset:11520
  buffer_load_dwordx4 a[112:115], v117, s[20:23], s60 offen offset:2048 sc1
  s_waitcnt lgkmcnt(11)
  v_mfma_f32_16x16x32_bf16 a[176:179], v[92:95], v[28:31], a[176:179]
  ds_read_b64_tr_b16 v[90:91], v6 offset:27904
  v_mfma_f32_16x16x32_bf16 a[180:183], v[92:95], v[32:35], a[180:183]
  ds_read_b64_tr_b16 v[92:93], v6 offset:11776
  v_mfma_f32_16x16x32_bf16 a[184:187], v[96:99], v[28:31], a[184:187]
  ds_read_b64_tr_b16 v[94:95], v6 offset:28160
  buffer_load_dwordx4 a[116:119], v117, s[20:23], s61 offen offset:2048 sc1
  v_mfma_f32_16x16x32_bf16 a[188:191], v[96:99], v[32:35], a[188:191]
  ds_read_b64_tr_b16 v[96:97], v6 offset:12032
  s_waitcnt lgkmcnt(11)
  v_mfma_f32_16x16x32_bf16 a[192:195], v[68:71], v[28:31], a[192:195]
  ds_read_b64_tr_b16 v[98:99], v6 offset:28416
  v_mfma_f32_16x16x32_bf16 a[196:199], v[68:71], v[32:35], a[196:199]
  buffer_load_dwordx4 a[120:123], v117, s[20:23], s60 offen offset:3072 sc1
  v_mfma_f32_16x16x32_bf16 a[200:203], v[72:75], v[28:31], a[200:203]
  v_mfma_f32_16x16x32_bf16 a[204:207], v[72:75], v[32:35], a[204:207]
  s_waitcnt lgkmcnt(8)
  v_mfma_f32_16x16x32_bf16 a[208:211], v[76:79], v[28:31], a[208:211]
  buffer_load_dwordx4 a[124:127], v117, s[20:23], s61 offen offset:3072 sc1
  v_mfma_f32_16x16x32_bf16 a[212:215], v[76:79], v[32:35], a[212:215]
  v_mfma_f32_16x16x32_bf16 a[216:219], v[80:83], v[28:31], a[216:219]
  v_mfma_f32_16x16x32_bf16 a[220:223], v[80:83], v[32:35], a[220:223]
  s_waitcnt lgkmcnt(4)
  v_mfma_f32_16x16x32_bf16 a[224:227], v[84:87], v[28:31], a[224:227]
  v_mfma_f32_16x16x32_bf16 a[228:231], v[84:87], v[32:35], a[228:231]
  v_mfma_f32_16x16x32_bf16 a[232:235], v[88:91], v[28:31], a[232:235]
  v_mfma_f32_16x16x32_bf16 a[236:239], v[88:91], v[32:35], a[236:239]
  s_waitcnt lgkmcnt(0)
  v_mfma_f32_16x16x32_bf16 a[240:243], v[92:95], v[28:31], a[240:243]
  v_mfma_f32_16x16x32_bf16 a[244:247], v[92:95], v[32:35], a[244:247]
  v_mfma_f32_16x16x32_bf16 a[248:251], v[96:99], v[28:31], a[248:251]
  v_mfma_f32_16x16x32_bf16 a[252:255], v[96:99], v[32:35], a[252:255]
EPI:
  s_waitcnt vmcnt(17)
  s_barrier
  s_lshl_b32 s32, s28, 17
  s_add_u32 s32, s32, 8503296
  s_cmp_eq_u32 s28, 0
  s_cselect_b32 s34, 2130706432, s32
  s_add_u32 s32, s32, 131072
  s_cmp_eq_u32 s28, 63
  s_cselect_b32 s35, 2130706432, s32
  s_add_u32 s47, s47, 32768
  s_and_b32 s47, s47, 0x1ffff
  s_mov_b32 m0, s47
  s_nop 0
  buffer_load_dwordx4 v2, s[20:23], s34 offen offset:0 sc1 lds
  buffer_load_dwordx4 v2, s[20:23], s34 offen offset:1024 sc1 lds
  buffer_load_dwordx4 v2, s[20:23], s34 offen offset:2048 sc1 lds
  buffer_load_dwordx4 v2, s[20:23], s34 offen offset:3072 sc1 lds
  s_add_u32 m0, s47, 16384
  s_nop 0
  buffer_load_dwordx4 v3, s[20:23], s35 offen offset:0 sc1 lds
  buffer_load_dwordx4 v3, s[20:23], s35 offen offset:1024 sc1 lds
  buffer_load_dwordx4 v3, s[20:23], s35 offen offset:2048 sc1 lds
  buffer_load_dwordx4 v3, s[20:23], s35 offen offset:3072 sc1 lds
  v_mov_b32 v12, v7
  s_nop 1
  v_permlane16_swap_b32 v7, v12
  v_add_f32 v7, v7, v12
  v_mov_b32 v12, v7
  s_nop 1
  v_permlane32_swap_b32 v7, v12
  v_add_f32 v7, v7, v12
  v_mov_b32 v12, v8
  s_nop 1
  v_permlane16_swap_b32 v8, v12
  v_add_f32 v8, v8, v12
  v_mov_b32 v12, v8
  s_nop 1
  v_permlane32_swap_b32 v8, v12
  v_add_f32 v8, v8, v12
  v_and_b32 v12, 16, v0
  v_cmp_eq_u32 vcc, 0, v12
  s_nop 1
  v_cndmask_b32 v13, v24, v20, vcc
  v_cndmask_b32 v14, v8, v7, vcc
  v_sub_f32 v13, 0, v13
  v_cmp_gt_u32 vcc, 32, v0
  s_nop 1
  v_cndmask_b32 v124, v14, v13, vcc
  v_lshlrev_b32 v125, 2, v0
  s_add_u32 s32, s59, 0
  s_and_b32 s32, s32, 0x1ffff
  v_add_u32 v2, s32, v1
  v_xor_b32 v3, 128, v2
  s_add_u32 s32, s59, 32768
  s_and_b32 s32, s32, 0x1ffff
  v_add_u32 v4, s32, v1
  v_xor_b32 v5, 128, v4
  s_add_u32 s32, s59, 65536
  s_and_b32 s32, s32, 0x1ffff
  v_add_u32 v6, s32, v1
  v_xor_b32 v7, 128, v6
  s_mov_b32 s32, 131072
  v_add_u32 v8, s32, v1
  v_xor_b32 v9, 128, v8
  s_add_u32 s32, s59, 98304
  s_and_b32 s32, s32, 0x1ffff
  v_add_u32 v10, s32, v1
  v_xor_b32 v11, 128, v10
  ds_read_b128 v[96:99], v2 offset:0
  ds_read_b128 v[100:103], v2 offset:16384
  ds_read_b128 v[104:107], v4 offset:0
  ds_read_b128 v[108:111], v4 offset:16384
  ds_read_b128 v[112:115], v6 offset:0
  ds_read_b128 v[116:119], v6 offset:16384
  ds_read_b128 v[120:123], v8 offset:0
  s_lshl_b32 s33, s28, 2
  s_add_u32 s33, s33, s3
  s_lshl_b32 s35, s30, 8
  s_add_u32 s35, s35, s33
  s_lshl_b32 s35, s35, 8
  s_add_u32 s35, s35, 89915392
  s_lshl_b32 s36, s30, 23
  s_lshl_b32 s37, s33, 15
  s_add_u32 s36, s36, s37
  s_add_u32 s36, s36, 50593792
  s_cmp_eq_u32 s3, s30
  s_cselect_b32 s36, 2130706432, s36
  s_add_u32 s37, s36, 16384
  buffer_store_dword v124, v125, s[20:23], s35 offen sc1
  s_mul_i32 s42, s31, 10240
  s_add_u32 s42, s42, 88145920
  s_add_u32 s43, s42, 4096
  s_add_u32 s44, s42, 8192
  s_lshr_b32 s40, s28, 5
  s_and_b32 s41, s28, 31
  s_lshl_b32 s41, s41, 7
  s_mul_i32 s40, s40, 4000
  s_add_u32 s40, s40, s41
  s_lshl_b32 s40, s40, 10
  s_lshl_b32 s32, s31, 6
  s_add_u32 s40, s40, s32
  s_add_u32 s32, s41, 0
  s_add_u32 s38, s40, 0
  s_cmp_lt_u32 s32, 4000
  s_cselect_b32 s50, s38, 0x40000000
  s_add_u32 s32, s41, 16
  s_add_u32 s38, s40, 16384
  s_cmp_lt_u32 s32, 4000
  s_cselect_b32 s51, s38, 0x40000000
  s_add_u32 s32, s41, 32
  s_add_u32 s38, s40, 32768
  s_cmp_lt_u32 s32, 4000
  s_cselect_b32 s52, s38, 0x40000000
  s_add_u32 s32, s41, 48
  s_add_u32 s38, s40, 49152
  s_cmp_lt_u32 s32, 4000
  s_cselect_b32 s53, s38, 0x40000000
  s_add_u32 s32, s41, 64
  s_add_u32 s38, s40, 65536
  s_cmp_lt_u32 s32, 4000
  s_cselect_b32 s54, s38, 0x40000000
  s_add_u32 s32, s41, 80
  s_add_u32 s38, s40, 81920
  s_cmp_lt_u32 s32, 4000
  s_cselect_b32 s55, s38, 0x40000000
  s_add_u32 s32, s41, 96
  s_add_u32 s38, s40, 98304
  s_cmp_lt_u32 s32, 4000
  s_cselect_b32 s56, s38, 0x40000000
  s_add_u32 s32, s41, 112
  s_add_u32 s38, s40, 114688
  s_cmp_lt_u32 s32, 4000
  s_cselect_b32 s57, s38, 0x40000000
PF_ATT_END:
  s_waitcnt vmcnt(9)
  s_waitcnt lgkmcnt(5)
  v_mfma_f32_16x16x32_bf16 v[24:27], v[96:99], a[0:3], 0
  v_cvt_pk_bf16_f32 v128, v128, v129
  v_cvt_pk_bf16_f32 v129, v130, v131
  v_cvt_pk_bf16_f32 v130, v136, v137
  v_cvt_pk_bf16_f32 v131, v138, v139
  v_mfma_f32_16x16x32_bf16 v[28:31], v[96:99], a[4:7], 0
  ds_read_b128 v[96:99], v8 offset:16384
  v_mfma_f32_16x16x32_bf16 v[32:35], v[100:103], a[0:3], 0
  buffer_store_dwordx4 v[128:131], v1, s[20:23], s36 offen offset:0 sc1
  v_cvt_pk_bf16_f32 v132, v132, v133
  v_cvt_pk_bf16_f32 v133, v134, v135
  v_cvt_pk_bf16_f32 v134, v140, v141
  v_mfma_f32_16x16x32_bf16 v[36:39], v[100:103], a[4:7], 0
  ds_read_b128 v[100:103], v2 offset:1024
  v_cvt_pk_bf16_f32 v135, v142, v143
  s_waitcnt lgkmcnt(5)
  v_mfma_f32_16x16x32_bf16 v[40:43], v[104:107], a[0:3], 0
  buffer_store_dwordx4 v[132:135], v1, s[20:23], s37 offen offset:0 sc1
  v_cvt_pk_bf16_f32 v136, v144, v145
  v_cvt_pk_bf16_f32 v137, v146, v147
  v_cvt_pk_bf16_f32 v138, v152, v153
  v_mfma_f32_16x16x32_bf16 v[44:47], v[104:107], a[4:7], 0
  ds_read_b128 v[104:107], v2 offset:17408
  v_cvt_pk_bf16_f32 v139, v154, v155
  v_mfma_f32_16x16x32_bf16 v[48:51], v[108:111], a[0:3], 0
  buffer_store_dwordx4 v[136:139], v1, s[20:23], s36 offen offset:1024 sc1
  v_cvt_pk_bf16_f32 v140, v148, v149
  v_cvt_pk_bf16_f32 v141, v150, v151
  v_cvt_pk_bf16_f32 v142, v156, v157
  v_mfma_f32_16x16x32_bf16 v[52:55], v[108:111], a[4:7], 0
  ds_read_b128 v[108:111], v4 offset:1024
  v_cvt_pk_bf16_f32 v143, v158, v159
  s_waitcnt lgkmcnt(5)
  v_mfma_f32_16x16x32_bf16 v[56:59], v[112:115], a[0:3], 0
  buffer_store_dwordx4 v[140:143], v1, s[20:23], s37 offen offset:1024 sc1
  v_cvt_pk_bf16_f32 v144, v160, v161
  v_cvt_pk_bf16_f32 v145, v162, v163
  v_cvt_pk_bf16_f32 v146, v168, v169
  v_mfma_f32_16x16x32_bf16 v[60:63], v[112:115], a[4:7], 0
  ds_read_b128 v[112:115], v4 offset:17408
  v_cvt_pk_bf16_f32 v147, v170, v171
  v_mfma_f32_16x16x32_bf16 v[64:67], v[116:119], a[0:3], 0
  buffer_store_dwordx4 v[144:147], v1, s[20:23], s36 offen offset:2048 sc1
  v_cvt_pk_bf16_f32 v148, v164, v165
  v_cvt_pk_bf16_f32 v149, v166, v167
  v_cvt_pk_bf16_f32 v150, v172, v173
  v_mfma_f32_16x16x32_bf16 v[68:71], v[116:119], a[4:7], 0
  ds_read_b128 v[116:119], v6 offset:1024
  v_cvt_pk_bf16_f32 v151, v174, v175
  s_waitcnt lgkmcnt(5)
  v_mfma_f32_16x16x32_bf16 v[72:75], v[120:123], a[0:3], 0
  buffer_store_dwordx4 v[148:151], v1, s[20:23], s37 offen offset:2048 sc1
  v_cvt_pk_bf16_f32 v152, v176, v177
  v_cvt_pk_bf16_f32 v153, v178, v179
  v_cvt_pk_bf16_f32 v154, v184, v185
  v_mfma_f32_16x16x32_bf16 v[76:79], v[120:123], a[4:7], 0
  ds_read_b128 v[120:123], v6 offset:17408
  v_cvt_pk_bf16_f32 v155, v186, v187
  v_mfma_f32_16x16x32_bf16 v[80:83], v[96:99], a[0:3], 0
  buffer_store_dwordx4 v[152:155], v1, s[20:23], s36 offen offset:3072 sc1
  v_cvt_pk_bf16_f32 v156, v180, v181
  v_cvt_pk_bf16_f32 v157, v182, v183
  v_cvt_pk_bf16_f32 v158, v188, v189
  v_mfma_f32_16x16x32_bf16 v[84:87], v[96:99], a[4:7], 0
  ds_read_b128 v[96:99], v8 offset:1024
  v_cvt_pk_bf16_f32 v159, v190, v191
  s_waitcnt lgkmcnt(5)
  v_mfma_f32_16x16x32_bf16 v[24:27], v[100:103], a[8:11], v[24:27]
  buffer_store_dwordx4 v[156:159], v1, s[20:23], s37 offen offset:3072 sc1
  s_add_u32 s36, s36, 4096
  s_add_u32 s37, s37, 4096
  v_cvt_pk_bf16_f32 v160, v192, v193
  v_mfma_f32_16x16x32_bf16 v[28:31], v[100:103], a[12:15], v[28:31]
  ds_read_b128 v[100:103], v8 offset:17408
  v_cvt_pk_bf16_f32 v161, v194, v195
  v_cvt_pk_bf16_f32 v162, v200, v201
  v_cvt_pk_bf16_f32 v163, v202, v203
  v_mfma_f32_16x16x32_bf16 v[32:35], v[104:107], a[8:11], v[32:35]
  buffer_store_dwordx4 v[160:163], v1, s[20:23], s36 offen offset:0 sc1
  v_cvt_pk_bf16_f32 v164, v196, v197
  v_cvt_pk_bf16_f32 v165, v198, v199
  v_cvt_pk_bf16_f32 v166, v204, v205
  v_mfma_f32_16x16x32_bf16 v[36:39], v[104:107], a[12:15], v[36:39]
  ds_read_b128 v[104:107], v2 offset:2048
  v_cvt_pk_bf16_f32 v167, v206, v207
  s_waitcnt lgkmcnt(5)
  v_mfma_f32_16x16x32_bf16 v[40:43], v[108:111], a[8:11], v[40:43]
  buffer_store_dwordx4 v[164:167], v1, s[20:23], s37 offen offset:0 sc1
  v_cvt_pk_bf16_f32 v168, v208, v209
  v_cvt_pk_bf16_f32 v169, v210, v211
  v_cvt_pk_bf16_f32 v170, v216, v217
  v_mfma_f32_16x16x32_bf16 v[44:47], v[108:111], a[12:15], v[44:47]
  ds_read_b128 v[108:111], v2 offset:18432
  v_cvt_pk_bf16_f32 v171, v218, v219
  v_mfma_f32_16x16x32_bf16 v[48:51], v[112:115], a[8:11], v[48:51]
  buffer_store_dwordx4 v[168:171], v1, s[20:23], s36 offen offset:1024 sc1
  v_cvt_pk_bf16_f32 v172, v212, v213
  v_cvt_pk_bf16_f32 v173, v214, v215
  v_cvt_pk_bf16_f32 v174, v220, v221
  v_mfma_f32_16x16x32_bf16 v[52:55], v[112:115], a[12:15], v[52:55]
  ds_read_b128 v[112:115], v4 offset:2048
  v_cvt_pk_bf16_f32 v175, v222, v223
  s_waitcnt lgkmcnt(5)
  v_mfma_f32_16x16x32_bf16 v[56:59], v[116:119], a[8:11], v[56:59]
  buffer_store_dwordx4 v[172:175], v1, s[20:23], s37 offen offset:1024 sc1
  v_cvt_pk_bf16_f32 v176, v224, v225
  v_cvt_pk_bf16_f32 v177, v226, v227
  v_cvt_pk_bf16_f32 v178, v232, v233
  v_mfma_f32_16x16x32_bf16 v[60:63], v[116:119], a[12:15], v[60:63]
  ds_read_b128 v[116:119], v4 offset:18432
  v_cvt_pk_bf16_f32 v179, v234, v235
  v_mfma_f32_16x16x32_bf16 v[64:67], v[120:123], a[8:11], v[64:67]
  buffer_store_dwordx4 v[176:179], v1, s[20:23], s36 offen offset:2048 sc1
  v_cvt_pk_bf16_f32 v180, v228, v229
  v_cvt_pk_bf16_f32 v181, v230, v231
  v_cvt_pk_bf16_f32 v182, v236, v237
  v_mfma_f32_16x16x32_bf16 v[68:71], v[120:123], a[12:15], v[68:71]
  ds_read_b128 v[120:123], v6 offset:2048
  v_cvt_pk_bf16_f32 v183, v238, v239
  s_waitcnt lgkmcnt(5)
  v_mfma_f32_16x16x32_bf16 v[72:75], v[96:99], a[8:11], v[72:75]
  buffer_store_dwordx4 v[180:183], v1, s[20:23], s37 offen offset:2048 sc1
  v_cvt_pk_bf16_f32 v184, v240, v241
  v_cvt_pk_bf16_f32 v185, v242, v243
  v_cvt_pk_bf16_f32 v186, v248, v249
  v_mfma_f32_16x16x32_bf16 v[76:79], v[96:99], a[12:15], v[76:79]
  ds_read_b128 v[96:99], v6 offset:18432
  v_cvt_pk_bf16_f32 v187, v250, v251
  v_mfma_f32_16x16x32_bf16 v[80:83], v[100:103], a[8:11], v[80:83]
  buffer_store_dwordx4 v[184:187], v1, s[20:23], s36 offen offset:3072 sc1
  v_cvt_pk_bf16_f32 v188, v244, v245
  v_cvt_pk_bf16_f32 v189, v246, v247
  v_cvt_pk_bf16_f32 v190, v252, v253
  v_mfma_f32_16x16x32_bf16 v[84:87], v[100:103], a[12:15], v[84:87]
  ds_read_b128 v[100:103], v8 offset:2048
  v_cvt_pk_bf16_f32 v191, v254, v255
  s_waitcnt lgkmcnt(5)
  v_mfma_f32_16x16x32_bf16 v[24:27], v[104:107], a[16:19], v[24:27]
  buffer_store_dwordx4 v[188:191], v1, s[20:23], s37 offen offset:3072 sc1
  s_add_u32 s36, s36, 4096
  s_add_u32 s37, s37, 4096
  v_accvgpr_read_b32 v12, a128
  v_mfma_f32_16x16x32_bf16 v[28:31], v[104:107], a[20:23], v[28:31]
  ds_read_b128 v[104:107], v8 offset:18432
  v_accvgpr_read_b32 v13, a129
  v_cvt_pk_bf16_f32 v192, v12, v13
  v_accvgpr_read_b32 v14, a130
  v_mfma_f32_16x16x32_bf16 v[32:35], v[108:111], a[16:19], v[32:35]
  v_accvgpr_read_b32 v15, a131
  v_cvt_pk_bf16_f32 v193, v14, v15
  v_accvgpr_read_b32 v126, a136
  v_accvgpr_read_b32 v127, a137
  v_mfma_f32_16x16x32_bf16 v[36:39], v[108:111], a[20:23], v[36:39]
  ds_read_b128 v[108:111], v2 offset:3072
  v_cvt_pk_bf16_f32 v194, v126, v127
  v_accvgpr_read_b32 v12, a138
  s_waitcnt lgkmcnt(5)
  v_mfma_f32_16x16x32_bf16 v[40:43], v[112:115], a[16:19], v[40:43]
  v_accvgpr_read_b32 v13, a139
  v_cvt_pk_bf16_f32 v195, v12, v13
  buffer_store_dwordx4 v[192:195], v1, s[20:23], s36 offen offset:0 sc1
  v_accvgpr_read_b32 v14, a132
  v_mfma_f32_16x16x32_bf16 v[44:47], v[112:115], a[20:23], v[44:47]
  ds_read_b128 v[112:115], v2 offset:19456
  v_accvgpr_read_b32 v15, a133
  v_cvt_pk_bf16_f32 v196, v14, v15
  v_accvgpr_read_b32 v126, a134
  v_mfma_f32_16x16x32_bf16 v[48:51], v[116:119], a[16:19], v[48:51]
  v_accvgpr_read_b32 v127, a135
  v_cvt_pk_bf16_f32 v197, v126, v127
  v_accvgpr_read_b32 v12, a140
  v_accvgpr_read_b32 v13, a141
  v_mfma_f32_16x16x32_bf16 v[52:55], v[116:119], a[20:23], v[52:55]
  ds_read_b128 v[116:119], v4 offset:3072
  v_cvt_pk_bf16_f32 v198, v12, v13
  v_accvgpr_read_b32 v14, a142
  s_waitcnt lgkmcnt(5)
  v_mfma_f32_16x16x32_bf16 v[56:59], v[120:123], a[16:19], v[56:59]
  v_accvgpr_read_b32 v15, a143
  v_cvt_pk_bf16_f32 v199, v14, v15
  buffer_store_dwordx4 v[196:199], v1, s[20:23], s37 offen offset:0 sc1
  v_accvgpr_read_b32 v126, a144
  v_mfma_f32_16x16x32_bf16 v[60:63], v[120:123], a[20:23], v[60:63]
  ds_read_b128 v[120:123], v4 offset:19456
  v_accvgpr_read_b32 v127, a145
  v_cvt_pk_bf16_f32 v200, v126, v127
  v_accvgpr_read_b32 v12, a146
  v_mfma_f32_16x16x32_bf16 v[64:67], v[96:99], a[16:19], v[64:67]
  v_accvgpr_read_b32 v13, a147
  v_cvt_pk_bf16_f32 v201, v12, v13
  v_accvgpr_read_b32 v14, a152
  v_accvgpr_read_b32 v15, a153
  v_mfma_f32_16x16x32_bf16 v[68:71], v[96:99], a[20:23], v[68:71]
  ds_read_b128 v[96:99], v6 offset:3072
  v_cvt_pk_bf16_f32 v202, v14, v15
  v_accvgpr_read_b32 v126, a154
  s_waitcnt lgkmcnt(5)
  v_mfma_f32_16x16x32_bf16 v[72:75], v[100:103], a[16:19], v[72:75]
  v_accvgpr_read_b32 v127, a155
  v_cvt_pk_bf16_f32 v203, v126, v127
  buffer_store_dwordx4 v[200:203], v1, s[20:23], s36 offen offset:1024 sc1
  v_accvgpr_read_b32 v12, a148
  v_mfma_f32_16x16x32_bf16 v[76:79], v[100:103], a[20:23], v[76:79]
  ds_read_b128 v[100:103], v6 offset:19456
  v_accvgpr_read_b32 v13, a149
  v_cvt_pk_bf16_f32 v204, v12, v13
  v_accvgpr_read_b32 v14, a150
  v_mfma_f32_16x16x32_bf16 v[80:83], v[104:107], a[16:19], v[80:83]
  v_accvgpr_read_b32 v15, a151
  v_cvt_pk_bf16_f32 v205, v14, v15
  v_accvgpr_read_b32 v126, a156
  v_accvgpr_read_b32 v127, a157
  v_mfma_f32_16x16x32_bf16 v[84:87], v[104:107], a[20:23], v[84:87]
  ds_read_b128 v[104:107], v8 offset:3072
  v_cvt_pk_bf16_f32 v206, v126, v127
  v_accvgpr_read_b32 v12, a158
  s_waitcnt lgkmcnt(5)
  v_mfma_f32_16x16x32_bf16 v[24:27], v[108:111], a[24:27], v[24:27]
  v_accvgpr_read_b32 v13, a159
  v_cvt_pk_bf16_f32 v207, v12, v13
  buffer_store_dwordx4 v[204:207], v1, s[20:23], s37 offen offset:1024 sc1
  v_accvgpr_read_b32 v14, a160
  v_mfma_f32_16x16x32_bf16 v[28:31], v[108:111], a[28:31], v[28:31]
  ds_read_b128 v[108:111], v8 offset:19456
  v_accvgpr_read_b32 v15, a161
  v_cvt_pk_bf16_f32 v208, v14, v15
  v_accvgpr_read_b32 v126, a162
  v_mfma_f32_16x16x32_bf16 v[32:35], v[112:115], a[24:27], v[32:35]
  v_accvgpr_read_b32 v127, a163
  v_cvt_pk_bf16_f32 v209, v126, v127
  v_accvgpr_read_b32 v12, a168
  v_accvgpr_read_b32 v13, a169
  v_mfma_f32_16x16x32_bf16 v[36:39], v[112:115], a[28:31], v[36:39]
  ds_read_b128 v[112:115], v3 offset:4096
  v_cvt_pk_bf16_f32 v210, v12, v13
  v_accvgpr_read_b32 v14, a170
  s_waitcnt lgkmcnt(5)
  v_mfma_f32_16x16x32_bf16 v[40:43], v[116:119], a[24:27], v[40:43]
  v_accvgpr_read_b32 v15, a171
  v_cvt_pk_bf16_f32 v211, v14, v15
  buffer_store_dwordx4 v[208:211], v1, s[20:23], s36 offen offset:2048 sc1
  v_accvgpr_read_b32 v126, a164
  v_mfma_f32_16x16x32_bf16 v[44:47], v[116:119], a[28:31], v[44:47]
  ds_read_b128 v[116:119], v3 offset:20480
  v_accvgpr_read_b32 v127, a165
  v_cvt_pk_bf16_f32 v212, v126, v127
  v_accvgpr_read_b32 v12, a166
  v_mfma_f32_16x16x32_bf16 v[48:51], v[120:123], a[24:27], v[48:51]
  v_accvgpr_read_b32 v13, a167
  v_cvt_pk_bf16_f32 v213, v12, v13
  v_accvgpr_read_b32 v14, a172
  v_accvgpr_read_b32 v15, a173
  v_mfma_f32_16x16x32_bf16 v[52:55], v[120:123], a[28:31], v[52:55]
  ds_read_b128 v[120:123], v5 offset:4096
  v_cvt_pk_bf16_f32 v214, v14, v15
  v_accvgpr_read_b32 v126, a174
  s_waitcnt lgkmcnt(5)
  v_mfma_f32_16x16x32_bf16 v[56:59], v[96:99], a[24:27], v[56:59]
  v_accvgpr_read_b32 v127, a175
  v_cvt_pk_bf16_f32 v215, v126, v127
  buffer_store_dwordx4 v[212:215], v1, s[20:23], s37 offen offset:2048 sc1
  v_accvgpr_read_b32 v12, a176
  v_mfma_f32_16x16x32_bf16 v[60:63], v[96:99], a[28:31], v[60:63]
  ds_read_b128 v[96:99], v5 offset:20480
  v_accvgpr_read_b32 v13, a177
  v_cvt_pk_bf16_f32 v216, v12, v13
  v_accvgpr_read_b32 v14, a178
  v_mfma_f32_16x16x32_bf16 v[64:67], v[100:103], a[24:27], v[64:67]
  v_accvgpr_read_b32 v15, a179
  v_cvt_pk_bf16_f32 v217, v14, v15
  v_accvgpr_read_b32 v126, a184
  v_accvgpr_read_b32 v127, a185
  v_mfma_f32_16x16x32_bf16 v[68:71], v[100:103], a[28:31], v[68:71]
  ds_read_b128 v[100:103], v7 offset:4096
  v_cvt_pk_bf16_f32 v218, v126, v127
  v_accvgpr_read_b32 v12, a186
  s_waitcnt lgkmcnt(5)
  v_mfma_f32_16x16x32_bf16 v[72:75], v[104:107], a[24:27], v[72:75]
  v_accvgpr_read_b32 v13, a187
  v_cvt_pk_bf16_f32 v219, v12, v13
  buffer_store_dwordx4 v[216:219], v1, s[20:23], s36 offen offset:3072 sc1
  v_accvgpr_read_b32 v14, a180
  v_mfma_f32_16x16x32_bf16 v[76:79], v[104:107], a[28:31], v[76:79]
  ds_read_b128 v[104:107], v7 offset:20480
  v_accvgpr_read_b32 v15, a181
  v_cvt_pk_bf16_f32 v220, v14, v15
  v_accvgpr_read_b32 v126, a182
  v_mfma_f32_16x16x32_bf16 v[80:83], v[108:111], a[24:27], v[80:83]
  v_accvgpr_read_b32 v127, a183
  v_cvt_pk_bf16_f32 v221, v126, v127
  v_accvgpr_read_b32 v12, a188
  v_accvgpr_read_b32 v13, a189
  v_mfma_f32_16x16x32_bf16 v[84:87], v[108:111], a[28:31], v[84:87]
  ds_read_b128 v[108:111], v9 offset:4096
  v_cvt_pk_bf16_f32 v222, v12, v13
  v_accvgpr_read_b32 v14, a190
  s_waitcnt lgkmcnt(5)
  v_mfma_f32_16x16x32_bf16 v[24:27], v[112:115], a[32:35], v[24:27]
  v_accvgpr_read_b32 v15, a191
  v_cvt_pk_bf16_f32 v223, v14, v15
  buffer_store_dwordx4 v[220:223], v1, s[20:23], s37 offen offset:3072 sc1
  s_add_u32 s36, s36, 4096
  v_mfma_f32_16x16x32_bf16 v[28:31], v[112:115], a[36:39], v[28:31]
  ds_read_b128 v[112:115], v9 offset:20480
  s_add_u32 s37, s37, 4096
  v_accvgpr_read_b32 v126, a192
  v_accvgpr_read_b32 v127, a193
  v_mfma_f32_16x16x32_bf16 v[32:35], v[116:119], a[32:35], v[32:35]
  v_cvt_pk_bf16_f32 v224, v126, v127
  v_accvgpr_read_b32 v12, a194
  v_accvgpr_read_b32 v13, a195
  v_cvt_pk_bf16_f32 v225, v12, v13
  v_mfma_f32_16x16x32_bf16 v[36:39], v[116:119], a[36:39], v[36:39]
  ds_read_b128 v[116:119], v3 offset:5120
  v_accvgpr_read_b32 v14, a200
  v_accvgpr_read_b32 v15, a201
  s_waitcnt lgkmcnt(5)
  v_mfma_f32_16x16x32_bf16 v[40:43], v[120:123], a[32:35], v[40:43]
  v_cvt_pk_bf16_f32 v226, v14, v15
  v_accvgpr_read_b32 v126, a202
  v_accvgpr_read_b32 v127, a203
  v_cvt_pk_bf16_f32 v227, v126, v127
  v_mfma_f32_16x16x32_bf16 v[44:47], v[120:123], a[36:39], v[44:47]
  ds_read_b128 v[120:123], v3 offset:21504
  v_mfma_f32_16x16x32_bf16 v[48:51], v[96:99], a[32:35], v[48:51]
  buffer_store_dwordx4 v[224:227], v1, s[20:23], s36 offen offset:0 sc1
  v_accvgpr_read_b32 v12, a196
  v_accvgpr_read_b32 v13, a197
  v_cvt_pk_bf16_f32 v228, v12, v13
  v_mfma_f32_16x16x32_bf16 v[52:55], v[96:99], a[36:39], v[52:55]
  ds_read_b128 v[96:99], v5 offset:5120
  v_accvgpr_read_b32 v14, a198
  v_accvgpr_read_b32 v15, a199
  s_waitcnt lgkmcnt(5)
  v_mfma_f32_16x16x32_bf16 v[56:59], v[100:103], a[32:35], v[56:59]
  v_cvt_pk_bf16_f32 v229, v14, v15
  v_accvgpr_read_b32 v126, a204
  v_accvgpr_read_b32 v127, a205
  v_cvt_pk_bf16_f32 v230, v126, v127
  v_mfma_f32_16x16x32_bf16 v[60:63], v[100:103], a[36:39], v[60:63]
  ds_read_b128 v[100:103], v5 offset:21504
  v_accvgpr_read_b32 v12, a206
  v_accvgpr_read_b32 v13, a207
  v_cvt_pk_bf16_f32 v231, v12, v13
  v_mfma_f32_16x16x32_bf16 v[64:67], v[104:107], a[32:35], v[64:67]
  buffer_store_dwordx4 v[228:231], v1, s[20:23], s37 offen offset:0 sc1
  v_accvgpr_read_b32 v14, a208
  v_accvgpr_read_b32 v15, a209
  v_cvt_pk_bf16_f32 v232, v14, v15
  v_mfma_f32_16x16x32_bf16 v[68:71], v[104:107], a[36:39], v[68:71]
  ds_read_b128 v[104:107], v7 offset:5120
  v_accvgpr_read_b32 v126, a210
  v_accvgpr_read_b32 v127, a211
  s_waitcnt lgkmcnt(5)
  v_mfma_f32_16x16x32_bf16 v[72:75], v[108:111], a[32:35], v[72:75]
  v_cvt_pk_bf16_f32 v233, v126, v127
  v_accvgpr_read_b32 v12, a216
  v_accvgpr_read_b32 v13, a217
  v_cvt_pk_bf16_f32 v234, v12, v13
  v_mfma_f32_16x16x32_bf16 v[76:79], v[108:111], a[36:39], v[76:79]
  ds_read_b128 v[108:111], v7 offset:21504
  v_accvgpr_read_b32 v14, a218
  v_accvgpr_read_b32 v15, a219
  v_cvt_pk_bf16_f32 v235, v14, v15
  v_mfma_f32_16x16x32_bf16 v[80:83], v[112:115], a[32:35], v[80:83]
  buffer_store_dwordx4 v[232:235], v1, s[20:23], s36 offen offset:1024 sc1
  v_accvgpr_read_b32 v126, a212
  v_accvgpr_read_b32 v127, a213
  v_cvt_pk_bf16_f32 v236, v126, v127
  v_mfma_f32_16x16x32_bf16 v[84:87], v[112:115], a[36:39], v[84:87]
  ds_read_b128 v[112:115], v9 offset:5120
  v_accvgpr_read_b32 v12, a214
  v_accvgpr_read_b32 v13, a215
  s_waitcnt lgkmcnt(5)
  v_mfma_f32_16x16x32_bf16 v[24:27], v[116:119], a[40:43], v[24:27]
  v_cvt_pk_bf16_f32 v237, v12, v13
  v_accvgpr_read_b32 v14, a220
  v_accvgpr_read_b32 v15, a221
  v_cvt_pk_bf16_f32 v238, v14, v15
  v_mfma_f32_16x16x32_bf16 v[28:31], v[116:119], a[44:47], v[28:31]
  ds_read_b128 v[116:119], v9 offset:21504
  v_accvgpr_read_b32 v126, a222
  v_accvgpr_read_b32 v127, a223
  v_cvt_pk_bf16_f32 v239, v126, v127
  v_mfma_f32_16x16x32_bf16 v[32:35], v[120:123], a[40:43], v[32:35]
  buffer_store_dwordx4 v[236:239], v1, s[20:23], s37 offen offset:1024 sc1
  v_accvgpr_read_b32 v12, a224
  v_accvgpr_read_b32 v13, a225
  v_cvt_pk_bf16_f32 v240, v12, v13
  v_mfma_f32_16x16x32_bf16 v[36:39], v[120:123], a[44:47], v[36:39]
  ds_read_b128 v[120:123], v3 offset:6144
  v_accvgpr_read_b32 v14, a226
  v_accvgpr_read_b32 v15, a227
  s_waitcnt lgkmcnt(5)
  v_mfma_f32_16x16x32_bf16 v[40:43], v[96:99], a[40:43], v[40:43]
  v_cvt_pk_bf16_f32 v241, v14, v15
  v_accvgpr_read_b32 v126, a232
  v_accvgpr_read_b32 v127, a233
  v_cvt_pk_bf16_f32 v242, v126, v127
  v_mfma_f32_16x16x32_bf16 v[44:47], v[96:99], a[44:47], v[44:47]
  ds_read_b128 v[96:99], v3 offset:22528
  v_accvgpr_read_b32 v12, a234
  v_accvgpr_read_b32 v13, a235
  v_cvt_pk_bf16_f32 v243, v12, v13
  v_mfma_f32_16x16x32_bf16 v[48:51], v[100:103], a[40:43], v[48:51]
  buffer_store_dwordx4 v[240:243], v1, s[20:23], s36 offen offset:2048 sc1
  v_accvgpr_read_b32 v14, a228
  v_accvgpr_read_b32 v15, a229
  v_cvt_pk_bf16_f32 v244, v14, v15
  v_mfma_f32_16x16x32_bf16 v[52:55], v[100:103], a[44:47], v[52:55]
  ds_read_b128 v[100:103], v5 offset:6144
  v_accvgpr_read_b32 v126, a230
  v_accvgpr_read_b32 v127, a231
  s_waitcnt lgkmcnt(5)
  v_mfma_f32_16x16x32_bf16 v[56:59], v[104:107], a[40:43], v[56:59]
  v_cvt_pk_bf16_f32 v245, v126, v127
  v_accvgpr_read_b32 v12, a236
  v_accvgpr_read_b32 v13, a237
  v_cvt_pk_bf16_f32 v246, v12, v13
  v_mfma_f32_16x16x32_bf16 v[60:63], v[104:107], a[44:47], v[60:63]
  ds_read_b128 v[104:107], v5 offset:22528
  v_accvgpr_read_b32 v14, a238
  v_accvgpr_read_b32 v15, a239
  v_cvt_pk_bf16_f32 v247, v14, v15
  v_mfma_f32_16x16x32_bf16 v[64:67], v[108:111], a[40:43], v[64:67]
  buffer_store_dwordx4 v[244:247], v1, s[20:23], s37 offen offset:2048 sc1
  v_accvgpr_read_b32 v126, a240
  v_accvgpr_read_b32 v127, a241
  v_cvt_pk_bf16_f32 v248, v126, v127
  v_mfma_f32_16x16x32_bf16 v[68:71], v[108:111], a[44:47], v[68:71]
  ds_read_b128 v[108:111], v7 offset:6144
  v_accvgpr_read_b32 v12, a242
  v_accvgpr_read_b32 v13, a243
  s_waitcnt lgkmcnt(5)
  v_mfma_f32_16x16x32_bf16 v[72:75], v[112:115], a[40:43], v[72:75]
  v_cvt_pk_bf16_f32 v249, v12, v13
  v_accvgpr_read_b32 v14, a248
  v_accvgpr_read_b32 v15, a249
  v_cvt_pk_bf16_f32 v250, v14, v15
  v_mfma_f32_16x16x32_bf16 v[76:79], v[112:115], a[44:47], v[76:79]
  ds_read_b128 v[112:115], v7 offset:22528
  v_accvgpr_read_b32 v126, a250
  v_accvgpr_read_b32 v127, a251
  v_cvt_pk_bf16_f32 v251, v126, v127
  v_mfma_f32_16x16x32_bf16 v[80:83], v[116:119], a[40:43], v[80:83]
  buffer_store_dwordx4 v[248:251], v1, s[20:23], s36 offen offset:3072 sc1
  v_accvgpr_read_b32 v12, a244
  v_accvgpr_read_b32 v13, a245
  v_cvt_pk_bf16_f32 v252, v12, v13
  v_mfma_f32_16x16x32_bf16 v[84:87], v[116:119], a[44:47], v[84:87]
  ds_read_b128 v[116:119], v9 offset:6144
  v_accvgpr_read_b32 v14, a246
  v_accvgpr_read_b32 v15, a247
  s_waitcnt lgkmcnt(5)
  v_mfma_f32_16x16x32_bf16 v[24:27], v[120:123], a[48:51], v[24:27]
  v_cvt_pk_bf16_f32 v253, v14, v15
  v_accvgpr_read_b32 v126, a252
  v_accvgpr_read_b32 v127, a253
  v_cvt_pk_bf16_f32 v254, v126, v127
  v_mfma_f32_16x16x32_bf16 v[28:31], v[120:123], a[52:55], v[28:31]
  ds_read_b128 v[120:123], v9 offset:22528
  v_accvgpr_read_b32 v12, a254
  v_accvgpr_read_b32 v13, a255
  v_cvt_pk_bf16_f32 v255, v12, v13
  v_mfma_f32_16x16x32_bf16 v[32:35], v[96:99], a[48:51], v[32:35]
  buffer_store_dwordx4 v[252:255], v1, s[20:23], s37 offen offset:3072 sc1
  s_add_u32 s36, s36, 4096
  s_add_u32 s37, s37, 4096
  v_mfma_f32_16x16x32_bf16 v[36:39], v[96:99], a[52:55], v[36:39]
  ds_read_b128 v[96:99], v3 offset:7168
  s_waitcnt lgkmcnt(5)
  v_mfma_f32_16x16x32_bf16 v[40:43], v[100:103], a[48:51], v[40:43]
  buffer_load_dwordx4 a[208:211], v1, s[20:23], s42 offen offset:0 sc1
  v_mfma_f32_16x16x32_bf16 v[44:47], v[100:103], a[52:55], v[44:47]
  ds_read_b128 v[100:103], v3 offset:23552
  v_mfma_f32_16x16x32_bf16 v[48:51], v[104:107], a[48:51], v[48:51]
  buffer_load_dwordx4 a[212:215], v1, s[20:23], s42 offen offset:1024 sc1
  v_mfma_f32_16x16x32_bf16 v[52:55], v[104:107], a[52:55], v[52:55]
  ds_read_b128 v[104:107], v5 offset:7168
  s_waitcnt lgkmcnt(5)
  v_mfma_f32_16x16x32_bf16 v[56:59], v[108:111], a[48:51], v[56:59]
  buffer_load_dwordx4 a[216:219], v1, s[20:23], s42 offen offset:2048 sc1
  v_mfma_f32_16x16x32_bf16 v[60:63], v[108:111], a[52:55], v[60:63]
  ds_read_b128 v[108:111], v5 offset:23552
  v_mfma_f32_16x16x32_bf16 v[64:67], v[112:115], a[48:51], v[64:67]
  buffer_load_dwordx4 a[220:223], v1, s[20:23], s42 offen offset:3072 sc1
  v_mfma_f32_16x16x32_bf16 v[68:71], v[112:115], a[52:55], v[68:71]
  ds_read_b128 v[112:115], v7 offset:7168
  s_waitcnt lgkmcnt(5)
  v_mfma_f32_16x16x32_bf16 v[72:75], v[116:119], a[48:51], v[72:75]
  buffer_load_dwordx4 a[224:227], v1, s[20:23], s43 offen offset:0 sc1
  v_mfma_f32_16x16x32_bf16 v[76:79], v[116:119], a[52:55], v[76:79]
  ds_read_b128 v[116:119], v7 offset:23552
  v_mfma_f32_16x16x32_bf16 v[80:83], v[120:123], a[48:51], v[80:83]
  buffer_load_dwordx4 a[228:231], v1, s[20:23], s43 offen offset:1024 sc1
  v_mfma_f32_16x16x32_bf16 v[84:87], v[120:123], a[52:55], v[84:87]
  ds_read_b128 v[120:123], v9 offset:7168
  s_waitcnt lgkmcnt(5)
  v_mfma_f32_16x16x32_bf16 v[24:27], v[96:99], a[56:59], v[24:27]
  buffer_load_dwordx4 a[232:235], v1, s[20:23], s43 offen offset:2048 sc1
  v_mfma_f32_16x16x32_bf16 v[28:31], v[96:99], a[60:63], v[28:31]
  ds_read_b128 v[96:99], v9 offset:23552
  v_mfma_f32_16x16x32_bf16 v[32:35], v[100:103], a[56:59], v[32:35]
  buffer_load_dwordx4 a[236:239], v1, s[20:23], s43 offen offset:3072 sc1
  v_mfma_f32_16x16x32_bf16 v[36:39], v[100:103], a[60:63], v[36:39]
  ds_read_b128 v[100:103], v2 offset:8192
  s_waitcnt lgkmcnt(5)
  v_mfma_f32_16x16x32_bf16 v[40:43], v[104:107], a[56:59], v[40:43]
  buffer_load_dwordx4 a[240:243], v1, s[20:23], s44 offen offset:0 sc1
  v_mfma_f32_16x16x32_bf16 v[44:47], v[104:107], a[60:63], v[44:47]
  ds_read_b128 v[104:107], v2 offset:24576
  v_mfma_f32_16x16x32_bf16 v[48:51], v[108:111], a[56:59], v[48:51]
  buffer_load_dwordx4 a[244:247], v1, s[20:23], s44 offen offset:1024 sc1
  v_and_b32 v12, 15, v0
  v_lshlrev_b32 v12, 10, v12
  v_lshrrev_b32 v13, 4, v0
  v_mfma_f32_16x16x32_bf16 v[52:55], v[108:111], a[60:63], v[52:55]
  ds_read_b128 v[108:111], v4 offset:8192
  v_lshl_add_u32 v12, v13, 4, v12
  s_waitcnt lgkmcnt(5)
  v_mfma_f32_16x16x32_bf16 v[56:59], v[112:115], a[56:59], v[56:59]
  buffer_load_dwordx4 a[128:131], v12, s[8:11], s50 offen
  v_mfma_f32_16x16x32_bf16 v[60:63], v[112:115], a[60:63], v[60:63]
  v_mov_b32 v124, 1
  s_add_u32 s26, s24, 98304
  s_lshl_b32 s29, s3, 13
  s_add_u32 s26, s26, s29
  s_waitcnt vmcnt(27)
  s_mov_b64 exec, 1
  buffer_atomic_add v124, off, s[20:23], s26 sc1
  s_mov_b64 exec, -1
  ds_read_b128 v[112:115], v4 offset:24576
  v_mfma_f32_16x16x32_bf16 v[64:67], v[116:119], a[56:59], v[64:67]
  buffer_load_dwordx4 a[132:135], v12, s[8:11], s51 offen
  v_mfma_f32_16x16x32_bf16 v[68:71], v[116:119], a[60:63], v[68:71]
  ds_read_b128 v[116:119], v6 offset:8192
  s_waitcnt lgkmcnt(5)
  v_mfma_f32_16x16x32_bf16 v[72:75], v[120:123], a[56:59], v[72:75]
  buffer_load_dwordx4 a[136:139], v12, s[8:11], s52 offen
  v_mfma_f32_16x16x32_bf16 v[76:79], v[120:123], a[60:63], v[76:79]
  ds_read_b128 v[120:123], v6 offset:24576
  v_mfma_f32_16x16x32_bf16 v[80:83], v[96:99], a[56:59], v[80:83]
  buffer_load_dwordx4 a[140:143], v12, s[8:11], s53 offen
  v_mfma_f32_16x16x32_bf16 v[84:87], v[96:99], a[60:63], v[84:87]
  ds_read_b128 v[96:99], v8 offset:8192
  s_waitcnt lgkmcnt(5)
  v_mfma_f32_16x16x32_bf16 v[24:27], v[100:103], a[64:67], v[24:27]
  buffer_load_dwordx4 a[144:147], v12, s[8:11], s54 offen
  v_mfma_f32_16x16x32_bf16 v[28:31], v[100:103], a[68:71], v[28:31]
  ds_read_b128 v[100:103], v8 offset:24576
  v_mfma_f32_16x16x32_bf16 v[32:35], v[104:107], a[64:67], v[32:35]
  buffer_load_dwordx4 a[148:151], v12, s[8:11], s55 offen
  v_mfma_f32_16x16x32_bf16 v[36:39], v[104:107], a[68:71], v[36:39]
  ds_read_b128 v[104:107], v2 offset:9216
  s_waitcnt lgkmcnt(5)
  v_mfma_f32_16x16x32_bf16 v[40:43], v[108:111], a[64:67], v[40:43]
  buffer_load_dwordx4 a[152:155], v12, s[8:11], s56 offen
  v_mfma_f32_16x16x32_bf16 v[44:47], v[108:111], a[68:71], v[44:47]
  ds_read_b128 v[108:111], v2 offset:25600
  v_mfma_f32_16x16x32_bf16 v[48:51], v[112:115], a[64:67], v[48:51]
  buffer_load_dwordx4 a[156:159], v12, s[8:11], s57 offen
  v_mfma_f32_16x16x32_bf16 v[52:55], v[112:115], a[68:71], v[52:55]
  ds_read_b128 v[112:115], v4 offset:9216
  s_waitcnt lgkmcnt(5)
  v_mfma_f32_16x16x32_bf16 v[56:59], v[116:119], a[64:67], v[56:59]
  v_mfma_f32_16x16x32_bf16 v[60:63], v[116:119], a[68:71], v[60:63]
  ds_read_b128 v[116:119], v4 offset:25600
  v_mfma_f32_16x16x32_bf16 v[64:67], v[120:123], a[64:67], v[64:67]
  v_mfma_f32_16x16x32_bf16 v[68:71], v[120:123], a[68:71], v[68:71]
  ds_read_b128 v[120:123], v6 offset:9216
  s_waitcnt lgkmcnt(5)
  v_mfma_f32_16x16x32_bf16 v[72:75], v[96:99], a[64:67], v[72:75]
  v_mfma_f32_16x16x32_bf16 v[76:79], v[96:99], a[68:71], v[76:79]
  ds_read_b128 v[96:99], v6 offset:25600
  v_mfma_f32_16x16x32_bf16 v[80:83], v[100:103], a[64:67], v[80:83]
  v_mfma_f32_16x16x32_bf16 v[84:87], v[100:103], a[68:71], v[84:87]
  ds_read_b128 v[100:103], v8 offset:9216
  s_waitcnt lgkmcnt(5)
  v_mfma_f32_16x16x32_bf16 v[24:27], v[104:107], a[72:75], v[24:27]
  v_mfma_f32_16x16x32_bf16 v[28:31], v[104:107], a[76:79], v[28:31]
  ds_read_b128 v[104:107], v8 offset:25600
  v_mfma_f32_16x16x32_bf16 v[32:35], v[108:111], a[72:75], v[32:35]
  v_mfma_f32_16x16x32_bf16 v[36:39], v[108:111], a[76:79], v[36:39]
  ds_read_b128 v[108:111], v2 offset:10240
  s_waitcnt lgkmcnt(5)
  v_mfma_f32_16x16x32_bf16 v[40:43], v[112:115], a[72:75], v[40:43]
  v_mfma_f32_16x16x32_bf16 v[44:47], v[112:115], a[76:79], v[44:47]
  ds_read_b128 v[112:115], v2 offset:26624
  v_mfma_f32_16x16x32_bf16 v[48:51], v[116:119], a[72:75], v[48:51]
  v_mfma_f32_16x16x32_bf16 v[52:55], v[116:119], a[76:79], v[52:55]
  ds_read_b128 v[116:119], v4 offset:10240
  s_waitcnt lgkmcnt(5)
  v_mfma_f32_16x16x32_bf16 v[56:59], v[120:123], a[72:75], v[56:59]
  v_mfma_f32_16x16x32_bf16 v[60:63], v[120:123], a[76:79], v[60:63]
  ds_read_b128 v[120:123], v4 offset:26624
  v_mfma_f32_16x16x32_bf16 v[64:67], v[96:99], a[72:75], v[64:67]
  v_mfma_f32_16x16x32_bf16 v[68:71], v[96:99], a[76:79], v[68:71]
  ds_read_b128 v[96:99], v6 offset:10240
  s_waitcnt lgkmcnt(5)
  v_mfma_f32_16x16x32_bf16 v[72:75], v[100:103], a[72:75], v[72:75]
  v_mfma_f32_16x16x32_bf16 v[76:79], v[100:103], a[76:79], v[76:79]
  ds_read_b128 v[100:103], v6 offset:26624
  v_mfma_f32_16x16x32_bf16 v[80:83], v[104:107], a[72:75], v[80:83]
  v_mfma_f32_16x16x32_bf16 v[84:87], v[104:107], a[76:79], v[84:87]
  ds_read_b128 v[104:107], v8 offset:10240
  s_waitcnt lgkmcnt(5)
  v_mfma_f32_16x16x32_bf16 v[24:27], v[108:111], a[80:83], v[24:27]
  v_mfma_f32_16x16x32_bf16 v[28:31], v[108:111], a[84:87], v[28:31]
  ds_read_b128 v[108:111], v8 offset:26624
  v_mfma_f32_16x16x32_bf16 v[32:35], v[112:115], a[80:83], v[32:35]
  v_mfma_f32_16x16x32_bf16 v[36:39], v[112:115], a[84:87], v[36:39]
  ds_read_b128 v[112:115], v2 offset:11264
  s_waitcnt lgkmcnt(5)
  v_mfma_f32_16x16x32_bf16 v[40:43], v[116:119], a[80:83], v[40:43]
  v_mfma_f32_16x16x32_bf16 v[44:47], v[116:119], a[84:87], v[44:47]
  ds_read_b128 v[116:119], v2 offset:27648
  v_mfma_f32_16x16x32_bf16 v[48:51], v[120:123], a[80:83], v[48:51]
  v_mfma_f32_16x16x32_bf16 v[52:55], v[120:123], a[84:87], v[52:55]
  ds_read_b128 v[120:123], v4 offset:11264
  s_waitcnt lgkmcnt(5)
  v_mfma_f32_16x16x32_bf16 v[56:59], v[96:99], a[80:83], v[56:59]
  v_mfma_f32_16x16x32_bf16 v[60:63], v[96:99], a[84:87], v[60:63]
  ds_read_b128 v[96:99], v4 offset:27648
  v_mfma_f32_16x16x32_bf16 v[64:67], v[100:103], a[80:83], v[64:67]
  v_mfma_f32_16x16x32_bf16 v[68:71], v[100:103], a[84:87], v[68:71]
  ds_read_b128 v[100:103], v6 offset:11264
  s_waitcnt lgkmcnt(5)
  v_mfma_f32_16x16x32_bf16 v[72:75], v[104:107], a[80:83], v[72:75]
  v_mfma_f32_16x16x32_bf16 v[76:79], v[104:107], a[84:87], v[76:79]
  ds_read_b128 v[104:107], v6 offset:27648
  v_mfma_f32_16x16x32_bf16 v[80:83], v[108:111], a[80:83], v[80:83]
  v_mfma_f32_16x16x32_bf16 v[84:87], v[108:111], a[84:87], v[84:87]
  ds_read_b128 v[108:111], v8 offset:11264
  s_waitcnt lgkmcnt(5)
  v_mfma_f32_16x16x32_bf16 v[24:27], v[112:115], a[88:91], v[24:27]
  v_mfma_f32_16x16x32_bf16 v[28:31], v[112:115], a[92:95], v[28:31]
  ds_read_b128 v[112:115], v8 offset:27648
  v_mfma_f32_16x16x32_bf16 v[32:35], v[116:119], a[88:91], v[32:35]
  v_mfma_f32_16x16x32_bf16 v[36:39], v[116:119], a[92:95], v[36:39]
  ds_read_b128 v[116:119], v3 offset:12288
  s_waitcnt lgkmcnt(5)
  v_mfma_f32_16x16x32_bf16 v[40:43], v[120:123], a[88:91], v[40:43]
  v_mfma_f32_16x16x32_bf16 v[44:47], v[120:123], a[92:95], v[44:47]
  ds_read_b128 v[120:123], v3 offset:28672
  v_mfma_f32_16x16x32_bf16 v[48:51], v[96:99], a[88:91], v[48:51]
  v_mfma_f32_16x16x32_bf16 v[52:55], v[96:99], a[92:95], v[52:55]
  ds_read_b128 v[96:99], v5 offset:12288
  s_waitcnt lgkmcnt(5)
  v_mfma_f32_16x16x32_bf16 v[56:59], v[100:103], a[88:91], v[56:59]
  v_mfma_f32_16x16x32_bf16 v[60:63], v[100:103], a[92:95], v[60:63]
  ds_read_b128 v[100:103], v5 offset:28672
  v_mfma_f32_16x16x32_bf16 v[64:67], v[104:107], a[88:91], v[64:67]
  v_mfma_f32_16x16x32_bf16 v[68:71], v[104:107], a[92:95], v[68:71]
  ds_read_b128 v[104:107], v7 offset:12288
  s_waitcnt lgkmcnt(5)
  v_mfma_f32_16x16x32_bf16 v[72:75], v[108:111], a[88:91], v[72:75]
  v_mfma_f32_16x16x32_bf16 v[76:79], v[108:111], a[92:95], v[76:79]
  ds_read_b128 v[108:111], v7 offset:28672
  v_mfma_f32_16x16x32_bf16 v[80:83], v[112:115], a[88:91], v[80:83]
  v_mfma_f32_16x16x32_bf16 v[84:87], v[112:115], a[92:95], v[84:87]
  ds_read_b128 v[112:115], v9 offset:12288
  s_waitcnt lgkmcnt(5)
  v_mfma_f32_16x16x32_bf16 v[24:27], v[116:119], a[96:99], v[24:27]
  v_mfma_f32_16x16x32_bf16 v[28:31], v[116:119], a[100:103], v[28:31]
  ds_read_b128 v[116:119], v9 offset:28672
  v_mfma_f32_16x16x32_bf16 v[32:35], v[120:123], a[96:99], v[32:35]
  v_mfma_f32_16x16x32_bf16 v[36:39], v[120:123], a[100:103], v[36:39]
  ds_read_b128 v[120:123], v3 offset:13312
  s_waitcnt lgkmcnt(5)
  v_mfma_f32_16x16x32_bf16 v[40:43], v[96:99], a[96:99], v[40:43]
  v_mfma_f32_16x16x32_bf16 v[44:47], v[96:99], a[100:103], v[44:47]
  ds_read_b128 v[96:99], v3 offset:29696
  v_mfma_f32_16x16x32_bf16 v[48:51], v[100:103], a[96:99], v[48:51]
  v_mfma_f32_16x16x32_bf16 v[52:55], v[100:103], a[100:103], v[52:55]
  ds_read_b128 v[100:103], v5 offset:13312
  s_waitcnt lgkmcnt(5)
  v_mfma_f32_16x16x32_bf16 v[56:59], v[104:107], a[96:99], v[56:59]
  v_mfma_f32_16x16x32_bf16 v[60:63], v[104:107], a[100:103], v[60:63]
  ds_read_b128 v[104:107], v5 offset:29696
  v_mfma_f32_16x16x32_bf16 v[64:67], v[108:111], a[96:99], v[64:67]
  v_mfma_f32_16x16x32_bf16 v[68:71], v[108:111], a[100:103], v[68:71]
  ds_read_b128 v[108:111], v7 offset:13312
  s_waitcnt lgkmcnt(5)
  v_mfma_f32_16x16x32_bf16 v[72:75], v[112:115], a[96:99], v[72:75]
  v_mfma_f32_16x16x32_bf16 v[76:79], v[112:115], a[100:103], v[76:79]
  ds_read_b128 v[112:115], v7 offset:29696
  v_mfma_f32_16x16x32_bf16 v[80:83], v[116:119], a[96:99], v[80:83]
  v_mfma_f32_16x16x32_bf16 v[84:87], v[116:119], a[100:103], v[84:87]
  ds_read_b128 v[116:119], v9 offset:13312
  s_waitcnt lgkmcnt(5)
  v_mfma_f32_16x16x32_bf16 v[24:27], v[120:123], a[104:107], v[24:27]
  v_mfma_f32_16x16x32_bf16 v[28:31], v[120:123], a[108:111], v[28:31]
  ds_read_b128 v[120:123], v9 offset:29696
  v_mfma_f32_16x16x32_bf16 v[32:35], v[96:99], a[104:107], v[32:35]
  v_mfma_f32_16x16x32_bf16 v[36:39], v[96:99], a[108:111], v[36:39]
  ds_read_b128 v[96:99], v3 offset:14336
  s_waitcnt lgkmcnt(5)
  v_mfma_f32_16x16x32_bf16 v[40:43], v[100:103], a[104:107], v[40:43]
  v_mfma_f32_16x16x32_bf16 v[44:47], v[100:103], a[108:111], v[44:47]
  ds_read_b128 v[100:103], v3 offset:30720
  v_mfma_f32_16x16x32_bf16 v[48:51], v[104:107], a[104:107], v[48:51]
  v_mfma_f32_16x16x32_bf16 v[52:55], v[104:107], a[108:111], v[52:55]
  ds_read_b128 v[104:107], v5 offset:14336
  s_waitcnt lgkmcnt(5)
  v_mfma_f32_16x16x32_bf16 v[56:59], v[108:111], a[104:107], v[56:59]
  v_mfma_f32_16x16x32_bf16 v[60:63], v[108:111], a[108:111], v[60:63]
  ds_read_b128 v[108:111], v5 offset:30720
  v_mfma_f32_16x16x32_bf16 v[64:67], v[112:115], a[104:107], v[64:67]
  v_mfma_f32_16x16x32_bf16 v[68:71], v[112:115], a[108:111], v[68:71]
  ds_read_b128 v[112:115], v7 offset:14336
  s_waitcnt lgkmcnt(5)
  v_mfma_f32_16x16x32_bf16 v[72:75], v[116:119], a[104:107], v[72:75]
  v_mfma_f32_16x16x32_bf16 v[76:79], v[116:119], a[108:111], v[76:79]
  ds_read_b128 v[116:119], v7 offset:30720
  v_mfma_f32_16x16x32_bf16 v[80:83], v[120:123], a[104:107], v[80:83]
  v_mfma_f32_16x16x32_bf16 v[84:87], v[120:123], a[108:111], v[84:87]
  ds_read_b128 v[120:123], v9 offset:14336
  s_waitcnt lgkmcnt(5)
  v_mfma_f32_16x16x32_bf16 v[24:27], v[96:99], a[112:115], v[24:27]
  v_mfma_f32_16x16x32_bf16 v[28:31], v[96:99], a[116:119], v[28:31]
  ds_read_b128 v[96:99], v9 offset:30720
  v_mfma_f32_16x16x32_bf16 v[32:35], v[100:103], a[112:115], v[32:35]
  v_mfma_f32_16x16x32_bf16 v[36:39], v[100:103], a[116:119], v[36:39]
  ds_read_b128 v[100:103], v3 offset:15360
  s_waitcnt lgkmcnt(5)
  v_mfma_f32_16x16x32_bf16 v[40:43], v[104:107], a[112:115], v[40:43]
  v_mfma_f32_16x16x32_bf16 v[44:47], v[104:107], a[116:119], v[44:47]
  ds_read_b128 v[104:107], v3 offset:31744
  v_mfma_f32_16x16x32_bf16 v[48:51], v[108:111], a[112:115], v[48:51]
  v_mfma_f32_16x16x32_bf16 v[52:55], v[108:111], a[116:119], v[52:55]
  ds_read_b128 v[108:111], v5 offset:15360
  s_waitcnt lgkmcnt(5)
  v_mfma_f32_16x16x32_bf16 v[56:59], v[112:115], a[112:115], v[56:59]
  v_mfma_f32_16x16x32_bf16 v[60:63], v[112:115], a[116:119], v[60:63]
  ds_read_b128 v[112:115], v5 offset:31744
  v_mfma_f32_16x16x32_bf16 v[64:67], v[116:119], a[112:115], v[64:67]
  v_mfma_f32_16x16x32_bf16 v[68:71], v[116:119], a[116:119], v[68:71]
  ds_read_b128 v[116:119], v7 offset:15360
  s_waitcnt lgkmcnt(5)
  v_mfma_f32_16x16x32_bf16 v[72:75], v[120:123], a[112:115], v[72:75]
  v_mfma_f32_16x16x32_bf16 v[76:79], v[120:123], a[116:119], v[76:79]
  ds_read_b128 v[120:123], v7 offset:31744
  v_mfma_f32_16x16x32_bf16 v[80:83], v[96:99], a[112:115], v[80:83]
  v_mfma_f32_16x16x32_bf16 v[84:87], v[96:99], a[116:119], v[84:87]
  ds_read_b128 v[96:99], v9 offset:15360
  s_waitcnt lgkmcnt(5)
  v_mfma_f32_16x16x32_bf16 v[24:27], v[100:103], a[120:123], v[24:27]
  v_mfma_f32_16x16x32_bf16 v[28:31], v[100:103], a[124:127], v[28:31]
  v_mov_b32 v124, 1
  s_add_u32 s26, s24, 65536
  s_lshl_b32 s29, s3, 13
  s_add_u32 s26, s26, s29
  s_waitcnt vmcnt(19)
  s_mov_b64 exec, 1
  buffer_atomic_add v124, off, s[20:23], s26 sc1
  s_mov_b64 exec, -1
  ds_read_b128 v[100:103], v9 offset:31744
  v_mfma_f32_16x16x32_bf16 v[32:35], v[104:107], a[120:123], v[32:35]
  v_mfma_f32_16x16x32_bf16 v[36:39], v[104:107], a[124:127], v[36:39]
  s_barrier
  ds_read_b128 v[104:107], v10 offset:0
  s_waitcnt lgkmcnt(5)
  v_mfma_f32_16x16x32_bf16 v[40:43], v[108:111], a[120:123], v[40:43]
  v_mfma_f32_16x16x32_bf16 v[44:47], v[108:111], a[124:127], v[44:47]
  ds_read_b128 v[108:111], v10 offset:16384
  v_mfma_f32_16x16x32_bf16 v[48:51], v[112:115], a[120:123], v[48:51]
  v_mfma_f32_16x16x32_bf16 v[52:55], v[112:115], a[124:127], v[52:55]
  ds_read_b128 v[112:115], v10 offset:1024
  s_waitcnt lgkmcnt(5)
  v_mfma_f32_16x16x32_bf16 v[56:59], v[116:119], a[120:123], v[56:59]
  v_mfma_f32_16x16x32_bf16 v[60:63], v[116:119], a[124:127], v[60:63]
  ds_read_b128 v[116:119], v10 offset:17408
  v_mfma_f32_16x16x32_bf16 v[64:67], v[120:123], a[120:123], v[64:67]
  v_mfma_f32_16x16x32_bf16 v[68:71], v[120:123], a[124:127], v[68:71]
  ds_read_b128 v[120:123], v10 offset:2048
  s_waitcnt lgkmcnt(5)
  v_mfma_f32_16x16x32_bf16 v[72:75], v[96:99], a[120:123], v[72:75]
  v_mfma_f32_16x16x32_bf16 v[76:79], v[96:99], a[124:127], v[76:79]
  ds_read_b128 v[96:99], v10 offset:18432
  v_mfma_f32_16x16x32_bf16 v[80:83], v[100:103], a[120:123], v[80:83]
  v_mfma_f32_16x16x32_bf16 v[84:87], v[100:103], a[124:127], v[84:87]
  ds_read_b128 v[100:103], v10 offset:3072
  s_waitcnt lgkmcnt(5)
  v_mfma_f32_16x16x32_bf16 v[16:19], v[104:107], a[0:3], 0
  v_mfma_f32_16x16x32_bf16 v[20:23], v[104:107], a[4:7], 0
  ds_read_b128 v[104:107], v10 offset:19456
  v_mfma_f32_16x16x32_bf16 v[88:91], v[108:111], a[0:3], 0
  v_mfma_f32_16x16x32_bf16 v[92:95], v[108:111], a[4:7], 0
  ds_read_b128 v[108:111], v11 offset:4096
  s_waitcnt lgkmcnt(5)
  v_mfma_f32_16x16x32_bf16 v[16:19], v[112:115], a[8:11], v[16:19]
  v_mfma_f32_16x16x32_bf16 v[20:23], v[112:115], a[12:15], v[20:23]
  ds_read_b128 v[112:115], v11 offset:20480
  v_mfma_f32_16x16x32_bf16 v[88:91], v[116:119], a[8:11], v[88:91]
  v_mfma_f32_16x16x32_bf16 v[92:95], v[116:119], a[12:15], v[92:95]
  ds_read_b128 v[116:119], v11 offset:5120
  s_waitcnt lgkmcnt(5)
  v_mfma_f32_16x16x32_bf16 v[16:19], v[120:123], a[16:19], v[16:19]
  v_mfma_f32_16x16x32_bf16 v[20:23], v[120:123], a[20:23], v[20:23]
  ds_read_b128 v[120:123], v11 offset:21504
  v_mfma_f32_16x16x32_bf16 v[88:91], v[96:99], a[16:19], v[88:91]
  v_mfma_f32_16x16x32_bf16 v[92:95], v[96:99], a[20:23], v[92:95]
  ds_read_b128 v[96:99], v11 offset:6144
  s_waitcnt lgkmcnt(5)
  v_mfma_f32_16x16x32_bf16 v[16:19], v[100:103], a[24:27], v[16:19]
  v_mfma_f32_16x16x32_bf16 v[20:23], v[100:103], a[28:31], v[20:23]
  ds_read_b128 v[100:103], v11 offset:22528
  v_mfma_f32_16x16x32_bf16 v[88:91], v[104:107], a[24:27], v[88:91]
  v_mfma_f32_16x16x32_bf16 v[92:95], v[104:107], a[28:31], v[92:95]
  ds_read_b128 v[104:107], v11 offset:7168
  s_waitcnt lgkmcnt(5)
  v_mfma_f32_16x16x32_bf16 v[16:19], v[108:111], a[32:35], v[16:19]
  v_mfma_f32_16x16x32_bf16 v[20:23], v[108:111], a[36:39], v[20:23]
  ds_read_b128 v[108:111], v11 offset:23552
  v_mfma_f32_16x16x32_bf16 v[88:91], v[112:115], a[32:35], v[88:91]
  v_mfma_f32_16x16x32_bf16 v[92:95], v[112:115], a[36:39], v[92:95]
  ds_read_b128 v[112:115], v10 offset:8192
  s_waitcnt lgkmcnt(5)
  v_mfma_f32_16x16x32_bf16 v[16:19], v[116:119], a[40:43], v[16:19]
  v_mfma_f32_16x16x32_bf16 v[20:23], v[116:119], a[44:47], v[20:23]
  ds_read_b128 v[116:119], v10 offset:24576
  v_mfma_f32_16x16x32_bf16 v[88:91], v[120:123], a[40:43], v[88:91]
  v_mfma_f32_16x16x32_bf16 v[92:95], v[120:123], a[44:47], v[92:95]
  ds_read_b128 v[120:123], v10 offset:9216
  s_waitcnt lgkmcnt(5)
  v_mfma_f32_16x16x32_bf16 v[16:19], v[96:99], a[48:51], v[16:19]
  v_mfma_f32_16x16x32_bf16 v[20:23], v[96:99], a[52:55], v[20:23]
  ds_read_b128 v[96:99], v10 offset:25600
  v_mfma_f32_16x16x32_bf16 v[88:91], v[100:103], a[48:51], v[88:91]
  v_mfma_f32_16x16x32_bf16 v[92:95], v[100:103], a[52:55], v[92:95]
  ds_read_b128 v[100:103], v10 offset:10240
  s_waitcnt lgkmcnt(5)
  v_mfma_f32_16x16x32_bf16 v[16:19], v[104:107], a[56:59], v[16:19]
  v_mfma_f32_16x16x32_bf16 v[20:23], v[104:107], a[60:63], v[20:23]
  ds_read_b128 v[104:107], v10 offset:26624
  v_mfma_f32_16x16x32_bf16 v[88:91], v[108:111], a[56:59], v[88:91]
  v_mfma_f32_16x16x32_bf16 v[92:95], v[108:111], a[60:63], v[92:95]
  ds_read_b128 v[108:111], v10 offset:11264
  s_waitcnt lgkmcnt(5)
  v_mfma_f32_16x16x32_bf16 v[16:19], v[112:115], a[64:67], v[16:19]
  v_mfma_f32_16x16x32_bf16 v[20:23], v[112:115], a[68:71], v[20:23]
  ds_read_b128 v[112:115], v10 offset:27648
  v_mfma_f32_16x16x32_bf16 v[88:91], v[116:119], a[64:67], v[88:91]
  v_mfma_f32_16x16x32_bf16 v[92:95], v[116:119], a[68:71], v[92:95]
  ds_read_b128 v[116:119], v11 offset:12288
  s_waitcnt lgkmcnt(5)
  v_mfma_f32_16x16x32_bf16 v[16:19], v[120:123], a[72:75], v[16:19]
  v_mfma_f32_16x16x32_bf16 v[20:23], v[120:123], a[76:79], v[20:23]
  ds_read_b128 v[120:123], v11 offset:28672
  v_mfma_f32_16x16x32_bf16 v[88:91], v[96:99], a[72:75], v[88:91]
  v_mfma_f32_16x16x32_bf16 v[92:95], v[96:99], a[76:79], v[92:95]
  ds_read_b128 v[96:99], v11 offset:13312
  s_waitcnt lgkmcnt(5)
  v_mfma_f32_16x16x32_bf16 v[16:19], v[100:103], a[80:83], v[16:19]
  v_mfma_f32_16x16x32_bf16 v[20:23], v[100:103], a[84:87], v[20:23]
  ds_read_b128 v[100:103], v11 offset:29696
  v_mfma_f32_16x16x32_bf16 v[88:91], v[104:107], a[80:83], v[88:91]
  v_mfma_f32_16x16x32_bf16 v[92:95], v[104:107], a[84:87], v[92:95]
  ds_read_b128 v[104:107], v11 offset:14336
  s_waitcnt lgkmcnt(5)
  v_mfma_f32_16x16x32_bf16 v[16:19], v[108:111], a[88:91], v[16:19]
  v_mfma_f32_16x16x32_bf16 v[20:23], v[108:111], a[92:95], v[20:23]
  s_add_u32 s27, s24, 98304
  s_lshl_b32 s29, s30, 13
  s_add_u32 s27, s27, s29
  buffer_load_dword v125, off, s[20:23], s27 sc1
  ds_read_b128 v[108:111], v11 offset:30720
  v_mfma_f32_16x16x32_bf16 v[88:91], v[112:115], a[88:91], v[88:91]
  v_mfma_f32_16x16x32_bf16 v[92:95], v[112:115], a[92:95], v[92:95]
  ds_read_b128 v[112:115], v11 offset:15360
  s_waitcnt lgkmcnt(5)
  v_mfma_f32_16x16x32_bf16 v[16:19], v[116:119], a[96:99], v[16:19]
  v_mfma_f32_16x16x32_bf16 v[20:23], v[116:119], a[100:103], v[20:23]
  ds_read_b128 v[116:119], v11 offset:31744
  v_mfma_f32_16x16x32_bf16 v[88:91], v[120:123], a[96:99], v[88:91]
  v_mfma_f32_16x16x32_bf16 v[92:95], v[120:123], a[100:103], v[92:95]
  s_waitcnt lgkmcnt(4)
  v_mfma_f32_16x16x32_bf16 v[16:19], v[96:99], a[104:107], v[16:19]
  v_mfma_f32_16x16x32_bf16 v[20:23], v[96:99], a[108:111], v[20:23]
  v_mfma_f32_16x16x32_bf16 v[88:91], v[100:103], a[104:107], v[88:91]
  v_mfma_f32_16x16x32_bf16 v[92:95], v[100:103], a[108:111], v[92:95]
  s_waitcnt lgkmcnt(2)
  v_mfma_f32_16x16x32_bf16 v[16:19], v[104:107], a[112:115], v[16:19]
  v_mfma_f32_16x16x32_bf16 v[20:23], v[104:107], a[116:119], v[20:23]
  v_mfma_f32_16x16x32_bf16 v[88:91], v[108:111], a[112:115], v[88:91]
  v_mfma_f32_16x16x32_bf16 v[92:95], v[108:111], a[116:119], v[92:95]
  s_waitcnt lgkmcnt(0)
  v_mfma_f32_16x16x32_bf16 v[16:19], v[112:115], a[120:123], v[16:19]
  v_mfma_f32_16x16x32_bf16 v[20:23], v[112:115], a[124:127], v[20:23]
  v_mfma_f32_16x16x32_bf16 v[88:91], v[116:119], a[120:123], v[88:91]
  v_mfma_f32_16x16x32_bf16 v[92:95], v[116:119], a[124:127], v[92:95]
  s_barrier
  s_mul_i32 s45, s3, 10752
  s_add_u32 s45, s45, 0
  v_and_b32 v8, 15, v0
  v_mul_u32_u24 v8, 336, v8
  v_lshrrev_b32 v9, 4, v0
  v_lshl_add_u32 v8, v9, 3, v8
  v_add_u32 v8, s45, v8
  v_lshrrev_b32 v9, 2, v0
  v_mul_u32_u24 v9, 336, v9
  v_add_u32 v9, s45, v9
  v_and_b32 v11, 3, v0
  v_lshl_add_u32 v10, v11, 3, v9
  v_lshl_add_u32 v9, v11, 6, v9
  v_add_u32 v118, 0x10000, v1
  s_cmp_lg_u32 s3, s30
  s_cbranch_scc1 NOT_OWN
  ds_write_b128 v118, v[128:131] offset:0
  ds_write_b128 v118, v[132:135] offset:16384
  ds_write_b128 v118, v[136:139] offset:1024
  ds_write_b128 v118, v[140:143] offset:17408
  ds_write_b128 v118, v[144:147] offset:2048
  ds_write_b128 v118, v[148:151] offset:18432
  ds_write_b128 v118, v[152:155] offset:3072
  ds_write_b128 v118, v[156:159] offset:19456
  s_waitcnt lgkmcnt(4)
  ds_write_b128 v118, v[160:163] offset:4096
  ds_write_b128 v118, v[164:167] offset:20480
  ds_write_b128 v118, v[168:171] offset:5120
  ds_write_b128 v118, v[172:175] offset:21504
  ds_write_b128 v118, v[176:179] offset:6144
  ds_write_b128 v118, v[180:183] offset:22528
  ds_write_b128 v118, v[184:187] offset:7168
  ds_write_b128 v118, v[188:191] offset:23552
  s_waitcnt lgkmcnt(4)
  ds_write_b128 v118, v[192:195] offset:8192
  ds_write_b128 v118, v[196:199] offset:24576
  ds_write_b128 v118, v[200:203] offset:9216
  ds_write_b128 v118, v[204:207] offset:25600
  ds_write_b128 v118, v[208:211] offset:10240
  ds_write_b128 v118, v[212:215] offset:26624
  ds_write_b128 v118, v[216:219] offset:11264
  ds_write_b128 v118, v[220:223] offset:27648
  s_waitcnt lgkmcnt(4)
  ds_write_b128 v118, v[224:227] offset:12288
  ds_write_b128 v118, v[228:231] offset:28672
  ds_write_b128 v118, v[232:235] offset:13312
  ds_write_b128 v118, v[236:239] offset:29696
  ds_write_b128 v118, v[240:243] offset:14336
  ds_write_b128 v118, v[244:247] offset:30720
  ds_write_b128 v118, v[248:251] offset:15360
  ds_write_b128 v118, v[252:255] offset:31744
  s_waitcnt lgkmcnt(4)
NOT_OWN:
  s_lshl_b32 s32, s28, 18
  s_add_u32 s32, s32, 33832960
  s_lshl_b32 s60, s31, 16
  s_add_u32 s60, s60, 86786048
  s_lshl_b32 s61, s31, 16
  s_add_u32 s61, s61, 86818816
  s_mul_i32 s50, s3, 4
  s_add_u32 s50, s50, 0
  s_lshr_b32 s51, s50, 1
  s_mul_i32 s51, s51, 32768
  s_and_b32 s50, s50, 1
  s_lshl_b32 s50, s50, 10
  s_add_u32 s51, s51, s50
  s_add_u32 s52, s51, s32
  s_mul_i32 s50, s3, 4
  s_add_u32 s50, s50, 1
  s_lshr_b32 s51, s50, 1
  s_mul_i32 s51, s51, 32768
  s_and_b32 s50, s50, 1
  s_lshl_b32 s50, s50, 10
  s_add_u32 s51, s51, s50
  s_add_u32 s53, s51, s32
  s_mul_i32 s50, s3, 4
  s_add_u32 s50, s50, 2
  s_lshr_b32 s51, s50, 1
  s_mul_i32 s51, s51, 32768
  s_and_b32 s50, s50, 1
  s_lshl_b32 s50, s50, 10
  s_add_u32 s51, s51, s50
  s_add_u32 s54, s51, s32
  s_mul_i32 s50, s3, 4
  s_add_u32 s50, s50, 3
  s_lshr_b32 s51, s50, 1
  s_mul_i32 s51, s51, 32768
  s_and_b32 s50, s50, 1
  s_lshl_b32 s50, s50, 10
  s_add_u32 s51, s51, s50
  s_add_u32 s55, s51, s32
  s_mul_i32 s50, s3, 4096
  s_add_u32 s50, s50, 65536
  v_mov_b32 v116, v1
  v_mov_b32 v117, v1
  v_add_u32 v118, 0x10000, v1
  v_add_u32 v119, 0x20000, v1
  s_lshl_b32 s32, s30, 12
  v_add_u32 v117, s32, v1
  s_add_u32 s32, s32, 4096
  s_and_b32 s32, s32, 16383
  v_add_u32 v116, s32, v1
  s_lshr_b32 s32, s3, 1
  s_lshl_b32 s32, s32, 14
  s_and_b32 s33, s3, 1
  s_lshl_b32 s33, s33, 10
  s_add_u32 s32, s32, s33
  s_add_u32 s32, s32, 98304
  v_add_u32 v7, s32, v1
  buffer_load_dwordx4 a[0:3], v117, s[20:23], s60 offen offset:0 sc1
  buffer_load_dwordx4 a[4:7], v117, s[20:23], s61 offen offset:0 sc1
  buffer_load_dwordx4 a[8:11], v117, s[20:23], s60 offen offset:1024 sc1
  buffer_load_dwordx4 a[12:15], v117, s[20:23], s61 offen offset:1024 sc1
  buffer_load_dwordx4 a[16:19], v117, s[20:23], s60 offen offset:2048 sc1
  buffer_load_dwordx4 a[20:23], v117, s[20:23], s61 offen offset:2048 sc1
  buffer_load_dwordx4 a[24:27], v117, s[20:23], s60 offen offset:3072 sc1
  buffer_load_dwordx4 a[28:31], v117, s[20:23], s61 offen offset:3072 sc1
  v_add_u32 v117, 4096, v117
  v_and_b32 v117, 16383, v117
  s_lshl_b32 s32, s28, 17
  s_add_u32 s32, s32, 16957440
  s_lshl_b32 s70, s31, 15
  s_add_u32 s70, s70, 85721088
  s_lshl_b32 s71, s31, 15
  s_add_u32 s71, s71, 85737472
  s_mul_i32 s62, s3, 5
  s_add_u32 s62, s62, 0
  s_lshr_b32 s63, s62, 1
  s_lshl_b32 s29, s28, 3
  s_add_u32 s29, s29, s63
  s_sub_u32 s29, s29, 1
  s_mul_i32 s63, s63, 16384
  s_and_b32 s62, s62, 1
  s_lshl_b32 s62, s62, 10
  s_add_u32 s63, s63, s62
  s_add_u32 s64, s63, s32
  s_cmp_lt_u32 s29, 512
  s_cselect_b32 s64, s64, 0x7f000000
  s_mul_i32 s62, s3, 5
  s_add_u32 s62, s62, 1
  s_lshr_b32 s63, s62, 1
  s_lshl_b32 s29, s28, 3
  s_add_u32 s29, s29, s63
  s_sub_u32 s29, s29, 1
  s_mul_i32 s63, s63, 16384
  s_and_b32 s62, s62, 1
  s_lshl_b32 s62, s62, 10
  s_add_u32 s63, s63, s62
  s_add_u32 s65, s63, s32
  s_cmp_lt_u32 s29, 512
  s_cselect_b32 s65, s65, 0x7f000000
  s_mul_i32 s62, s3, 5
  s_add_u32 s62, s62, 2
  s_lshr_b32 s63, s62, 1
  s_lshl_b32 s29, s28, 3
  s_add_u32 s29, s29, s63
  s_sub_u32 s29, s29, 1
  s_mul_i32 s63, s63, 16384
  s_and_b32 s62, s62, 1
  s_lshl_b32 s62, s62, 10
  s_add_u32 s63, s63, s62
  s_add_u32 s66, s63, s32
  s_cmp_lt_u32 s29, 512
  s_cselect_b32 s66, s66, 0x7f000000
  s_mul_i32 s62, s3, 5
  s_add_u32 s62, s62, 3
  s_lshr_b32 s63, s62, 1
  s_lshl_b32 s29, s28, 3
  s_add_u32 s29, s29, s63
  s_sub_u32 s29, s29, 1
  s_mul_i32 s63, s63, 16384
  s_and_b32 s62, s62, 1
  s_lshl_b32 s62, s62, 10
  s_add_u32 s63, s63, s62
  s_add_u32 s67, s63, s32
  s_cmp_lt_u32 s29, 512
  s_cselect_b32 s67, s67, 0x7f000000
  s_mul_i32 s62, s3, 5
  s_add_u32 s62, s62, 4
  s_lshr_b32 s63, s62, 1
  s_lshl_b32 s29, s28, 3
  s_add_u32 s29, s29, s63
  s_sub_u32 s29, s29, 1
  s_mul_i32 s63, s63, 16384
  s_and_b32 s62, s62, 1
  s_lshl_b32 s62, s62, 10
  s_add_u32 s63, s63, s62
  s_add_u32 s68, s63, s32
  s_cmp_lt_u32 s29, 512
  s_cselect_b32 s68, s68, 0x7f000000
  s_mul_i32 s62, s3, 5120
  v_mov_b32 v120, v1
  v_mov_b32 v121, v1
  v_add_u32 v122, 0x10000, v1
  v_add_u32 v123, 0x20000, v1
  s_lshl_b32 s33, s28, 2
  s_add_u32 s33, s33, s30
  v_and_b32 v4, 15, v0
  v_lshlrev_b32 v4, 2, v4
  s_lshl_b32 s34, s33, 8
  s_lshr_b32 s35, s3, 1
  s_lshl_b32 s35, s35, 6
  s_add_u32 s34, s34, s35
  s_add_u32 s34, s34, 89915392
  s_lshr_b32 s35, s3, 1
  s_lshl_b32 s35, s35, 14
  s_and_b32 s48, s3, 1
  s_lshl_b32 s48, s48, 12
  s_add_u32 s35, s35, s48
  s_lshl_b32 s48, s33, 15
  s_add_u32 s48, s48, s35
  s_add_u32 s35, s35, 65536
  v_add_u32 v5, s35, v1
  s_add_u32 s35, s30, 0
  s_and_b32 s35, s35, 3
  s_lshl_b32 s36, s35, 16
  s_add_u32 s36, s36, s34
  s_add_u32 s35, s30, 1
  s_and_b32 s35, s35, 3
  s_lshl_b32 s37, s35, 16
  s_add_u32 s37, s37, s34
  s_lshl_b32 s35, s35, 23
  s_add_u32 s35, s35, s48
  s_add_u32 s4, s35, 50593792
  s_add_u32 s5, s4, 8192
  s_add_u32 s35, s30, 2
  s_and_b32 s35, s35, 3
  s_lshl_b32 s38, s35, 16
  s_add_u32 s38, s38, s34
  s_lshl_b32 s35, s35, 23
  s_add_u32 s35, s35, s48
  s_add_u32 s6, s35, 50593792
  s_add_u32 s7, s6, 8192
  s_add_u32 s35, s30, 3
  s_and_b32 s35, s35, 3
  s_lshl_b32 s39, s35, 16
  s_add_u32 s39, s39, s34
  s_lshl_b32 s35, s35, 23
  s_add_u32 s35, s35, s48
  s_add_u32 s46, s35, 50593792
  s_add_u32 s47, s46, 8192
  v_cvt_pk_bf16_f32 v16, v16, v17
  v_cvt_pk_bf16_f32 v17, v18, v19
  ds_write_b64 v8, v[16:17] offset:0
  v_cvt_pk_bf16_f32 v24, v24, v25
  v_cvt_pk_bf16_f32 v25, v26, v27
  ds_write_b64 v8, v[24:25] offset:32
  v_cvt_pk_bf16_f32 v32, v32, v33
  v_cvt_pk_bf16_f32 v33, v34, v35
  ds_write_b64 v8, v[32:33] offset:64
  v_cvt_pk_bf16_f32 v40, v40, v41
  v_cvt_pk_bf16_f32 v41, v42, v43
  ds_write_b64 v8, v[40:41] offset:96
  v_cvt_pk_bf16_f32 v48, v48, v49
  v_cvt_pk_bf16_f32 v49, v50, v51
  ds_write_b64 v8, v[48:49] offset:128
  v_cvt_pk_bf16_f32 v56, v56, v57
  v_cvt_pk_bf16_f32 v57, v58, v59
  ds_write_b64 v8, v[56:57] offset:160
  v_cvt_pk_bf16_f32 v64, v64, v65
  v_cvt_pk_bf16_f32 v65, v66, v67
  ds_write_b64 v8, v[64:65] offset:192
  v_cvt_pk_bf16_f32 v72, v72, v73
  v_cvt_pk_bf16_f32 v73, v74, v75
  ds_write_b64 v8, v[72:73] offset:224
  v_cvt_pk_bf16_f32 v80, v80, v81
  v_cvt_pk_bf16_f32 v81, v82, v83
  ds_write_b64 v8, v[80:81] offset:256
  v_cvt_pk_bf16_f32 v88, v88, v89
  v_cvt_pk_bf16_f32 v89, v90, v91
  ds_write_b64 v8, v[88:89] offset:288
  ds_read_b128 v[128:131], v9 offset:0
  ds_read_b128 v[132:135], v9 offset:16
  ds_read_b128 v[136:139], v9 offset:32
  ds_read_b128 v[140:143], v9 offset:48
  ds_read_b128 v[144:147], v9 offset:64
  ds_read_b128 v[148:151], v9 offset:80
  ds_read_b128 v[152:155], v9 offset:96
  ds_read_b128 v[156:159], v9 offset:112
  v_cvt_pk_bf16_f32 v20, v20, v21
  v_cvt_pk_bf16_f32 v21, v22, v23
  ds_write_b64 v8, v[20:21] offset:5376
  v_cvt_pk_bf16_f32 v28, v28, v29
  v_cvt_pk_bf16_f32 v29, v30, v31
  ds_write_b64 v8, v[28:29] offset:5408
  v_cvt_pk_bf16_f32 v36, v36, v37
  v_cvt_pk_bf16_f32 v37, v38, v39
  ds_write_b64 v8, v[36:37] offset:5440
  v_cvt_pk_bf16_f32 v44, v44, v45
  v_cvt_pk_bf16_f32 v45, v46, v47
  ds_write_b64 v8, v[44:45] offset:5472
  v_cvt_pk_bf16_f32 v52, v52, v53
  v_cvt_pk_bf16_f32 v53, v54, v55
  ds_write_b64 v8, v[52:53] offset:5504
  v_cvt_pk_bf16_f32 v60, v60, v61
  v_cvt_pk_bf16_f32 v61, v62, v63
  ds_write_b64 v8, v[60:61] offset:5536
  v_cvt_pk_bf16_f32 v68, v68, v69
  v_cvt_pk_bf16_f32 v69, v70, v71
  ds_write_b64 v8, v[68:69] offset:5568
  v_cvt_pk_bf16_f32 v76, v76, v77
  v_cvt_pk_bf16_f32 v77, v78, v79
  ds_write_b64 v8, v[76:77] offset:5600
  v_cvt_pk_bf16_f32 v84, v84, v85
  v_cvt_pk_bf16_f32 v85, v86, v87
  ds_write_b64 v8, v[84:85] offset:5632
  v_cvt_pk_bf16_f32 v92, v92, v93
  v_cvt_pk_bf16_f32 v93, v94, v95
  ds_write_b64 v8, v[92:93] offset:5664
  s_waitcnt vmcnt(19)
  s_waitcnt vmcnt(8)
PLP_22:
  v_cmp_le_u32 vcc, 4, v125
  s_cmp_eq_u64 vcc, -1
  s_cbranch_scc1 POK_21
  s_sleep 1
  buffer_load_dword v125, off, s[20:23], s27 sc1
  s_sub_u32 s25, s25, 1
  s_waitcnt vmcnt(0)
  s_cbranch_scc0 PLP_22
  s_endpgm
POK_21:
  buffer_load_dword v112, v4, s[20:23], s36 offen sc1
  buffer_load_dword v124, v4, s[20:23], s36 offen offset:128 sc1
  buffer_load_dword v113, v4, s[20:23], s37 offen sc1
  buffer_load_dword v125, v4, s[20:23], s37 offen offset:128 sc1
  buffer_load_dword v114, v4, s[20:23], s38 offen sc1
  buffer_load_dword v126, v4, s[20:23], s38 offen offset:128 sc1
  buffer_load_dword v115, v4, s[20:23], s39 offen sc1
  buffer_load_dword v127, v4, s[20:23], s39 offen offset:128 sc1
  buffer_load_dwordx4 v[196:199], v1, s[20:23], s4 offen offset:0 sc1
  buffer_load_dwordx4 v[200:203], v1, s[20:23], s6 offen offset:0 sc1
  buffer_load_dwordx4 v[204:207], v1, s[20:23], s46 offen offset:0 sc1
  buffer_load_dwordx4 v[212:215], v1, s[20:23], s4 offen offset:1024 sc1
  buffer_load_dwordx4 v[216:219], v1, s[20:23], s6 offen offset:1024 sc1
  buffer_load_dwordx4 v[220:223], v1, s[20:23], s46 offen offset:1024 sc1
  buffer_load_dwordx4 v[228:231], v1, s[20:23], s4 offen offset:2048 sc1
  buffer_load_dwordx4 v[232:235], v1, s[20:23], s6 offen offset:2048 sc1
  buffer_load_dwordx4 v[236:239], v1, s[20:23], s46 offen offset:2048 sc1
  buffer_load_dwordx4 v[244:247], v1, s[20:23], s4 offen offset:3072 sc1
  buffer_load_dwordx4 v[248:251], v1, s[20:23], s6 offen offset:3072 sc1
  buffer_load_dwordx4 v[252:255], v1, s[20:23], s46 offen offset:3072 sc1
  ds_read_b128 v[160:163], v9 offset:5376
  ds_read_b128 v[164:167], v9 offset:5392
  ds_read_b128 v[168:171], v9 offset:5408
  ds_read_b128 v[172:175], v9 offset:5424
  ds_read_b128 v[176:179], v9 offset:5440
  ds_read_b128 v[180:183], v9 offset:5456
  ds_read_b128 v[184:187], v9 offset:5472
  ds_read_b128 v[188:191], v9 offset:5488
  s_waitcnt lgkmcnt(15)
  v_mfma_f32_4x4x4_16b_bf16 v[16:19], a[208:209], v[128:129], 0
  v_mfma_f32_4x4x4_16b_bf16 v[20:23], a[208:209], v[130:131], 0
  v_mfma_f32_4x4x4_16b_bf16 v[24:27], a[208:209], v[132:133], 0
  v_mfma_f32_4x4x4_16b_bf16 v[28:31], a[208:209], v[134:135], 0
  v_mfma_f32_4x4x4_16b_bf16 v[32:35], a[208:209], v[136:137], 0
  v_mfma_f32_4x4x4_16b_bf16 v[36:39], a[208:209], v[138:139], 0
  v_mfma_f32_4x4x4_16b_bf16 v[40:43], a[208:209], v[140:141], 0
  v_mfma_f32_4x4x4_16b_bf16 v[44:47], a[208:209], v[142:143], 0
  v_mfma_f32_4x4x4_16b_bf16 v[16:19], a[210:211], v[130:131], v[16:19]
  v_mfma_f32_4x4x4_16b_bf16 v[20:23], a[210:211], v[132:133], v[20:23]
  v_mfma_f32_4x4x4_16b_bf16 v[24:27], a[210:211], v[134:135], v[24:27]
  v_mfma_f32_4x4x4_16b_bf16 v[28:31], a[210:211], v[136:137], v[28:31]
  v_mfma_f32_4x4x4_16b_bf16 v[32:35], a[210:211], v[138:139], v[32:35]
  v_mfma_f32_4x4x4_16b_bf16 v[36:39], a[210:211], v[140:141], v[36:39]
  v_mfma_f32_4x4x4_16b_bf16 v[40:43], a[210:211], v[142:143], v[40:43]
  v_mfma_f32_4x4x4_16b_bf16 v[44:47], a[210:211], v[144:145], v[44:47]
  v_mfma_f32_4x4x4_16b_bf16 v[16:19], a[212:213], v[132:133], v[16:19]
  v_mfma_f32_4x4x4_16b_bf16 v[20:23], a[212:213], v[134:135], v[20:23]
  v_mfma_f32_4x4x4_16b_bf16 v[24:27], a[212:213], v[136:137], v[24:27]
  v_mfma_f32_4x4x4_16b_bf16 v[28:31], a[212:213], v[138:139], v[28:31]
  v_mfma_f32_4x4x4_16b_bf16 v[32:35], a[212:213], v[140:141], v[32:35]
  v_mfma_f32_4x4x4_16b_bf16 v[36:39], a[212:213], v[142:143], v[36:39]
  v_mfma_f32_4x4x4_16b_bf16 v[40:43], a[212:213], v[144:145], v[40:43]
  v_mfma_f32_4x4x4_16b_bf16 v[44:47], a[212:213], v[146:147], v[44:47]
  v_mfma_f32_4x4x4_16b_bf16 v[16:19], a[214:215], v[134:135], v[16:19]
  v_mfma_f32_4x4x4_16b_bf16 v[20:23], a[214:215], v[136:137], v[20:23]
  v_mfma_f32_4x4x4_16b_bf16 v[24:27], a[214:215], v[138:139], v[24:27]
  v_mfma_f32_4x4x4_16b_bf16 v[28:31], a[214:215], v[140:141], v[28:31]
  v_mfma_f32_4x4x4_16b_bf16 v[32:35], a[214:215], v[142:143], v[32:35]
  v_mfma_f32_4x4x4_16b_bf16 v[36:39], a[214:215], v[144:145], v[36:39]
  v_mfma_f32_4x4x4_16b_bf16 v[40:43], a[214:215], v[146:147], v[40:43]
  v_mfma_f32_4x4x4_16b_bf16 v[44:47], a[214:215], v[148:149], v[44:47]
  v_mfma_f32_4x4x4_16b_bf16 v[16:19], a[216:217], v[136:137], v[16:19]
  v_mfma_f32_4x4x4_16b_bf16 v[20:23], a[216:217], v[138:139], v[20:23]
  v_mfma_f32_4x4x4_16b_bf16 v[24:27], a[216:217], v[140:141], v[24:27]
  v_mfma_f32_4x4x4_16b_bf16 v[28:31], a[216:217], v[142:143], v[28:31]
  v_mfma_f32_4x4x4_16b_bf16 v[32:35], a[216:217], v[144:145], v[32:35]
  v_mfma_f32_4x4x4_16b_bf16 v[36:39], a[216:217], v[146:147], v[36:39]
  v_mfma_f32_4x4x4_16b_bf16 v[40:43], a[216:217], v[148:149], v[40:43]
  v_mfma_f32_4x4x4_16b_bf16 v[44:47], a[216:217], v[150:151], v[44:47]
  v_mfma_f32_4x4x4_16b_bf16 v[16:19], a[218:219], v[138:139], v[16:19]
  v_mfma_f32_4x4x4_16b_bf16 v[20:23], a[218:219], v[140:141], v[20:23]
  v_mfma_f32_4x4x4_16b_bf16 v[24:27], a[218:219], v[142:143], v[24:27]
  v_mfma_f32_4x4x4_16b_bf16 v[28:31], a[218:219], v[144:145], v[28:31]
  v_mfma_f32_4x4x4_16b_bf16 v[32:35], a[218:219], v[146:147], v[32:35]
  v_mfma_f32_4x4x4_16b_bf16 v[36:39], a[218:219], v[148:149], v[36:39]
  v_mfma_f32_4x4x4_16b_bf16 v[40:43], a[218:219], v[150:151], v[40:43]
  v_mfma_f32_4x4x4_16b_bf16 v[44:47], a[218:219], v[152:153], v[44:47]
  v_mfma_f32_4x4x4_16b_bf16 v[16:19], a[220:221], v[140:141], v[16:19]
  v_mfma_f32_4x4x4_16b_bf16 v[20:23], a[220:221], v[142:143], v[20:23]
  v_mfma_f32_4x4x4_16b_bf16 v[24:27], a[220:221], v[144:145], v[24:27]
  v_mfma_f32_4x4x4_16b_bf16 v[28:31], a[220:221], v[146:147], v[28:31]
  v_mfma_f32_4x4x4_16b_bf16 v[32:35], a[220:221], v[148:149], v[32:35]
  v_mfma_f32_4x4x4_16b_bf16 v[36:39], a[220:221], v[150:151], v[36:39]
  v_mfma_f32_4x4x4_16b_bf16 v[40:43], a[220:221], v[152:153], v[40:43]
  v_mfma_f32_4x4x4_16b_bf16 v[44:47], a[220:221], v[154:155], v[44:47]
  v_mfma_f32_4x4x4_16b_bf16 v[16:19], a[222:223], v[142:143], v[16:19]
  v_mfma_f32_4x4x4_16b_bf16 v[20:23], a[222:223], v[144:145], v[20:23]
  v_mfma_f32_4x4x4_16b_bf16 v[24:27], a[222:223], v[146:147], v[24:27]
  v_mfma_f32_4x4x4_16b_bf16 v[28:31], a[222:223], v[148:149], v[28:31]
  v_mfma_f32_4x4x4_16b_bf16 v[32:35], a[222:223], v[150:151], v[32:35]
  v_mfma_f32_4x4x4_16b_bf16 v[36:39], a[222:223], v[152:153], v[36:39]
  v_mfma_f32_4x4x4_16b_bf16 v[40:43], a[222:223], v[154:155], v[40:43]
  v_mfma_f32_4x4x4_16b_bf16 v[44:47], a[222:223], v[156:157], v[44:47]
  v_mfma_f32_4x4x4_16b_bf16 v[16:19], a[224:225], v[144:145], v[16:19]
  v_mfma_f32_4x4x4_16b_bf16 v[20:23], a[224:225], v[146:147], v[20:23]
  v_mfma_f32_4x4x4_16b_bf16 v[24:27], a[224:225], v[148:149], v[24:27]
  v_mfma_f32_4x4x4_16b_bf16 v[28:31], a[224:225], v[150:151], v[28:31]
  v_mfma_f32_4x4x4_16b_bf16 v[32:35], a[224:225], v[152:153], v[32:35]
  v_mfma_f32_4x4x4_16b_bf16 v[36:39], a[224:225], v[154:155], v[36:39]
  v_mfma_f32_4x4x4_16b_bf16 v[40:43], a[224:225], v[156:157], v[40:43]
  v_mfma_f32_4x4x4_16b_bf16 v[44:47], a[224:225], v[158:159], v[44:47]
  v_mfma_f32_4x4x4_16b_bf16 v[16:19], a[226:227], v[136:137], v[16:19]
  v_mfma_f32_4x4x4_16b_bf16 v[20:23], a[226:227], v[138:139], v[20:23]
  v_mfma_f32_4x4x4_16b_bf16 v[24:27], a[226:227], v[140:141], v[24:27]
  v_mfma_f32_4x4x4_16b_bf16 v[28:31], a[226:227], v[142:143], v[28:31]
  v_mfma_f32_4x4x4_16b_bf16 v[32:35], a[226:227], v[144:145], v[32:35]
  v_mfma_f32_4x4x4_16b_bf16 v[36:39], a[226:227], v[146:147], v[36:39]
  v_mfma_f32_4x4x4_16b_bf16 v[40:43], a[226:227], v[148:149], v[40:43]
  v_mfma_f32_4x4x4_16b_bf16 v[44:47], a[226:227], v[150:151], v[44:47]
  s_waitcnt lgkmcnt(4)
  v_mfma_f32_4x4x4_16b_bf16 v[48:51], a[228:229], v[160:161], 0
  v_mfma_f32_4x4x4_16b_bf16 v[52:55], a[228:229], v[162:163], 0
  v_mfma_f32_4x4x4_16b_bf16 v[56:59], a[228:229], v[164:165], 0
  v_mfma_f32_4x4x4_16b_bf16 v[60:63], a[228:229], v[166:167], 0
  v_mfma_f32_4x4x4_16b_bf16 v[64:67], a[228:229], v[168:169], 0
  v_mfma_f32_4x4x4_16b_bf16 v[68:71], a[228:229], v[170:171], 0
  v_mfma_f32_4x4x4_16b_bf16 v[72:75], a[228:229], v[172:173], 0
  v_mfma_f32_4x4x4_16b_bf16 v[76:79], a[228:229], v[174:175], 0
  s_waitcnt lgkmcnt(3)
  v_mfma_f32_4x4x4_16b_bf16 v[48:51], a[230:231], v[162:163], v[48:51]
  v_cvt_pk_bf16_f32 v128, v16, v17
  v_mfma_f32_4x4x4_16b_bf16 v[52:55], a[230:231], v[164:165], v[52:55]
  v_mfma_f32_4x4x4_16b_bf16 v[56:59], a[230:231], v[166:167], v[56:59]
  v_cvt_pk_bf16_f32 v129, v18, v19
  v_mfma_f32_4x4x4_16b_bf16 v[60:63], a[230:231], v[168:169], v[60:63]
  v_mfma_f32_4x4x4_16b_bf16 v[64:67], a[230:231], v[170:171], v[64:67]
  v_cvt_pk_bf16_f32 v130, v20, v21
  v_mfma_f32_4x4x4_16b_bf16 v[68:71], a[230:231], v[172:173], v[68:71]
  v_mfma_f32_4x4x4_16b_bf16 v[72:75], a[230:231], v[174:175], v[72:75]
  v_cvt_pk_bf16_f32 v131, v22, v23
  v_mfma_f32_4x4x4_16b_bf16 v[76:79], a[230:231], v[176:177], v[76:79]
  v_mfma_f32_4x4x4_16b_bf16 v[48:51], a[232:233], v[164:165], v[48:51]
  v_cvt_pk_bf16_f32 v132, v24, v25
  v_mfma_f32_4x4x4_16b_bf16 v[52:55], a[232:233], v[166:167], v[52:55]
  v_mfma_f32_4x4x4_16b_bf16 v[56:59], a[232:233], v[168:169], v[56:59]
  v_cvt_pk_bf16_f32 v133, v26, v27
  v_mfma_f32_4x4x4_16b_bf16 v[60:63], a[232:233], v[170:171], v[60:63]
  v_mfma_f32_4x4x4_16b_bf16 v[64:67], a[232:233], v[172:173], v[64:67]
  v_cvt_pk_bf16_f32 v134, v28, v29
  v_mfma_f32_4x4x4_16b_bf16 v[68:71], a[232:233], v[174:175], v[68:71]
  v_mfma_f32_4x4x4_16b_bf16 v[72:75], a[232:233], v[176:177], v[72:75]
  v_cvt_pk_bf16_f32 v135, v30, v31
  v_mfma_f32_4x4x4_16b_bf16 v[76:79], a[232:233], v[178:179], v[76:79]
  s_add_u32 s27, s24, 65536
  s_lshl_b32 s29, s30, 13
  s_add_u32 s27, s27, s29
  buffer_load_dword v13, off, s[20:23], s27 sc1
  s_waitcnt lgkmcnt(2)
  v_mfma_f32_4x4x4_16b_bf16 v[48:51], a[234:235], v[166:167], v[48:51]
  v_cvt_pk_bf16_f32 v136, v32, v33
  v_mfma_f32_4x4x4_16b_bf16 v[52:55], a[234:235], v[168:169], v[52:55]
  v_mfma_f32_4x4x4_16b_bf16 v[56:59], a[234:235], v[170:171], v[56:59]
  v_cvt_pk_bf16_f32 v137, v34, v35
  v_mfma_f32_4x4x4_16b_bf16 v[60:63], a[234:235], v[172:173], v[60:63]
  v_mfma_f32_4x4x4_16b_bf16 v[64:67], a[234:235], v[174:175], v[64:67]
  v_cvt_pk_bf16_f32 v138, v36, v37
  v_mfma_f32_4x4x4_16b_bf16 v[68:71], a[234:235], v[176:177], v[68:71]
  v_mfma_f32_4x4x4_16b_bf16 v[72:75], a[234:235], v[178:179], v[72:75]
  v_cvt_pk_bf16_f32 v139, v38, v39
  v_mfma_f32_4x4x4_16b_bf16 v[76:79], a[234:235], v[180:181], v[76:79]
  v_mfma_f32_4x4x4_16b_bf16 v[48:51], a[236:237], v[168:169], v[48:51]
  v_cvt_pk_bf16_f32 v140, v40, v41
  v_mfma_f32_4x4x4_16b_bf16 v[52:55], a[236:237], v[170:171], v[52:55]
  v_mfma_f32_4x4x4_16b_bf16 v[56:59], a[236:237], v[172:173], v[56:59]
  v_cvt_pk_bf16_f32 v141, v42, v43
  v_mfma_f32_4x4x4_16b_bf16 v[60:63], a[236:237], v[174:175], v[60:63]
  v_mfma_f32_4x4x4_16b_bf16 v[64:67], a[236:237], v[176:177], v[64:67]
  v_cvt_pk_bf16_f32 v142, v44, v45
  v_mfma_f32_4x4x4_16b_bf16 v[68:71], a[236:237], v[178:179], v[68:71]
  v_mfma_f32_4x4x4_16b_bf16 v[72:75], a[236:237], v[180:181], v[72:75]
  v_cvt_pk_bf16_f32 v143, v46, v47
  v_mfma_f32_4x4x4_16b_bf16 v[76:79], a[236:237], v[182:183], v[76:79]
  s_waitcnt lgkmcnt(1)
  v_mfma_f32_4x4x4_16b_bf16 v[48:51], a[238:239], v[170:171], v[48:51]
  v_mfma_f32_4x4x4_16b_bf16 v[52:55], a[238:239], v[172:173], v[52:55]
  v_mfma_f32_4x4x4_16b_bf16 v[56:59], a[238:239], v[174:175], v[56:59]
  v_mfma_f32_4x4x4_16b_bf16 v[60:63], a[238:239], v[176:177], v[60:63]
  v_mfma_f32_4x4x4_16b_bf16 v[64:67], a[238:239], v[178:179], v[64:67]
  v_mfma_f32_4x4x4_16b_bf16 v[68:71], a[238:239], v[180:181], v[68:71]
  v_mfma_f32_4x4x4_16b_bf16 v[72:75], a[238:239], v[182:183], v[72:75]
  v_mfma_f32_4x4x4_16b_bf16 v[76:79], a[238:239], v[184:185], v[76:79]
  ds_write_b128 v9, v[128:131] offset:0
  ds_write_b128 v9, v[132:135] offset:16
  ds_write_b128 v9, v[136:139] offset:32
  ds_write_b128 v9, v[140:143] offset:48
  v_mfma_f32_4x4x4_16b_bf16 v[48:51], a[240:241], v[172:173], v[48:51]
  v_mfma_f32_4x4x4_16b_bf16 v[52:55], a[240:241], v[174:175], v[52:55]
  v_mfma_f32_4x4x4_16b_bf16 v[56:59], a[240:241], v[176:177], v[56:59]
  v_mfma_f32_4x4x4_16b_bf16 v[60:63], a[240:241], v[178:179], v[60:63]
  v_mfma_f32_4x4x4_16b_bf16 v[64:67], a[240:241], v[180:181], v[64:67]
  v_mfma_f32_4x4x4_16b_bf16 v[68:71], a[240:241], v[182:183], v[68:71]
  v_mfma_f32_4x4x4_16b_bf16 v[72:75], a[240:241], v[184:185], v[72:75]
  v_mfma_f32_4x4x4_16b_bf16 v[76:79], a[240:241], v[186:187], v[76:79]
  s_waitcnt lgkmcnt(4)
  v_mfma_f32_4x4x4_16b_bf16 v[48:51], a[242:243], v[174:175], v[48:51]
  v_mfma_f32_4x4x4_16b_bf16 v[52:55], a[242:243], v[176:177], v[52:55]
  v_mfma_f32_4x4x4_16b_bf16 v[56:59], a[242:243], v[178:179], v[56:59]
  v_mfma_f32_4x4x4_16b_bf16 v[60:63], a[242:243], v[180:181], v[60:63]
  v_mfma_f32_4x4x4_16b_bf16 v[64:67], a[242:243], v[182:183], v[64:67]
  v_mfma_f32_4x4x4_16b_bf16 v[68:71], a[242:243], v[184:185], v[68:71]
  v_mfma_f32_4x4x4_16b_bf16 v[72:75], a[242:243], v[186:187], v[72:75]
  v_mfma_f32_4x4x4_16b_bf16 v[76:79], a[242:243], v[188:189], v[76:79]
  v_mfma_f32_4x4x4_16b_bf16 v[48:51], a[244:245], v[176:177], v[48:51]
  v_mfma_f32_4x4x4_16b_bf16 v[52:55], a[244:245], v[178:179], v[52:55]
  v_mfma_f32_4x4x4_16b_bf16 v[56:59], a[244:245], v[180:181], v[56:59]
  v_mfma_f32_4x4x4_16b_bf16 v[60:63], a[244:245], v[182:183], v[60:63]
  v_mfma_f32_4x4x4_16b_bf16 v[64:67], a[244:245], v[184:185], v[64:67]
  v_mfma_f32_4x4x4_16b_bf16 v[68:71], a[244:245], v[186:187], v[68:71]
  v_mfma_f32_4x4x4_16b_bf16 v[72:75], a[244:245], v[188:189], v[72:75]
  v_mfma_f32_4x4x4_16b_bf16 v[76:79], a[244:245], v[190:191], v[76:79]
  v_mfma_f32_4x4x4_16b_bf16 v[48:51], a[246:247], v[168:169], v[48:51]
  v_mfma_f32_4x4x4_16b_bf16 v[52:55], a[246:247], v[170:171], v[52:55]
  v_mfma_f32_4x4x4_16b_bf16 v[56:59], a[246:247], v[172:173], v[56:59]
  v_mfma_f32_4x4x4_16b_bf16 v[60:63], a[246:247], v[174:175], v[60:63]
  v_mfma_f32_4x4x4_16b_bf16 v[64:67], a[246:247], v[176:177], v[64:67]
  v_mfma_f32_4x4x4_16b_bf16 v[68:71], a[246:247], v[178:179], v[68:71]
  v_mfma_f32_4x4x4_16b_bf16 v[72:75], a[246:247], v[180:181], v[72:75]
  v_mfma_f32_4x4x4_16b_bf16 v[76:79], a[246:247], v[182:183], v[76:79]
  v_cvt_pk_bf16_f32 v160, v48, v49
  v_cvt_pk_bf16_f32 v161, v50, v51
  v_cvt_pk_bf16_f32 v162, v52, v53
  v_cvt_pk_bf16_f32 v163, v54, v55
  v_cvt_pk_bf16_f32 v164, v56, v57
  v_cvt_pk_bf16_f32 v165, v58, v59
  v_cvt_pk_bf16_f32 v166, v60, v61
  v_cvt_pk_bf16_f32 v167, v62, v63
  v_cvt_pk_bf16_f32 v168, v64, v65
  v_cvt_pk_bf16_f32 v169, v66, v67
  v_cvt_pk_bf16_f32 v170, v68, v69
  v_cvt_pk_bf16_f32 v171, v70, v71
  v_cvt_pk_bf16_f32 v172, v72, v73
  v_cvt_pk_bf16_f32 v173, v74, v75
  v_cvt_pk_bf16_f32 v174, v76, v77
  v_cvt_pk_bf16_f32 v175, v78, v79
  ds_write_b128 v9, v[160:163] offset:5376
  ds_write_b128 v9, v[164:167] offset:5392
  ds_write_b128 v9, v[168:171] offset:5408
  ds_write_b128 v9, v[172:175] offset:5424
  ds_read_b64_tr_b16 v[80:81], v10 offset:0
  ds_read_b64_tr_b16 v[82:83], v10 offset:5376
  ds_read_b64_tr_b16 v[84:85], v10 offset:32
  ds_read_b64_tr_b16 v[86:87], v10 offset:5408
  ds_read_b64_tr_b16 v[88:89], v10 offset:64
  ds_read_b64_tr_b16 v[90:91], v10 offset:5440
  ds_read_b64_tr_b16 v[92:93], v10 offset:96
  ds_read_b64_tr_b16 v[94:95], v10 offset:5472
  s_waitcnt lgkmcnt(4)
  ds_read_b64_tr_b16 v[96:97], v10 offset:128
  ds_read_b64_tr_b16 v[98:99], v10 offset:5504
  ds_read_b64_tr_b16 v[100:101], v10 offset:160
  ds_read_b64_tr_b16 v[102:103], v10 offset:5536
  ds_read_b64_tr_b16 v[104:105], v10 offset:192
  ds_read_b64_tr_b16 v[106:107], v10 offset:5568
  ds_read_b64_tr_b16 v[108:109], v10 offset:224
  ds_read_b64_tr_b16 v[110:111], v10 offset:5600
  s_lshl_b32 s40, s28, 18
  s_lshl_b32 s41, s31, 10
  s_add_u32 s40, s40, s41
  s_add_u32 s40, s40, 33832960
  buffer_store_dwordx4 v[80:83], v1, s[20:23], s40 offen sc1
  s_add_u32 s40, s40, 32768
  buffer_store_dwordx4 v[84:87], v1, s[20:23], s40 offen sc1
  s_add_u32 s40, s40, 32768
  s_waitcnt lgkmcnt(10)
  buffer_store_dwordx4 v[88:91], v1, s[20:23], s40 offen sc1
  s_add_u32 s40, s40, 32768
  s_waitcnt lgkmcnt(8)
  buffer_store_dwordx4 v[92:95], v1, s[20:23], s40 offen sc1
  s_add_u32 s40, s40, 32768
  s_waitcnt lgkmcnt(6)
  buffer_store_dwordx4 v[96:99], v1, s[20:23], s40 offen sc1
  s_add_u32 s40, s40, 32768
  s_waitcnt lgkmcnt(4)
  buffer_store_dwordx4 v[100:103], v1, s[20:23], s40 offen sc1
  s_add_u32 s40, s40, 32768
  s_waitcnt lgkmcnt(2)
  buffer_store_dwordx4 v[104:107], v1, s[20:23], s40 offen sc1
  s_add_u32 s40, s40, 32768
  s_waitcnt lgkmcnt(0)
  buffer_store_dwordx4 v[108:111], v1, s[20:23], s40 offen sc1
  s_add_u32 s40, s40, 32768
  ds_write_b128 v7, v[80:83] offset:0
  ds_write_b128 v7, v[84:87] offset:2048
  ds_write_b128 v7, v[88:91] offset:4096
  ds_write_b128 v7, v[92:95] offset:6144
  ds_write_b128 v7, v[96:99] offset:8192
  ds_write_b128 v7, v[100:103] offset:10240
  ds_write_b128 v7, v[104:107] offset:12288
  ds_write_b128 v7, v[108:111] offset:14336
  s_waitcnt lgkmcnt(0)
  s_barrier
  ds_read_b128 v[192:195], v5 offset:0
  ds_read_b128 v[208:211], v5 offset:1024
  ds_read_b128 v[224:227], v5 offset:2048
  ds_read_b128 v[240:243], v5 offset:3072
  ds_read_b128 v[128:131], v5 offset:8192
  ds_read_b128 v[144:147], v5 offset:9216
  ds_read_b128 v[160:163], v5 offset:10240
  ds_read_b128 v[176:179], v5 offset:11264
  s_waitcnt vmcnt(8)
PLP_24:
  v_cmp_le_u32 vcc, 4, v13
  s_cmp_eq_u64 vcc, -1
  s_cbranch_scc1 POK_23
  s_sleep 1
  buffer_load_dword v13, off, s[20:23], s27 sc1
  s_sub_u32 s25, s25, 1
  s_waitcnt vmcnt(0)
  s_cbranch_scc0 PLP_24
  s_endpgm
POK_23:
  buffer_load_dwordx4 v[132:135], v1, s[20:23], s5 offen offset:0 sc1
  buffer_load_dwordx4 v[136:139], v1, s[20:23], s7 offen offset:0 sc1
  buffer_load_dwordx4 v[140:143], v1, s[20:23], s47 offen offset:0 sc1
  buffer_load_dwordx4 v[148:151], v1, s[20:23], s5 offen offset:1024 sc1
  buffer_load_dwordx4 v[152:155], v1, s[20:23], s7 offen offset:1024 sc1
  buffer_load_dwordx4 v[156:159], v1, s[20:23], s47 offen offset:1024 sc1
  buffer_load_dwordx4 v[164:167], v1, s[20:23], s5 offen offset:2048 sc1
  buffer_load_dwordx4 v[168:171], v1, s[20:23], s7 offen offset:2048 sc1
  buffer_load_dwordx4 v[172:175], v1, s[20:23], s47 offen offset:2048 sc1
  buffer_load_dwordx4 v[180:183], v1, s[20:23], s5 offen offset:3072 sc1
  buffer_load_dwordx4 v[184:187], v1, s[20:23], s7 offen offset:3072 sc1
  buffer_load_dwordx4 v[188:191], v1, s[20:23], s47 offen offset:3072 sc1
  s_waitcnt lgkmcnt(0)
  v_max3_f32 v24, v112, v113, v114
  v_max_f32 v24, v24, v115
  v_sub_f32 v16, v112, v24
  v_sub_f32 v17, v113, v24
  v_sub_f32 v18, v114, v24
  v_sub_f32 v19, v115, v24
  v_exp_f32 v16, v16
  v_exp_f32 v17, v17
  v_exp_f32 v18, v18
  v_exp_f32 v19, v19
  v_mul_f32 v25, v16, v124
  v_fmac_f32 v25, v17, v125
  v_fmac_f32 v25, v18, v126
  v_fmac_f32 v25, v19, v127
  v_rcp_f32 v25, v25
  s_and_b32 s34, s33, 127
  s_cmp_lt_u32 s34, 125
  s_cselect_b32 s34, 1.0, 0
  v_mul_f32 v25, s34, v25
  v_mul_f32 v26, v16, v25
  v_mul_f32 v28, v17, v25
  v_mul_f32 v30, v18, v25
  v_mul_f32 v32, v19, v25
  s_add_u32 s34, s48, 16973824
  s_add_u32 s35, s34, 8192
  v_lshlrev_b32 v48, 16, v192
  v_and_b32 v49, s49, v192
  v_lshlrev_b32 v50, 16, v193
  v_and_b32 v51, s49, v193
  v_lshlrev_b32 v52, 16, v194
  v_and_b32 v53, s49, v194
  v_lshlrev_b32 v54, 16, v195
  v_and_b32 v55, s49, v195
  v_pk_mul_f32 v[40:41], v[48:49], v[26:27] op_sel_hi:[1,0]
  v_pk_mul_f32 v[42:43], v[50:51], v[26:27] op_sel_hi:[1,0]
  v_pk_mul_f32 v[44:45], v[52:53], v[26:27] op_sel_hi:[1,0]
  v_pk_mul_f32 v[46:47], v[54:55], v[26:27] op_sel_hi:[1,0]
  v_lshlrev_b32 v48, 16, v196
  v_and_b32 v49, s49, v196
  v_lshlrev_b32 v50, 16, v197
  v_and_b32 v51, s49, v197
  v_lshlrev_b32 v52, 16, v198
  v_and_b32 v53, s49, v198
  v_lshlrev_b32 v54, 16, v199
  v_and_b32 v55, s49, v199
  v_pk_fma_f32 v[40:41], v[48:49], v[28:29], v[40:41] op_sel_hi:[1,0,1]
  v_pk_fma_f32 v[42:43], v[50:51], v[28:29], v[42:43] op_sel_hi:[1,0,1]
  v_pk_fma_f32 v[44:45], v[52:53], v[28:29], v[44:45] op_sel_hi:[1,0,1]
  v_pk_fma_f32 v[46:47], v[54:55], v[28:29], v[46:47] op_sel_hi:[1,0,1]
  v_lshlrev_b32 v48, 16, v200
  v_and_b32 v49, s49, v200
  v_lshlrev_b32 v50, 16, v201
  v_and_b32 v51, s49, v201
  v_lshlrev_b32 v52, 16, v202
  v_and_b32 v53, s49, v202
  v_lshlrev_b32 v54, 16, v203
  v_and_b32 v55, s49, v203
  v_pk_fma_f32 v[40:41], v[48:49], v[30:31], v[40:41] op_sel_hi:[1,0,1]
  v_pk_fma_f32 v[42:43], v[50:51], v[30:31], v[42:43] op_sel_hi:[1,0,1]
  v_pk_fma_f32 v[44:45], v[52:53], v[30:31], v[44:45] op_sel_hi:[1,0,1]
  v_pk_fma_f32 v[46:47], v[54:55], v[30:31], v[46:47] op_sel_hi:[1,0,1]
  v_lshlrev_b32 v48, 16, v204
  v_and_b32 v49, s49, v204
  v_lshlrev_b32 v50, 16, v205
  v_and_b32 v51, s49, v205
  v_lshlrev_b32 v52, 16, v206
  v_and_b32 v53, s49, v206
  v_lshlrev_b32 v54, 16, v207
  v_and_b32 v55, s49, v207
  v_pk_fma_f32 v[40:41], v[48:49], v[32:33], v[40:41] op_sel_hi:[1,0,1]
  v_pk_fma_f32 v[42:43], v[50:51], v[32:33], v[42:43] op_sel_hi:[1,0,1]
  v_pk_fma_f32 v[44:45], v[52:53], v[32:33], v[44:45] op_sel_hi:[1,0,1]
  v_pk_fma_f32 v[46:47], v[54:55], v[32:33], v[46:47] op_sel_hi:[1,0,1]
  v_cvt_pk_bf16_f32 v80, v40, v41
  v_cvt_pk_bf16_f32 v81, v42, v43
  v_cvt_pk_bf16_f32 v82, v44, v45
  v_cvt_pk_bf16_f32 v83, v46, v47
  buffer_store_dwordx4 v[80:83], v1, s[20:23], s34 offen offset:0 sc1
  v_lshlrev_b32 v48, 16, v208
  v_and_b32 v49, s49, v208
  v_lshlrev_b32 v50, 16, v209
  v_and_b32 v51, s49, v209
  v_lshlrev_b32 v52, 16, v210
  v_and_b32 v53, s49, v210
  v_lshlrev_b32 v54, 16, v211
  v_and_b32 v55, s49, v211
  v_pk_mul_f32 v[40:41], v[48:49], v[26:27] op_sel_hi:[1,0]
  v_pk_mul_f32 v[42:43], v[50:51], v[26:27] op_sel_hi:[1,0]
  v_pk_mul_f32 v[44:45], v[52:53], v[26:27] op_sel_hi:[1,0]
  v_pk_mul_f32 v[46:47], v[54:55], v[26:27] op_sel_hi:[1,0]
  v_lshlrev_b32 v48, 16, v212
  v_and_b32 v49, s49, v212
  v_lshlrev_b32 v50, 16, v213
  v_and_b32 v51, s49, v213
  v_lshlrev_b32 v52, 16, v214
  v_and_b32 v53, s49, v214
  v_lshlrev_b32 v54, 16, v215
  v_and_b32 v55, s49, v215
  v_pk_fma_f32 v[40:41], v[48:49], v[28:29], v[40:41] op_sel_hi:[1,0,1]
  v_pk_fma_f32 v[42:43], v[50:51], v[28:29], v[42:43] op_sel_hi:[1,0,1]
  v_pk_fma_f32 v[44:45], v[52:53], v[28:29], v[44:45] op_sel_hi:[1,0,1]
  v_pk_fma_f32 v[46:47], v[54:55], v[28:29], v[46:47] op_sel_hi:[1,0,1]
  v_lshlrev_b32 v48, 16, v216
  v_and_b32 v49, s49, v216
  v_lshlrev_b32 v50, 16, v217
  v_and_b32 v51, s49, v217
  v_lshlrev_b32 v52, 16, v218
  v_and_b32 v53, s49, v218
  v_lshlrev_b32 v54, 16, v219
  v_and_b32 v55, s49, v219
  v_pk_fma_f32 v[40:41], v[48:49], v[30:31], v[40:41] op_sel_hi:[1,0,1]
  v_pk_fma_f32 v[42:43], v[50:51], v[30:31], v[42:43] op_sel_hi:[1,0,1]
  v_pk_fma_f32 v[44:45], v[52:53], v[30:31], v[44:45] op_sel_hi:[1,0,1]
  v_pk_fma_f32 v[46:47], v[54:55], v[30:31], v[46:47] op_sel_hi:[1,0,1]
  v_lshlrev_b32 v48, 16, v220
  v_and_b32 v49, s49, v220
  v_lshlrev_b32 v50, 16, v221
  v_and_b32 v51, s49, v221
  v_lshlrev_b32 v52, 16, v222
  v_and_b32 v53, s49, v222
  v_lshlrev_b32 v54, 16, v223
  v_and_b32 v55, s49, v223
  v_pk_fma_f32 v[40:41], v[48:49], v[32:33], v[40:41] op_sel_hi:[1,0,1]
  v_pk_fma_f32 v[42:43], v[50:51], v[32:33], v[42:43] op_sel_hi:[1,0,1]
  v_pk_fma_f32 v[44:45], v[52:53], v[32:33], v[44:45] op_sel_hi:[1,0,1]
  v_pk_fma_f32 v[46:47], v[54:55], v[32:33], v[46:47] op_sel_hi:[1,0,1]
  v_cvt_pk_bf16_f32 v84, v40, v41
  v_cvt_pk_bf16_f32 v85, v42, v43
  v_cvt_pk_bf16_f32 v86, v44, v45
  v_cvt_pk_bf16_f32 v87, v46, v47
  buffer_store_dwordx4 v[84:87], v1, s[20:23], s34 offen offset:1024 sc1
  v_lshlrev_b32 v48, 16, v224
  v_and_b32 v49, s49, v224
  v_lshlrev_b32 v50, 16, v225
  v_and_b32 v51, s49, v225
  v_lshlrev_b32 v52, 16, v226
  v_and_b32 v53, s49, v226
  v_lshlrev_b32 v54, 16, v227
  v_and_b32 v55, s49, v227
  v_pk_mul_f32 v[40:41], v[48:49], v[26:27] op_sel_hi:[1,0]
  v_pk_mul_f32 v[42:43], v[50:51], v[26:27] op_sel_hi:[1,0]
  v_pk_mul_f32 v[44:45], v[52:53], v[26:27] op_sel_hi:[1,0]
  v_pk_mul_f32 v[46:47], v[54:55], v[26:27] op_sel_hi:[1,0]
  v_lshlrev_b32 v48, 16, v228
  v_and_b32 v49, s49, v228
  v_lshlrev_b32 v50, 16, v229
  v_and_b32 v51, s49, v229
  v_lshlrev_b32 v52, 16, v230
  v_and_b32 v53, s49, v230
  v_lshlrev_b32 v54, 16, v231
  v_and_b32 v55, s49, v231
  v_pk_fma_f32 v[40:41], v[48:49], v[28:29], v[40:41] op_sel_hi:[1,0,1]
  v_pk_fma_f32 v[42:43], v[50:51], v[28:29], v[42:43] op_sel_hi:[1,0,1]
  v_pk_fma_f32 v[44:45], v[52:53], v[28:29], v[44:45] op_sel_hi:[1,0,1]
  v_pk_fma_f32 v[46:47], v[54:55], v[28:29], v[46:47] op_sel_hi:[1,0,1]
  v_lshlrev_b32 v48, 16, v232
  v_and_b32 v49, s49, v232
  v_lshlrev_b32 v50, 16, v233
  v_and_b32 v51, s49, v233
  v_lshlrev_b32 v52, 16, v234
  v_and_b32 v53, s49, v234
  v_lshlrev_b32 v54, 16, v235
  v_and_b32 v55, s49, v235
  v_pk_fma_f32 v[40:41], v[48:49], v[30:31], v[40:41] op_sel_hi:[1,0,1]
  v_pk_fma_f32 v[42:43], v[50:51], v[30:31], v[42:43] op_sel_hi:[1,0,1]
  v_pk_fma_f32 v[44:45], v[52:53], v[30:31], v[44:45] op_sel_hi:[1,0,1]
  v_pk_fma_f32 v[46:47], v[54:55], v[30:31], v[46:47] op_sel_hi:[1,0,1]
  v_lshlrev_b32 v48, 16, v236
  v_and_b32 v49, s49, v236
  v_lshlrev_b32 v50, 16, v237
  v_and_b32 v51, s49, v237
  v_lshlrev_b32 v52, 16, v238
  v_and_b32 v53, s49, v238
  v_lshlrev_b32 v54, 16, v239
  v_and_b32 v55, s49, v239
  v_pk_fma_f32 v[40:41], v[48:49], v[32:33], v[40:41] op_sel_hi:[1,0,1]
  v_pk_fma_f32 v[42:43], v[50:51], v[32:33], v[42:43] op_sel_hi:[1,0,1]
  v_pk_fma_f32 v[44:45], v[52:53], v[32:33], v[44:45] op_sel_hi:[1,0,1]
  v_pk_fma_f32 v[46:47], v[54:55], v[32:33], v[46:47] op_sel_hi:[1,0,1]
  v_cvt_pk_bf16_f32 v88, v40, v41
  v_cvt_pk_bf16_f32 v89, v42, v43
  v_cvt_pk_bf16_f32 v90, v44, v45
  v_cvt_pk_bf16_f32 v91, v46, v47
  buffer_store_dwordx4 v[88:91], v1, s[20:23], s34 offen offset:2048 sc1
  v_lshlrev_b32 v48, 16, v240
  v_and_b32 v49, s49, v240
  v_lshlrev_b32 v50, 16, v241
  v_and_b32 v51, s49, v241
  v_lshlrev_b32 v52, 16, v242
  v_and_b32 v53, s49, v242
  v_lshlrev_b32 v54, 16, v243
  v_and_b32 v55, s49, v243
  v_pk_mul_f32 v[40:41], v[48:49], v[26:27] op_sel_hi:[1,0]
  v_pk_mul_f32 v[42:43], v[50:51], v[26:27] op_sel_hi:[1,0]
  v_pk_mul_f32 v[44:45], v[52:53], v[26:27] op_sel_hi:[1,0]
  v_pk_mul_f32 v[46:47], v[54:55], v[26:27] op_sel_hi:[1,0]
  v_lshlrev_b32 v48, 16, v244
  v_and_b32 v49, s49, v244
  v_lshlrev_b32 v50, 16, v245
  v_and_b32 v51, s49, v245
  v_lshlrev_b32 v52, 16, v246
  v_and_b32 v53, s49, v246
  v_lshlrev_b32 v54, 16, v247
  v_and_b32 v55, s49, v247
  v_pk_fma_f32 v[40:41], v[48:49], v[28:29], v[40:41] op_sel_hi:[1,0,1]
  v_pk_fma_f32 v[42:43], v[50:51], v[28:29], v[42:43] op_sel_hi:[1,0,1]
  v_pk_fma_f32 v[44:45], v[52:53], v[28:29], v[44:45] op_sel_hi:[1,0,1]
  v_pk_fma_f32 v[46:47], v[54:55], v[28:29], v[46:47] op_sel_hi:[1,0,1]
  v_lshlrev_b32 v48, 16, v248
  v_and_b32 v49, s49, v248
  v_lshlrev_b32 v50, 16, v249
  v_and_b32 v51, s49, v249
  v_lshlrev_b32 v52, 16, v250
  v_and_b32 v53, s49, v250
  v_lshlrev_b32 v54, 16, v251
  v_and_b32 v55, s49, v251
  v_pk_fma_f32 v[40:41], v[48:49], v[30:31], v[40:41] op_sel_hi:[1,0,1]
  v_pk_fma_f32 v[42:43], v[50:51], v[30:31], v[42:43] op_sel_hi:[1,0,1]
  v_pk_fma_f32 v[44:45], v[52:53], v[30:31], v[44:45] op_sel_hi:[1,0,1]
  v_pk_fma_f32 v[46:47], v[54:55], v[30:31], v[46:47] op_sel_hi:[1,0,1]
  v_lshlrev_b32 v48, 16, v252
  v_and_b32 v49, s49, v252
  v_lshlrev_b32 v50, 16, v253
  v_and_b32 v51, s49, v253
  v_lshlrev_b32 v52, 16, v254
  v_and_b32 v53, s49, v254
  v_lshlrev_b32 v54, 16, v255
  v_and_b32 v55, s49, v255
  v_pk_fma_f32 v[40:41], v[48:49], v[32:33], v[40:41] op_sel_hi:[1,0,1]
  v_pk_fma_f32 v[42:43], v[50:51], v[32:33], v[42:43] op_sel_hi:[1,0,1]
  v_pk_fma_f32 v[44:45], v[52:53], v[32:33], v[44:45] op_sel_hi:[1,0,1]
  v_pk_fma_f32 v[46:47], v[54:55], v[32:33], v[46:47] op_sel_hi:[1,0,1]
  v_cvt_pk_bf16_f32 v92, v40, v41
  v_cvt_pk_bf16_f32 v93, v42, v43
  v_cvt_pk_bf16_f32 v94, v44, v45
  v_cvt_pk_bf16_f32 v95, v46, v47
  buffer_store_dwordx4 v[92:95], v1, s[20:23], s34 offen offset:3072 sc1
  v_mov_b32 v12, 1
  s_add_u32 s26, s24, 32768
  s_waitcnt vmcnt(16)
  s_mov_b64 exec, 1
  buffer_atomic_add v12, off, s[20:23], s26 sc1
  s_mov_b64 exec, -1
  v_accvgpr_read_b32 v64, a128
  v_accvgpr_read_b32 v65, a129
  v_accvgpr_read_b32 v66, a130
  v_accvgpr_read_b32 v67, a131
  v_lshlrev_b32 v56, 16, v64
  v_and_b32 v57, s49, v64
  v_lshlrev_b32 v58, 16, v65
  v_and_b32 v59, s49, v65
  v_lshlrev_b32 v60, 16, v66
  v_and_b32 v61, s49, v66
  v_lshlrev_b32 v62, 16, v67
  v_and_b32 v63, s49, v67
  v_accvgpr_write_b32 a192, v56
  v_accvgpr_write_b32 a193, v57
  v_accvgpr_write_b32 a194, v58
  v_accvgpr_write_b32 a195, v59
  v_accvgpr_write_b32 a196, v60
  v_accvgpr_write_b32 a197, v61
  v_accvgpr_write_b32 a198, v62
  v_accvgpr_write_b32 a199, v63
  v_accvgpr_read_b32 v76, a132
  v_accvgpr_read_b32 v77, a133
  v_accvgpr_read_b32 v78, a134
  v_accvgpr_read_b32 v79, a135
  v_lshlrev_b32 v68, 16, v76
  v_and_b32 v69, s49, v76
  v_lshlrev_b32 v70, 16, v77
  v_and_b32 v71, s49, v77
  v_lshlrev_b32 v72, 16, v78
  v_and_b32 v73, s49, v78
  v_lshlrev_b32 v74, 16, v79
  v_and_b32 v75, s49, v79
  v_accvgpr_write_b32 a200, v68
  v_accvgpr_write_b32 a201, v69
  v_accvgpr_write_b32 a202, v70
  v_accvgpr_write_b32 a203, v71
  v_accvgpr_write_b32 a204, v72
  v_accvgpr_write_b32 a205, v73
  v_accvgpr_write_b32 a206, v74
  v_accvgpr_write_b32 a207, v75
  v_accvgpr_read_b32 v64, a136
  v_accvgpr_read_b32 v65, a137
  v_accvgpr_read_b32 v66, a138
  v_accvgpr_read_b32 v67, a139
  v_lshlrev_b32 v56, 16, v64
  v_and_b32 v57, s49, v64
  v_lshlrev_b32 v58, 16, v65
  v_and_b32 v59, s49, v65
  v_lshlrev_b32 v60, 16, v66
  v_and_b32 v61, s49, v66
  v_lshlrev_b32 v62, 16, v67
  v_and_b32 v63, s49, v67
  v_accvgpr_write_b32 a208, v56
  v_accvgpr_write_b32 a209, v57
  v_accvgpr_write_b32 a210, v58
  v_accvgpr_write_b32 a211, v59
  v_accvgpr_write_b32 a212, v60
  v_accvgpr_write_b32 a213, v61
  v_accvgpr_write_b32 a214, v62
  v_accvgpr_write_b32 a215, v63
  v_accvgpr_read_b32 v76, a140
  v_accvgpr_read_b32 v77, a141
  v_accvgpr_read_b32 v78, a142
  v_accvgpr_read_b32 v79, a143
  v_lshlrev_b32 v68, 16, v76
  v_and_b32 v69, s49, v76
  v_lshlrev_b32 v70, 16, v77
  v_and_b32 v71, s49, v77
  v_lshlrev_b32 v72, 16, v78
  v_and_b32 v73, s49, v78
  v_lshlrev_b32 v74, 16, v79
  v_and_b32 v75, s49, v79
  v_accvgpr_write_b32 a216, v68
  v_accvgpr_write_b32 a217, v69
  v_accvgpr_write_b32 a218, v70
  v_accvgpr_write_b32 a219, v71
  v_accvgpr_write_b32 a220, v72
  v_accvgpr_write_b32 a221, v73
  v_accvgpr_write_b32 a222, v74
  v_accvgpr_write_b32 a223, v75
  v_accvgpr_read_b32 v64, a144
  v_accvgpr_read_b32 v65, a145
  v_accvgpr_read_b32 v66, a146
  v_accvgpr_read_b32 v67, a147
  v_lshlrev_b32 v56, 16, v64
  v_and_b32 v57, s49, v64
  v_lshlrev_b32 v58, 16, v65
  v_and_b32 v59, s49, v65
  v_lshlrev_b32 v60, 16, v66
  v_and_b32 v61, s49, v66
  v_lshlrev_b32 v62, 16, v67
  v_and_b32 v63, s49, v67
  v_accvgpr_write_b32 a224, v56
  v_accvgpr_write_b32 a225, v57
  v_accvgpr_write_b32 a226, v58
  v_accvgpr_write_b32 a227, v59
  v_accvgpr_write_b32 a228, v60
  v_accvgpr_write_b32 a229, v61
  v_accvgpr_write_b32 a230, v62
  v_accvgpr_write_b32 a231, v63
  v_accvgpr_read_b32 v76, a148
  v_accvgpr_read_b32 v77, a149
  v_accvgpr_read_b32 v78, a150
  v_accvgpr_read_b32 v79, a151
  v_lshlrev_b32 v68, 16, v76
  v_and_b32 v69, s49, v76
  v_lshlrev_b32 v70, 16, v77
  v_and_b32 v71, s49, v77
  v_lshlrev_b32 v72, 16, v78
  v_and_b32 v73, s49, v78
  v_lshlrev_b32 v74, 16, v79
  v_and_b32 v75, s49, v79
  v_accvgpr_write_b32 a232, v68
  v_accvgpr_write_b32 a233, v69
  v_accvgpr_write_b32 a234, v70
  v_accvgpr_write_b32 a235, v71
  v_accvgpr_write_b32 a236, v72
  v_accvgpr_write_b32 a237, v73
  v_accvgpr_write_b32 a238, v74
  v_accvgpr_write_b32 a239, v75
  v_accvgpr_read_b32 v64, a152
  v_accvgpr_read_b32 v65, a153
  v_accvgpr_read_b32 v66, a154
  v_accvgpr_read_b32 v67, a155
  v_lshlrev_b32 v56, 16, v64
  v_and_b32 v57, s49, v64
  v_lshlrev_b32 v58, 16, v65
  v_and_b32 v59, s49, v65
  v_lshlrev_b32 v60, 16, v66
  v_and_b32 v61, s49, v66
  v_lshlrev_b32 v62, 16, v67
  v_and_b32 v63, s49, v67
  v_accvgpr_write_b32 a240, v56
  v_accvgpr_write_b32 a241, v57
  v_accvgpr_write_b32 a242, v58
  v_accvgpr_write_b32 a243, v59
  v_accvgpr_write_b32 a244, v60
  v_accvgpr_write_b32 a245, v61
  v_accvgpr_write_b32 a246, v62
  v_accvgpr_write_b32 a247, v63
  v_accvgpr_read_b32 v76, a156
  v_accvgpr_read_b32 v77, a157
  v_accvgpr_read_b32 v78, a158
  v_accvgpr_read_b32 v79, a159
  v_lshlrev_b32 v68, 16, v76
  v_and_b32 v69, s49, v76
  v_lshlrev_b32 v70, 16, v77
  v_and_b32 v71, s49, v77
  v_lshlrev_b32 v72, 16, v78
  v_and_b32 v73, s49, v78
  v_lshlrev_b32 v74, 16, v79
  v_and_b32 v75, s49, v79
  v_accvgpr_write_b32 a248, v68
  v_accvgpr_write_b32 a249, v69
  v_accvgpr_write_b32 a250, v70
  v_accvgpr_write_b32 a251, v71
  v_accvgpr_write_b32 a252, v72
  v_accvgpr_write_b32 a253, v73
  v_accvgpr_write_b32 a254, v74
  v_accvgpr_write_b32 a255, v75
  ds_read_b128 v[192:195], v118 offset:32768
  ds_read_b128 v[196:199], v118 offset:34816
  ds_read_b128 v[200:203], v118 offset:36864
  ds_read_b128 v[204:207], v118 offset:38912
  ds_read_b128 v[208:211], v118 offset:40960
  ds_read_b128 v[212:215], v118 offset:43008
  ds_read_b128 v[216:219], v118 offset:45056
  ds_read_b128 v[220:223], v118 offset:47104
  s_waitcnt lgkmcnt(4)
  v_mfma_f32_16x16x32_bf16 a[192:195], a[0:3], v[192:195], a[192:195]
  ds_read_b128 v[224:227], v118 offset:33792
  v_mfma_f32_16x16x32_bf16 a[196:199], a[4:7], v[192:195], a[196:199]
  ds_read_b128 v[228:231], v118 offset:35840
  v_mfma_f32_16x16x32_bf16 a[200:203], a[0:3], v[196:199], a[200:203]
  v_mfma_f32_16x16x32_bf16 a[204:207], a[4:7], v[196:199], a[204:207]
  ds_read_b128 v[232:235], v118 offset:37888
  v_mfma_f32_16x16x32_bf16 a[208:211], a[0:3], v[200:203], a[208:211]
  v_mfma_f32_16x16x32_bf16 a[212:215], a[4:7], v[200:203], a[212:215]
  ds_read_b128 v[236:239], v118 offset:39936
  v_mfma_f32_16x16x32_bf16 a[216:219], a[0:3], v[204:207], a[216:219]
  v_mfma_f32_16x16x32_bf16 a[220:223], a[4:7], v[204:207], a[220:223]
  ds_read_b128 v[240:243], v118 offset:41984
  s_waitcnt lgkmcnt(5)
  v_mfma_f32_16x16x32_bf16 a[224:227], a[0:3], v[208:211], a[224:227]
  ds_read_b128 v[244:247], v118 offset:44032
  v_mfma_f32_16x16x32_bf16 a[228:231], a[4:7], v[208:211], a[228:231]
  v_mfma_f32_16x16x32_bf16 a[232:235], a[0:3], v[212:215], a[232:235]
  ds_read_b128 v[248:251], v118 offset:46080
  v_mfma_f32_16x16x32_bf16 a[236:239], a[4:7], v[212:215], a[236:239]
  v_mfma_f32_16x16x32_bf16 a[240:243], a[0:3], v[216:219], a[240:243]
  ds_read_b128 v[252:255], v118 offset:48128
  v_mfma_f32_16x16x32_bf16 a[244:247], a[4:7], v[216:219], a[244:247]
  v_mfma_f32_16x16x32_bf16 a[248:251], a[0:3], v[220:223], a[248:251]
  v_mfma_f32_16x16x32_bf16 a[252:255], a[4:7], v[220:223], a[252:255]
  s_waitcnt lgkmcnt(4)
  v_mfma_f32_16x16x32_bf16 a[192:195], a[8:11], v[224:227], a[192:195]
  ds_read_b128 v[192:195], v118 offset:49152
  v_mfma_f32_16x16x32_bf16 a[196:199], a[12:15], v[224:227], a[196:199]
  ds_read_b128 v[196:199], v118 offset:51200
  v_mfma_f32_16x16x32_bf16 a[200:203], a[8:11], v[228:231], a[200:203]
  v_mfma_f32_16x16x32_bf16 a[204:207], a[12:15], v[228:231], a[204:207]
  ds_read_b128 v[200:203], v118 offset:53248
  v_mfma_f32_16x16x32_bf16 a[208:211], a[8:11], v[232:235], a[208:211]
  v_mfma_f32_16x16x32_bf16 a[212:215], a[12:15], v[232:235], a[212:215]
  ds_read_b128 v[204:207], v118 offset:55296
  v_mfma_f32_16x16x32_bf16 a[216:219], a[8:11], v[236:239], a[216:219]
  v_mfma_f32_16x16x32_bf16 a[220:223], a[12:15], v[236:239], a[220:223]
  ds_read_b128 v[208:211], v118 offset:57344
  s_waitcnt lgkmcnt(5)
  v_mfma_f32_16x16x32_bf16 a[224:227], a[8:11], v[240:243], a[224:227]
  ds_read_b128 v[212:215], v118 offset:59392
  v_mfma_f32_16x16x32_bf16 a[228:231], a[12:15], v[240:243], a[228:231]
  v_mfma_f32_16x16x32_bf16 a[232:235], a[8:11], v[244:247], a[232:235]
  ds_read_b128 v[216:219], v118 offset:61440
  v_mfma_f32_16x16x32_bf16 a[236:239], a[12:15], v[244:247], a[236:239]
  v_mfma_f32_16x16x32_bf16 a[240:243], a[8:11], v[248:251], a[240:243]
  ds_read_b128 v[220:223], v118 offset:63488
  v_mfma_f32_16x16x32_bf16 a[244:247], a[12:15], v[248:251], a[244:247]
  v_mfma_f32_16x16x32_bf16 a[248:251], a[8:11], v[252:255], a[248:251]
  v_mfma_f32_16x16x32_bf16 a[252:255], a[12:15], v[252:255], a[252:255]
  s_waitcnt lgkmcnt(4)
  v_mfma_f32_16x16x32_bf16 a[192:195], a[16:19], v[192:195], a[192:195]
  ds_read_b128 v[224:227], v118 offset:50176
  v_mfma_f32_16x16x32_bf16 a[196:199], a[20:23], v[192:195], a[196:199]
  ds_read_b128 v[228:231], v118 offset:52224
  v_mfma_f32_16x16x32_bf16 a[200:203], a[16:19], v[196:199], a[200:203]
  v_mfma_f32_16x16x32_bf16 a[204:207], a[20:23], v[196:199], a[204:207]
  ds_read_b128 v[232:235], v118 offset:54272
  v_mfma_f32_16x16x32_bf16 a[208:211], a[16:19], v[200:203], a[208:211]
  v_mfma_f32_16x16x32_bf16 a[212:215], a[20:23], v[200:203], a[212:215]
  ds_read_b128 v[236:239], v118 offset:56320
  v_mfma_f32_16x16x32_bf16 a[216:219], a[16:19], v[204:207], a[216:219]
  v_mfma_f32_16x16x32_bf16 a[220:223], a[20:23], v[204:207], a[220:223]
  ds_read_b128 v[240:243], v118 offset:58368
  s_waitcnt lgkmcnt(5)
  v_mfma_f32_16x16x32_bf16 a[224:227], a[16:19], v[208:211], a[224:227]
  ds_read_b128 v[244:247], v118 offset:60416
  v_mfma_f32_16x16x32_bf16 a[228:231], a[20:23], v[208:211], a[228:231]
  v_mfma_f32_16x16x32_bf16 a[232:235], a[16:19], v[212:215], a[232:235]
  ds_read_b128 v[248:251], v118 offset:62464
  v_mfma_f32_16x16x32_bf16 a[236:239], a[20:23], v[212:215], a[236:239]
  v_mfma_f32_16x16x32_bf16 a[240:243], a[16:19], v[216:219], a[240:243]
  ds_read_b128 v[252:255], v118 offset:64512
  v_mfma_f32_16x16x32_bf16 a[244:247], a[20:23], v[216:219], a[244:247]
  v_mfma_f32_16x16x32_bf16 a[248:251], a[16:19], v[220:223], a[248:251]
  v_mfma_f32_16x16x32_bf16 a[252:255], a[20:23], v[220:223], a[252:255]
  s_waitcnt lgkmcnt(4)
  v_mfma_f32_16x16x32_bf16 a[192:195], a[24:27], v[224:227], a[192:195]
  v_mfma_f32_16x16x32_bf16 a[196:199], a[28:31], v[224:227], a[196:199]
  v_mfma_f32_16x16x32_bf16 a[200:203], a[24:27], v[228:231], a[200:203]
  v_mfma_f32_16x16x32_bf16 a[204:207], a[28:31], v[228:231], a[204:207]
  v_mfma_f32_16x16x32_bf16 a[208:211], a[24:27], v[232:235], a[208:211]
  v_mfma_f32_16x16x32_bf16 a[212:215], a[28:31], v[232:235], a[212:215]
  v_mfma_f32_16x16x32_bf16 a[216:219], a[24:27], v[236:239], a[216:219]
  v_mfma_f32_16x16x32_bf16 a[220:223], a[28:31], v[236:239], a[220:223]
  s_waitcnt lgkmcnt(0)
  v_mfma_f32_16x16x32_bf16 a[224:227], a[24:27], v[240:243], a[224:227]
  v_mfma_f32_16x16x32_bf16 a[228:231], a[28:31], v[240:243], a[228:231]
  v_mfma_f32_16x16x32_bf16 a[232:235], a[24:27], v[244:247], a[232:235]
  v_mfma_f32_16x16x32_bf16 a[236:239], a[28:31], v[244:247], a[236:239]
  v_mfma_f32_16x16x32_bf16 a[240:243], a[24:27], v[248:251], a[240:243]
  v_mfma_f32_16x16x32_bf16 a[244:247], a[28:31], v[248:251], a[244:247]
  v_mfma_f32_16x16x32_bf16 a[248:251], a[24:27], v[252:255], a[248:251]
  v_mfma_f32_16x16x32_bf16 a[252:255], a[28:31], v[252:255], a[252:255]
  buffer_load_dwordx4 a[0:3], v117, s[20:23], s60 offen offset:0 sc1
  buffer_load_dwordx4 a[4:7], v117, s[20:23], s61 offen offset:0 sc1
  buffer_load_dwordx4 a[8:11], v117, s[20:23], s60 offen offset:1024 sc1
  buffer_load_dwordx4 a[12:15], v117, s[20:23], s61 offen offset:1024 sc1
  buffer_load_dwordx4 a[16:19], v117, s[20:23], s60 offen offset:2048 sc1
  buffer_load_dwordx4 a[20:23], v117, s[20:23], s61 offen offset:2048 sc1
  buffer_load_dwordx4 a[24:27], v117, s[20:23], s60 offen offset:3072 sc1
  buffer_load_dwordx4 a[28:31], v117, s[20:23], s61 offen offset:3072 sc1
  v_add_u32 v117, 4096, v117
  v_and_b32 v117, 16383, v117
  buffer_load_dwordx4 a[32:35], v117, s[20:23], s60 offen offset:0 sc1
  buffer_load_dwordx4 a[36:39], v117, s[20:23], s61 offen offset:0 sc1
  buffer_load_dwordx4 a[40:43], v117, s[20:23], s60 offen offset:1024 sc1
  buffer_load_dwordx4 a[44:47], v117, s[20:23], s61 offen offset:1024 sc1
  buffer_load_dwordx4 a[48:51], v117, s[20:23], s60 offen offset:2048 sc1
  buffer_load_dwordx4 a[52:55], v117, s[20:23], s61 offen offset:2048 sc1
  buffer_load_dwordx4 a[56:59], v117, s[20:23], s60 offen offset:3072 sc1
  buffer_load_dwordx4 a[60:63], v117, s[20:23], s61 offen offset:3072 sc1
  v_add_u32 v117, 4096, v117
  v_and_b32 v117, 16383, v117
  buffer_load_dwordx4 a[64:67], v121, s[20:23], s70 offen offset:0 sc1
  buffer_load_dwordx4 a[68:71], v121, s[20:23], s71 offen offset:0 sc1
  buffer_load_dwordx4 a[72:75], v121, s[20:23], s70 offen offset:1024 sc1
  buffer_load_dwordx4 a[76:79], v121, s[20:23], s71 offen offset:1024 sc1
  buffer_load_dwordx4 a[80:83], v121, s[20:23], s70 offen offset:2048 sc1
  buffer_load_dwordx4 a[84:87], v121, s[20:23], s71 offen offset:2048 sc1
  buffer_load_dwordx4 a[88:91], v121, s[20:23], s70 offen offset:3072 sc1
  buffer_load_dwordx4 a[92:95], v121, s[20:23], s71 offen offset:3072 sc1
  v_add_u32 v121, 4096, v121
  buffer_load_dwordx4 a[96:99], v121, s[20:23], s70 offen offset:0 sc1
  buffer_load_dwordx4 a[100:103], v121, s[20:23], s71 offen offset:0 sc1
  buffer_load_dwordx4 a[104:107], v121, s[20:23], s70 offen offset:1024 sc1
  buffer_load_dwordx4 a[108:111], v121, s[20:23], s71 offen offset:1024 sc1
  buffer_load_dwordx4 a[112:115], v121, s[20:23], s70 offen offset:2048 sc1
  buffer_load_dwordx4 a[116:119], v121, s[20:23], s71 offen offset:2048 sc1
  s_waitcnt vmcnt(44)
  v_lshlrev_b32 v48, 16, v128
  v_and_b32 v49, s49, v128
  v_lshlrev_b32 v50, 16, v129
  v_and_b32 v51, s49, v129
  v_lshlrev_b32 v52, 16, v130
  v_and_b32 v53, s49, v130
  v_lshlrev_b32 v54, 16, v131
  v_and_b32 v55, s49, v131
  v_pk_mul_f32 v[40:41], v[48:49], v[26:27] op_sel_hi:[1,0]
  v_pk_mul_f32 v[42:43], v[50:51], v[26:27] op_sel_hi:[1,0]
  v_pk_mul_f32 v[44:45], v[52:53], v[26:27] op_sel_hi:[1,0]
  v_pk_mul_f32 v[46:47], v[54:55], v[26:27] op_sel_hi:[1,0]
  v_lshlrev_b32 v48, 16, v132
  v_and_b32 v49, s49, v132
  v_lshlrev_b32 v50, 16, v133
  v_and_b32 v51, s49, v133
  v_lshlrev_b32 v52, 16, v134
  v_and_b32 v53, s49, v134
  v_lshlrev_b32 v54, 16, v135
  v_and_b32 v55, s49, v135
  v_pk_fma_f32 v[40:41], v[48:49], v[28:29], v[40:41] op_sel_hi:[1,0,1]
  v_pk_fma_f32 v[42:43], v[50:51], v[28:29], v[42:43] op_sel_hi:[1,0,1]
  v_pk_fma_f32 v[44:45], v[52:53], v[28:29], v[44:45] op_sel_hi:[1,0,1]
  v_pk_fma_f32 v[46:47], v[54:55], v[28:29], v[46:47] op_sel_hi:[1,0,1]
  v_lshlrev_b32 v48, 16, v136
  v_and_b32 v49, s49, v136
  v_lshlrev_b32 v50, 16, v137
  v_and_b32 v51, s49, v137
  v_lshlrev_b32 v52, 16, v138
  v_and_b32 v53, s49, v138
  v_lshlrev_b32 v54, 16, v139
  v_and_b32 v55, s49, v139
  v_pk_fma_f32 v[40:41], v[48:49], v[30:31], v[40:41] op_sel_hi:[1,0,1]
  v_pk_fma_f32 v[42:43], v[50:51], v[30:31], v[42:43] op_sel_hi:[1,0,1]
  v_pk_fma_f32 v[44:45], v[52:53], v[30:31], v[44:45] op_sel_hi:[1,0,1]
  v_pk_fma_f32 v[46:47], v[54:55], v[30:31], v[46:47] op_sel_hi:[1,0,1]
  v_lshlrev_b32 v48, 16, v140
  v_and_b32 v49, s49, v140
  v_lshlrev_b32 v50, 16, v141
  v_and_b32 v51, s49, v141
  v_lshlrev_b32 v52, 16, v142
  v_and_b32 v53, s49, v142
  v_lshlrev_b32 v54, 16, v143
  v_and_b32 v55, s49, v143
  v_pk_fma_f32 v[40:41], v[48:49], v[32:33], v[40:41] op_sel_hi:[1,0,1]
  v_pk_fma_f32 v[42:43], v[50:51], v[32:33], v[42:43] op_sel_hi:[1,0,1]
  v_pk_fma_f32 v[44:45], v[52:53], v[32:33], v[44:45] op_sel_hi:[1,0,1]
  v_pk_fma_f32 v[46:47], v[54:55], v[32:33], v[46:47] op_sel_hi:[1,0,1]
  v_cvt_pk_bf16_f32 v96, v40, v41
  v_cvt_pk_bf16_f32 v97, v42, v43
  v_cvt_pk_bf16_f32 v98, v44, v45
  v_cvt_pk_bf16_f32 v99, v46, v47
  buffer_store_dwordx4 v[96:99], v1, s[20:23], s35 offen offset:0 sc1
  s_waitcnt vmcnt(42)
  v_lshlrev_b32 v48, 16, v144
  v_and_b32 v49, s49, v144
  v_lshlrev_b32 v50, 16, v145
  v_and_b32 v51, s49, v145
  v_lshlrev_b32 v52, 16, v146
  v_and_b32 v53, s49, v146
  v_lshlrev_b32 v54, 16, v147
  v_and_b32 v55, s49, v147
  v_pk_mul_f32 v[40:41], v[48:49], v[26:27] op_sel_hi:[1,0]
  v_pk_mul_f32 v[42:43], v[50:51], v[26:27] op_sel_hi:[1,0]
  v_pk_mul_f32 v[44:45], v[52:53], v[26:27] op_sel_hi:[1,0]
  v_pk_mul_f32 v[46:47], v[54:55], v[26:27] op_sel_hi:[1,0]
  v_lshlrev_b32 v48, 16, v148
  v_and_b32 v49, s49, v148
  v_lshlrev_b32 v50, 16, v149
  v_and_b32 v51, s49, v149
  v_lshlrev_b32 v52, 16, v150
  v_and_b32 v53, s49, v150
  v_lshlrev_b32 v54, 16, v151
  v_and_b32 v55, s49, v151
  v_pk_fma_f32 v[40:41], v[48:49], v[28:29], v[40:41] op_sel_hi:[1,0,1]
  v_pk_fma_f32 v[42:43], v[50:51], v[28:29], v[42:43] op_sel_hi:[1,0,1]
  v_pk_fma_f32 v[44:45], v[52:53], v[28:29], v[44:45] op_sel_hi:[1,0,1]
  v_pk_fma_f32 v[46:47], v[54:55], v[28:29], v[46:47] op_sel_hi:[1,0,1]
  v_lshlrev_b32 v48, 16, v152
  v_and_b32 v49, s49, v152
  v_lshlrev_b32 v50, 16, v153
  v_and_b32 v51, s49, v153
  v_lshlrev_b32 v52, 16, v154
  v_and_b32 v53, s49, v154
  v_lshlrev_b32 v54, 16, v155
  v_and_b32 v55, s49, v155
  v_pk_fma_f32 v[40:41], v[48:49], v[30:31], v[40:41] op_sel_hi:[1,0,1]
  v_pk_fma_f32 v[42:43], v[50:51], v[30:31], v[42:43] op_sel_hi:[1,0,1]
  v_pk_fma_f32 v[44:45], v[52:53], v[30:31], v[44:45] op_sel_hi:[1,0,1]
  v_pk_fma_f32 v[46:47], v[54:55], v[30:31], v[46:47] op_sel_hi:[1,0,1]
  v_lshlrev_b32 v48, 16, v156
  v_and_b32 v49, s49, v156
  v_lshlrev_b32 v50, 16, v157
  v_and_b32 v51, s49, v157
  v_lshlrev_b32 v52, 16, v158
  v_and_b32 v53, s49, v158
  v_lshlrev_b32 v54, 16, v159
  v_and_b32 v55, s49, v159
  v_pk_fma_f32 v[40:41], v[48:49], v[32:33], v[40:41] op_sel_hi:[1,0,1]
  v_pk_fma_f32 v[42:43], v[50:51], v[32:33], v[42:43] op_sel_hi:[1,0,1]
  v_pk_fma_f32 v[44:45], v[52:53], v[32:33], v[44:45] op_sel_hi:[1,0,1]
  v_pk_fma_f32 v[46:47], v[54:55], v[32:33], v[46:47] op_sel_hi:[1,0,1]
  v_cvt_pk_bf16_f32 v100, v40, v41
  v_cvt_pk_bf16_f32 v101, v42, v43
  v_cvt_pk_bf16_f32 v102, v44, v45
  v_cvt_pk_bf16_f32 v103, v46, v47
  buffer_store_dwordx4 v[100:103], v1, s[20:23], s35 offen offset:1024 sc1
  s_add_u32 s27, s24, 32768
  s_cmp_eq_u32 s3, 0
  s_cselect_b32 s27, s27, 2130706432
  buffer_load_dword v13, off, s[20:23], s27 sc1
  s_waitcnt vmcnt(41)
  v_lshlrev_b32 v48, 16, v160
  v_and_b32 v49, s49, v160
  v_lshlrev_b32 v50, 16, v161
  v_and_b32 v51, s49, v161
  v_lshlrev_b32 v52, 16, v162
  v_and_b32 v53, s49, v162
  v_lshlrev_b32 v54, 16, v163
  v_and_b32 v55, s49, v163
  v_pk_mul_f32 v[40:41], v[48:49], v[26:27] op_sel_hi:[1,0]
  v_pk_mul_f32 v[42:43], v[50:51], v[26:27] op_sel_hi:[1,0]
  v_pk_mul_f32 v[44:45], v[52:53], v[26:27] op_sel_hi:[1,0]
  v_pk_mul_f32 v[46:47], v[54:55], v[26:27] op_sel_hi:[1,0]
  v_lshlrev_b32 v48, 16, v164
  v_and_b32 v49, s49, v164
  v_lshlrev_b32 v50, 16, v165
  v_and_b32 v51, s49, v165
  v_lshlrev_b32 v52, 16, v166
  v_and_b32 v53, s49, v166
  v_lshlrev_b32 v54, 16, v167
  v_and_b32 v55, s49, v167
  v_pk_fma_f32 v[40:41], v[48:49], v[28:29], v[40:41] op_sel_hi:[1,0,1]
  v_pk_fma_f32 v[42:43], v[50:51], v[28:29], v[42:43] op_sel_hi:[1,0,1]
  v_pk_fma_f32 v[44:45], v[52:53], v[28:29], v[44:45] op_sel_hi:[1,0,1]
  v_pk_fma_f32 v[46:47], v[54:55], v[28:29], v[46:47] op_sel_hi:[1,0,1]
  v_lshlrev_b32 v48, 16, v168
  v_and_b32 v49, s49, v168
  v_lshlrev_b32 v50, 16, v169
  v_and_b32 v51, s49, v169
  v_lshlrev_b32 v52, 16, v170
  v_and_b32 v53, s49, v170
  v_lshlrev_b32 v54, 16, v171
  v_and_b32 v55, s49, v171
  v_pk_fma_f32 v[40:41], v[48:49], v[30:31], v[40:41] op_sel_hi:[1,0,1]
  v_pk_fma_f32 v[42:43], v[50:51], v[30:31], v[42:43] op_sel_hi:[1,0,1]
  v_pk_fma_f32 v[44:45], v[52:53], v[30:31], v[44:45] op_sel_hi:[1,0,1]
  v_pk_fma_f32 v[46:47], v[54:55], v[30:31], v[46:47] op_sel_hi:[1,0,1]
  v_lshlrev_b32 v48, 16, v172
  v_and_b32 v49, s49, v172
  v_lshlrev_b32 v50, 16, v173
  v_and_b32 v51, s49, v173
  v_lshlrev_b32 v52, 16, v174
  v_and_b32 v53, s49, v174
  v_lshlrev_b32 v54, 16, v175
  v_and_b32 v55, s49, v175
  v_pk_fma_f32 v[40:41], v[48:49], v[32:33], v[40:41] op_sel_hi:[1,0,1]
  v_pk_fma_f32 v[42:43], v[50:51], v[32:33], v[42:43] op_sel_hi:[1,0,1]
  v_pk_fma_f32 v[44:45], v[52:53], v[32:33], v[44:45] op_sel_hi:[1,0,1]
  v_pk_fma_f32 v[46:47], v[54:55], v[32:33], v[46:47] op_sel_hi:[1,0,1]
  v_cvt_pk_bf16_f32 v104, v40, v41
  v_cvt_pk_bf16_f32 v105, v42, v43
  v_cvt_pk_bf16_f32 v106, v44, v45
  v_cvt_pk_bf16_f32 v107, v46, v47
  buffer_store_dwordx4 v[104:107], v1, s[20:23], s35 offen offset:2048 sc1
  s_waitcnt vmcnt(39)
  v_lshlrev_b32 v48, 16, v176
  v_and_b32 v49, s49, v176
  v_lshlrev_b32 v50, 16, v177
  v_and_b32 v51, s49, v177
  v_lshlrev_b32 v52, 16, v178
  v_and_b32 v53, s49, v178
  v_lshlrev_b32 v54, 16, v179
  v_and_b32 v55, s49, v179
  v_pk_mul_f32 v[40:41], v[48:49], v[26:27] op_sel_hi:[1,0]
  v_pk_mul_f32 v[42:43], v[50:51], v[26:27] op_sel_hi:[1,0]
  v_pk_mul_f32 v[44:45], v[52:53], v[26:27] op_sel_hi:[1,0]
  v_pk_mul_f32 v[46:47], v[54:55], v[26:27] op_sel_hi:[1,0]
  v_lshlrev_b32 v48, 16, v180
  v_and_b32 v49, s49, v180
  v_lshlrev_b32 v50, 16, v181
  v_and_b32 v51, s49, v181
  v_lshlrev_b32 v52, 16, v182
  v_and_b32 v53, s49, v182
  v_lshlrev_b32 v54, 16, v183
  v_and_b32 v55, s49, v183
  v_pk_fma_f32 v[40:41], v[48:49], v[28:29], v[40:41] op_sel_hi:[1,0,1]
  v_pk_fma_f32 v[42:43], v[50:51], v[28:29], v[42:43] op_sel_hi:[1,0,1]
  v_pk_fma_f32 v[44:45], v[52:53], v[28:29], v[44:45] op_sel_hi:[1,0,1]
  v_pk_fma_f32 v[46:47], v[54:55], v[28:29], v[46:47] op_sel_hi:[1,0,1]
  v_lshlrev_b32 v48, 16, v184
  v_and_b32 v49, s49, v184
  v_lshlrev_b32 v50, 16, v185
  v_and_b32 v51, s49, v185
  v_lshlrev_b32 v52, 16, v186
  v_and_b32 v53, s49, v186
  v_lshlrev_b32 v54, 16, v187
  v_and_b32 v55, s49, v187
  v_pk_fma_f32 v[40:41], v[48:49], v[30:31], v[40:41] op_sel_hi:[1,0,1]
  v_pk_fma_f32 v[42:43], v[50:51], v[30:31], v[42:43] op_sel_hi:[1,0,1]
  v_pk_fma_f32 v[44:45], v[52:53], v[30:31], v[44:45] op_sel_hi:[1,0,1]
  v_pk_fma_f32 v[46:47], v[54:55], v[30:31], v[46:47] op_sel_hi:[1,0,1]
  v_lshlrev_b32 v48, 16, v188
  v_and_b32 v49, s49, v188
  v_lshlrev_b32 v50, 16, v189
  v_and_b32 v51, s49, v189
  v_lshlrev_b32 v52, 16, v190
  v_and_b32 v53, s49, v190
  v_lshlrev_b32 v54, 16, v191
  v_and_b32 v55, s49, v191
  v_pk_fma_f32 v[40:41], v[48:49], v[32:33], v[40:41] op_sel_hi:[1,0,1]
  v_pk_fma_f32 v[42:43], v[50:51], v[32:33], v[42:43] op_sel_hi:[1,0,1]
  v_pk_fma_f32 v[44:45], v[52:53], v[32:33], v[44:45] op_sel_hi:[1,0,1]
  v_pk_fma_f32 v[46:47], v[54:55], v[32:33], v[46:47] op_sel_hi:[1,0,1]
  v_cvt_pk_bf16_f32 v108, v40, v41
  v_cvt_pk_bf16_f32 v109, v42, v43
  v_cvt_pk_bf16_f32 v110, v44, v45
  v_cvt_pk_bf16_f32 v111, v46, v47
  buffer_store_dwordx4 v[108:111], v1, s[20:23], s35 offen offset:3072 sc1
  s_cmp_lg_u32 s3, 0
  s_cbranch_scc1 POK_25
  s_waitcnt vmcnt(2)
PLP_26:
  v_cmp_le_u32 vcc, 16, v13
  s_cmp_eq_u64 vcc, -1
  s_cbranch_scc1 POK_25
  buffer_load_dword v13, off, s[20:23], s27 sc1
  s_sub_u32 s25, s25, 1
  s_waitcnt vmcnt(0)
  s_cbranch_scc0 PLP_26
  s_endpgm
POK_25:
  s_waitcnt vmcnt(0)
  s_barrier
  v_mov_b32 v12, 4
  s_add_u32 s26, s24, 40960
  s_cmp_eq_u32 s3, 0
  s_cselect_b32 s26, s26, 2130706432
  s_mov_b64 exec, 1
  buffer_atomic_add v12, off, s[20:23], s26 sc1
  s_mov_b64 exec, -1
  s_add_u32 m0, s50, 0
  s_nop 0
  buffer_load_dwordx4 v116, s[20:23], s52 offen sc1 lds
  s_add_u32 m0, s50, 1024
  s_nop 0
  buffer_load_dwordx4 v116, s[20:23], s53 offen sc1 lds
  s_add_u32 m0, s50, 2048
  s_nop 0
  buffer_load_dwordx4 v116, s[20:23], s54 offen sc1 lds
  s_add_u32 m0, s50, 3072
  s_nop 0
  buffer_load_dwordx4 v116, s[20:23], s55 offen sc1 lds
  v_add_u32 v116, 2048, v116
  v_and_b32 v116, 16383, v116
  s_add_u32 m0, s50, 16384
  s_nop 0
  buffer_load_dwordx4 v116, s[20:23], s52 offen sc1 lds
  s_add_u32 m0, s50, 17408
  s_nop 0
  buffer_load_dwordx4 v116, s[20:23], s53 offen sc1 lds
  s_add_u32 m0, s50, 18432
  s_nop 0
  buffer_load_dwordx4 v116, s[20:23], s54 offen sc1 lds
  s_add_u32 m0, s50, 19456
  s_nop 0
  buffer_load_dwordx4 v116, s[20:23], s55 offen sc1 lds
  v_add_u32 v116, 2048, v116
  v_and_b32 v116, 16383, v116
  s_add_u32 m0, s50, 32768
  s_nop 0
  buffer_load_dwordx4 v116, s[20:23], s52 offen sc1 lds
  s_add_u32 m0, s50, 33792
  s_nop 0
  buffer_load_dwordx4 v116, s[20:23], s53 offen sc1 lds
  s_add_u32 m0, s50, 34816
  s_nop 0
  buffer_load_dwordx4 v116, s[20:23], s54 offen sc1 lds
  s_add_u32 m0, s50, 35840
  s_nop 0
  buffer_load_dwordx4 v116, s[20:23], s55 offen sc1 lds
  v_add_u32 v116, 2048, v116
  v_and_b32 v116, 16383, v116
PF_F_END:
  s_waitcnt vmcnt(8)
  s_barrier
  ds_read_b128 v[128:131], v118 offset:0
  ds_read_b128 v[132:135], v118 offset:2048
  ds_read_b128 v[136:139], v118 offset:4096
  ds_read_b128 v[140:143], v118 offset:6144
  ds_read_b128 v[144:147], v118 offset:8192
  ds_read_b128 v[148:151], v118 offset:10240
  ds_read_b128 v[152:155], v118 offset:12288
  ds_read_b128 v[156:159], v118 offset:14336
  s_waitcnt lgkmcnt(4)
  v_mfma_f32_16x16x32_bf16 a[192:195], a[0:3], v[128:131], a[192:195]
  ds_read_b128 v[160:163], v118 offset:1024
  s_add_u32 m0, s50, 49152
  v_mfma_f32_16x16x32_bf16 a[196:199], a[4:7], v[128:131], a[196:199]
  ds_read_b128 v[164:167], v118 offset:3072
  v_mfma_f32_16x16x32_bf16 a[200:203], a[0:3], v[132:135], a[200:203]
  buffer_load_dwordx4 v116, s[20:23], s52 offen sc1 lds
  s_add_u32 m0, s50, 50176
  v_mfma_f32_16x16x32_bf16 a[204:207], a[4:7], v[132:135], a[204:207]
  ds_read_b128 v[168:171], v118 offset:5120
  v_mfma_f32_16x16x32_bf16 a[208:211], a[0:3], v[136:139], a[208:211]
  v_mfma_f32_16x16x32_bf16 a[212:215], a[4:7], v[136:139], a[212:215]
  ds_read_b128 v[172:175], v118 offset:7168
  v_mfma_f32_16x16x32_bf16 a[216:219], a[0:3], v[140:143], a[216:219]
  buffer_load_dwordx4 v116, s[20:23], s53 offen sc1 lds
  s_add_u32 m0, s50, 51200
  v_mfma_f32_16x16x32_bf16 a[220:223], a[4:7], v[140:143], a[220:223]
  ds_read_b128 v[176:179], v118 offset:9216
  s_waitcnt lgkmcnt(5)
  v_mfma_f32_16x16x32_bf16 a[224:227], a[0:3], v[144:147], a[224:227]
  ds_read_b128 v[180:183], v118 offset:11264
  v_mfma_f32_16x16x32_bf16 a[228:231], a[4:7], v[144:147], a[228:231]
  v_mfma_f32_16x16x32_bf16 a[232:235], a[0:3], v[148:151], a[232:235]
  ds_read_b128 v[184:187], v118 offset:13312
  v_mfma_f32_16x16x32_bf16 a[236:239], a[4:7], v[148:151], a[236:239]
  buffer_load_dwordx4 v116, s[20:23], s54 offen sc1 lds
  s_add_u32 m0, s50, 52224
  v_mfma_f32_16x16x32_bf16 a[240:243], a[0:3], v[152:155], a[240:243]
  ds_read_b128 v[188:191], v118 offset:15360
  v_mfma_f32_16x16x32_bf16 a[244:247], a[4:7], v[152:155], a[244:247]
  v_mfma_f32_16x16x32_bf16 a[248:251], a[0:3], v[156:159], a[248:251]
  v_mfma_f32_16x16x32_bf16 a[252:255], a[4:7], v[156:159], a[252:255]
  s_waitcnt vmcnt(7) lgkmcnt(0)
  s_barrier
  v_mfma_f32_16x16x32_bf16 a[192:195], a[8:11], v[160:163], a[192:195]
  ds_read_b128 v[128:131], v118 offset:16384
  v_mfma_f32_16x16x32_bf16 a[196:199], a[12:15], v[160:163], a[196:199]
  ds_read_b128 v[132:135], v118 offset:18432
  v_mfma_f32_16x16x32_bf16 a[200:203], a[8:11], v[164:167], a[200:203]
  buffer_load_dwordx4 v116, s[20:23], s55 offen sc1 lds
  v_add_u32 v116, 2048, v116
  v_mfma_f32_16x16x32_bf16 a[204:207], a[12:15], v[164:167], a[204:207]
  ds_read_b128 v[136:139], v118 offset:20480
  v_and_b32 v116, 16383, v116
  v_mfma_f32_16x16x32_bf16 a[208:211], a[8:11], v[168:171], a[208:211]
  s_add_u32 m0, s50, 65536
  v_mfma_f32_16x16x32_bf16 a[212:215], a[12:15], v[168:171], a[212:215]
  ds_read_b128 v[140:143], v118 offset:22528
  v_mfma_f32_16x16x32_bf16 a[216:219], a[8:11], v[172:175], a[216:219]
  buffer_load_dwordx4 v116, s[20:23], s52 offen sc1 lds
  s_add_u32 m0, s50, 66560
  v_mfma_f32_16x16x32_bf16 a[220:223], a[12:15], v[172:175], a[220:223]
  ds_read_b128 v[144:147], v118 offset:24576
  v_mfma_f32_16x16x32_bf16 a[224:227], a[8:11], v[176:179], a[224:227]
  ds_read_b128 v[148:151], v118 offset:26624
  v_mfma_f32_16x16x32_bf16 a[228:231], a[12:15], v[176:179], a[228:231]
  v_mfma_f32_16x16x32_bf16 a[232:235], a[8:11], v[180:183], a[232:235]
  ds_read_b128 v[152:155], v118 offset:28672
  v_mfma_f32_16x16x32_bf16 a[236:239], a[12:15], v[180:183], a[236:239]
  buffer_load_dwordx4 v116, s[20:23], s53 offen sc1 lds
  s_add_u32 m0, s50, 67584
  v_mfma_f32_16x16x32_bf16 a[240:243], a[8:11], v[184:187], a[240:243]
  ds_read_b128 v[156:159], v118 offset:30720
  v_mfma_f32_16x16x32_bf16 a[244:247], a[12:15], v[184:187], a[244:247]
  v_mfma_f32_16x16x32_bf16 a[248:251], a[8:11], v[188:191], a[248:251]
  v_mfma_f32_16x16x32_bf16 a[252:255], a[12:15], v[188:191], a[252:255]
  buffer_load_dwordx4 v116, s[20:23], s54 offen sc1 lds
  s_waitcnt lgkmcnt(4)
  v_mfma_f32_16x16x32_bf16 a[192:195], a[16:19], v[128:131], a[192:195]
  ds_read_b128 v[160:163], v118 offset:17408
  s_add_u32 m0, s50, 68608
  v_mfma_f32_16x16x32_bf16 a[196:199], a[20:23], v[128:131], a[196:199]
  ds_read_b128 v[164:167], v118 offset:19456
  v_mfma_f32_16x16x32_bf16 a[200:203], a[16:19], v[132:135], a[200:203]
  v_mfma_f32_16x16x32_bf16 a[204:207], a[20:23], v[132:135], a[204:207]
  ds_read_b128 v[168:171], v118 offset:21504
  v_mfma_f32_16x16x32_bf16 a[208:211], a[16:19], v[136:139], a[208:211]
  buffer_load_dwordx4 v116, s[20:23], s55 offen sc1 lds
  v_add_u32 v116, 2048, v116
  v_mfma_f32_16x16x32_bf16 a[212:215], a[20:23], v[136:139], a[212:215]
  ds_read_b128 v[172:175], v118 offset:23552
  v_and_b32 v116, 16383, v116
  v_mfma_f32_16x16x32_bf16 a[216:219], a[16:19], v[140:143], a[216:219]
  s_add_u32 m0, s50, 81920
  v_mfma_f32_16x16x32_bf16 a[220:223], a[20:23], v[140:143], a[220:223]
  ds_read_b128 v[176:179], v118 offset:25600
  s_waitcnt lgkmcnt(5)
  v_mfma_f32_16x16x32_bf16 a[224:227], a[16:19], v[144:147], a[224:227]
  ds_read_b128 v[180:183], v118 offset:27648
  v_mfma_f32_16x16x32_bf16 a[228:231], a[20:23], v[144:147], a[228:231]
  buffer_load_dwordx4 v116, s[20:23], s52 offen sc1 lds
  s_add_u32 m0, s50, 82944
  v_mfma_f32_16x16x32_bf16 a[232:235], a[16:19], v[148:151], a[232:235]
  ds_read_b128 v[184:187], v118 offset:29696
  v_mfma_f32_16x16x32_bf16 a[236:239], a[20:23], v[148:151], a[236:239]
  v_mfma_f32_16x16x32_bf16 a[240:243], a[16:19], v[152:155], a[240:243]
  ds_read_b128 v[188:191], v118 offset:31744
  v_mfma_f32_16x16x32_bf16 a[244:247], a[20:23], v[152:155], a[244:247]
  buffer_load_dwordx4 v116, s[20:23], s53 offen sc1 lds
  s_add_u32 m0, s50, 83968
  v_mfma_f32_16x16x32_bf16 a[248:251], a[16:19], v[156:159], a[248:251]
  v_mfma_f32_16x16x32_bf16 a[252:255], a[20:23], v[156:159], a[252:255]
  s_waitcnt vmcnt(10) lgkmcnt(0)
  s_barrier
  v_mfma_f32_16x16x32_bf16 a[192:195], a[24:27], v[160:163], a[192:195]
  ds_read_b128 v[128:131], v118 offset:32768
  v_mfma_f32_16x16x32_bf16 a[196:199], a[28:31], v[160:163], a[196:199]
  ds_read_b128 v[132:135], v118 offset:34816
  v_mfma_f32_16x16x32_bf16 a[200:203], a[24:27], v[164:167], a[200:203]
  buffer_load_dwordx4 v116, s[20:23], s54 offen sc1 lds
  s_add_u32 m0, s50, 84992
  v_mfma_f32_16x16x32_bf16 a[204:207], a[28:31], v[164:167], a[204:207]
  ds_read_b128 v[136:139], v118 offset:36864
  v_mfma_f32_16x16x32_bf16 a[208:211], a[24:27], v[168:171], a[208:211]
  v_mfma_f32_16x16x32_bf16 a[212:215], a[28:31], v[168:171], a[212:215]
  ds_read_b128 v[140:143], v118 offset:38912
  v_mfma_f32_16x16x32_bf16 a[216:219], a[24:27], v[172:175], a[216:219]
  buffer_load_dwordx4 v116, s[20:23], s55 offen sc1 lds
  v_add_u32 v116, 2048, v116
  v_mfma_f32_16x16x32_bf16 a[220:223], a[28:31], v[172:175], a[220:223]
  ds_read_b128 v[144:147], v118 offset:40960
  v_mfma_f32_16x16x32_bf16 a[224:227], a[24:27], v[176:179], a[224:227]
  ds_read_b128 v[148:151], v118 offset:43008
  v_and_b32 v116, 16383, v116
  v_mfma_f32_16x16x32_bf16 a[228:231], a[28:31], v[176:179], a[228:231]
  v_mfma_f32_16x16x32_bf16 a[232:235], a[24:27], v[180:183], a[232:235]
  ds_read_b128 v[152:155], v118 offset:45056
  v_mfma_f32_16x16x32_bf16 a[236:239], a[28:31], v[180:183], a[236:239]
  buffer_load_dwordx4 a[0:3], v117, s[20:23], s60 offen offset:0 sc1
  v_mfma_f32_16x16x32_bf16 a[240:243], a[24:27], v[184:187], a[240:243]
  ds_read_b128 v[156:159], v118 offset:47104
  v_mfma_f32_16x16x32_bf16 a[244:247], a[28:31], v[184:187], a[244:247]
  v_mfma_f32_16x16x32_bf16 a[248:251], a[24:27], v[188:191], a[248:251]
  v_mfma_f32_16x16x32_bf16 a[252:255], a[28:31], v[188:191], a[252:255]
  buffer_load_dwordx4 a[4:7], v117, s[20:23], s61 offen offset:0 sc1
  s_waitcnt lgkmcnt(4)
  v_mfma_f32_16x16x32_bf16 a[192:195], a[32:35], v[128:131], a[192:195]
  ds_read_b128 v[160:163], v118 offset:33792
  v_mfma_f32_16x16x32_bf16 a[196:199], a[36:39], v[128:131], a[196:199]
  ds_read_b128 v[164:167], v118 offset:35840
  v_mfma_f32_16x16x32_bf16 a[200:203], a[32:35], v[132:135], a[200:203]
  v_mfma_f32_16x16x32_bf16 a[204:207], a[36:39], v[132:135], a[204:207]
  ds_read_b128 v[168:171], v118 offset:37888
  v_mfma_f32_16x16x32_bf16 a[208:211], a[32:35], v[136:139], a[208:211]
  buffer_load_dwordx4 a[8:11], v117, s[20:23], s60 offen offset:1024 sc1
  v_mfma_f32_16x16x32_bf16 a[212:215], a[36:39], v[136:139], a[212:215]
  ds_read_b128 v[172:175], v118 offset:39936
  v_mfma_f32_16x16x32_bf16 a[216:219], a[32:35], v[140:143], a[216:219]
  v_mfma_f32_16x16x32_bf16 a[220:223], a[36:39], v[140:143], a[220:223]
  ds_read_b128 v[176:179], v118 offset:41984
  s_waitcnt lgkmcnt(5)
  v_mfma_f32_16x16x32_bf16 a[224:227], a[32:35], v[144:147], a[224:227]
  ds_read_b128 v[180:183], v118 offset:44032
  v_mfma_f32_16x16x32_bf16 a[228:231], a[36:39], v[144:147], a[228:231]
  buffer_load_dwordx4 a[12:15], v117, s[20:23], s61 offen offset:1024 sc1
  v_mfma_f32_16x16x32_bf16 a[232:235], a[32:35], v[148:151], a[232:235]
  ds_read_b128 v[184:187], v118 offset:46080
  v_mfma_f32_16x16x32_bf16 a[236:239], a[36:39], v[148:151], a[236:239]
  v_mfma_f32_16x16x32_bf16 a[240:243], a[32:35], v[152:155], a[240:243]
  ds_read_b128 v[188:191], v118 offset:48128
  v_mfma_f32_16x16x32_bf16 a[244:247], a[36:39], v[152:155], a[244:247]
  buffer_load_dwordx4 a[16:19], v117, s[20:23], s60 offen offset:2048 sc1
  v_mfma_f32_16x16x32_bf16 a[248:251], a[32:35], v[156:159], a[248:251]
  v_mfma_f32_16x16x32_bf16 a[252:255], a[36:39], v[156:159], a[252:255]
  s_waitcnt vmcnt(13) lgkmcnt(0)
  s_barrier
  v_mfma_f32_16x16x32_bf16 a[192:195], a[40:43], v[160:163], a[192:195]
  ds_read_b128 v[128:131], v118 offset:49152
  v_mfma_f32_16x16x32_bf16 a[196:199], a[44:47], v[160:163], a[196:199]
  ds_read_b128 v[132:135], v118 offset:51200
  v_mfma_f32_16x16x32_bf16 a[200:203], a[40:43], v[164:167], a[200:203]
  buffer_load_dwordx4 a[20:23], v117, s[20:23], s61 offen offset:2048 sc1
  v_mfma_f32_16x16x32_bf16 a[204:207], a[44:47], v[164:167], a[204:207]
  ds_read_b128 v[136:139], v118 offset:53248
  v_mfma_f32_16x16x32_bf16 a[208:211], a[40:43], v[168:171], a[208:211]
  v_mfma_f32_16x16x32_bf16 a[212:215], a[44:47], v[168:171], a[212:215]
  ds_read_b128 v[140:143], v118 offset:55296
  v_mfma_f32_16x16x32_bf16 a[216:219], a[40:43], v[172:175], a[216:219]
  buffer_load_dwordx4 a[24:27], v117, s[20:23], s60 offen offset:3072 sc1
  v_mfma_f32_16x16x32_bf16 a[220:223], a[44:47], v[172:175], a[220:223]
  ds_read_b128 v[144:147], v118 offset:57344
  v_mfma_f32_16x16x32_bf16 a[224:227], a[40:43], v[176:179], a[224:227]
  ds_read_b128 v[148:151], v118 offset:59392
  v_mfma_f32_16x16x32_bf16 a[228:231], a[44:47], v[176:179], a[228:231]
  v_mfma_f32_16x16x32_bf16 a[232:235], a[40:43], v[180:183], a[232:235]
  ds_read_b128 v[152:155], v118 offset:61440
  v_mfma_f32_16x16x32_bf16 a[236:239], a[44:47], v[180:183], a[236:239]
  buffer_load_dwordx4 a[28:31], v117, s[20:23], s61 offen offset:3072 sc1
  v_add_u32 v117, 4096, v117
  v_mfma_f32_16x16x32_bf16 a[240:243], a[40:43], v[184:187], a[240:243]
  ds_read_b128 v[156:159], v118 offset:63488
  v_and_b32 v117, 16383, v117
  v_mfma_f32_16x16x32_bf16 a[244:247], a[44:47], v[184:187], a[244:247]
  v_mfma_f32_16x16x32_bf16 a[248:251], a[40:43], v[188:191], a[248:251]
  v_mfma_f32_16x16x32_bf16 a[252:255], a[44:47], v[188:191], a[252:255]
  s_waitcnt lgkmcnt(4)
  v_mfma_f32_16x16x32_bf16 a[192:195], a[48:51], v[128:131], a[192:195]
  ds_read_b128 v[160:163], v118 offset:50176
  v_mfma_f32_16x16x32_bf16 a[196:199], a[52:55], v[128:131], a[196:199]
  ds_read_b128 v[164:167], v118 offset:52224
  v_mfma_f32_16x16x32_bf16 a[200:203], a[48:51], v[132:135], a[200:203]
  s_mov_b32 s27, 90218496
  s_sub_u32 s26, s28, 1
  v_min_u32 v14, 2, v0
  v_add_u32 v14, s26, v14
  v_med3_i32 v14, v14, 0, 63
  v_lshlrev_b32 v14, 7, v14
  s_cmp_eq_u32 s3, 0
  s_cselect_b32 s27, s27, 2130706432
  buffer_load_dword v13, v14, s[20:23], s27 offen sc1
  v_mfma_f32_16x16x32_bf16 a[204:207], a[52:55], v[132:135], a[204:207]
  ds_read_b128 v[168:171], v118 offset:54272
  v_mfma_f32_16x16x32_bf16 a[208:211], a[48:51], v[136:139], a[208:211]
  v_mfma_f32_16x16x32_bf16 a[212:215], a[52:55], v[136:139], a[212:215]
  ds_read_b128 v[172:175], v118 offset:56320
  v_mfma_f32_16x16x32_bf16 a[216:219], a[48:51], v[140:143], a[216:219]
  v_mfma_f32_16x16x32_bf16 a[220:223], a[52:55], v[140:143], a[220:223]
  ds_read_b128 v[176:179], v118 offset:58368
  s_waitcnt lgkmcnt(5)
  v_mfma_f32_16x16x32_bf16 a[224:227], a[48:51], v[144:147], a[224:227]
  ds_read_b128 v[180:183], v118 offset:60416
  v_mfma_f32_16x16x32_bf16 a[228:231], a[52:55], v[144:147], a[228:231]
  v_mfma_f32_16x16x32_bf16 a[232:235], a[48:51], v[148:151], a[232:235]
  ds_read_b128 v[184:187], v118 offset:62464
  v_mfma_f32_16x16x32_bf16 a[236:239], a[52:55], v[148:151], a[236:239]
  v_mfma_f32_16x16x32_bf16 a[240:243], a[48:51], v[152:155], a[240:243]
  ds_read_b128 v[188:191], v118 offset:64512
  v_mfma_f32_16x16x32_bf16 a[244:247], a[52:55], v[152:155], a[244:247]
  v_mfma_f32_16x16x32_bf16 a[248:251], a[48:51], v[156:159], a[248:251]
  v_mfma_f32_16x16x32_bf16 a[252:255], a[52:55], v[156:159], a[252:255]
  s_waitcnt vmcnt(13) lgkmcnt(0)
  s_barrier
  v_mfma_f32_16x16x32_bf16 a[192:195], a[56:59], v[160:163], a[192:195]
  ds_read_b128 v[128:131], v119 offset:0
  v_mfma_f32_16x16x32_bf16 a[196:199], a[60:63], v[160:163], a[196:199]
  ds_read_b128 v[132:135], v119 offset:2048
  v_mfma_f32_16x16x32_bf16 a[200:203], a[56:59], v[164:167], a[200:203]
  v_mfma_f32_16x16x32_bf16 a[204:207], a[60:63], v[164:167], a[204:207]
  ds_read_b128 v[136:139], v119 offset:4096
  v_mfma_f32_16x16x32_bf16 a[208:211], a[56:59], v[168:171], a[208:211]
  v_mfma_f32_16x16x32_bf16 a[212:215], a[60:63], v[168:171], a[212:215]
  ds_read_b128 v[140:143], v119 offset:6144
  v_mfma_f32_16x16x32_bf16 a[216:219], a[56:59], v[172:175], a[216:219]
  v_mfma_f32_16x16x32_bf16 a[220:223], a[60:63], v[172:175], a[220:223]
  ds_read_b128 v[144:147], v119 offset:8192
  v_mfma_f32_16x16x32_bf16 a[224:227], a[56:59], v[176:179], a[224:227]
  ds_read_b128 v[148:151], v119 offset:10240
  v_mfma_f32_16x16x32_bf16 a[228:231], a[60:63], v[176:179], a[228:231]
  v_mfma_f32_16x16x32_bf16 a[232:235], a[56:59], v[180:183], a[232:235]
  ds_read_b128 v[152:155], v119 offset:12288
  v_mfma_f32_16x16x32_bf16 a[236:239], a[60:63], v[180:183], a[236:239]
  v_mfma_f32_16x16x32_bf16 a[240:243], a[56:59], v[184:187], a[240:243]
  ds_read_b128 v[156:159], v119 offset:14336
  v_mfma_f32_16x16x32_bf16 a[244:247], a[60:63], v[184:187], a[244:247]
  v_mfma_f32_16x16x32_bf16 a[248:251], a[56:59], v[188:191], a[248:251]
  v_mfma_f32_16x16x32_bf16 a[252:255], a[60:63], v[188:191], a[252:255]
  s_waitcnt vmcnt(7) lgkmcnt(4)
  v_mfma_f32_16x16x32_bf16 a[192:195], a[0:3], v[128:131], a[192:195]
  ds_read_b128 v[160:163], v119 offset:1024
  v_mfma_f32_16x16x32_bf16 a[196:199], a[4:7], v[128:131], a[196:199]
  ds_read_b128 v[164:167], v119 offset:3072
  v_mfma_f32_16x16x32_bf16 a[200:203], a[0:3], v[132:135], a[200:203]
  s_cmp_lg_u32 s3, 0
  s_cbranch_scc1 POK_27
  s_waitcnt vmcnt(0)
PLP_28:
  v_cmp_le_u32 vcc, 16, v13
  s_cmp_eq_u64 vcc, -1
  s_cbranch_scc1 POK_27
  buffer_load_dword v13, v14, s[20:23], s27 offen sc1
  s_sub_u32 s25, s25, 1
  s_waitcnt vmcnt(0)
  s_cbranch_scc0 PLP_28
  s_endpgm
POK_27:
  v_mfma_f32_16x16x32_bf16 a[204:207], a[4:7], v[132:135], a[204:207]
  ds_read_b128 v[168:171], v119 offset:5120
  v_mfma_f32_16x16x32_bf16 a[208:211], a[0:3], v[136:139], a[208:211]
  v_mfma_f32_16x16x32_bf16 a[212:215], a[4:7], v[136:139], a[212:215]
  ds_read_b128 v[172:175], v119 offset:7168
  v_mfma_f32_16x16x32_bf16 a[216:219], a[0:3], v[140:143], a[216:219]
  v_mfma_f32_16x16x32_bf16 a[220:223], a[4:7], v[140:143], a[220:223]
  ds_read_b128 v[176:179], v119 offset:9216
  s_waitcnt lgkmcnt(5)
  v_mfma_f32_16x16x32_bf16 a[224:227], a[0:3], v[144:147], a[224:227]
  ds_read_b128 v[180:183], v119 offset:11264
  v_mfma_f32_16x16x32_bf16 a[228:231], a[4:7], v[144:147], a[228:231]
  v_mfma_f32_16x16x32_bf16 a[232:235], a[0:3], v[148:151], a[232:235]
  ds_read_b128 v[184:187], v119 offset:13312
  v_mfma_f32_16x16x32_bf16 a[236:239], a[4:7], v[148:151], a[236:239]
  v_mfma_f32_16x16x32_bf16 a[240:243], a[0:3], v[152:155], a[240:243]
  ds_read_b128 v[188:191], v119 offset:15360
  v_mfma_f32_16x16x32_bf16 a[244:247], a[4:7], v[152:155], a[244:247]
  v_mfma_f32_16x16x32_bf16 a[248:251], a[0:3], v[156:159], a[248:251]
  v_mfma_f32_16x16x32_bf16 a[252:255], a[4:7], v[156:159], a[252:255]
  s_waitcnt vmcnt(5) lgkmcnt(0)
  s_barrier
  v_mfma_f32_16x16x32_bf16 a[192:195], a[8:11], v[160:163], a[192:195]
  ds_read_b128 v[128:131], v119 offset:16384
  s_add_u32 m0, s62, 0
  v_mfma_f32_16x16x32_bf16 a[196:199], a[12:15], v[160:163], a[196:199]
  ds_read_b128 v[132:135], v119 offset:18432
  v_mfma_f32_16x16x32_bf16 a[200:203], a[8:11], v[164:167], a[200:203]
  buffer_load_dwordx4 v120, s[20:23], s64 offen sc1 lds
  s_add_u32 m0, s62, 1024
  v_mfma_f32_16x16x32_bf16 a[204:207], a[12:15], v[164:167], a[204:207]
  ds_read_b128 v[136:139], v119 offset:20480
  v_mfma_f32_16x16x32_bf16 a[208:211], a[8:11], v[168:171], a[208:211]
  v_mfma_f32_16x16x32_bf16 a[212:215], a[12:15], v[168:171], a[212:215]
  ds_read_b128 v[140:143], v119 offset:22528
  v_mfma_f32_16x16x32_bf16 a[216:219], a[8:11], v[172:175], a[216:219]
  buffer_load_dwordx4 v120, s[20:23], s65 offen sc1 lds
  s_add_u32 m0, s62, 2048
  v_mfma_f32_16x16x32_bf16 a[220:223], a[12:15], v[172:175], a[220:223]
  ds_read_b128 v[144:147], v119 offset:24576
  v_mfma_f32_16x16x32_bf16 a[224:227], a[8:11], v[176:179], a[224:227]
  ds_read_b128 v[148:151], v119 offset:26624
  v_mfma_f32_16x16x32_bf16 a[228:231], a[12:15], v[176:179], a[228:231]
  v_mfma_f32_16x16x32_bf16 a[232:235], a[8:11], v[180:183], a[232:235]
  ds_read_b128 v[152:155], v119 offset:28672
  v_mfma_f32_16x16x32_bf16 a[236:239], a[12:15], v[180:183], a[236:239]
  buffer_load_dwordx4 v120, s[20:23], s66 offen sc1 lds
  s_add_u32 m0, s62, 3072
  v_mfma_f32_16x16x32_bf16 a[240:243], a[8:11], v[184:187], a[240:243]
  ds_read_b128 v[156:159], v119 offset:30720
  v_mfma_f32_16x16x32_bf16 a[244:247], a[12:15], v[184:187], a[244:247]
  v_mfma_f32_16x16x32_bf16 a[248:251], a[8:11], v[188:191], a[248:251]
  v_mfma_f32_16x16x32_bf16 a[252:255], a[12:15], v[188:191], a[252:255]
  buffer_load_dwordx4 v120, s[20:23], s67 offen sc1 lds
  s_waitcnt vmcnt(7) lgkmcnt(4)
  v_mfma_f32_16x16x32_bf16 a[192:195], a[16:19], v[128:131], a[192:195]
  ds_read_b128 v[160:163], v119 offset:17408
  s_add_u32 m0, s62, 4096
  v_mfma_f32_16x16x32_bf16 a[196:199], a[20:23], v[128:131], a[196:199]
  ds_read_b128 v[164:167], v119 offset:19456
  v_mfma_f32_16x16x32_bf16 a[200:203], a[16:19], v[132:135], a[200:203]
  v_mfma_f32_16x16x32_bf16 a[204:207], a[20:23], v[132:135], a[204:207]
  ds_read_b128 v[168:171], v119 offset:21504
  v_mfma_f32_16x16x32_bf16 a[208:211], a[16:19], v[136:139], a[208:211]
  buffer_load_dwordx4 v120, s[20:23], s68 offen sc1 lds
  v_add_u32 v120, 2048, v120
  v_mfma_f32_16x16x32_bf16 a[212:215], a[20:23], v[136:139], a[212:215]
  ds_read_b128 v[172:175], v119 offset:23552
  s_add_u32 m0, s62, 20480
  v_mfma_f32_16x16x32_bf16 a[216:219], a[16:19], v[140:143], a[216:219]
  v_mfma_f32_16x16x32_bf16 a[220:223], a[20:23], v[140:143], a[220:223]
  ds_read_b128 v[176:179], v119 offset:25600
  s_waitcnt lgkmcnt(5)
  v_mfma_f32_16x16x32_bf16 a[224:227], a[16:19], v[144:147], a[224:227]
  ds_read_b128 v[180:183], v119 offset:27648
  v_mfma_f32_16x16x32_bf16 a[228:231], a[20:23], v[144:147], a[228:231]
  buffer_load_dwordx4 v120, s[20:23], s64 offen sc1 lds
  s_add_u32 m0, s62, 21504
  v_mfma_f32_16x16x32_bf16 a[232:235], a[16:19], v[148:151], a[232:235]
  ds_read_b128 v[184:187], v119 offset:29696
  v_mfma_f32_16x16x32_bf16 a[236:239], a[20:23], v[148:151], a[236:239]
  v_mfma_f32_16x16x32_bf16 a[240:243], a[16:19], v[152:155], a[240:243]
  ds_read_b128 v[188:191], v119 offset:31744
  v_mfma_f32_16x16x32_bf16 a[244:247], a[20:23], v[152:155], a[244:247]
  buffer_load_dwordx4 v120, s[20:23], s65 offen sc1 lds
  s_add_u32 m0, s62, 22528
  v_mfma_f32_16x16x32_bf16 a[248:251], a[16:19], v[156:159], a[248:251]
  v_mfma_f32_16x16x32_bf16 a[252:255], a[20:23], v[156:159], a[252:255]
  s_waitcnt vmcnt(8) lgkmcnt(4)
  v_mfma_f32_16x16x32_bf16 a[192:195], a[24:27], v[160:163], a[192:195]
  v_mfma_f32_16x16x32_bf16 a[196:199], a[28:31], v[160:163], a[196:199]
  buffer_load_dwordx4 v120, s[20:23], s66 offen sc1 lds
  s_add_u32 m0, s62, 23552
  v_mfma_f32_16x16x32_bf16 a[200:203], a[24:27], v[164:167], a[200:203]
  v_mfma_f32_16x16x32_bf16 a[204:207], a[28:31], v[164:167], a[204:207]
  v_mfma_f32_16x16x32_bf16 a[208:211], a[24:27], v[168:171], a[208:211]
  v_mfma_f32_16x16x32_bf16 a[212:215], a[28:31], v[168:171], a[212:215]
  buffer_load_dwordx4 v120, s[20:23], s67 offen sc1 lds
  s_add_u32 m0, s62, 24576
  v_mfma_f32_16x16x32_bf16 a[216:219], a[24:27], v[172:175], a[216:219]
  v_mfma_f32_16x16x32_bf16 a[220:223], a[28:31], v[172:175], a[220:223]
  s_waitcnt lgkmcnt(0)
  v_mfma_f32_16x16x32_bf16 a[224:227], a[24:27], v[176:179], a[224:227]
  v_mfma_f32_16x16x32_bf16 a[228:231], a[28:31], v[176:179], a[228:231]
  buffer_load_dwordx4 v120, s[20:23], s68 offen sc1 lds
  v_add_u32 v120, 2048, v120
  v_mfma_f32_16x16x32_bf16 a[232:235], a[24:27], v[180:183], a[232:235]
  s_add_u32 m0, s62, 40960
  v_mfma_f32_16x16x32_bf16 a[236:239], a[28:31], v[180:183], a[236:239]
  v_mfma_f32_16x16x32_bf16 a[240:243], a[24:27], v[184:187], a[240:243]
  v_mfma_f32_16x16x32_bf16 a[244:247], a[28:31], v[184:187], a[244:247]
  buffer_load_dwordx4 v120, s[20:23], s64 offen sc1 lds
  s_add_u32 m0, s62, 41984
  v_mfma_f32_16x16x32_bf16 a[248:251], a[24:27], v[188:191], a[248:251]
  v_mfma_f32_16x16x32_bf16 a[252:255], a[28:31], v[188:191], a[252:255]
  buffer_load_dwordx4 v120, s[20:23], s65 offen sc1 lds
  s_add_u32 m0, s62, 43008
  s_nop 0
  buffer_load_dwordx4 v120, s[20:23], s66 offen sc1 lds
  s_add_u32 m0, s62, 44032
  s_nop 0
  buffer_load_dwordx4 v120, s[20:23], s67 offen sc1 lds
  s_add_u32 m0, s62, 45056
  s_nop 0
  buffer_load_dwordx4 v120, s[20:23], s68 offen sc1 lds
  v_add_u32 v120, 2048, v120
  s_add_u32 m0, s62, 61440
  s_nop 0
  buffer_load_dwordx4 v120, s[20:23], s64 offen sc1 lds
  s_add_u32 m0, s62, 62464
  s_nop 0
  buffer_load_dwordx4 v120, s[20:23], s65 offen sc1 lds
  s_add_u32 m0, s62, 63488
  s_nop 0
  buffer_load_dwordx4 v120, s[20:23], s66 offen sc1 lds
  s_add_u32 m0, s62, 64512
  s_nop 0
  buffer_load_dwordx4 v120, s[20:23], s67 offen sc1 lds
  s_add_u32 m0, s62, 65536
  s_nop 0
  buffer_load_dwordx4 v120, s[20:23], s68 offen sc1 lds
  v_add_u32 v120, 2048, v120
  s_lshl_b32 s32, s28, 18
  s_add_u32 s32, s32, 33816576
  s_lshl_b32 s60, s31, 16
  s_add_u32 s60, s60, 86769664
  s_lshl_b32 s61, s31, 16
  s_add_u32 s61, s61, 86802432
  s_mul_i32 s50, s3, 4
  s_add_u32 s50, s50, 0
  s_lshr_b32 s51, s50, 1
  s_mul_i32 s51, s51, 32768
  s_and_b32 s50, s50, 1
  s_lshl_b32 s50, s50, 10
  s_add_u32 s51, s51, s50
  s_add_u32 s52, s51, s32
  s_mul_i32 s50, s3, 4
  s_add_u32 s50, s50, 1
  s_lshr_b32 s51, s50, 1
  s_mul_i32 s51, s51, 32768
  s_and_b32 s50, s50, 1
  s_lshl_b32 s50, s50, 10
  s_add_u32 s51, s51, s50
  s_add_u32 s53, s51, s32
  s_mul_i32 s50, s3, 4
  s_add_u32 s50, s50, 2
  s_lshr_b32 s51, s50, 1
  s_mul_i32 s51, s51, 32768
  s_and_b32 s50, s50, 1
  s_lshl_b32 s50, s50, 10
  s_add_u32 s51, s51, s50
  s_add_u32 s54, s51, s32
  s_mul_i32 s50, s3, 4
  s_add_u32 s50, s50, 3
  s_lshr_b32 s51, s50, 1
  s_mul_i32 s51, s51, 32768
  s_and_b32 s50, s50, 1
  s_lshl_b32 s50, s50, 10
  s_add_u32 s51, s51, s50
  s_add_u32 s55, s51, s32
  s_mul_i32 s50, s3, 4096
  v_mov_b32 v116, v1
  v_mov_b32 v117, v1
  v_add_u32 v118, 0x10000, v1
  v_add_u32 v119, 0x20000, v1
  s_lshl_b32 s32, s30, 12
  v_add_u32 v117, s32, v1
  s_add_u32 s32, s32, 4096
  s_and_b32 s32, s32, 16383
  v_add_u32 v116, s32, v1
  s_mul_i32 s42, s31, 10240
  s_add_u32 s42, s42, 87982080
  s_add_u32 s43, s42, 4096
  s_add_u32 s44, s42, 8192
  s_waitcnt vmcnt(15)
  s_barrier
  ds_read_b128 v[128:131], v1 offset:0
  ds_read_b128 v[132:135], v1 offset:2048
  ds_read_b128 v[136:139], v1 offset:4096
  ds_read_b128 v[140:143], v1 offset:6144
  ds_read_b128 v[144:147], v1 offset:8192
  ds_read_b128 v[148:151], v1 offset:10240
  ds_read_b128 v[152:155], v1 offset:12288
  ds_read_b128 v[156:159], v1 offset:14336
  ds_read_b128 v[160:163], v1 offset:16384
  ds_read_b128 v[164:167], v1 offset:18432
  s_waitcnt lgkmcnt(5)
  v_mfma_f32_16x16x32_bf16 v[16:19], v[128:131], a[64:67], 0
  ds_read_b128 v[168:171], v1 offset:1024
  v_mfma_f32_16x16x32_bf16 v[20:23], v[128:131], a[68:71], 0
  ds_read_b128 v[172:175], v1 offset:3072
  v_mfma_f32_16x16x32_bf16 v[24:27], v[132:135], a[64:67], 0
  buffer_load_dwordx4 a[120:123], v121, s[20:23], s70 offen offset:3072 sc1
  v_mfma_f32_16x16x32_bf16 v[28:31], v[132:135], a[68:71], 0
  ds_read_b128 v[176:179], v1 offset:5120
  v_mfma_f32_16x16x32_bf16 v[32:35], v[136:139], a[64:67], 0
  v_mfma_f32_16x16x32_bf16 v[36:39], v[136:139], a[68:71], 0
  ds_read_b128 v[180:183], v1 offset:7168
  v_mfma_f32_16x16x32_bf16 v[40:43], v[140:143], a[64:67], 0
  buffer_load_dwordx4 a[124:127], v121, s[20:23], s71 offen offset:3072 sc1
  v_add_u32 v121, 4096, v121
  v_mfma_f32_16x16x32_bf16 v[44:47], v[140:143], a[68:71], 0
  ds_read_b128 v[184:187], v1 offset:9216
  v_mfma_f32_16x16x32_bf16 v[48:51], v[144:147], a[64:67], 0
  v_mfma_f32_16x16x32_bf16 v[52:55], v[144:147], a[68:71], 0
  ds_read_b128 v[188:191], v1 offset:11264
  s_waitcnt lgkmcnt(6)
  v_mfma_f32_16x16x32_bf16 v[56:59], v[148:151], a[64:67], 0
  ds_read_b128 v[192:195], v1 offset:13312
  v_mfma_f32_16x16x32_bf16 v[60:63], v[148:151], a[68:71], 0
  buffer_load_dwordx4 a[128:131], v121, s[20:23], s70 offen offset:0 sc1
  v_mfma_f32_16x16x32_bf16 v[64:67], v[152:155], a[64:67], 0
  ds_read_b128 v[196:199], v1 offset:15360
  v_mfma_f32_16x16x32_bf16 v[68:71], v[152:155], a[68:71], 0
  v_mfma_f32_16x16x32_bf16 v[72:75], v[156:159], a[64:67], 0
  ds_read_b128 v[200:203], v1 offset:17408
  v_mfma_f32_16x16x32_bf16 v[76:79], v[156:159], a[68:71], 0
  buffer_load_dwordx4 a[132:135], v121, s[20:23], s71 offen offset:0 sc1
  v_mfma_f32_16x16x32_bf16 v[80:83], v[160:163], a[64:67], 0
  ds_read_b128 v[204:207], v1 offset:19456
  v_mfma_f32_16x16x32_bf16 v[84:87], v[160:163], a[68:71], 0
  v_mfma_f32_16x16x32_bf16 v[88:91], v[164:167], a[64:67], 0
  v_mfma_f32_16x16x32_bf16 v[92:95], v[164:167], a[68:71], 0
  s_waitcnt vmcnt(14) lgkmcnt(0)
  s_barrier
  v_mfma_f32_16x16x32_bf16 v[16:19], v[168:171], a[72:75], v[16:19]
  ds_read_b128 v[128:131], v1 offset:20480
  v_mfma_f32_16x16x32_bf16 v[20:23], v[168:171], a[76:79], v[20:23]
  ds_read_b128 v[132:135], v1 offset:22528
  v_mfma_f32_16x16x32_bf16 v[24:27], v[172:175], a[72:75], v[24:27]
  buffer_load_dwordx4 a[136:139], v121, s[20:23], s70 offen offset:1024 sc1
  v_mfma_f32_16x16x32_bf16 v[28:31], v[172:175], a[76:79], v[28:31]
  ds_read_b128 v[136:139], v1 offset:24576
  v_mfma_f32_16x16x32_bf16 v[32:35], v[176:179], a[72:75], v[32:35]
  v_mfma_f32_16x16x32_bf16 v[36:39], v[176:179], a[76:79], v[36:39]
  ds_read_b128 v[140:143], v1 offset:26624
  v_mfma_f32_16x16x32_bf16 v[40:43], v[180:183], a[72:75], v[40:43]
  buffer_load_dwordx4 a[140:143], v121, s[20:23], s71 offen offset:1024 sc1
  v_mfma_f32_16x16x32_bf16 v[44:47], v[180:183], a[76:79], v[44:47]
  ds_read_b128 v[144:147], v1 offset:28672
  v_mfma_f32_16x16x32_bf16 v[48:51], v[184:187], a[72:75], v[48:51]
  v_mfma_f32_16x16x32_bf16 v[52:55], v[184:187], a[76:79], v[52:55]
  ds_read_b128 v[148:151], v1 offset:30720
  v_mfma_f32_16x16x32_bf16 v[56:59], v[188:191], a[72:75], v[56:59]
  ds_read_b128 v[152:155], v1 offset:32768
  v_mfma_f32_16x16x32_bf16 v[60:63], v[188:191], a[76:79], v[60:63]
  buffer_load_dwordx4 a[144:147], v121, s[20:23], s70 offen offset:2048 sc1
  v_mfma_f32_16x16x32_bf16 v[64:67], v[192:195], a[72:75], v[64:67]
  ds_read_b128 v[156:159], v1 offset:34816
  v_mfma_f32_16x16x32_bf16 v[68:71], v[192:195], a[76:79], v[68:71]
  v_mfma_f32_16x16x32_bf16 v[72:75], v[196:199], a[72:75], v[72:75]
  ds_read_b128 v[160:163], v1 offset:36864
  v_mfma_f32_16x16x32_bf16 v[76:79], v[196:199], a[76:79], v[76:79]
  buffer_load_dwordx4 a[148:151], v121, s[20:23], s71 offen offset:2048 sc1
  v_mfma_f32_16x16x32_bf16 v[80:83], v[200:203], a[72:75], v[80:83]
  ds_read_b128 v[164:167], v1 offset:38912
  v_mfma_f32_16x16x32_bf16 v[84:87], v[200:203], a[76:79], v[84:87]
  v_mfma_f32_16x16x32_bf16 v[88:91], v[204:207], a[72:75], v[88:91]
  v_mfma_f32_16x16x32_bf16 v[92:95], v[204:207], a[76:79], v[92:95]
  buffer_load_dwordx4 a[152:155], v121, s[20:23], s70 offen offset:3072 sc1
  s_waitcnt lgkmcnt(5)
  v_mfma_f32_16x16x32_bf16 v[16:19], v[128:131], a[80:83], v[16:19]
  ds_read_b128 v[168:171], v1 offset:21504
  v_mfma_f32_16x16x32_bf16 v[20:23], v[128:131], a[84:87], v[20:23]
  ds_read_b128 v[172:175], v1 offset:23552
  v_mfma_f32_16x16x32_bf16 v[24:27], v[132:135], a[80:83], v[24:27]
  v_mfma_f32_16x16x32_bf16 v[28:31], v[132:135], a[84:87], v[28:31]
  ds_read_b128 v[176:179], v1 offset:25600
  v_mfma_f32_16x16x32_bf16 v[32:35], v[136:139], a[80:83], v[32:35]
  buffer_load_dwordx4 a[156:159], v121, s[20:23], s71 offen offset:3072 sc1
  v_add_u32 v121, 4096, v121
  v_mfma_f32_16x16x32_bf16 v[36:39], v[136:139], a[84:87], v[36:39]
  ds_read_b128 v[180:183], v1 offset:27648
  v_mfma_f32_16x16x32_bf16 v[40:43], v[140:143], a[80:83], v[40:43]
  v_mfma_f32_16x16x32_bf16 v[44:47], v[140:143], a[84:87], v[44:47]
  ds_read_b128 v[184:187], v1 offset:29696
  v_mfma_f32_16x16x32_bf16 v[48:51], v[144:147], a[80:83], v[48:51]
  buffer_load_dwordx4 a[160:163], v121, s[20:23], s70 offen offset:0 sc1
  v_mfma_f32_16x16x32_bf16 v[52:55], v[144:147], a[84:87], v[52:55]
  ds_read_b128 v[188:191], v1 offset:31744
  s_waitcnt lgkmcnt(6)
  v_mfma_f32_16x16x32_bf16 v[56:59], v[148:151], a[80:83], v[56:59]
  ds_read_b128 v[192:195], v1 offset:33792
  v_mfma_f32_16x16x32_bf16 v[60:63], v[148:151], a[84:87], v[60:63]
  v_mfma_f32_16x16x32_bf16 v[64:67], v[152:155], a[80:83], v[64:67]
  ds_read_b128 v[196:199], v1 offset:35840
  v_mfma_f32_16x16x32_bf16 v[68:71], v[152:155], a[84:87], v[68:71]
  buffer_load_dwordx4 a[164:167], v121, s[20:23], s71 offen offset:0 sc1
  v_mfma_f32_16x16x32_bf16 v[72:75], v[156:159], a[80:83], v[72:75]
  ds_read_b128 v[200:203], v1 offset:37888
  v_mfma_f32_16x16x32_bf16 v[76:79], v[156:159], a[84:87], v[76:79]
  v_mfma_f32_16x16x32_bf16 v[80:83], v[160:163], a[80:83], v[80:83]
  ds_read_b128 v[204:207], v1 offset:39936
  v_mfma_f32_16x16x32_bf16 v[84:87], v[160:163], a[84:87], v[84:87]
  buffer_load_dwordx4 a[168:171], v121, s[20:23], s70 offen offset:1024 sc1
  v_mfma_f32_16x16x32_bf16 v[88:91], v[164:167], a[80:83], v[88:91]
  v_mfma_f32_16x16x32_bf16 v[92:95], v[164:167], a[84:87], v[92:95]
  s_waitcnt vmcnt(18) lgkmcnt(0)
  s_barrier
  v_mfma_f32_16x16x32_bf16 v[16:19], v[168:171], a[88:91], v[16:19]
  ds_read_b128 v[128:131], v1 offset:40960
  v_mfma_f32_16x16x32_bf16 v[20:23], v[168:171], a[92:95], v[20:23]
  ds_read_b128 v[132:135], v1 offset:43008
  v_mfma_f32_16x16x32_bf16 v[24:27], v[172:175], a[88:91], v[24:27]
  buffer_load_dwordx4 a[172:175], v121, s[20:23], s71 offen offset:1024 sc1
  v_mfma_f32_16x16x32_bf16 v[28:31], v[172:175], a[92:95], v[28:31]
  ds_read_b128 v[136:139], v1 offset:45056
  v_mfma_f32_16x16x32_bf16 v[32:35], v[176:179], a[88:91], v[32:35]
  v_mfma_f32_16x16x32_bf16 v[36:39], v[176:179], a[92:95], v[36:39]
  ds_read_b128 v[140:143], v1 offset:47104
  v_mfma_f32_16x16x32_bf16 v[40:43], v[180:183], a[88:91], v[40:43]
  buffer_load_dwordx4 a[176:179], v121, s[20:23], s70 offen offset:2048 sc1
  v_mfma_f32_16x16x32_bf16 v[44:47], v[180:183], a[92:95], v[44:47]
  ds_read_b128 v[144:147], v1 offset:49152
  v_mfma_f32_16x16x32_bf16 v[48:51], v[184:187], a[88:91], v[48:51]
  v_mfma_f32_16x16x32_bf16 v[52:55], v[184:187], a[92:95], v[52:55]
  ds_read_b128 v[148:151], v1 offset:51200
  v_mfma_f32_16x16x32_bf16 v[56:59], v[188:191], a[88:91], v[56:59]
  ds_read_b128 v[152:155], v1 offset:53248
  v_mfma_f32_16x16x32_bf16 v[60:63], v[188:191], a[92:95], v[60:63]
  buffer_load_dwordx4 a[180:183], v121, s[20:23], s71 offen offset:2048 sc1
  v_mfma_f32_16x16x32_bf16 v[64:67], v[192:195], a[88:91], v[64:67]
  ds_read_b128 v[156:159], v1 offset:55296
  v_mfma_f32_16x16x32_bf16 v[68:71], v[192:195], a[92:95], v[68:71]
  v_mfma_f32_16x16x32_bf16 v[72:75], v[196:199], a[88:91], v[72:75]
  ds_read_b128 v[160:163], v1 offset:57344
  v_mfma_f32_16x16x32_bf16 v[76:79], v[196:199], a[92:95], v[76:79]
  buffer_load_dwordx4 a[184:187], v121, s[20:23], s70 offen offset:3072 sc1
  v_mfma_f32_16x16x32_bf16 v[80:83], v[200:203], a[88:91], v[80:83]
  ds_read_b128 v[164:167], v1 offset:59392
  v_mfma_f32_16x16x32_bf16 v[84:87], v[200:203], a[92:95], v[84:87]
  v_mfma_f32_16x16x32_bf16 v[88:91], v[204:207], a[88:91], v[88:91]
  v_mfma_f32_16x16x32_bf16 v[92:95], v[204:207], a[92:95], v[92:95]
  buffer_load_dwordx4 a[188:191], v121, s[20:23], s71 offen offset:3072 sc1
  s_waitcnt lgkmcnt(5)
  v_mfma_f32_16x16x32_bf16 v[16:19], v[128:131], a[96:99], v[16:19]
  ds_read_b128 v[168:171], v1 offset:41984
  v_add_u32 v121, 4096, v121
  v_mfma_f32_16x16x32_bf16 v[20:23], v[128:131], a[100:103], v[20:23]
  ds_read_b128 v[172:175], v1 offset:44032
  s_add_u32 m0, s62, 81920
  v_mfma_f32_16x16x32_bf16 v[24:27], v[132:135], a[96:99], v[24:27]
  v_mfma_f32_16x16x32_bf16 v[28:31], v[132:135], a[100:103], v[28:31]
  ds_read_b128 v[176:179], v1 offset:46080
  v_mfma_f32_16x16x32_bf16 v[32:35], v[136:139], a[96:99], v[32:35]
  buffer_load_dwordx4 v120, s[20:23], s64 offen sc1 lds
  s_add_u32 m0, s62, 82944
  v_mfma_f32_16x16x32_bf16 v[36:39], v[136:139], a[100:103], v[36:39]
  ds_read_b128 v[180:183], v1 offset:48128
  v_mfma_f32_16x16x32_bf16 v[40:43], v[140:143], a[96:99], v[40:43]
  v_mfma_f32_16x16x32_bf16 v[44:47], v[140:143], a[100:103], v[44:47]
  ds_read_b128 v[184:187], v1 offset:50176
  v_mfma_f32_16x16x32_bf16 v[48:51], v[144:147], a[96:99], v[48:51]
  buffer_load_dwordx4 v120, s[20:23], s65 offen sc1 lds
  s_add_u32 m0, s62, 83968
  v_mfma_f32_16x16x32_bf16 v[52:55], v[144:147], a[100:103], v[52:55]
  ds_read_b128 v[188:191], v1 offset:52224
  s_waitcnt lgkmcnt(6)
  v_mfma_f32_16x16x32_bf16 v[56:59], v[148:151], a[96:99], v[56:59]
  ds_read_b128 v[192:195], v1 offset:54272
  v_mfma_f32_16x16x32_bf16 v[60:63], v[148:151], a[100:103], v[60:63]
  v_mfma_f32_16x16x32_bf16 v[64:67], v[152:155], a[96:99], v[64:67]
  ds_read_b128 v[196:199], v1 offset:56320
  v_mfma_f32_16x16x32_bf16 v[68:71], v[152:155], a[100:103], v[68:71]
  buffer_load_dwordx4 v120, s[20:23], s66 offen sc1 lds
  s_add_u32 m0, s62, 84992
  v_mfma_f32_16x16x32_bf16 v[72:75], v[156:159], a[96:99], v[72:75]
  ds_read_b128 v[200:203], v1 offset:58368
  v_mfma_f32_16x16x32_bf16 v[76:79], v[156:159], a[100:103], v[76:79]
  v_mfma_f32_16x16x32_bf16 v[80:83], v[160:163], a[96:99], v[80:83]
  ds_read_b128 v[204:207], v1 offset:60416
  v_mfma_f32_16x16x32_bf16 v[84:87], v[160:163], a[100:103], v[84:87]
  buffer_load_dwordx4 v120, s[20:23], s67 offen sc1 lds
  s_add_u32 m0, s62, 86016
  v_mfma_f32_16x16x32_bf16 v[88:91], v[164:167], a[96:99], v[88:91]
  v_mfma_f32_16x16x32_bf16 v[92:95], v[164:167], a[100:103], v[92:95]
  s_waitcnt vmcnt(22) lgkmcnt(0)
  s_barrier
  v_mfma_f32_16x16x32_bf16 v[16:19], v[168:171], a[104:107], v[16:19]
  ds_read_b128 v[128:131], v1 offset:61440
  v_mfma_f32_16x16x32_bf16 v[20:23], v[168:171], a[108:111], v[20:23]
  ds_read_b128 v[132:135], v1 offset:63488
  v_mfma_f32_16x16x32_bf16 v[24:27], v[172:175], a[104:107], v[24:27]
  buffer_load_dwordx4 v120, s[20:23], s68 offen sc1 lds
  v_add_u32 v120, 2048, v120
  v_mfma_f32_16x16x32_bf16 v[28:31], v[172:175], a[108:111], v[28:31]
  ds_read_b128 v[136:139], v122 offset:0
  s_add_u32 m0, s62, 102400
  v_mfma_f32_16x16x32_bf16 v[32:35], v[176:179], a[104:107], v[32:35]
  v_mfma_f32_16x16x32_bf16 v[36:39], v[176:179], a[108:111], v[36:39]
  ds_read_b128 v[140:143], v122 offset:2048
  v_mfma_f32_16x16x32_bf16 v[40:43], v[180:183], a[104:107], v[40:43]
  buffer_load_dwordx4 v120, s[20:23], s64 offen sc1 lds
  s_add_u32 m0, s62, 103424
  v_mfma_f32_16x16x32_bf16 v[44:47], v[180:183], a[108:111], v[44:47]
  ds_read_b128 v[144:147], v122 offset:4096
  v_mfma_f32_16x16x32_bf16 v[48:51], v[184:187], a[104:107], v[48:51]
  v_mfma_f32_16x16x32_bf16 v[52:55], v[184:187], a[108:111], v[52:55]
  ds_read_b128 v[148:151], v122 offset:6144
  v_mfma_f32_16x16x32_bf16 v[56:59], v[188:191], a[104:107], v[56:59]
  ds_read_b128 v[152:155], v122 offset:8192
  v_mfma_f32_16x16x32_bf16 v[60:63], v[188:191], a[108:111], v[60:63]
  buffer_load_dwordx4 v120, s[20:23], s65 offen sc1 lds
  s_add_u32 m0, s62, 104448
  v_mfma_f32_16x16x32_bf16 v[64:67], v[192:195], a[104:107], v[64:67]
  ds_read_b128 v[156:159], v122 offset:10240
  v_mfma_f32_16x16x32_bf16 v[68:71], v[192:195], a[108:111], v[68:71]
  v_mfma_f32_16x16x32_bf16 v[72:75], v[196:199], a[104:107], v[72:75]
  ds_read_b128 v[160:163], v122 offset:12288
  v_mfma_f32_16x16x32_bf16 v[76:79], v[196:199], a[108:111], v[76:79]
  buffer_load_dwordx4 v120, s[20:23], s66 offen sc1 lds
  s_add_u32 m0, s62, 105472
  v_mfma_f32_16x16x32_bf16 v[80:83], v[200:203], a[104:107], v[80:83]
  ds_read_b128 v[164:167], v122 offset:14336
  v_mfma_f32_16x16x32_bf16 v[84:87], v[200:203], a[108:111], v[84:87]
  v_mfma_f32_16x16x32_bf16 v[88:91], v[204:207], a[104:107], v[88:91]
  v_mfma_f32_16x16x32_bf16 v[92:95], v[204:207], a[108:111], v[92:95]
  buffer_load_dwordx4 v120, s[20:23], s67 offen sc1 lds
  s_waitcnt lgkmcnt(5)
  v_mfma_f32_16x16x32_bf16 v[16:19], v[128:131], a[112:115], v[16:19]
  ds_read_b128 v[168:171], v1 offset:62464
  s_add_u32 m0, s62, 106496
  v_mfma_f32_16x16x32_bf16 v[20:23], v[128:131], a[116:119], v[20:23]
  ds_read_b128 v[172:175], v1 offset:64512
  v_mfma_f32_16x16x32_bf16 v[24:27], v[132:135], a[112:115], v[24:27]
  v_mfma_f32_16x16x32_bf16 v[28:31], v[132:135], a[116:119], v[28:31]
  ds_read_b128 v[176:179], v122 offset:1024
  v_mfma_f32_16x16x32_bf16 v[32:35], v[136:139], a[112:115], v[32:35]
  buffer_load_dwordx4 v120, s[20:23], s68 offen sc1 lds
  v_add_u32 v120, 2048, v120
  v_mfma_f32_16x16x32_bf16 v[36:39], v[136:139], a[116:119], v[36:39]
  ds_read_b128 v[180:183], v122 offset:3072
  s_add_u32 m0, s62, 122880
  v_mfma_f32_16x16x32_bf16 v[40:43], v[140:143], a[112:115], v[40:43]
  v_mfma_f32_16x16x32_bf16 v[44:47], v[140:143], a[116:119], v[44:47]
  ds_read_b128 v[184:187], v122 offset:5120
  v_mfma_f32_16x16x32_bf16 v[48:51], v[144:147], a[112:115], v[48:51]
  buffer_load_dwordx4 v120, s[20:23], s64 offen sc1 lds
  s_add_u32 m0, s62, 123904
  v_mfma_f32_16x16x32_bf16 v[52:55], v[144:147], a[116:119], v[52:55]
  ds_read_b128 v[188:191], v122 offset:7168
  s_waitcnt lgkmcnt(6)
  v_mfma_f32_16x16x32_bf16 v[56:59], v[148:151], a[112:115], v[56:59]
  ds_read_b128 v[192:195], v122 offset:9216
  v_mfma_f32_16x16x32_bf16 v[60:63], v[148:151], a[116:119], v[60:63]
  v_mfma_f32_16x16x32_bf16 v[64:67], v[152:155], a[112:115], v[64:67]
  ds_read_b128 v[196:199], v122 offset:11264
  v_mfma_f32_16x16x32_bf16 v[68:71], v[152:155], a[116:119], v[68:71]
  buffer_load_dwordx4 v120, s[20:23], s65 offen sc1 lds
  s_add_u32 m0, s62, 124928
  v_mfma_f32_16x16x32_bf16 v[72:75], v[156:159], a[112:115], v[72:75]
  ds_read_b128 v[200:203], v122 offset:13312
  v_mfma_f32_16x16x32_bf16 v[76:79], v[156:159], a[116:119], v[76:79]
  v_mfma_f32_16x16x32_bf16 v[80:83], v[160:163], a[112:115], v[80:83]
  ds_read_b128 v[204:207], v122 offset:15360
  v_mfma_f32_16x16x32_bf16 v[84:87], v[160:163], a[116:119], v[84:87]
  buffer_load_dwordx4 v120, s[20:23], s66 offen sc1 lds
  s_add_u32 m0, s62, 125952
  v_mfma_f32_16x16x32_bf16 v[88:91], v[164:167], a[112:115], v[88:91]
  v_mfma_f32_16x16x32_bf16 v[92:95], v[164:167], a[116:119], v[92:95]
  s_waitcnt vmcnt(8) lgkmcnt(0)
  s_barrier
  v_mfma_f32_16x16x32_bf16 v[16:19], v[168:171], a[120:123], v[16:19]
  ds_read_b128 v[128:131], v122 offset:16384
  v_mfma_f32_16x16x32_bf16 v[20:23], v[168:171], a[124:127], v[20:23]
  ds_read_b128 v[132:135], v122 offset:18432
  v_mfma_f32_16x16x32_bf16 v[24:27], v[172:175], a[120:123], v[24:27]
  buffer_load_dwordx4 v120, s[20:23], s67 offen sc1 lds
  s_add_u32 m0, s62, 126976
  v_mfma_f32_16x16x32_bf16 v[28:31], v[172:175], a[124:127], v[28:31]
  ds_read_b128 v[136:139], v122 offset:20480
  v_mfma_f32_16x16x32_bf16 v[32:35], v[176:179], a[120:123], v[32:35]
  v_mfma_f32_16x16x32_bf16 v[36:39], v[176:179], a[124:127], v[36:39]
  ds_read_b128 v[140:143], v122 offset:22528
  v_mfma_f32_16x16x32_bf16 v[40:43], v[180:183], a[120:123], v[40:43]
  buffer_load_dwordx4 v120, s[20:23], s68 offen sc1 lds
  v_add_u32 v120, 2048, v120
  v_mfma_f32_16x16x32_bf16 v[44:47], v[180:183], a[124:127], v[44:47]
  ds_read_b128 v[144:147], v122 offset:24576
  s_add_u32 m0, s62, 143360
  v_mfma_f32_16x16x32_bf16 v[48:51], v[184:187], a[120:123], v[48:51]
  v_mfma_f32_16x16x32_bf16 v[52:55], v[184:187], a[124:127], v[52:55]
  ds_read_b128 v[148:151], v122 offset:26624
  v_mfma_f32_16x16x32_bf16 v[56:59], v[188:191], a[120:123], v[56:59]
  ds_read_b128 v[152:155], v122 offset:28672
  v_mfma_f32_16x16x32_bf16 v[60:63], v[188:191], a[124:127], v[60:63]
  buffer_load_dwordx4 v120, s[20:23], s64 offen sc1 lds
  s_add_u32 m0, s62, 144384
  v_mfma_f32_16x16x32_bf16 v[64:67], v[192:195], a[120:123], v[64:67]
  ds_read_b128 v[156:159], v122 offset:30720
  v_mfma_f32_16x16x32_bf16 v[68:71], v[192:195], a[124:127], v[68:71]
  v_mfma_f32_16x16x32_bf16 v[72:75], v[196:199], a[120:123], v[72:75]
  ds_read_b128 v[160:163], v122 offset:32768
  v_mfma_f32_16x16x32_bf16 v[76:79], v[196:199], a[124:127], v[76:79]
  buffer_load_dwordx4 v120, s[20:23], s65 offen sc1 lds
  s_add_u32 m0, s62, 145408
  v_mfma_f32_16x16x32_bf16 v[80:83], v[200:203], a[120:123], v[80:83]
  ds_read_b128 v[164:167], v122 offset:34816
  v_mfma_f32_16x16x32_bf16 v[84:87], v[200:203], a[124:127], v[84:87]
  v_mfma_f32_16x16x32_bf16 v[88:91], v[204:207], a[120:123], v[88:91]
  v_mfma_f32_16x16x32_bf16 v[92:95], v[204:207], a[124:127], v[92:95]
  buffer_load_dwordx4 v120, s[20:23], s66 offen sc1 lds
  s_waitcnt lgkmcnt(5)
  v_mfma_f32_16x16x32_bf16 v[16:19], v[128:131], a[128:131], v[16:19]
  ds_read_b128 v[168:171], v122 offset:17408
  s_add_u32 m0, s62, 146432
  v_mfma_f32_16x16x32_bf16 v[20:23], v[128:131], a[132:135], v[20:23]
  ds_read_b128 v[172:175], v122 offset:19456
  v_mfma_f32_16x16x32_bf16 v[24:27], v[132:135], a[128:131], v[24:27]
  v_mfma_f32_16x16x32_bf16 v[28:31], v[132:135], a[132:135], v[28:31]
  ds_read_b128 v[176:179], v122 offset:21504
  v_mfma_f32_16x16x32_bf16 v[32:35], v[136:139], a[128:131], v[32:35]
  buffer_load_dwordx4 v120, s[20:23], s67 offen sc1 lds
  s_add_u32 m0, s62, 147456
  v_mfma_f32_16x16x32_bf16 v[36:39], v[136:139], a[132:135], v[36:39]
  ds_read_b128 v[180:183], v122 offset:23552
  v_mfma_f32_16x16x32_bf16 v[40:43], v[140:143], a[128:131], v[40:43]
  v_mfma_f32_16x16x32_bf16 v[44:47], v[140:143], a[132:135], v[44:47]
  ds_read_b128 v[184:187], v122 offset:25600
  v_mfma_f32_16x16x32_bf16 v[48:51], v[144:147], a[128:131], v[48:51]
  buffer_load_dwordx4 v120, s[20:23], s68 offen sc1 lds
  v_add_u32 v120, 2048, v120
  v_mfma_f32_16x16x32_bf16 v[52:55], v[144:147], a[132:135], v[52:55]
  ds_read_b128 v[188:191], v122 offset:27648
  s_waitcnt lgkmcnt(6)
  v_mfma_f32_16x16x32_bf16 v[56:59], v[148:151], a[128:131], v[56:59]
  ds_read_b128 v[192:195], v122 offset:29696
  v_mfma_f32_16x16x32_bf16 v[60:63], v[148:151], a[132:135], v[60:63]
  v_mfma_f32_16x16x32_bf16 v[64:67], v[152:155], a[128:131], v[64:67]
  ds_read_b128 v[196:199], v122 offset:31744
  v_mfma_f32_16x16x32_bf16 v[68:71], v[152:155], a[132:135], v[68:71]
  buffer_load_dwordx4 v[208:211], v1, s[20:23], s42 offen offset:0 sc1
  v_mfma_f32_16x16x32_bf16 v[72:75], v[156:159], a[128:131], v[72:75]
  ds_read_b128 v[200:203], v122 offset:33792
  v_mfma_f32_16x16x32_bf16 v[76:79], v[156:159], a[132:135], v[76:79]
  v_mfma_f32_16x16x32_bf16 v[80:83], v[160:163], a[128:131], v[80:83]
  ds_read_b128 v[204:207], v122 offset:35840
  v_mfma_f32_16x16x32_bf16 v[84:87], v[160:163], a[132:135], v[84:87]
  buffer_load_dwordx4 v[212:215], v1, s[20:23], s42 offen offset:1024 sc1
  v_mfma_f32_16x16x32_bf16 v[88:91], v[164:167], a[128:131], v[88:91]
  v_mfma_f32_16x16x32_bf16 v[92:95], v[164:167], a[132:135], v[92:95]
  s_waitcnt vmcnt(12) lgkmcnt(0)
  s_barrier
  v_mfma_f32_16x16x32_bf16 v[16:19], v[168:171], a[136:139], v[16:19]
  ds_read_b128 v[128:131], v122 offset:36864
  v_mfma_f32_16x16x32_bf16 v[20:23], v[168:171], a[140:143], v[20:23]
  ds_read_b128 v[132:135], v122 offset:38912
  v_mfma_f32_16x16x32_bf16 v[24:27], v[172:175], a[136:139], v[24:27]
  buffer_load_dwordx4 v[216:219], v1, s[20:23], s42 offen offset:2048 sc1
  v_mfma_f32_16x16x32_bf16 v[28:31], v[172:175], a[140:143], v[28:31]
  ds_read_b128 v[136:139], v122 offset:40960
  v_mfma_f32_16x16x32_bf16 v[32:35], v[176:179], a[136:139], v[32:35]
  v_mfma_f32_16x16x32_bf16 v[36:39], v[176:179], a[140:143], v[36:39]
  ds_read_b128 v[140:143], v122 offset:43008
  v_mfma_f32_16x16x32_bf16 v[40:43], v[180:183], a[136:139], v[40:43]
  buffer_load_dwordx4 v[220:223], v1, s[20:23], s42 offen offset:3072 sc1
  v_mfma_f32_16x16x32_bf16 v[44:47], v[180:183], a[140:143], v[44:47]
  ds_read_b128 v[144:147], v122 offset:45056
  v_mfma_f32_16x16x32_bf16 v[48:51], v[184:187], a[136:139], v[48:51]
  v_mfma_f32_16x16x32_bf16 v[52:55], v[184:187], a[140:143], v[52:55]
  ds_read_b128 v[148:151], v122 offset:47104
  v_mfma_f32_16x16x32_bf16 v[56:59], v[188:191], a[136:139], v[56:59]
  ds_read_b128 v[152:155], v122 offset:49152
  v_mfma_f32_16x16x32_bf16 v[60:63], v[188:191], a[140:143], v[60:63]
  buffer_load_dwordx4 v[224:227], v1, s[20:23], s43 offen offset:0 sc1
  v_mfma_f32_16x16x32_bf16 v[64:67], v[192:195], a[136:139], v[64:67]
  ds_read_b128 v[156:159], v122 offset:51200
  v_mfma_f32_16x16x32_bf16 v[68:71], v[192:195], a[140:143], v[68:71]
  v_mfma_f32_16x16x32_bf16 v[72:75], v[196:199], a[136:139], v[72:75]
  ds_read_b128 v[160:163], v122 offset:53248
  v_mfma_f32_16x16x32_bf16 v[76:79], v[196:199], a[140:143], v[76:79]
  buffer_load_dwordx4 v[228:231], v1, s[20:23], s43 offen offset:1024 sc1
  v_mfma_f32_16x16x32_bf16 v[80:83], v[200:203], a[136:139], v[80:83]
  ds_read_b128 v[164:167], v122 offset:55296
  v_mfma_f32_16x16x32_bf16 v[84:87], v[200:203], a[140:143], v[84:87]
  v_mfma_f32_16x16x32_bf16 v[88:91], v[204:207], a[136:139], v[88:91]
  v_mfma_f32_16x16x32_bf16 v[92:95], v[204:207], a[140:143], v[92:95]
  buffer_load_dwordx4 v[232:235], v1, s[20:23], s43 offen offset:2048 sc1
  s_waitcnt lgkmcnt(5)
  v_mfma_f32_16x16x32_bf16 v[16:19], v[128:131], a[144:147], v[16:19]
  ds_read_b128 v[168:171], v122 offset:37888
  v_mfma_f32_16x16x32_bf16 v[20:23], v[128:131], a[148:151], v[20:23]
  ds_read_b128 v[172:175], v122 offset:39936
  v_mfma_f32_16x16x32_bf16 v[24:27], v[132:135], a[144:147], v[24:27]
  v_mfma_f32_16x16x32_bf16 v[28:31], v[132:135], a[148:151], v[28:31]
  ds_read_b128 v[176:179], v122 offset:41984
  v_mfma_f32_16x16x32_bf16 v[32:35], v[136:139], a[144:147], v[32:35]
  buffer_load_dwordx4 v[236:239], v1, s[20:23], s43 offen offset:3072 sc1
  v_mfma_f32_16x16x32_bf16 v[36:39], v[136:139], a[148:151], v[36:39]
  ds_read_b128 v[180:183], v122 offset:44032
  v_mfma_f32_16x16x32_bf16 v[40:43], v[140:143], a[144:147], v[40:43]
  v_mfma_f32_16x16x32_bf16 v[44:47], v[140:143], a[148:151], v[44:47]
  ds_read_b128 v[184:187], v122 offset:46080
  v_mfma_f32_16x16x32_bf16 v[48:51], v[144:147], a[144:147], v[48:51]
  buffer_load_dwordx4 v[240:243], v1, s[20:23], s44 offen offset:0 sc1
  v_mfma_f32_16x16x32_bf16 v[52:55], v[144:147], a[148:151], v[52:55]
  ds_read_b128 v[188:191], v122 offset:48128
  s_waitcnt lgkmcnt(6)
  v_mfma_f32_16x16x32_bf16 v[56:59], v[148:151], a[144:147], v[56:59]
  ds_read_b128 v[192:195], v122 offset:50176
  v_mfma_f32_16x16x32_bf16 v[60:63], v[148:151], a[148:151], v[60:63]
  v_mfma_f32_16x16x32_bf16 v[64:67], v[152:155], a[144:147], v[64:67]
  ds_read_b128 v[196:199], v122 offset:52224
  v_mfma_f32_16x16x32_bf16 v[68:71], v[152:155], a[148:151], v[68:71]
  buffer_load_dwordx4 v[244:247], v1, s[20:23], s44 offen offset:1024 sc1
  v_mfma_f32_16x16x32_bf16 v[72:75], v[156:159], a[144:147], v[72:75]
  ds_read_b128 v[200:203], v122 offset:54272
  v_mfma_f32_16x16x32_bf16 v[76:79], v[156:159], a[148:151], v[76:79]
  v_mfma_f32_16x16x32_bf16 v[80:83], v[160:163], a[144:147], v[80:83]
  ds_read_b128 v[204:207], v122 offset:56320
  v_mfma_f32_16x16x32_bf16 v[84:87], v[160:163], a[148:151], v[84:87]
  buffer_load_dwordx4 a[0:3], v117, s[20:23], s60 offen offset:0 sc1
  v_mfma_f32_16x16x32_bf16 v[88:91], v[164:167], a[144:147], v[88:91]
  v_mfma_f32_16x16x32_bf16 v[92:95], v[164:167], a[148:151], v[92:95]
  s_waitcnt vmcnt(16) lgkmcnt(0)
  s_barrier
  v_mfma_f32_16x16x32_bf16 v[16:19], v[168:171], a[152:155], v[16:19]
  ds_read_b128 v[128:131], v122 offset:57344
  v_mfma_f32_16x16x32_bf16 v[20:23], v[168:171], a[156:159], v[20:23]
  ds_read_b128 v[132:135], v122 offset:59392
  v_mfma_f32_16x16x32_bf16 v[24:27], v[172:175], a[152:155], v[24:27]
  buffer_load_dwordx4 a[4:7], v117, s[20:23], s61 offen offset:0 sc1
  v_mfma_f32_16x16x32_bf16 v[28:31], v[172:175], a[156:159], v[28:31]
  ds_read_b128 v[136:139], v122 offset:61440
  v_mfma_f32_16x16x32_bf16 v[32:35], v[176:179], a[152:155], v[32:35]
  v_mfma_f32_16x16x32_bf16 v[36:39], v[176:179], a[156:159], v[36:39]
  ds_read_b128 v[140:143], v122 offset:63488
  v_mfma_f32_16x16x32_bf16 v[40:43], v[180:183], a[152:155], v[40:43]
  buffer_load_dwordx4 a[8:11], v117, s[20:23], s60 offen offset:1024 sc1
  v_mfma_f32_16x16x32_bf16 v[44:47], v[180:183], a[156:159], v[44:47]
  ds_read_b128 v[144:147], v123 offset:0
  v_mfma_f32_16x16x32_bf16 v[48:51], v[184:187], a[152:155], v[48:51]
  v_mfma_f32_16x16x32_bf16 v[52:55], v[184:187], a[156:159], v[52:55]
  ds_read_b128 v[148:151], v123 offset:2048
  v_mfma_f32_16x16x32_bf16 v[56:59], v[188:191], a[152:155], v[56:59]
  ds_read_b128 v[152:155], v123 offset:4096
  v_mfma_f32_16x16x32_bf16 v[60:63], v[188:191], a[156:159], v[60:63]
  buffer_load_dwordx4 a[12:15], v117, s[20:23], s61 offen offset:1024 sc1
  v_mfma_f32_16x16x32_bf16 v[64:67], v[192:195], a[152:155], v[64:67]
  ds_read_b128 v[156:159], v123 offset:6144
  v_mfma_f32_16x16x32_bf16 v[68:71], v[192:195], a[156:159], v[68:71]
  v_mfma_f32_16x16x32_bf16 v[72:75], v[196:199], a[152:155], v[72:75]
  ds_read_b128 v[160:163], v123 offset:8192
  v_mfma_f32_16x16x32_bf16 v[76:79], v[196:199], a[156:159], v[76:79]
  buffer_load_dwordx4 a[16:19], v117, s[20:23], s60 offen offset:2048 sc1
  v_mfma_f32_16x16x32_bf16 v[80:83], v[200:203], a[152:155], v[80:83]
  ds_read_b128 v[164:167], v123 offset:10240
  v_mfma_f32_16x16x32_bf16 v[84:87], v[200:203], a[156:159], v[84:87]
  v_mfma_f32_16x16x32_bf16 v[88:91], v[204:207], a[152:155], v[88:91]
  v_mfma_f32_16x16x32_bf16 v[92:95], v[204:207], a[156:159], v[92:95]
  buffer_load_dwordx4 a[20:23], v117, s[20:23], s61 offen offset:2048 sc1
  s_waitcnt lgkmcnt(5)
  v_mfma_f32_16x16x32_bf16 v[16:19], v[128:131], a[160:163], v[16:19]
  ds_read_b128 v[168:171], v122 offset:58368
  v_mfma_f32_16x16x32_bf16 v[20:23], v[128:131], a[164:167], v[20:23]
  ds_read_b128 v[172:175], v122 offset:60416
  v_mfma_f32_16x16x32_bf16 v[24:27], v[132:135], a[160:163], v[24:27]
  v_mfma_f32_16x16x32_bf16 v[28:31], v[132:135], a[164:167], v[28:31]
  ds_read_b128 v[176:179], v122 offset:62464
  v_mfma_f32_16x16x32_bf16 v[32:35], v[136:139], a[160:163], v[32:35]
  buffer_load_dwordx4 a[24:27], v117, s[20:23], s60 offen offset:3072 sc1
  v_mfma_f32_16x16x32_bf16 v[36:39], v[136:139], a[164:167], v[36:39]
  ds_read_b128 v[180:183], v122 offset:64512
  v_mfma_f32_16x16x32_bf16 v[40:43], v[140:143], a[160:163], v[40:43]
  v_mfma_f32_16x16x32_bf16 v[44:47], v[140:143], a[164:167], v[44:47]
  ds_read_b128 v[184:187], v123 offset:1024
  v_mfma_f32_16x16x32_bf16 v[48:51], v[144:147], a[160:163], v[48:51]
  buffer_load_dwordx4 a[28:31], v117, s[20:23], s61 offen offset:3072 sc1
  v_add_u32 v117, 4096, v117
  v_mfma_f32_16x16x32_bf16 v[52:55], v[144:147], a[164:167], v[52:55]
  ds_read_b128 v[188:191], v123 offset:3072
  s_waitcnt lgkmcnt(6)
  v_mfma_f32_16x16x32_bf16 v[56:59], v[148:151], a[160:163], v[56:59]
  ds_read_b128 v[192:195], v123 offset:5120
  v_and_b32 v117, 16383, v117
  v_mfma_f32_16x16x32_bf16 v[60:63], v[148:151], a[164:167], v[60:63]
  v_mfma_f32_16x16x32_bf16 v[64:67], v[152:155], a[160:163], v[64:67]
  ds_read_b128 v[196:199], v123 offset:7168
  v_mfma_f32_16x16x32_bf16 v[68:71], v[152:155], a[164:167], v[68:71]
  buffer_load_dwordx4 a[32:35], v117, s[20:23], s60 offen offset:0 sc1
  v_mfma_f32_16x16x32_bf16 v[72:75], v[156:159], a[160:163], v[72:75]
  ds_read_b128 v[200:203], v123 offset:9216
  v_mfma_f32_16x16x32_bf16 v[76:79], v[156:159], a[164:167], v[76:79]
  v_mfma_f32_16x16x32_bf16 v[80:83], v[160:163], a[160:163], v[80:83]
  ds_read_b128 v[204:207], v123 offset:11264
  v_mfma_f32_16x16x32_bf16 v[84:87], v[160:163], a[164:167], v[84:87]
  buffer_load_dwordx4 a[36:39], v117, s[20:23], s61 offen offset:0 sc1
  v_mfma_f32_16x16x32_bf16 v[88:91], v[164:167], a[160:163], v[88:91]
  v_mfma_f32_16x16x32_bf16 v[92:95], v[164:167], a[164:167], v[92:95]
  s_waitcnt vmcnt(20) lgkmcnt(0)
  s_barrier
  v_mfma_f32_16x16x32_bf16 v[16:19], v[168:171], a[168:171], v[16:19]
  ds_read_b128 v[128:131], v123 offset:12288
  v_mfma_f32_16x16x32_bf16 v[20:23], v[168:171], a[172:175], v[20:23]
  ds_read_b128 v[132:135], v123 offset:14336
  v_mfma_f32_16x16x32_bf16 v[24:27], v[172:175], a[168:171], v[24:27]
  buffer_load_dwordx4 a[40:43], v117, s[20:23], s60 offen offset:1024 sc1
  v_mfma_f32_16x16x32_bf16 v[28:31], v[172:175], a[172:175], v[28:31]
  ds_read_b128 v[136:139], v123 offset:16384
  v_mfma_f32_16x16x32_bf16 v[32:35], v[176:179], a[168:171], v[32:35]
  v_mfma_f32_16x16x32_bf16 v[36:39], v[176:179], a[172:175], v[36:39]
  ds_read_b128 v[140:143], v123 offset:18432
  v_mfma_f32_16x16x32_bf16 v[40:43], v[180:183], a[168:171], v[40:43]
  buffer_load_dwordx4 a[44:47], v117, s[20:23], s61 offen offset:1024 sc1
  v_mfma_f32_16x16x32_bf16 v[44:47], v[180:183], a[172:175], v[44:47]
  ds_read_b128 v[144:147], v123 offset:20480
  v_mfma_f32_16x16x32_bf16 v[48:51], v[184:187], a[168:171], v[48:51]
  v_mfma_f32_16x16x32_bf16 v[52:55], v[184:187], a[172:175], v[52:55]
  ds_read_b128 v[148:151], v123 offset:22528
  v_mfma_f32_16x16x32_bf16 v[56:59], v[188:191], a[168:171], v[56:59]
  ds_read_b128 v[152:155], v123 offset:24576
  v_mfma_f32_16x16x32_bf16 v[60:63], v[188:191], a[172:175], v[60:63]
  buffer_load_dwordx4 a[48:51], v117, s[20:23], s60 offen offset:2048 sc1
  v_mfma_f32_16x16x32_bf16 v[64:67], v[192:195], a[168:171], v[64:67]
  ds_read_b128 v[156:159], v123 offset:26624
  v_mfma_f32_16x16x32_bf16 v[68:71], v[192:195], a[172:175], v[68:71]
  v_mfma_f32_16x16x32_bf16 v[72:75], v[196:199], a[168:171], v[72:75]
  ds_read_b128 v[160:163], v123 offset:28672
  v_mfma_f32_16x16x32_bf16 v[76:79], v[196:199], a[172:175], v[76:79]
  buffer_load_dwordx4 a[52:55], v117, s[20:23], s61 offen offset:2048 sc1
  v_mfma_f32_16x16x32_bf16 v[80:83], v[200:203], a[168:171], v[80:83]
  ds_read_b128 v[164:167], v123 offset:30720
  v_mfma_f32_16x16x32_bf16 v[84:87], v[200:203], a[172:175], v[84:87]
  v_mfma_f32_16x16x32_bf16 v[88:91], v[204:207], a[168:171], v[88:91]
  v_mfma_f32_16x16x32_bf16 v[92:95], v[204:207], a[172:175], v[92:95]
  buffer_load_dwordx4 a[56:59], v117, s[20:23], s60 offen offset:3072 sc1
  s_waitcnt lgkmcnt(5)
  v_mfma_f32_16x16x32_bf16 v[16:19], v[128:131], a[176:179], v[16:19]
  ds_read_b128 v[168:171], v123 offset:13312
  v_mfma_f32_16x16x32_bf16 v[20:23], v[128:131], a[180:183], v[20:23]
  ds_read_b128 v[172:175], v123 offset:15360
  v_mfma_f32_16x16x32_bf16 v[24:27], v[132:135], a[176:179], v[24:27]
  v_mfma_f32_16x16x32_bf16 v[28:31], v[132:135], a[180:183], v[28:31]
  ds_read_b128 v[176:179], v123 offset:17408
  v_mfma_f32_16x16x32_bf16 v[32:35], v[136:139], a[176:179], v[32:35]
  buffer_load_dwordx4 a[60:63], v117, s[20:23], s61 offen offset:3072 sc1
  v_add_u32 v117, 4096, v117
  v_mfma_f32_16x16x32_bf16 v[36:39], v[136:139], a[180:183], v[36:39]
  ds_read_b128 v[180:183], v123 offset:19456
  v_and_b32 v117, 16383, v117
  v_mfma_f32_16x16x32_bf16 v[40:43], v[140:143], a[176:179], v[40:43]
  v_mfma_f32_16x16x32_bf16 v[44:47], v[140:143], a[180:183], v[44:47]
  ds_read_b128 v[184:187], v123 offset:21504
  v_mfma_f32_16x16x32_bf16 v[48:51], v[144:147], a[176:179], v[48:51]
  v_mfma_f32_16x16x32_bf16 v[52:55], v[144:147], a[180:183], v[52:55]
  ds_read_b128 v[188:191], v123 offset:23552
  s_waitcnt lgkmcnt(6)
  v_mfma_f32_16x16x32_bf16 v[56:59], v[148:151], a[176:179], v[56:59]
  ds_read_b128 v[192:195], v123 offset:25600
  v_mfma_f32_16x16x32_bf16 v[60:63], v[148:151], a[180:183], v[60:63]
  v_mfma_f32_16x16x32_bf16 v[64:67], v[152:155], a[176:179], v[64:67]
  ds_read_b128 v[196:199], v123 offset:27648
  v_mfma_f32_16x16x32_bf16 v[68:71], v[152:155], a[180:183], v[68:71]
  v_mfma_f32_16x16x32_bf16 v[72:75], v[156:159], a[176:179], v[72:75]
  ds_read_b128 v[200:203], v123 offset:29696
  v_mfma_f32_16x16x32_bf16 v[76:79], v[156:159], a[180:183], v[76:79]
  v_mfma_f32_16x16x32_bf16 v[80:83], v[160:163], a[176:179], v[80:83]
  ds_read_b128 v[204:207], v123 offset:31744
  v_mfma_f32_16x16x32_bf16 v[84:87], v[160:163], a[180:183], v[84:87]
  v_mfma_f32_16x16x32_bf16 v[88:91], v[164:167], a[176:179], v[88:91]
  v_mfma_f32_16x16x32_bf16 v[92:95], v[164:167], a[180:183], v[92:95]
  s_waitcnt lgkmcnt(5)
  v_mfma_f32_16x16x32_bf16 v[16:19], v[168:171], a[184:187], v[16:19]
  v_mfma_f32_16x16x32_bf16 v[20:23], v[168:171], a[188:191], v[20:23]
  v_mfma_f32_16x16x32_bf16 v[24:27], v[172:175], a[184:187], v[24:27]
  v_mfma_f32_16x16x32_bf16 v[28:31], v[172:175], a[188:191], v[28:31]
  v_mfma_f32_16x16x32_bf16 v[32:35], v[176:179], a[184:187], v[32:35]
  v_mfma_f32_16x16x32_bf16 v[36:39], v[176:179], a[188:191], v[36:39]
  v_mfma_f32_16x16x32_bf16 v[40:43], v[180:183], a[184:187], v[40:43]
  v_mfma_f32_16x16x32_bf16 v[44:47], v[180:183], a[188:191], v[44:47]
  v_mfma_f32_16x16x32_bf16 v[48:51], v[184:187], a[184:187], v[48:51]
  v_mfma_f32_16x16x32_bf16 v[52:55], v[184:187], a[188:191], v[52:55]
  s_waitcnt lgkmcnt(0)
  v_mfma_f32_16x16x32_bf16 v[56:59], v[188:191], a[184:187], v[56:59]
  v_mfma_f32_16x16x32_bf16 v[60:63], v[188:191], a[188:191], v[60:63]
  v_mfma_f32_16x16x32_bf16 v[64:67], v[192:195], a[184:187], v[64:67]
  v_mfma_f32_16x16x32_bf16 v[68:71], v[192:195], a[188:191], v[68:71]
  v_mfma_f32_16x16x32_bf16 v[72:75], v[196:199], a[184:187], v[72:75]
  v_mfma_f32_16x16x32_bf16 v[76:79], v[196:199], a[188:191], v[76:79]
  v_mfma_f32_16x16x32_bf16 v[80:83], v[200:203], a[184:187], v[80:83]
  v_mfma_f32_16x16x32_bf16 v[84:87], v[200:203], a[188:191], v[84:87]
  v_mfma_f32_16x16x32_bf16 v[88:91], v[204:207], a[184:187], v[88:91]
  v_mfma_f32_16x16x32_bf16 v[92:95], v[204:207], a[188:191], v[92:95]
  s_barrier
  s_lshr_b32 s32, s3, 1
  s_lshl_b32 s32, s32, 14
  s_and_b32 s33, s3, 1
  s_lshl_b32 s33, s33, 10
  s_add_u32 s32, s32, s33
  s_add_u32 s32, s32, 98304
  v_add_u32 v5, s32, v1
  v_cvt_pk_bf16_f32 v16, v16, v17
  v_cvt_pk_bf16_f32 v17, v18, v19
  ds_write_b64 v8, v[16:17] offset:0
  v_cvt_pk_bf16_f32 v24, v24, v25
  v_cvt_pk_bf16_f32 v25, v26, v27
  ds_write_b64 v8, v[24:25] offset:32
  v_cvt_pk_bf16_f32 v32, v32, v33
  v_cvt_pk_bf16_f32 v33, v34, v35
  ds_write_b64 v8, v[32:33] offset:64
  v_cvt_pk_bf16_f32 v40, v40, v41
  v_cvt_pk_bf16_f32 v41, v42, v43
  ds_write_b64 v8, v[40:41] offset:96
  v_cvt_pk_bf16_f32 v48, v48, v49
  v_cvt_pk_bf16_f32 v49, v50, v51
  ds_write_b64 v8, v[48:49] offset:128
  v_cvt_pk_bf16_f32 v56, v56, v57
  v_cvt_pk_bf16_f32 v57, v58, v59
  ds_write_b64 v8, v[56:57] offset:160
  v_cvt_pk_bf16_f32 v64, v64, v65
  v_cvt_pk_bf16_f32 v65, v66, v67
  ds_write_b64 v8, v[64:65] offset:192
  v_cvt_pk_bf16_f32 v72, v72, v73
  v_cvt_pk_bf16_f32 v73, v74, v75
  ds_write_b64 v8, v[72:73] offset:224
  v_cvt_pk_bf16_f32 v80, v80, v81
  v_cvt_pk_bf16_f32 v81, v82, v83
  ds_write_b64 v8, v[80:81] offset:256
  v_cvt_pk_bf16_f32 v88, v88, v89
  v_cvt_pk_bf16_f32 v89, v90, v91
  ds_write_b64 v8, v[88:89] offset:288
  ds_read_b128 v[128:131], v9 offset:0
  ds_read_b128 v[132:135], v9 offset:16
  ds_read_b128 v[136:139], v9 offset:32
  ds_read_b128 v[140:143], v9 offset:48
  ds_read_b128 v[144:147], v9 offset:64
  ds_read_b128 v[148:151], v9 offset:80
  ds_read_b128 v[152:155], v9 offset:96
  ds_read_b128 v[156:159], v9 offset:112
  v_cvt_pk_bf16_f32 v20, v20, v21
  v_cvt_pk_bf16_f32 v21, v22, v23
  ds_write_b64 v8, v[20:21] offset:5376
  v_cvt_pk_bf16_f32 v28, v28, v29
  v_cvt_pk_bf16_f32 v29, v30, v31
  ds_write_b64 v8, v[28:29] offset:5408
  v_cvt_pk_bf16_f32 v36, v36, v37
  v_cvt_pk_bf16_f32 v37, v38, v39
  ds_write_b64 v8, v[36:37] offset:5440
  v_cvt_pk_bf16_f32 v44, v44, v45
  v_cvt_pk_bf16_f32 v45, v46, v47
  ds_write_b64 v8, v[44:45] offset:5472
  v_cvt_pk_bf16_f32 v52, v52, v53
  v_cvt_pk_bf16_f32 v53, v54, v55
  ds_write_b64 v8, v[52:53] offset:5504
  v_cvt_pk_bf16_f32 v60, v60, v61
  v_cvt_pk_bf16_f32 v61, v62, v63
  ds_write_b64 v8, v[60:61] offset:5536
  v_cvt_pk_bf16_f32 v68, v68, v69
  v_cvt_pk_bf16_f32 v69, v70, v71
  ds_write_b64 v8, v[68:69] offset:5568
  v_cvt_pk_bf16_f32 v76, v76, v77
  v_cvt_pk_bf16_f32 v77, v78, v79
  ds_write_b64 v8, v[76:77] offset:5600
  v_cvt_pk_bf16_f32 v84, v84, v85
  v_cvt_pk_bf16_f32 v85, v86, v87
  ds_write_b64 v8, v[84:85] offset:5632
  v_cvt_pk_bf16_f32 v92, v92, v93
  v_cvt_pk_bf16_f32 v93, v94, v95
  ds_write_b64 v8, v[92:93] offset:5664
  s_waitcnt vmcnt(16)
  ds_read_b128 v[160:163], v9 offset:5376
  ds_read_b128 v[164:167], v9 offset:5392
  ds_read_b128 v[168:171], v9 offset:5408
  ds_read_b128 v[172:175], v9 offset:5424
  ds_read_b128 v[176:179], v9 offset:5440
  ds_read_b128 v[180:183], v9 offset:5456
  ds_read_b128 v[184:187], v9 offset:5472
  ds_read_b128 v[188:191], v9 offset:5488
  s_waitcnt lgkmcnt(15)
  v_mfma_f32_4x4x4_16b_bf16 v[16:19], v[208:209], v[128:129], 0
  v_mfma_f32_4x4x4_16b_bf16 v[20:23], v[208:209], v[130:131], 0
  v_mfma_f32_4x4x4_16b_bf16 v[24:27], v[208:209], v[132:133], 0
  v_mfma_f32_4x4x4_16b_bf16 v[28:31], v[208:209], v[134:135], 0
  v_mfma_f32_4x4x4_16b_bf16 v[32:35], v[208:209], v[136:137], 0
  v_mfma_f32_4x4x4_16b_bf16 v[36:39], v[208:209], v[138:139], 0
  v_mfma_f32_4x4x4_16b_bf16 v[40:43], v[208:209], v[140:141], 0
  v_mfma_f32_4x4x4_16b_bf16 v[44:47], v[208:209], v[142:143], 0
  buffer_load_dwordx4 a[64:67], v117, s[20:23], s60 offen offset:0 sc1
  v_mfma_f32_4x4x4_16b_bf16 v[16:19], v[210:211], v[130:131], v[16:19]
  v_mfma_f32_4x4x4_16b_bf16 v[20:23], v[210:211], v[132:133], v[20:23]
  v_mfma_f32_4x4x4_16b_bf16 v[24:27], v[210:211], v[134:135], v[24:27]
  v_mfma_f32_4x4x4_16b_bf16 v[28:31], v[210:211], v[136:137], v[28:31]
  v_mfma_f32_4x4x4_16b_bf16 v[32:35], v[210:211], v[138:139], v[32:35]
  v_mfma_f32_4x4x4_16b_bf16 v[36:39], v[210:211], v[140:141], v[36:39]
  v_mfma_f32_4x4x4_16b_bf16 v[40:43], v[210:211], v[142:143], v[40:43]
  v_mfma_f32_4x4x4_16b_bf16 v[44:47], v[210:211], v[144:145], v[44:47]
  buffer_load_dwordx4 a[68:71], v117, s[20:23], s61 offen offset:0 sc1
  v_mfma_f32_4x4x4_16b_bf16 v[16:19], v[212:213], v[132:133], v[16:19]
  v_mfma_f32_4x4x4_16b_bf16 v[20:23], v[212:213], v[134:135], v[20:23]
  v_mfma_f32_4x4x4_16b_bf16 v[24:27], v[212:213], v[136:137], v[24:27]
  v_mfma_f32_4x4x4_16b_bf16 v[28:31], v[212:213], v[138:139], v[28:31]
  v_mfma_f32_4x4x4_16b_bf16 v[32:35], v[212:213], v[140:141], v[32:35]
  v_mfma_f32_4x4x4_16b_bf16 v[36:39], v[212:213], v[142:143], v[36:39]
  v_mfma_f32_4x4x4_16b_bf16 v[40:43], v[212:213], v[144:145], v[40:43]
  v_mfma_f32_4x4x4_16b_bf16 v[44:47], v[212:213], v[146:147], v[44:47]
  buffer_load_dwordx4 a[72:75], v117, s[20:23], s60 offen offset:1024 sc1
  v_mfma_f32_4x4x4_16b_bf16 v[16:19], v[214:215], v[134:135], v[16:19]
  v_mfma_f32_4x4x4_16b_bf16 v[20:23], v[214:215], v[136:137], v[20:23]
  v_mfma_f32_4x4x4_16b_bf16 v[24:27], v[214:215], v[138:139], v[24:27]
  v_mfma_f32_4x4x4_16b_bf16 v[28:31], v[214:215], v[140:141], v[28:31]
  v_mfma_f32_4x4x4_16b_bf16 v[32:35], v[214:215], v[142:143], v[32:35]
  v_mfma_f32_4x4x4_16b_bf16 v[36:39], v[214:215], v[144:145], v[36:39]
  v_mfma_f32_4x4x4_16b_bf16 v[40:43], v[214:215], v[146:147], v[40:43]
  v_mfma_f32_4x4x4_16b_bf16 v[44:47], v[214:215], v[148:149], v[44:47]
  buffer_load_dwordx4 a[76:79], v117, s[20:23], s61 offen offset:1024 sc1
  v_mfma_f32_4x4x4_16b_bf16 v[16:19], v[216:217], v[136:137], v[16:19]
  v_mfma_f32_4x4x4_16b_bf16 v[20:23], v[216:217], v[138:139], v[20:23]
  v_mfma_f32_4x4x4_16b_bf16 v[24:27], v[216:217], v[140:141], v[24:27]
  v_mfma_f32_4x4x4_16b_bf16 v[28:31], v[216:217], v[142:143], v[28:31]
  v_mfma_f32_4x4x4_16b_bf16 v[32:35], v[216:217], v[144:145], v[32:35]
  v_mfma_f32_4x4x4_16b_bf16 v[36:39], v[216:217], v[146:147], v[36:39]
  v_mfma_f32_4x4x4_16b_bf16 v[40:43], v[216:217], v[148:149], v[40:43]
  v_mfma_f32_4x4x4_16b_bf16 v[44:47], v[216:217], v[150:151], v[44:47]
  buffer_load_dwordx4 a[80:83], v117, s[20:23], s60 offen offset:2048 sc1
  v_mfma_f32_4x4x4_16b_bf16 v[16:19], v[218:219], v[138:139], v[16:19]
  v_mfma_f32_4x4x4_16b_bf16 v[20:23], v[218:219], v[140:141], v[20:23]
  v_mfma_f32_4x4x4_16b_bf16 v[24:27], v[218:219], v[142:143], v[24:27]
  v_mfma_f32_4x4x4_16b_bf16 v[28:31], v[218:219], v[144:145], v[28:31]
  v_mfma_f32_4x4x4_16b_bf16 v[32:35], v[218:219], v[146:147], v[32:35]
  v_mfma_f32_4x4x4_16b_bf16 v[36:39], v[218:219], v[148:149], v[36:39]
  v_mfma_f32_4x4x4_16b_bf16 v[40:43], v[218:219], v[150:151], v[40:43]
  v_mfma_f32_4x4x4_16b_bf16 v[44:47], v[218:219], v[152:153], v[44:47]
  buffer_load_dwordx4 a[84:87], v117, s[20:23], s61 offen offset:2048 sc1
  v_mfma_f32_4x4x4_16b_bf16 v[16:19], v[220:221], v[140:141], v[16:19]
  v_mfma_f32_4x4x4_16b_bf16 v[20:23], v[220:221], v[142:143], v[20:23]
  v_mfma_f32_4x4x4_16b_bf16 v[24:27], v[220:221], v[144:145], v[24:27]
  v_mfma_f32_4x4x4_16b_bf16 v[28:31], v[220:221], v[146:147], v[28:31]
  v_mfma_f32_4x4x4_16b_bf16 v[32:35], v[220:221], v[148:149], v[32:35]
  v_mfma_f32_4x4x4_16b_bf16 v[36:39], v[220:221], v[150:151], v[36:39]
  v_mfma_f32_4x4x4_16b_bf16 v[40:43], v[220:221], v[152:153], v[40:43]
  v_mfma_f32_4x4x4_16b_bf16 v[44:47], v[220:221], v[154:155], v[44:47]
  buffer_load_dwordx4 a[88:91], v117, s[20:23], s60 offen offset:3072 sc1
  v_mfma_f32_4x4x4_16b_bf16 v[16:19], v[222:223], v[142:143], v[16:19]
  v_mfma_f32_4x4x4_16b_bf16 v[20:23], v[222:223], v[144:145], v[20:23]
  v_mfma_f32_4x4x4_16b_bf16 v[24:27], v[222:223], v[146:147], v[24:27]
  v_mfma_f32_4x4x4_16b_bf16 v[28:31], v[222:223], v[148:149], v[28:31]
  v_mfma_f32_4x4x4_16b_bf16 v[32:35], v[222:223], v[150:151], v[32:35]
  v_mfma_f32_4x4x4_16b_bf16 v[36:39], v[222:223], v[152:153], v[36:39]
  v_mfma_f32_4x4x4_16b_bf16 v[40:43], v[222:223], v[154:155], v[40:43]
  v_mfma_f32_4x4x4_16b_bf16 v[44:47], v[222:223], v[156:157], v[44:47]
  buffer_load_dwordx4 a[92:95], v117, s[20:23], s61 offen offset:3072 sc1
  v_mfma_f32_4x4x4_16b_bf16 v[16:19], v[224:225], v[144:145], v[16:19]
  v_mfma_f32_4x4x4_16b_bf16 v[20:23], v[224:225], v[146:147], v[20:23]
  v_mfma_f32_4x4x4_16b_bf16 v[24:27], v[224:225], v[148:149], v[24:27]
  v_mfma_f32_4x4x4_16b_bf16 v[28:31], v[224:225], v[150:151], v[28:31]
  v_mfma_f32_4x4x4_16b_bf16 v[32:35], v[224:225], v[152:153], v[32:35]
  v_mfma_f32_4x4x4_16b_bf16 v[36:39], v[224:225], v[154:155], v[36:39]
  v_mfma_f32_4x4x4_16b_bf16 v[40:43], v[224:225], v[156:157], v[40:43]
  v_mfma_f32_4x4x4_16b_bf16 v[44:47], v[224:225], v[158:159], v[44:47]
  v_add_u32 v117, 4096, v117
  v_mfma_f32_4x4x4_16b_bf16 v[16:19], v[226:227], v[136:137], v[16:19]
  v_mfma_f32_4x4x4_16b_bf16 v[20:23], v[226:227], v[138:139], v[20:23]
  v_mfma_f32_4x4x4_16b_bf16 v[24:27], v[226:227], v[140:141], v[24:27]
  v_mfma_f32_4x4x4_16b_bf16 v[28:31], v[226:227], v[142:143], v[28:31]
  v_mfma_f32_4x4x4_16b_bf16 v[32:35], v[226:227], v[144:145], v[32:35]
  v_mfma_f32_4x4x4_16b_bf16 v[36:39], v[226:227], v[146:147], v[36:39]
  v_mfma_f32_4x4x4_16b_bf16 v[40:43], v[226:227], v[148:149], v[40:43]
  v_mfma_f32_4x4x4_16b_bf16 v[44:47], v[226:227], v[150:151], v[44:47]
  v_and_b32 v117, 16383, v117
  s_waitcnt lgkmcnt(4)
  v_mfma_f32_4x4x4_16b_bf16 v[48:51], v[228:229], v[160:161], 0
  v_mfma_f32_4x4x4_16b_bf16 v[52:55], v[228:229], v[162:163], 0
  v_mfma_f32_4x4x4_16b_bf16 v[56:59], v[228:229], v[164:165], 0
  v_mfma_f32_4x4x4_16b_bf16 v[60:63], v[228:229], v[166:167], 0
  v_mfma_f32_4x4x4_16b_bf16 v[64:67], v[228:229], v[168:169], 0
  v_mfma_f32_4x4x4_16b_bf16 v[68:71], v[228:229], v[170:171], 0
  v_mfma_f32_4x4x4_16b_bf16 v[72:75], v[228:229], v[172:173], 0
  v_mfma_f32_4x4x4_16b_bf16 v[76:79], v[228:229], v[174:175], 0
  buffer_load_dwordx4 a[96:99], v117, s[20:23], s60 offen offset:0 sc1
  s_waitcnt lgkmcnt(3)
  v_mfma_f32_4x4x4_16b_bf16 v[48:51], v[230:231], v[162:163], v[48:51]
  v_cvt_pk_bf16_f32 v128, v16, v17
  v_mfma_f32_4x4x4_16b_bf16 v[52:55], v[230:231], v[164:165], v[52:55]
  v_mfma_f32_4x4x4_16b_bf16 v[56:59], v[230:231], v[166:167], v[56:59]
  v_cvt_pk_bf16_f32 v129, v18, v19
  v_mfma_f32_4x4x4_16b_bf16 v[60:63], v[230:231], v[168:169], v[60:63]
  v_mfma_f32_4x4x4_16b_bf16 v[64:67], v[230:231], v[170:171], v[64:67]
  v_cvt_pk_bf16_f32 v130, v20, v21
  v_mfma_f32_4x4x4_16b_bf16 v[68:71], v[230:231], v[172:173], v[68:71]
  v_mfma_f32_4x4x4_16b_bf16 v[72:75], v[230:231], v[174:175], v[72:75]
  v_cvt_pk_bf16_f32 v131, v22, v23
  v_mfma_f32_4x4x4_16b_bf16 v[76:79], v[230:231], v[176:177], v[76:79]
  buffer_load_dwordx4 a[100:103], v117, s[20:23], s61 offen offset:0 sc1
  v_mfma_f32_4x4x4_16b_bf16 v[48:51], v[232:233], v[164:165], v[48:51]
  v_cvt_pk_bf16_f32 v132, v24, v25
  v_mfma_f32_4x4x4_16b_bf16 v[52:55], v[232:233], v[166:167], v[52:55]
  v_mfma_f32_4x4x4_16b_bf16 v[56:59], v[232:233], v[168:169], v[56:59]
  v_cvt_pk_bf16_f32 v133, v26, v27
  v_mfma_f32_4x4x4_16b_bf16 v[60:63], v[232:233], v[170:171], v[60:63]
  v_mfma_f32_4x4x4_16b_bf16 v[64:67], v[232:233], v[172:173], v[64:67]
  v_cvt_pk_bf16_f32 v134, v28, v29
  v_mfma_f32_4x4x4_16b_bf16 v[68:71], v[232:233], v[174:175], v[68:71]
  v_mfma_f32_4x4x4_16b_bf16 v[72:75], v[232:233], v[176:177], v[72:75]
  v_cvt_pk_bf16_f32 v135, v30, v31
  v_mfma_f32_4x4x4_16b_bf16 v[76:79], v[232:233], v[178:179], v[76:79]
  buffer_load_dwordx4 a[104:107], v117, s[20:23], s60 offen offset:1024 sc1
  s_waitcnt lgkmcnt(2)
  v_mfma_f32_4x4x4_16b_bf16 v[48:51], v[234:235], v[166:167], v[48:51]
  v_cvt_pk_bf16_f32 v136, v32, v33
  v_mfma_f32_4x4x4_16b_bf16 v[52:55], v[234:235], v[168:169], v[52:55]
  v_mfma_f32_4x4x4_16b_bf16 v[56:59], v[234:235], v[170:171], v[56:59]
  v_cvt_pk_bf16_f32 v137, v34, v35
  v_mfma_f32_4x4x4_16b_bf16 v[60:63], v[234:235], v[172:173], v[60:63]
  v_mfma_f32_4x4x4_16b_bf16 v[64:67], v[234:235], v[174:175], v[64:67]
  v_cvt_pk_bf16_f32 v138, v36, v37
  v_mfma_f32_4x4x4_16b_bf16 v[68:71], v[234:235], v[176:177], v[68:71]
  v_mfma_f32_4x4x4_16b_bf16 v[72:75], v[234:235], v[178:179], v[72:75]
  v_cvt_pk_bf16_f32 v139, v38, v39
  v_mfma_f32_4x4x4_16b_bf16 v[76:79], v[234:235], v[180:181], v[76:79]
  buffer_load_dwordx4 a[108:111], v117, s[20:23], s61 offen offset:1024 sc1
  v_mfma_f32_4x4x4_16b_bf16 v[48:51], v[236:237], v[168:169], v[48:51]
  v_cvt_pk_bf16_f32 v140, v40, v41
  v_mfma_f32_4x4x4_16b_bf16 v[52:55], v[236:237], v[170:171], v[52:55]
  v_mfma_f32_4x4x4_16b_bf16 v[56:59], v[236:237], v[172:173], v[56:59]
  v_cvt_pk_bf16_f32 v141, v42, v43
  v_mfma_f32_4x4x4_16b_bf16 v[60:63], v[236:237], v[174:175], v[60:63]
  v_mfma_f32_4x4x4_16b_bf16 v[64:67], v[236:237], v[176:177], v[64:67]
  v_cvt_pk_bf16_f32 v142, v44, v45
  v_mfma_f32_4x4x4_16b_bf16 v[68:71], v[236:237], v[178:179], v[68:71]
  v_mfma_f32_4x4x4_16b_bf16 v[72:75], v[236:237], v[180:181], v[72:75]
  v_cvt_pk_bf16_f32 v143, v46, v47
  v_mfma_f32_4x4x4_16b_bf16 v[76:79], v[236:237], v[182:183], v[76:79]
  buffer_load_dwordx4 a[112:115], v117, s[20:23], s60 offen offset:2048 sc1
  s_waitcnt lgkmcnt(1)
  v_mfma_f32_4x4x4_16b_bf16 v[48:51], v[238:239], v[170:171], v[48:51]
  v_mfma_f32_4x4x4_16b_bf16 v[52:55], v[238:239], v[172:173], v[52:55]
  v_mfma_f32_4x4x4_16b_bf16 v[56:59], v[238:239], v[174:175], v[56:59]
  v_mfma_f32_4x4x4_16b_bf16 v[60:63], v[238:239], v[176:177], v[60:63]
  v_mfma_f32_4x4x4_16b_bf16 v[64:67], v[238:239], v[178:179], v[64:67]
  v_mfma_f32_4x4x4_16b_bf16 v[68:71], v[238:239], v[180:181], v[68:71]
  v_mfma_f32_4x4x4_16b_bf16 v[72:75], v[238:239], v[182:183], v[72:75]
  v_mfma_f32_4x4x4_16b_bf16 v[76:79], v[238:239], v[184:185], v[76:79]
  buffer_load_dwordx4 a[116:119], v117, s[20:23], s61 offen offset:2048 sc1
  ds_write_b128 v9, v[128:131] offset:0
  ds_write_b128 v9, v[132:135] offset:16
  ds_write_b128 v9, v[136:139] offset:32
  ds_write_b128 v9, v[140:143] offset:48
  v_mfma_f32_4x4x4_16b_bf16 v[48:51], v[240:241], v[172:173], v[48:51]
  v_mfma_f32_4x4x4_16b_bf16 v[52:55], v[240:241], v[174:175], v[52:55]
  v_mfma_f32_4x4x4_16b_bf16 v[56:59], v[240:241], v[176:177], v[56:59]
  v_mfma_f32_4x4x4_16b_bf16 v[60:63], v[240:241], v[178:179], v[60:63]
  v_mfma_f32_4x4x4_16b_bf16 v[64:67], v[240:241], v[180:181], v[64:67]
  v_mfma_f32_4x4x4_16b_bf16 v[68:71], v[240:241], v[182:183], v[68:71]
  v_mfma_f32_4x4x4_16b_bf16 v[72:75], v[240:241], v[184:185], v[72:75]
  v_mfma_f32_4x4x4_16b_bf16 v[76:79], v[240:241], v[186:187], v[76:79]
  buffer_load_dwordx4 a[120:123], v117, s[20:23], s60 offen offset:3072 sc1
  s_waitcnt lgkmcnt(4)
  v_mfma_f32_4x4x4_16b_bf16 v[48:51], v[242:243], v[174:175], v[48:51]
  v_mfma_f32_4x4x4_16b_bf16 v[52:55], v[242:243], v[176:177], v[52:55]
  v_mfma_f32_4x4x4_16b_bf16 v[56:59], v[242:243], v[178:179], v[56:59]
  v_mfma_f32_4x4x4_16b_bf16 v[60:63], v[242:243], v[180:181], v[60:63]
  v_mfma_f32_4x4x4_16b_bf16 v[64:67], v[242:243], v[182:183], v[64:67]
  v_mfma_f32_4x4x4_16b_bf16 v[68:71], v[242:243], v[184:185], v[68:71]
  v_mfma_f32_4x4x4_16b_bf16 v[72:75], v[242:243], v[186:187], v[72:75]
  v_mfma_f32_4x4x4_16b_bf16 v[76:79], v[242:243], v[188:189], v[76:79]
  buffer_load_dwordx4 a[124:127], v117, s[20:23], s61 offen offset:3072 sc1
  v_mfma_f32_4x4x4_16b_bf16 v[48:51], v[244:245], v[176:177], v[48:51]
  v_mfma_f32_4x4x4_16b_bf16 v[52:55], v[244:245], v[178:179], v[52:55]
  v_mfma_f32_4x4x4_16b_bf16 v[56:59], v[244:245], v[180:181], v[56:59]
  v_mfma_f32_4x4x4_16b_bf16 v[60:63], v[244:245], v[182:183], v[60:63]
  v_mfma_f32_4x4x4_16b_bf16 v[64:67], v[244:245], v[184:185], v[64:67]
  v_mfma_f32_4x4x4_16b_bf16 v[68:71], v[244:245], v[186:187], v[68:71]
  v_mfma_f32_4x4x4_16b_bf16 v[72:75], v[244:245], v[188:189], v[72:75]
  v_mfma_f32_4x4x4_16b_bf16 v[76:79], v[244:245], v[190:191], v[76:79]
  v_add_u32 v117, 4096, v117
  v_mfma_f32_4x4x4_16b_bf16 v[48:51], v[246:247], v[168:169], v[48:51]
  v_mfma_f32_4x4x4_16b_bf16 v[52:55], v[246:247], v[170:171], v[52:55]
  v_mfma_f32_4x4x4_16b_bf16 v[56:59], v[246:247], v[172:173], v[56:59]
  v_mfma_f32_4x4x4_16b_bf16 v[60:63], v[246:247], v[174:175], v[60:63]
  v_mfma_f32_4x4x4_16b_bf16 v[64:67], v[246:247], v[176:177], v[64:67]
  v_mfma_f32_4x4x4_16b_bf16 v[68:71], v[246:247], v[178:179], v[68:71]
  v_mfma_f32_4x4x4_16b_bf16 v[72:75], v[246:247], v[180:181], v[72:75]
  v_mfma_f32_4x4x4_16b_bf16 v[76:79], v[246:247], v[182:183], v[76:79]
  v_and_b32 v117, 16383, v117
  v_cvt_pk_bf16_f32 v160, v48, v49
  v_cvt_pk_bf16_f32 v161, v50, v51
  v_cvt_pk_bf16_f32 v162, v52, v53
  v_cvt_pk_bf16_f32 v163, v54, v55
  v_cvt_pk_bf16_f32 v164, v56, v57
  v_cvt_pk_bf16_f32 v165, v58, v59
  v_cvt_pk_bf16_f32 v166, v60, v61
  v_cvt_pk_bf16_f32 v167, v62, v63
  v_cvt_pk_bf16_f32 v168, v64, v65
  v_cvt_pk_bf16_f32 v169, v66, v67
  v_cvt_pk_bf16_f32 v170, v68, v69
  v_cvt_pk_bf16_f32 v171, v70, v71
  v_cvt_pk_bf16_f32 v172, v72, v73
  v_cvt_pk_bf16_f32 v173, v74, v75
  v_cvt_pk_bf16_f32 v174, v76, v77
  v_cvt_pk_bf16_f32 v175, v78, v79
  ds_write_b128 v9, v[160:163] offset:5376
  ds_write_b128 v9, v[164:167] offset:5392
  ds_write_b128 v9, v[168:171] offset:5408
  ds_write_b128 v9, v[172:175] offset:5424
  ds_read_b64_tr_b16 v[80:81], v10 offset:0
  ds_read_b64_tr_b16 v[82:83], v10 offset:5376
  ds_read_b64_tr_b16 v[84:85], v10 offset:32
  ds_read_b64_tr_b16 v[86:87], v10 offset:5408
  ds_read_b64_tr_b16 v[88:89], v10 offset:64
  ds_read_b64_tr_b16 v[90:91], v10 offset:5440
  ds_read_b64_tr_b16 v[92:93], v10 offset:96
  ds_read_b64_tr_b16 v[94:95], v10 offset:5472
  s_waitcnt lgkmcnt(4)
  ds_read_b64_tr_b16 v[96:97], v10 offset:128
  ds_read_b64_tr_b16 v[98:99], v10 offset:5504
  ds_read_b64_tr_b16 v[100:101], v10 offset:160
  ds_read_b64_tr_b16 v[102:103], v10 offset:5536
  ds_read_b64_tr_b16 v[104:105], v10 offset:192
  ds_read_b64_tr_b16 v[106:107], v10 offset:5568
  ds_read_b64_tr_b16 v[108:109], v10 offset:224
  ds_read_b64_tr_b16 v[110:111], v10 offset:5600
  s_lshl_b32 s40, s28, 18
  s_lshl_b32 s41, s31, 10
  s_add_u32 s40, s40, s41
  s_add_u32 s40, s40, 33816576
  buffer_store_dwordx4 v[80:83], v1, s[20:23], s40 offen sc1
  s_add_u32 s40, s40, 32768
  buffer_store_dwordx4 v[84:87], v1, s[20:23], s40 offen sc1
  s_add_u32 s40, s40, 32768
  s_waitcnt lgkmcnt(10)
  buffer_store_dwordx4 v[88:91], v1, s[20:23], s40 offen sc1
  s_add_u32 s40, s40, 32768
  s_waitcnt lgkmcnt(8)
  buffer_store_dwordx4 v[92:95], v1, s[20:23], s40 offen sc1
  s_add_u32 s40, s40, 32768
  s_waitcnt lgkmcnt(6)
  buffer_store_dwordx4 v[96:99], v1, s[20:23], s40 offen sc1
  s_add_u32 s40, s40, 32768
  s_waitcnt lgkmcnt(4)
  buffer_store_dwordx4 v[100:103], v1, s[20:23], s40 offen sc1
  s_add_u32 s40, s40, 32768
  s_waitcnt lgkmcnt(2)
  buffer_store_dwordx4 v[104:107], v1, s[20:23], s40 offen sc1
  s_add_u32 s40, s40, 32768
  s_waitcnt lgkmcnt(0)
  buffer_store_dwordx4 v[108:111], v1, s[20:23], s40 offen sc1
  s_add_u32 s40, s40, 32768
  ds_write_b128 v5, v[80:83] offset:0
  ds_write_b128 v5, v[84:87] offset:2048
  ds_write_b128 v5, v[88:91] offset:4096
  ds_write_b128 v5, v[92:95] offset:6144
  ds_write_b128 v5, v[96:99] offset:8192
  ds_write_b128 v5, v[100:103] offset:10240
  ds_write_b128 v5, v[104:107] offset:12288
  ds_write_b128 v5, v[108:111] offset:14336
  v_lshrrev_b32 v6, 4, v0
  s_lshr_b32 s33, s28, 5
  s_and_b32 s34, s28, 31
  s_lshl_b32 s34, s34, 7
  s_mul_i32 s33, s33, 4000
  s_waitcnt vmcnt(0)
  s_waitcnt lgkmcnt(0)
  s_barrier
  v_mov_b32 v12, 4
  s_add_u32 s26, s24, 49152
  s_cmp_eq_u32 s3, 0
  s_cselect_b32 s26, s26, 2130706432
  s_mov_b64 exec, 1
  buffer_atomic_add v12, off, s[20:23], s26 sc1
  s_mov_b64 exec, -1
  ds_read_b128 v[128:131], v118 offset:32768
  ds_read_b128 v[132:135], v118 offset:34816
  ds_read_b128 v[136:139], v118 offset:36864
  ds_read_b128 v[140:143], v118 offset:38912
  ds_read_b128 v[144:147], v118 offset:40960
  ds_read_b128 v[148:151], v118 offset:43008
  ds_read_b128 v[152:155], v118 offset:45056
  ds_read_b128 v[156:159], v118 offset:47104
  s_waitcnt lgkmcnt(4)
  v_mfma_f32_16x16x32_bf16 a[192:195], a[0:3], v[128:131], a[192:195]
  ds_read_b128 v[160:163], v118 offset:33792
  v_mfma_f32_16x16x32_bf16 a[196:199], a[4:7], v[128:131], a[196:199]
  ds_read_b128 v[164:167], v118 offset:35840
  v_mfma_f32_16x16x32_bf16 a[200:203], a[0:3], v[132:135], a[200:203]
  v_mfma_f32_16x16x32_bf16 a[204:207], a[4:7], v[132:135], a[204:207]
  ds_read_b128 v[168:171], v118 offset:37888
  v_mfma_f32_16x16x32_bf16 a[208:211], a[0:3], v[136:139], a[208:211]
  v_mfma_f32_16x16x32_bf16 a[212:215], a[4:7], v[136:139], a[212:215]
  ds_read_b128 v[172:175], v118 offset:39936
  v_mfma_f32_16x16x32_bf16 a[216:219], a[0:3], v[140:143], a[216:219]
  v_mfma_f32_16x16x32_bf16 a[220:223], a[4:7], v[140:143], a[220:223]
  ds_read_b128 v[176:179], v118 offset:41984
  s_waitcnt lgkmcnt(5)
  v_mfma_f32_16x16x32_bf16 a[224:227], a[0:3], v[144:147], a[224:227]
  ds_read_b128 v[180:183], v118 offset:44032
  v_mfma_f32_16x16x32_bf16 a[228:231], a[4:7], v[144:147], a[228:231]
  v_mfma_f32_16x16x32_bf16 a[232:235], a[0:3], v[148:151], a[232:235]
  ds_read_b128 v[184:187], v118 offset:46080
  v_mfma_f32_16x16x32_bf16 a[236:239], a[4:7], v[148:151], a[236:239]
  v_mfma_f32_16x16x32_bf16 a[240:243], a[0:3], v[152:155], a[240:243]
  ds_read_b128 v[188:191], v118 offset:48128
  v_mfma_f32_16x16x32_bf16 a[244:247], a[4:7], v[152:155], a[244:247]
  v_mfma_f32_16x16x32_bf16 a[248:251], a[0:3], v[156:159], a[248:251]
  v_mfma_f32_16x16x32_bf16 a[252:255], a[4:7], v[156:159], a[252:255]
  s_waitcnt lgkmcnt(0)
  s_barrier
  v_mfma_f32_16x16x32_bf16 a[192:195], a[8:11], v[160:163], a[192:195]
  ds_read_b128 v[128:131], v118 offset:49152
  v_mfma_f32_16x16x32_bf16 a[196:199], a[12:15], v[160:163], a[196:199]
  ds_read_b128 v[132:135], v118 offset:51200
  v_mfma_f32_16x16x32_bf16 a[200:203], a[8:11], v[164:167], a[200:203]
  v_mfma_f32_16x16x32_bf16 a[204:207], a[12:15], v[164:167], a[204:207]
  ds_read_b128 v[136:139], v118 offset:53248
  v_mfma_f32_16x16x32_bf16 a[208:211], a[8:11], v[168:171], a[208:211]
  v_mfma_f32_16x16x32_bf16 a[212:215], a[12:15], v[168:171], a[212:215]
  ds_read_b128 v[140:143], v118 offset:55296
  v_mfma_f32_16x16x32_bf16 a[216:219], a[8:11], v[172:175], a[216:219]
  v_mfma_f32_16x16x32_bf16 a[220:223], a[12:15], v[172:175], a[220:223]
  ds_read_b128 v[144:147], v118 offset:57344
  v_mfma_f32_16x16x32_bf16 a[224:227], a[8:11], v[176:179], a[224:227]
  ds_read_b128 v[148:151], v118 offset:59392
  v_mfma_f32_16x16x32_bf16 a[228:231], a[12:15], v[176:179], a[228:231]
  v_mfma_f32_16x16x32_bf16 a[232:235], a[8:11], v[180:183], a[232:235]
  ds_read_b128 v[152:155], v118 offset:61440
  v_mfma_f32_16x16x32_bf16 a[236:239], a[12:15], v[180:183], a[236:239]
  v_mfma_f32_16x16x32_bf16 a[240:243], a[8:11], v[184:187], a[240:243]
  ds_read_b128 v[156:159], v118 offset:63488
  v_mfma_f32_16x16x32_bf16 a[244:247], a[12:15], v[184:187], a[244:247]
  v_mfma_f32_16x16x32_bf16 a[248:251], a[8:11], v[188:191], a[248:251]
  v_mfma_f32_16x16x32_bf16 a[252:255], a[12:15], v[188:191], a[252:255]
  s_waitcnt lgkmcnt(4)
  v_mfma_f32_16x16x32_bf16 a[192:195], a[16:19], v[128:131], a[192:195]
  ds_read_b128 v[160:163], v118 offset:50176
  v_mfma_f32_16x16x32_bf16 a[196:199], a[20:23], v[128:131], a[196:199]
  ds_read_b128 v[164:167], v118 offset:52224
  v_mfma_f32_16x16x32_bf16 a[200:203], a[16:19], v[132:135], a[200:203]
  s_add_u32 s27, s24, 49152
  s_cmp_eq_u32 s3, 0
  s_cselect_b32 s27, s27, 2130706432
  buffer_load_dword v13, off, s[20:23], s27 sc1
  v_mfma_f32_16x16x32_bf16 a[204:207], a[20:23], v[132:135], a[204:207]
  ds_read_b128 v[168:171], v118 offset:54272
  v_mfma_f32_16x16x32_bf16 a[208:211], a[16:19], v[136:139], a[208:211]
  v_mfma_f32_16x16x32_bf16 a[212:215], a[20:23], v[136:139], a[212:215]
  ds_read_b128 v[172:175], v118 offset:56320
  v_mfma_f32_16x16x32_bf16 a[216:219], a[16:19], v[140:143], a[216:219]
  v_mfma_f32_16x16x32_bf16 a[220:223], a[20:23], v[140:143], a[220:223]
  ds_read_b128 v[176:179], v118 offset:58368
  s_waitcnt lgkmcnt(5)
  v_mfma_f32_16x16x32_bf16 a[224:227], a[16:19], v[144:147], a[224:227]
  ds_read_b128 v[180:183], v118 offset:60416
  v_mfma_f32_16x16x32_bf16 a[228:231], a[20:23], v[144:147], a[228:231]
  v_mfma_f32_16x16x32_bf16 a[232:235], a[16:19], v[148:151], a[232:235]
  ds_read_b128 v[184:187], v118 offset:62464
  v_mfma_f32_16x16x32_bf16 a[236:239], a[20:23], v[148:151], a[236:239]
  v_mfma_f32_16x16x32_bf16 a[240:243], a[16:19], v[152:155], a[240:243]
  ds_read_b128 v[188:191], v118 offset:64512
  v_mfma_f32_16x16x32_bf16 a[244:247], a[20:23], v[152:155], a[244:247]
  v_mfma_f32_16x16x32_bf16 a[248:251], a[16:19], v[156:159], a[248:251]
  v_mfma_f32_16x16x32_bf16 a[252:255], a[20:23], v[156:159], a[252:255]
  s_waitcnt lgkmcnt(4)
  v_mfma_f32_16x16x32_bf16 a[192:195], a[24:27], v[160:163], a[192:195]
  v_mfma_f32_16x16x32_bf16 a[196:199], a[28:31], v[160:163], a[196:199]
  v_mfma_f32_16x16x32_bf16 a[200:203], a[24:27], v[164:167], a[200:203]
  v_mfma_f32_16x16x32_bf16 a[204:207], a[28:31], v[164:167], a[204:207]
  v_mfma_f32_16x16x32_bf16 a[208:211], a[24:27], v[168:171], a[208:211]
  v_mfma_f32_16x16x32_bf16 a[212:215], a[28:31], v[168:171], a[212:215]
  v_mfma_f32_16x16x32_bf16 a[216:219], a[24:27], v[172:175], a[216:219]
  v_mfma_f32_16x16x32_bf16 a[220:223], a[28:31], v[172:175], a[220:223]
  s_waitcnt lgkmcnt(0)
  v_mfma_f32_16x16x32_bf16 a[224:227], a[24:27], v[176:179], a[224:227]
  v_mfma_f32_16x16x32_bf16 a[228:231], a[28:31], v[176:179], a[228:231]
  v_mfma_f32_16x16x32_bf16 a[232:235], a[24:27], v[180:183], a[232:235]
  v_mfma_f32_16x16x32_bf16 a[236:239], a[28:31], v[180:183], a[236:239]
  v_mfma_f32_16x16x32_bf16 a[240:243], a[24:27], v[184:187], a[240:243]
  v_mfma_f32_16x16x32_bf16 a[244:247], a[28:31], v[184:187], a[244:247]
  v_mfma_f32_16x16x32_bf16 a[248:251], a[24:27], v[188:191], a[248:251]
  v_mfma_f32_16x16x32_bf16 a[252:255], a[28:31], v[188:191], a[252:255]
  v_and_b32 v8, 15, v0
  v_mul_u32_u24 v9, 272, v8
  v_lshl_add_u32 v9, v6, 4, v9
  s_lshl_b32 s36, s3, 6
  s_add_u32 s36, s36, 98304
  v_add_u32 v9, s36, v9
  v_mul_u32_u24 v10, 272, v6
  v_lshl_add_u32 v10, v8, 4, v10
  s_mul_i32 s36, s3, 8704
  s_add_u32 s36, s36, 98304
  v_add_u32 v10, s36, v10
  v_lshlrev_b32 v11, 10, v6
  v_lshl_add_u32 v11, v8, 4, v11
  s_lshl_b32 s36, s3, 5
  s_add_u32 s36, s36, s34
  s_add_u32 s37, s36, s33
  s_lshl_b32 s37, s37, 10
  s_lshl_b32 s35, s30, 8
  s_add_u32 s37, s37, s35
  s_cmp_lt_u32 s36, 4000
  s_cselect_b32 s38, s37, 0x40000000
  s_cmp_lg_u32 s3, 0
  s_cbranch_scc1 POK_29
  s_waitcnt vmcnt(0)
PLP_30:
  v_cmp_le_u32 vcc, 16, v13
  s_cmp_eq_u64 vcc, -1
  s_cbranch_scc1 POK_29
  buffer_load_dword v13, off, s[20:23], s27 sc1
  s_sub_u32 s25, s25, 1
  s_waitcnt vmcnt(0)
  s_cbranch_scc0 PLP_30
  s_endpgm
POK_29:
  s_barrier
  s_add_u32 m0, s50, 0
  s_nop 0
  buffer_load_dwordx4 v116, s[20:23], s52 offen sc1 lds
  s_add_u32 m0, s50, 1024
  s_nop 0
  buffer_load_dwordx4 v116, s[20:23], s53 offen sc1 lds
  s_add_u32 m0, s50, 2048
  s_nop 0
  buffer_load_dwordx4 v116, s[20:23], s54 offen sc1 lds
  s_add_u32 m0, s50, 3072
  s_nop 0
  buffer_load_dwordx4 v116, s[20:23], s55 offen sc1 lds
  v_add_u32 v116, 2048, v116
  v_and_b32 v116, 16383, v116
  s_add_u32 m0, s50, 16384
  s_nop 0
  buffer_load_dwordx4 v116, s[20:23], s52 offen sc1 lds
  s_add_u32 m0, s50, 17408
  s_nop 0
  buffer_load_dwordx4 v116, s[20:23], s53 offen sc1 lds
  s_add_u32 m0, s50, 18432
  s_nop 0
  buffer_load_dwordx4 v116, s[20:23], s54 offen sc1 lds
  s_add_u32 m0, s50, 19456
  s_nop 0
  buffer_load_dwordx4 v116, s[20:23], s55 offen sc1 lds
  v_add_u32 v116, 2048, v116
  v_and_b32 v116, 16383, v116
  s_add_u32 m0, s50, 32768
  s_nop 0
  buffer_load_dwordx4 v116, s[20:23], s52 offen sc1 lds
  s_add_u32 m0, s50, 33792
  s_nop 0
  buffer_load_dwordx4 v116, s[20:23], s53 offen sc1 lds
  s_add_u32 m0, s50, 34816
  s_nop 0
  buffer_load_dwordx4 v116, s[20:23], s54 offen sc1 lds
  s_add_u32 m0, s50, 35840
  s_nop 0
  buffer_load_dwordx4 v116, s[20:23], s55 offen sc1 lds
  v_add_u32 v116, 2048, v116
  v_and_b32 v116, 16383, v116
  s_waitcnt vmcnt(8)
  s_barrier
  ds_read_b128 v[128:131], v1 offset:0
  ds_read_b128 v[132:135], v1 offset:2048
  ds_read_b128 v[136:139], v1 offset:4096
  ds_read_b128 v[140:143], v1 offset:6144
  ds_read_b128 v[144:147], v1 offset:8192
  ds_read_b128 v[148:151], v1 offset:10240
  ds_read_b128 v[152:155], v1 offset:12288
  ds_read_b128 v[156:159], v1 offset:14336
  s_waitcnt lgkmcnt(4)
  v_mfma_f32_16x16x32_bf16 a[192:195], a[32:35], v[128:131], a[192:195]
  ds_read_b128 v[160:163], v1 offset:1024
  s_add_u32 m0, s50, 49152
  v_mfma_f32_16x16x32_bf16 a[196:199], a[36:39], v[128:131], a[196:199]
  ds_read_b128 v[164:167], v1 offset:3072
  v_mfma_f32_16x16x32_bf16 a[200:203], a[32:35], v[132:135], a[200:203]
  buffer_load_dwordx4 v116, s[20:23], s52 offen sc1 lds
  s_add_u32 m0, s50, 50176
  v_mfma_f32_16x16x32_bf16 a[204:207], a[36:39], v[132:135], a[204:207]
  ds_read_b128 v[168:171], v1 offset:5120
  v_mfma_f32_16x16x32_bf16 a[208:211], a[32:35], v[136:139], a[208:211]
  v_mfma_f32_16x16x32_bf16 a[212:215], a[36:39], v[136:139], a[212:215]
  ds_read_b128 v[172:175], v1 offset:7168
  v_mfma_f32_16x16x32_bf16 a[216:219], a[32:35], v[140:143], a[216:219]
  buffer_load_dwordx4 v116, s[20:23], s53 offen sc1 lds
  s_add_u32 m0, s50, 51200
  v_mfma_f32_16x16x32_bf16 a[220:223], a[36:39], v[140:143], a[220:223]
  ds_read_b128 v[176:179], v1 offset:9216
  s_waitcnt lgkmcnt(5)
  v_mfma_f32_16x16x32_bf16 a[224:227], a[32:35], v[144:147], a[224:227]
  ds_read_b128 v[180:183], v1 offset:11264
  v_mfma_f32_16x16x32_bf16 a[228:231], a[36:39], v[144:147], a[228:231]
  v_mfma_f32_16x16x32_bf16 a[232:235], a[32:35], v[148:151], a[232:235]
  ds_read_b128 v[184:187], v1 offset:13312
  v_mfma_f32_16x16x32_bf16 a[236:239], a[36:39], v[148:151], a[236:239]
  buffer_load_dwordx4 v116, s[20:23], s54 offen sc1 lds
  s_add_u32 m0, s50, 52224
  v_mfma_f32_16x16x32_bf16 a[240:243], a[32:35], v[152:155], a[240:243]
  ds_read_b128 v[188:191], v1 offset:15360
  v_mfma_f32_16x16x32_bf16 a[244:247], a[36:39], v[152:155], a[244:247]
  v_mfma_f32_16x16x32_bf16 a[248:251], a[32:35], v[156:159], a[248:251]
  v_mfma_f32_16x16x32_bf16 a[252:255], a[36:39], v[156:159], a[252:255]
  s_waitcnt vmcnt(7) lgkmcnt(0)
  s_barrier
  v_mfma_f32_16x16x32_bf16 a[192:195], a[40:43], v[160:163], a[192:195]
  ds_read_b128 v[128:131], v1 offset:16384
  v_mfma_f32_16x16x32_bf16 a[196:199], a[44:47], v[160:163], a[196:199]
  ds_read_b128 v[132:135], v1 offset:18432
  v_mfma_f32_16x16x32_bf16 a[200:203], a[40:43], v[164:167], a[200:203]
  buffer_load_dwordx4 v116, s[20:23], s55 offen sc1 lds
  v_add_u32 v116, 2048, v116
  v_mfma_f32_16x16x32_bf16 a[204:207], a[44:47], v[164:167], a[204:207]
  ds_read_b128 v[136:139], v1 offset:20480
  v_and_b32 v116, 16383, v116
  v_mfma_f32_16x16x32_bf16 a[208:211], a[40:43], v[168:171], a[208:211]
  s_add_u32 m0, s50, 65536
  v_mfma_f32_16x16x32_bf16 a[212:215], a[44:47], v[168:171], a[212:215]
  ds_read_b128 v[140:143], v1 offset:22528
  v_mfma_f32_16x16x32_bf16 a[216:219], a[40:43], v[172:175], a[216:219]
  buffer_load_dwordx4 v116, s[20:23], s52 offen sc1 lds
  s_add_u32 m0, s50, 66560
  v_mfma_f32_16x16x32_bf16 a[220:223], a[44:47], v[172:175], a[220:223]
  ds_read_b128 v[144:147], v1 offset:24576
  v_mfma_f32_16x16x32_bf16 a[224:227], a[40:43], v[176:179], a[224:227]
  ds_read_b128 v[148:151], v1 offset:26624
  v_mfma_f32_16x16x32_bf16 a[228:231], a[44:47], v[176:179], a[228:231]
  v_mfma_f32_16x16x32_bf16 a[232:235], a[40:43], v[180:183], a[232:235]
  ds_read_b128 v[152:155], v1 offset:28672
  v_mfma_f32_16x16x32_bf16 a[236:239], a[44:47], v[180:183], a[236:239]
  buffer_load_dwordx4 v116, s[20:23], s53 offen sc1 lds
  s_add_u32 m0, s50, 67584
  v_mfma_f32_16x16x32_bf16 a[240:243], a[40:43], v[184:187], a[240:243]
  ds_read_b128 v[156:159], v1 offset:30720
  v_mfma_f32_16x16x32_bf16 a[244:247], a[44:47], v[184:187], a[244:247]
  v_mfma_f32_16x16x32_bf16 a[248:251], a[40:43], v[188:191], a[248:251]
  v_mfma_f32_16x16x32_bf16 a[252:255], a[44:47], v[188:191], a[252:255]
  buffer_load_dwordx4 v116, s[20:23], s54 offen sc1 lds
  s_waitcnt lgkmcnt(4)
  v_mfma_f32_16x16x32_bf16 a[192:195], a[48:51], v[128:131], a[192:195]
  ds_read_b128 v[160:163], v1 offset:17408
  s_add_u32 m0, s50, 68608
  v_mfma_f32_16x16x32_bf16 a[196:199], a[52:55], v[128:131], a[196:199]
  ds_read_b128 v[164:167], v1 offset:19456
  v_mfma_f32_16x16x32_bf16 a[200:203], a[48:51], v[132:135], a[200:203]
  v_mfma_f32_16x16x32_bf16 a[204:207], a[52:55], v[132:135], a[204:207]
  ds_read_b128 v[168:171], v1 offset:21504
  v_mfma_f32_16x16x32_bf16 a[208:211], a[48:51], v[136:139], a[208:211]
  buffer_load_dwordx4 v116, s[20:23], s55 offen sc1 lds
  v_add_u32 v116, 2048, v116
  v_mfma_f32_16x16x32_bf16 a[212:215], a[52:55], v[136:139], a[212:215]
  ds_read_b128 v[172:175], v1 offset:23552
  v_and_b32 v116, 16383, v116
  v_mfma_f32_16x16x32_bf16 a[216:219], a[48:51], v[140:143], a[216:219]
  s_add_u32 m0, s50, 81920
  v_mfma_f32_16x16x32_bf16 a[220:223], a[52:55], v[140:143], a[220:223]
  ds_read_b128 v[176:179], v1 offset:25600
  s_waitcnt lgkmcnt(5)
  v_mfma_f32_16x16x32_bf16 a[224:227], a[48:51], v[144:147], a[224:227]
  ds_read_b128 v[180:183], v1 offset:27648
  v_mfma_f32_16x16x32_bf16 a[228:231], a[52:55], v[144:147], a[228:231]
  buffer_load_dwordx4 v116, s[20:23], s52 offen sc1 lds
  s_add_u32 m0, s50, 82944
  v_mfma_f32_16x16x32_bf16 a[232:235], a[48:51], v[148:151], a[232:235]
  ds_read_b128 v[184:187], v1 offset:29696
  v_mfma_f32_16x16x32_bf16 a[236:239], a[52:55], v[148:151], a[236:239]
  v_mfma_f32_16x16x32_bf16 a[240:243], a[48:51], v[152:155], a[240:243]
  ds_read_b128 v[188:191], v1 offset:31744
  v_mfma_f32_16x16x32_bf16 a[244:247], a[52:55], v[152:155], a[244:247]
  buffer_load_dwordx4 v116, s[20:23], s53 offen sc1 lds
  s_add_u32 m0, s50, 83968
  v_mfma_f32_16x16x32_bf16 a[248:251], a[48:51], v[156:159], a[248:251]
  v_mfma_f32_16x16x32_bf16 a[252:255], a[52:55], v[156:159], a[252:255]
  s_waitcnt vmcnt(10) lgkmcnt(0)
  s_barrier
  v_mfma_f32_16x16x32_bf16 a[192:195], a[56:59], v[160:163], a[192:195]
  ds_read_b128 v[128:131], v1 offset:32768
  v_mfma_f32_16x16x32_bf16 a[196:199], a[60:63], v[160:163], a[196:199]
  ds_read_b128 v[132:135], v1 offset:34816
  v_mfma_f32_16x16x32_bf16 a[200:203], a[56:59], v[164:167], a[200:203]
  buffer_load_dwordx4 v116, s[20:23], s54 offen sc1 lds
  s_add_u32 m0, s50, 84992
  v_mfma_f32_16x16x32_bf16 a[204:207], a[60:63], v[164:167], a[204:207]
  ds_read_b128 v[136:139], v1 offset:36864
  v_mfma_f32_16x16x32_bf16 a[208:211], a[56:59], v[168:171], a[208:211]
  v_mfma_f32_16x16x32_bf16 a[212:215], a[60:63], v[168:171], a[212:215]
  ds_read_b128 v[140:143], v1 offset:38912
  v_mfma_f32_16x16x32_bf16 a[216:219], a[56:59], v[172:175], a[216:219]
  buffer_load_dwordx4 v116, s[20:23], s55 offen sc1 lds
  v_add_u32 v116, 2048, v116
  v_mfma_f32_16x16x32_bf16 a[220:223], a[60:63], v[172:175], a[220:223]
  ds_read_b128 v[144:147], v1 offset:40960
  v_mfma_f32_16x16x32_bf16 a[224:227], a[56:59], v[176:179], a[224:227]
  ds_read_b128 v[148:151], v1 offset:43008
  v_and_b32 v116, 16383, v116
  v_mfma_f32_16x16x32_bf16 a[228:231], a[60:63], v[176:179], a[228:231]
  v_mfma_f32_16x16x32_bf16 a[232:235], a[56:59], v[180:183], a[232:235]
  ds_read_b128 v[152:155], v1 offset:45056
  v_mfma_f32_16x16x32_bf16 a[236:239], a[60:63], v[180:183], a[236:239]
  v_mfma_f32_16x16x32_bf16 a[240:243], a[56:59], v[184:187], a[240:243]
  ds_read_b128 v[156:159], v1 offset:47104
  v_mfma_f32_16x16x32_bf16 a[244:247], a[60:63], v[184:187], a[244:247]
  v_mfma_f32_16x16x32_bf16 a[248:251], a[56:59], v[188:191], a[248:251]
  v_mfma_f32_16x16x32_bf16 a[252:255], a[60:63], v[188:191], a[252:255]
  s_waitcnt lgkmcnt(4)
  v_mfma_f32_16x16x32_bf16 a[192:195], a[64:67], v[128:131], a[192:195]
  ds_read_b128 v[160:163], v1 offset:33792
  v_mfma_f32_16x16x32_bf16 a[196:199], a[68:71], v[128:131], a[196:199]
  ds_read_b128 v[164:167], v1 offset:35840
  v_mfma_f32_16x16x32_bf16 a[200:203], a[64:67], v[132:135], a[200:203]
  v_mfma_f32_16x16x32_bf16 a[204:207], a[68:71], v[132:135], a[204:207]
  ds_read_b128 v[168:171], v1 offset:37888
  v_mfma_f32_16x16x32_bf16 a[208:211], a[64:67], v[136:139], a[208:211]
  v_mfma_f32_16x16x32_bf16 a[212:215], a[68:71], v[136:139], a[212:215]
  ds_read_b128 v[172:175], v1 offset:39936
  v_mfma_f32_16x16x32_bf16 a[216:219], a[64:67], v[140:143], a[216:219]
  v_mfma_f32_16x16x32_bf16 a[220:223], a[68:71], v[140:143], a[220:223]
  ds_read_b128 v[176:179], v1 offset:41984
  s_waitcnt lgkmcnt(5)
  v_mfma_f32_16x16x32_bf16 a[224:227], a[64:67], v[144:147], a[224:227]
  ds_read_b128 v[180:183], v1 offset:44032
  v_mfma_f32_16x16x32_bf16 a[228:231], a[68:71], v[144:147], a[228:231]
  v_mfma_f32_16x16x32_bf16 a[232:235], a[64:67], v[148:151], a[232:235]
  ds_read_b128 v[184:187], v1 offset:46080
  v_mfma_f32_16x16x32_bf16 a[236:239], a[68:71], v[148:151], a[236:239]
  v_mfma_f32_16x16x32_bf16 a[240:243], a[64:67], v[152:155], a[240:243]
  ds_read_b128 v[188:191], v1 offset:48128
  v_mfma_f32_16x16x32_bf16 a[244:247], a[68:71], v[152:155], a[244:247]
  v_mfma_f32_16x16x32_bf16 a[248:251], a[64:67], v[156:159], a[248:251]
  v_mfma_f32_16x16x32_bf16 a[252:255], a[68:71], v[156:159], a[252:255]
  s_waitcnt vmcnt(8) lgkmcnt(0)
  s_barrier
  v_mfma_f32_16x16x32_bf16 a[192:195], a[72:75], v[160:163], a[192:195]
  ds_read_b128 v[128:131], v1 offset:49152
  v_mfma_f32_16x16x32_bf16 a[196:199], a[76:79], v[160:163], a[196:199]
  ds_read_b128 v[132:135], v1 offset:51200
  v_mfma_f32_16x16x32_bf16 a[200:203], a[72:75], v[164:167], a[200:203]
  v_mfma_f32_16x16x32_bf16 a[204:207], a[76:79], v[164:167], a[204:207]
  ds_read_b128 v[136:139], v1 offset:53248
  v_mfma_f32_16x16x32_bf16 a[208:211], a[72:75], v[168:171], a[208:211]
  v_mfma_f32_16x16x32_bf16 a[212:215], a[76:79], v[168:171], a[212:215]
  ds_read_b128 v[140:143], v1 offset:55296
  v_mfma_f32_16x16x32_bf16 a[216:219], a[72:75], v[172:175], a[216:219]
  v_mfma_f32_16x16x32_bf16 a[220:223], a[76:79], v[172:175], a[220:223]
  ds_read_b128 v[144:147], v1 offset:57344
  v_mfma_f32_16x16x32_bf16 a[224:227], a[72:75], v[176:179], a[224:227]
  ds_read_b128 v[148:151], v1 offset:59392
  v_mfma_f32_16x16x32_bf16 a[228:231], a[76:79], v[176:179], a[228:231]
  v_mfma_f32_16x16x32_bf16 a[232:235], a[72:75], v[180:183], a[232:235]
  ds_read_b128 v[152:155], v1 offset:61440
  v_mfma_f32_16x16x32_bf16 a[236:239], a[76:79], v[180:183], a[236:239]
  v_mfma_f32_16x16x32_bf16 a[240:243], a[72:75], v[184:187], a[240:243]
  ds_read_b128 v[156:159], v1 offset:63488
  v_mfma_f32_16x16x32_bf16 a[244:247], a[76:79], v[184:187], a[244:247]
  v_mfma_f32_16x16x32_bf16 a[248:251], a[72:75], v[188:191], a[248:251]
  v_mfma_f32_16x16x32_bf16 a[252:255], a[76:79], v[188:191], a[252:255]
  s_waitcnt lgkmcnt(4)
  v_mfma_f32_16x16x32_bf16 a[192:195], a[80:83], v[128:131], a[192:195]
  ds_read_b128 v[160:163], v1 offset:50176
  v_mfma_f32_16x16x32_bf16 a[196:199], a[84:87], v[128:131], a[196:199]
  ds_read_b128 v[164:167], v1 offset:52224
  v_mfma_f32_16x16x32_bf16 a[200:203], a[80:83], v[132:135], a[200:203]
  v_mfma_f32_16x16x32_bf16 a[204:207], a[84:87], v[132:135], a[204:207]
  ds_read_b128 v[168:171], v1 offset:54272
  v_mfma_f32_16x16x32_bf16 a[208:211], a[80:83], v[136:139], a[208:211]
  v_mfma_f32_16x16x32_bf16 a[212:215], a[84:87], v[136:139], a[212:215]
  ds_read_b128 v[172:175], v1 offset:56320
  v_mfma_f32_16x16x32_bf16 a[216:219], a[80:83], v[140:143], a[216:219]
  v_mfma_f32_16x16x32_bf16 a[220:223], a[84:87], v[140:143], a[220:223]
  ds_read_b128 v[176:179], v1 offset:58368
  s_waitcnt lgkmcnt(5)
  v_mfma_f32_16x16x32_bf16 a[224:227], a[80:83], v[144:147], a[224:227]
  ds_read_b128 v[180:183], v1 offset:60416
  v_mfma_f32_16x16x32_bf16 a[228:231], a[84:87], v[144:147], a[228:231]
  v_mfma_f32_16x16x32_bf16 a[232:235], a[80:83], v[148:151], a[232:235]
  ds_read_b128 v[184:187], v1 offset:62464
  v_mfma_f32_16x16x32_bf16 a[236:239], a[84:87], v[148:151], a[236:239]
  v_mfma_f32_16x16x32_bf16 a[240:243], a[80:83], v[152:155], a[240:243]
  ds_read_b128 v[188:191], v1 offset:64512
  v_mfma_f32_16x16x32_bf16 a[244:247], a[84:87], v[152:155], a[244:247]
  v_mfma_f32_16x16x32_bf16 a[248:251], a[80:83], v[156:159], a[248:251]
  v_mfma_f32_16x16x32_bf16 a[252:255], a[84:87], v[156:159], a[252:255]
  s_waitcnt vmcnt(4) lgkmcnt(0)
  s_barrier
  v_mfma_f32_16x16x32_bf16 a[192:195], a[88:91], v[160:163], a[192:195]
  ds_read_b128 v[128:131], v118 offset:0
  v_mfma_f32_16x16x32_bf16 a[196:199], a[92:95], v[160:163], a[196:199]
  ds_read_b128 v[132:135], v118 offset:2048
  v_mfma_f32_16x16x32_bf16 a[200:203], a[88:91], v[164:167], a[200:203]
  v_mfma_f32_16x16x32_bf16 a[204:207], a[92:95], v[164:167], a[204:207]
  ds_read_b128 v[136:139], v118 offset:4096
  v_mfma_f32_16x16x32_bf16 a[208:211], a[88:91], v[168:171], a[208:211]
  v_mfma_f32_16x16x32_bf16 a[212:215], a[92:95], v[168:171], a[212:215]
  ds_read_b128 v[140:143], v118 offset:6144
  v_mfma_f32_16x16x32_bf16 a[216:219], a[88:91], v[172:175], a[216:219]
  v_mfma_f32_16x16x32_bf16 a[220:223], a[92:95], v[172:175], a[220:223]
  ds_read_b128 v[144:147], v118 offset:8192
  v_mfma_f32_16x16x32_bf16 a[224:227], a[88:91], v[176:179], a[224:227]
  ds_read_b128 v[148:151], v118 offset:10240
  v_mfma_f32_16x16x32_bf16 a[228:231], a[92:95], v[176:179], a[228:231]
  v_mfma_f32_16x16x32_bf16 a[232:235], a[88:91], v[180:183], a[232:235]
  ds_read_b128 v[152:155], v118 offset:12288
  v_mfma_f32_16x16x32_bf16 a[236:239], a[92:95], v[180:183], a[236:239]
  v_mfma_f32_16x16x32_bf16 a[240:243], a[88:91], v[184:187], a[240:243]
  ds_read_b128 v[156:159], v118 offset:14336
  v_mfma_f32_16x16x32_bf16 a[244:247], a[92:95], v[184:187], a[244:247]
  v_mfma_f32_16x16x32_bf16 a[248:251], a[88:91], v[188:191], a[248:251]
  v_mfma_f32_16x16x32_bf16 a[252:255], a[92:95], v[188:191], a[252:255]
  s_waitcnt lgkmcnt(4)
  v_mfma_f32_16x16x32_bf16 a[192:195], a[96:99], v[128:131], a[192:195]
  ds_read_b128 v[160:163], v118 offset:1024
  v_mfma_f32_16x16x32_bf16 a[196:199], a[100:103], v[128:131], a[196:199]
  ds_read_b128 v[164:167], v118 offset:3072
  v_mfma_f32_16x16x32_bf16 a[200:203], a[96:99], v[132:135], a[200:203]
  v_mfma_f32_16x16x32_bf16 a[204:207], a[100:103], v[132:135], a[204:207]
  ds_read_b128 v[168:171], v118 offset:5120
  v_mfma_f32_16x16x32_bf16 a[208:211], a[96:99], v[136:139], a[208:211]
  v_mfma_f32_16x16x32_bf16 a[212:215], a[100:103], v[136:139], a[212:215]
  ds_read_b128 v[172:175], v118 offset:7168
  v_mfma_f32_16x16x32_bf16 a[216:219], a[96:99], v[140:143], a[216:219]
  v_mfma_f32_16x16x32_bf16 a[220:223], a[100:103], v[140:143], a[220:223]
  ds_read_b128 v[176:179], v118 offset:9216
  s_waitcnt lgkmcnt(5)
  v_mfma_f32_16x16x32_bf16 a[224:227], a[96:99], v[144:147], a[224:227]
  ds_read_b128 v[180:183], v118 offset:11264
  v_mfma_f32_16x16x32_bf16 a[228:231], a[100:103], v[144:147], a[228:231]
  v_mfma_f32_16x16x32_bf16 a[232:235], a[96:99], v[148:151], a[232:235]
  ds_read_b128 v[184:187], v118 offset:13312
  v_mfma_f32_16x16x32_bf16 a[236:239], a[100:103], v[148:151], a[236:239]
  v_mfma_f32_16x16x32_bf16 a[240:243], a[96:99], v[152:155], a[240:243]
  ds_read_b128 v[188:191], v118 offset:15360
  v_mfma_f32_16x16x32_bf16 a[244:247], a[100:103], v[152:155], a[244:247]
  v_mfma_f32_16x16x32_bf16 a[248:251], a[96:99], v[156:159], a[248:251]
  v_mfma_f32_16x16x32_bf16 a[252:255], a[100:103], v[156:159], a[252:255]
  s_waitcnt vmcnt(0) lgkmcnt(0)
  s_barrier
  v_mfma_f32_16x16x32_bf16 a[192:195], a[104:107], v[160:163], a[192:195]
  ds_read_b128 v[128:131], v118 offset:16384
  v_mfma_f32_16x16x32_bf16 a[196:199], a[108:111], v[160:163], a[196:199]
  ds_read_b128 v[132:135], v118 offset:18432
  v_mfma_f32_16x16x32_bf16 a[200:203], a[104:107], v[164:167], a[200:203]
  v_mfma_f32_16x16x32_bf16 a[204:207], a[108:111], v[164:167], a[204:207]
  ds_read_b128 v[136:139], v118 offset:20480
  v_mfma_f32_16x16x32_bf16 a[208:211], a[104:107], v[168:171], a[208:211]
  v_mfma_f32_16x16x32_bf16 a[212:215], a[108:111], v[168:171], a[212:215]
  ds_read_b128 v[140:143], v118 offset:22528
  v_mfma_f32_16x16x32_bf16 a[216:219], a[104:107], v[172:175], a[216:219]
  v_mfma_f32_16x16x32_bf16 a[220:223], a[108:111], v[172:175], a[220:223]
  ds_read_b128 v[144:147], v118 offset:24576
  v_mfma_f32_16x16x32_bf16 a[224:227], a[104:107], v[176:179], a[224:227]
  ds_read_b128 v[148:151], v118 offset:26624
  v_mfma_f32_16x16x32_bf16 a[228:231], a[108:111], v[176:179], a[228:231]
  v_mfma_f32_16x16x32_bf16 a[232:235], a[104:107], v[180:183], a[232:235]
  ds_read_b128 v[152:155], v118 offset:28672
  v_mfma_f32_16x16x32_bf16 a[236:239], a[108:111], v[180:183], a[236:239]
  v_mfma_f32_16x16x32_bf16 a[240:243], a[104:107], v[184:187], a[240:243]
  ds_read_b128 v[156:159], v118 offset:30720
  v_mfma_f32_16x16x32_bf16 a[244:247], a[108:111], v[184:187], a[244:247]
  v_mfma_f32_16x16x32_bf16 a[248:251], a[104:107], v[188:191], a[248:251]
  v_mfma_f32_16x16x32_bf16 a[252:255], a[108:111], v[188:191], a[252:255]
  s_waitcnt lgkmcnt(4)
  v_mfma_f32_16x16x32_bf16 a[192:195], a[112:115], v[128:131], a[192:195]
  ds_read_b128 v[160:163], v118 offset:17408
  v_mfma_f32_16x16x32_bf16 a[196:199], a[116:119], v[128:131], a[196:199]
  ds_read_b128 v[164:167], v118 offset:19456
  v_mfma_f32_16x16x32_bf16 a[200:203], a[112:115], v[132:135], a[200:203]
  v_mfma_f32_16x16x32_bf16 a[204:207], a[116:119], v[132:135], a[204:207]
  ds_read_b128 v[168:171], v118 offset:21504
  v_mfma_f32_16x16x32_bf16 a[208:211], a[112:115], v[136:139], a[208:211]
  v_mfma_f32_16x16x32_bf16 a[212:215], a[116:119], v[136:139], a[212:215]
  ds_read_b128 v[172:175], v118 offset:23552
  v_mfma_f32_16x16x32_bf16 a[216:219], a[112:115], v[140:143], a[216:219]
  v_mfma_f32_16x16x32_bf16 a[220:223], a[116:119], v[140:143], a[220:223]
  ds_read_b128 v[176:179], v118 offset:25600
  s_waitcnt lgkmcnt(5)
  v_mfma_f32_16x16x32_bf16 a[224:227], a[112:115], v[144:147], a[224:227]
  ds_read_b128 v[180:183], v118 offset:27648
  v_mfma_f32_16x16x32_bf16 a[228:231], a[116:119], v[144:147], a[228:231]
  v_mfma_f32_16x16x32_bf16 a[232:235], a[112:115], v[148:151], a[232:235]
  ds_read_b128 v[184:187], v118 offset:29696
  v_mfma_f32_16x16x32_bf16 a[236:239], a[116:119], v[148:151], a[236:239]
  v_mfma_f32_16x16x32_bf16 a[240:243], a[112:115], v[152:155], a[240:243]
  ds_read_b128 v[188:191], v118 offset:31744
  v_mfma_f32_16x16x32_bf16 a[244:247], a[116:119], v[152:155], a[244:247]
  v_mfma_f32_16x16x32_bf16 a[248:251], a[112:115], v[156:159], a[248:251]
  v_mfma_f32_16x16x32_bf16 a[252:255], a[116:119], v[156:159], a[252:255]
  s_waitcnt lgkmcnt(4)
  v_mfma_f32_16x16x32_bf16 a[192:195], a[120:123], v[160:163], a[192:195]
  v_mfma_f32_16x16x32_bf16 a[196:199], a[124:127], v[160:163], a[196:199]
  v_mfma_f32_16x16x32_bf16 a[200:203], a[120:123], v[164:167], a[200:203]
  v_mfma_f32_16x16x32_bf16 a[204:207], a[124:127], v[164:167], a[204:207]
  v_mfma_f32_16x16x32_bf16 a[208:211], a[120:123], v[168:171], a[208:211]
  v_mfma_f32_16x16x32_bf16 a[212:215], a[124:127], v[168:171], a[212:215]
  v_mfma_f32_16x16x32_bf16 a[216:219], a[120:123], v[172:175], a[216:219]
  v_mfma_f32_16x16x32_bf16 a[220:223], a[124:127], v[172:175], a[220:223]
  s_waitcnt lgkmcnt(0)
  v_mfma_f32_16x16x32_bf16 a[224:227], a[120:123], v[176:179], a[224:227]
  v_mfma_f32_16x16x32_bf16 a[228:231], a[124:127], v[176:179], a[228:231]
  v_mfma_f32_16x16x32_bf16 a[232:235], a[120:123], v[180:183], a[232:235]
  v_mfma_f32_16x16x32_bf16 a[236:239], a[124:127], v[180:183], a[236:239]
  v_mfma_f32_16x16x32_bf16 a[240:243], a[120:123], v[184:187], a[240:243]
  v_mfma_f32_16x16x32_bf16 a[244:247], a[124:127], v[184:187], a[244:247]
  v_mfma_f32_16x16x32_bf16 a[248:251], a[120:123], v[188:191], a[248:251]
  v_mfma_f32_16x16x32_bf16 a[252:255], a[124:127], v[188:191], a[252:255]
  v_accvgpr_read_b32 v20, a192
  v_accvgpr_read_b32 v21, a193
  v_accvgpr_read_b32 v22, a194
  v_accvgpr_read_b32 v23, a195
  v_accvgpr_read_b32 v24, a196
  v_accvgpr_read_b32 v25, a197
  v_accvgpr_read_b32 v26, a198
  v_accvgpr_read_b32 v27, a199
  v_cvt_pk_bf16_f32 v16, v20, v21
  v_cvt_pk_bf16_f32 v17, v22, v23
  v_cvt_pk_bf16_f32 v18, v24, v25
  v_cvt_pk_bf16_f32 v19, v26, v27
  ds_write_b128 v9, v[16:19] offset:0
  v_accvgpr_read_b32 v32, a200
  v_accvgpr_read_b32 v33, a201
  v_accvgpr_read_b32 v34, a202
  v_accvgpr_read_b32 v35, a203
  v_accvgpr_read_b32 v36, a204
  v_accvgpr_read_b32 v37, a205
  v_accvgpr_read_b32 v38, a206
  v_accvgpr_read_b32 v39, a207
  v_cvt_pk_bf16_f32 v28, v32, v33
  v_cvt_pk_bf16_f32 v29, v34, v35
  v_cvt_pk_bf16_f32 v30, v36, v37
  v_cvt_pk_bf16_f32 v31, v38, v39
  ds_write_b128 v9, v[28:31] offset:4352
  v_accvgpr_read_b32 v44, a208
  v_accvgpr_read_b32 v45, a209
  v_accvgpr_read_b32 v46, a210
  v_accvgpr_read_b32 v47, a211
  v_accvgpr_read_b32 v48, a212
  v_accvgpr_read_b32 v49, a213
  v_accvgpr_read_b32 v50, a214
  v_accvgpr_read_b32 v51, a215
  v_cvt_pk_bf16_f32 v40, v44, v45
  v_cvt_pk_bf16_f32 v41, v46, v47
  v_cvt_pk_bf16_f32 v42, v48, v49
  v_cvt_pk_bf16_f32 v43, v50, v51
  ds_write_b128 v9, v[40:43] offset:8704
  v_accvgpr_read_b32 v56, a216
  v_accvgpr_read_b32 v57, a217
  v_accvgpr_read_b32 v58, a218
  v_accvgpr_read_b32 v59, a219
  v_accvgpr_read_b32 v60, a220
  v_accvgpr_read_b32 v61, a221
  v_accvgpr_read_b32 v62, a222
  v_accvgpr_read_b32 v63, a223
  v_cvt_pk_bf16_f32 v52, v56, v57
  v_cvt_pk_bf16_f32 v53, v58, v59
  v_cvt_pk_bf16_f32 v54, v60, v61
  v_cvt_pk_bf16_f32 v55, v62, v63
  ds_write_b128 v9, v[52:55] offset:13056
  v_accvgpr_read_b32 v68, a224
  v_accvgpr_read_b32 v69, a225
  v_accvgpr_read_b32 v70, a226
  v_accvgpr_read_b32 v71, a227
  v_accvgpr_read_b32 v72, a228
  v_accvgpr_read_b32 v73, a229
  v_accvgpr_read_b32 v74, a230
  v_accvgpr_read_b32 v75, a231
  v_cvt_pk_bf16_f32 v64, v68, v69
  v_cvt_pk_bf16_f32 v65, v70, v71
  v_cvt_pk_bf16_f32 v66, v72, v73
  v_cvt_pk_bf16_f32 v67, v74, v75
  ds_write_b128 v9, v[64:67] offset:17408
  v_accvgpr_read_b32 v80, a232
  v_accvgpr_read_b32 v81, a233
  v_accvgpr_read_b32 v82, a234
  v_accvgpr_read_b32 v83, a235
  v_accvgpr_read_b32 v84, a236
  v_accvgpr_read_b32 v85, a237
  v_accvgpr_read_b32 v86, a238
  v_accvgpr_read_b32 v87, a239
  v_cvt_pk_bf16_f32 v76, v80, v81
  v_cvt_pk_bf16_f32 v77, v82, v83
  v_cvt_pk_bf16_f32 v78, v84, v85
  v_cvt_pk_bf16_f32 v79, v86, v87
  ds_write_b128 v9, v[76:79] offset:21760
  v_accvgpr_read_b32 v92, a240
  v_accvgpr_read_b32 v93, a241
  v_accvgpr_read_b32 v94, a242
  v_accvgpr_read_b32 v95, a243
  v_accvgpr_read_b32 v96, a244
  v_accvgpr_read_b32 v97, a245
  v_accvgpr_read_b32 v98, a246
  v_accvgpr_read_b32 v99, a247
  v_cvt_pk_bf16_f32 v88, v92, v93
  v_cvt_pk_bf16_f32 v89, v94, v95
  v_cvt_pk_bf16_f32 v90, v96, v97
  v_cvt_pk_bf16_f32 v91, v98, v99
  ds_write_b128 v9, v[88:91] offset:26112
  v_accvgpr_read_b32 v104, a248
  v_accvgpr_read_b32 v105, a249
  v_accvgpr_read_b32 v106, a250
  v_accvgpr_read_b32 v107, a251
  v_accvgpr_read_b32 v108, a252
  v_accvgpr_read_b32 v109, a253
  v_accvgpr_read_b32 v110, a254
  v_accvgpr_read_b32 v111, a255
  v_cvt_pk_bf16_f32 v100, v104, v105
  v_cvt_pk_bf16_f32 v101, v106, v107
  v_cvt_pk_bf16_f32 v102, v108, v109
  v_cvt_pk_bf16_f32 v103, v110, v111
  ds_write_b128 v9, v[100:103] offset:30464
  s_waitcnt lgkmcnt(0)
  s_barrier
  ds_read_b128 v[128:131], v10 offset:0
  ds_read_b128 v[132:135], v10 offset:1088
  ds_read_b128 v[136:139], v10 offset:2176
  ds_read_b128 v[140:143], v10 offset:3264
  ds_read_b128 v[144:147], v10 offset:4352
  ds_read_b128 v[148:151], v10 offset:5440
  ds_read_b128 v[152:155], v10 offset:6528
  ds_read_b128 v[156:159], v10 offset:7616
  s_waitcnt lgkmcnt(7)
  buffer_store_dwordx4 v[128:131], v11, s[12:15], s38 offen sc1
  s_add_u32 s38, s38, 4096
  s_waitcnt lgkmcnt(6)
  buffer_store_dwordx4 v[132:135], v11, s[12:15], s38 offen sc1
  s_add_u32 s38, s38, 4096
  s_waitcnt lgkmcnt(5)
  buffer_store_dwordx4 v[136:139], v11, s[12:15], s38 offen sc1
  s_add_u32 s38, s38, 4096
  s_waitcnt lgkmcnt(4)
  buffer_store_dwordx4 v[140:143], v11, s[12:15], s38 offen sc1
  s_add_u32 s38, s38, 4096
  s_waitcnt lgkmcnt(3)
  buffer_store_dwordx4 v[144:147], v11, s[12:15], s38 offen sc1
  s_add_u32 s38, s38, 4096
  s_waitcnt lgkmcnt(2)
  buffer_store_dwordx4 v[148:151], v11, s[12:15], s38 offen sc1
  s_add_u32 s38, s38, 4096
  s_waitcnt lgkmcnt(1)
  buffer_store_dwordx4 v[152:155], v11, s[12:15], s38 offen sc1
  s_add_u32 s38, s38, 4096
  s_waitcnt lgkmcnt(0)
  buffer_store_dwordx4 v[156:159], v11, s[12:15], s38 offen sc1
  s_add_u32 s38, s38, 4096
  s_endpgm
PF_END:
RARE0:
  s_nop 15
  v_max3_f32 v100, v36, v37, v38
  v_max3_f32 v100, v100, v39, v44
  v_max3_f32 v100, v100, v45, v46
  v_max_f32 v100, v100, v47
  v_mov_b32 v104, v100
  s_nop 1
  v_permlane16_swap_b32 v100, v104
  v_max_f32 v100, v100, v104
  v_mov_b32 v104, v100
  s_nop 1
  v_permlane32_swap_b32 v100, v104
  v_max_f32 v100, v100, v104
  v_max_f32 v100, 0, v100
  v_sub_f32 v102, 0, v100
  v_exp_f32 v102, v102
  v_sub_f32 v36, v36, v100
  v_sub_f32 v37, v37, v100
  v_sub_f32 v38, v38, v100
  v_sub_f32 v39, v39, v100
  v_sub_f32 v44, v44, v100
  v_sub_f32 v45, v45, v100
  v_sub_f32 v46, v46, v100
  v_sub_f32 v47, v47, v100
  v_sub_f32 v52, v52, v100
  v_sub_f32 v53, v53, v100
  v_sub_f32 v54, v54, v100
  v_sub_f32 v55, v55, v100
  v_sub_f32 v60, v60, v100
  v_sub_f32 v61, v61, v100
  v_sub_f32 v62, v62, v100
  v_sub_f32 v63, v63, v100
  v_sub_f32 v20, v20, v100
  v_sub_f32 v21, v21, v100
  v_sub_f32 v22, v22, v100
  v_sub_f32 v23, v23, v100
  v_mul_f32 v7, v7, v102
  v_max3_f32 v101, v40, v41, v42
  v_max3_f32 v101, v101, v43, v48
  v_max3_f32 v101, v101, v49, v50
  v_max_f32 v101, v101, v51
  v_mov_b32 v104, v101
  s_nop 1
  v_permlane16_swap_b32 v101, v104
  v_max_f32 v101, v101, v104
  v_mov_b32 v104, v101
  s_nop 1
  v_permlane32_swap_b32 v101, v104
  v_max_f32 v101, v101, v104
  v_max_f32 v101, 0, v101
  v_sub_f32 v103, 0, v101
  v_exp_f32 v103, v103
  v_sub_f32 v40, v40, v101
  v_sub_f32 v41, v41, v101
  v_sub_f32 v42, v42, v101
  v_sub_f32 v43, v43, v101
  v_sub_f32 v48, v48, v101
  v_sub_f32 v49, v49, v101
  v_sub_f32 v50, v50, v101
  v_sub_f32 v51, v51, v101
  v_sub_f32 v56, v56, v101
  v_sub_f32 v57, v57, v101
  v_sub_f32 v58, v58, v101
  v_sub_f32 v59, v59, v101
  v_sub_f32 v64, v64, v101
  v_sub_f32 v65, v65, v101
  v_sub_f32 v66, v66, v101
  v_sub_f32 v67, v67, v101
  v_sub_f32 v24, v24, v101
  v_sub_f32 v25, v25, v101
  v_sub_f32 v26, v26, v101
  v_sub_f32 v27, v27, v101
  v_mul_f32 v8, v8, v103
  v_mul_f32 v128, v128, v102
  v_mul_f32 v129, v129, v102
  v_mul_f32 v130, v130, v102
  v_mul_f32 v131, v131, v102
  v_mul_f32 v132, v132, v103
  v_mul_f32 v133, v133, v103
  v_mul_f32 v134, v134, v103
  v_mul_f32 v135, v135, v103
  v_mul_f32 v136, v136, v102
  v_mul_f32 v137, v137, v102
  v_mul_f32 v138, v138, v102
  v_mul_f32 v139, v139, v102
  v_mul_f32 v140, v140, v103
  v_mul_f32 v141, v141, v103
  v_mul_f32 v142, v142, v103
  v_mul_f32 v143, v143, v103
  v_mul_f32 v144, v144, v102
  v_mul_f32 v145, v145, v102
  v_mul_f32 v146, v146, v102
  v_mul_f32 v147, v147, v102
  v_mul_f32 v148, v148, v103
  v_mul_f32 v149, v149, v103
  v_mul_f32 v150, v150, v103
  v_mul_f32 v151, v151, v103
  v_mul_f32 v152, v152, v102
  v_mul_f32 v153, v153, v102
  v_mul_f32 v154, v154, v102
  v_mul_f32 v155, v155, v102
  v_mul_f32 v156, v156, v103
  v_mul_f32 v157, v157, v103
  v_mul_f32 v158, v158, v103
  v_mul_f32 v159, v159, v103
  v_mul_f32 v160, v160, v102
  v_mul_f32 v161, v161, v102
  v_mul_f32 v162, v162, v102
  v_mul_f32 v163, v163, v102
  v_mul_f32 v164, v164, v103
  v_mul_f32 v165, v165, v103
  v_mul_f32 v166, v166, v103
  v_mul_f32 v167, v167, v103
  v_mul_f32 v168, v168, v102
  v_mul_f32 v169, v169, v102
  v_mul_f32 v170, v170, v102
  v_mul_f32 v171, v171, v102
  v_mul_f32 v172, v172, v103
  v_mul_f32 v173, v173, v103
  v_mul_f32 v174, v174, v103
  v_mul_f32 v175, v175, v103
  v_mul_f32 v176, v176, v102
  v_mul_f32 v177, v177, v102
  v_mul_f32 v178, v178, v102
  v_mul_f32 v179, v179, v102
  v_mul_f32 v180, v180, v103
  v_mul_f32 v181, v181, v103
  v_mul_f32 v182, v182, v103
  v_mul_f32 v183, v183, v103
  v_mul_f32 v184, v184, v102
  v_mul_f32 v185, v185, v102
  v_mul_f32 v186, v186, v102
  v_mul_f32 v187, v187, v102
  v_mul_f32 v188, v188, v103
  v_mul_f32 v189, v189, v103
  v_mul_f32 v190, v190, v103
  v_mul_f32 v191, v191, v103
  v_mul_f32 v192, v192, v102
  v_mul_f32 v193, v193, v102
  v_mul_f32 v194, v194, v102
  v_mul_f32 v195, v195, v102
  v_mul_f32 v196, v196, v103
  v_mul_f32 v197, v197, v103
  v_mul_f32 v198, v198, v103
  v_mul_f32 v199, v199, v103
  v_mul_f32 v200, v200, v102
  v_mul_f32 v201, v201, v102
  v_mul_f32 v202, v202, v102
  v_mul_f32 v203, v203, v102
  v_mul_f32 v204, v204, v103
  v_mul_f32 v205, v205, v103
  v_mul_f32 v206, v206, v103
  v_mul_f32 v207, v207, v103
  v_mul_f32 v208, v208, v102
  v_mul_f32 v209, v209, v102
  v_mul_f32 v210, v210, v102
  v_mul_f32 v211, v211, v102
  v_mul_f32 v212, v212, v103
  v_mul_f32 v213, v213, v103
  v_mul_f32 v214, v214, v103
  v_mul_f32 v215, v215, v103
  v_mul_f32 v216, v216, v102
  v_mul_f32 v217, v217, v102
  v_mul_f32 v218, v218, v102
  v_mul_f32 v219, v219, v102
  v_mul_f32 v220, v220, v103
  v_mul_f32 v221, v221, v103
  v_mul_f32 v222, v222, v103
  v_mul_f32 v223, v223, v103
  v_mul_f32 v224, v224, v102
  v_mul_f32 v225, v225, v102
  v_mul_f32 v226, v226, v102
  v_mul_f32 v227, v227, v102
  v_mul_f32 v228, v228, v103
  v_mul_f32 v229, v229, v103
  v_mul_f32 v230, v230, v103
  v_mul_f32 v231, v231, v103
  v_mul_f32 v232, v232, v102
  v_mul_f32 v233, v233, v102
  v_mul_f32 v234, v234, v102
  v_mul_f32 v235, v235, v102
  v_mul_f32 v236, v236, v103
  v_mul_f32 v237, v237, v103
  v_mul_f32 v238, v238, v103
  v_mul_f32 v239, v239, v103
  v_mul_f32 v240, v240, v102
  v_mul_f32 v241, v241, v102
  v_mul_f32 v242, v242, v102
  v_mul_f32 v243, v243, v102
  v_mul_f32 v244, v244, v103
  v_mul_f32 v245, v245, v103
  v_mul_f32 v246, v246, v103
  v_mul_f32 v247, v247, v103
  v_mul_f32 v248, v248, v102
  v_mul_f32 v249, v249, v102
  v_mul_f32 v250, v250, v102
  v_mul_f32 v251, v251, v102
  v_mul_f32 v252, v252, v103
  v_mul_f32 v253, v253, v103
  v_mul_f32 v254, v254, v103
  v_mul_f32 v255, v255, v103
  v_accvgpr_read_b32 v108, a128
  v_accvgpr_read_b32 v109, a129
  v_accvgpr_read_b32 v110, a130
  v_accvgpr_read_b32 v111, a131
  v_mul_f32 v108, v108, v102
  v_mul_f32 v109, v109, v102
  v_mul_f32 v110, v110, v102
  v_mul_f32 v111, v111, v102
  v_accvgpr_write_b32 a128, v108
  v_accvgpr_write_b32 a129, v109
  v_accvgpr_write_b32 a130, v110
  v_accvgpr_write_b32 a131, v111
  v_accvgpr_read_b32 v108, a132
  v_accvgpr_read_b32 v109, a133
  v_accvgpr_read_b32 v110, a134
  v_accvgpr_read_b32 v111, a135
  v_mul_f32 v108, v108, v103
  v_mul_f32 v109, v109, v103
  v_mul_f32 v110, v110, v103
  v_mul_f32 v111, v111, v103
  v_accvgpr_write_b32 a132, v108
  v_accvgpr_write_b32 a133, v109
  v_accvgpr_write_b32 a134, v110
  v_accvgpr_write_b32 a135, v111
  v_accvgpr_read_b32 v108, a136
  v_accvgpr_read_b32 v109, a137
  v_accvgpr_read_b32 v110, a138
  v_accvgpr_read_b32 v111, a139
  v_mul_f32 v108, v108, v102
  v_mul_f32 v109, v109, v102
  v_mul_f32 v110, v110, v102
  v_mul_f32 v111, v111, v102
  v_accvgpr_write_b32 a136, v108
  v_accvgpr_write_b32 a137, v109
  v_accvgpr_write_b32 a138, v110
  v_accvgpr_write_b32 a139, v111
  v_accvgpr_read_b32 v108, a140
  v_accvgpr_read_b32 v109, a141
  v_accvgpr_read_b32 v110, a142
  v_accvgpr_read_b32 v111, a143
  v_mul_f32 v108, v108, v103
  v_mul_f32 v109, v109, v103
  v_mul_f32 v110, v110, v103
  v_mul_f32 v111, v111, v103
  v_accvgpr_write_b32 a140, v108
  v_accvgpr_write_b32 a141, v109
  v_accvgpr_write_b32 a142, v110
  v_accvgpr_write_b32 a143, v111
  v_accvgpr_read_b32 v108, a144
  v_accvgpr_read_b32 v109, a145
  v_accvgpr_read_b32 v110, a146
  v_accvgpr_read_b32 v111, a147
  v_mul_f32 v108, v108, v102
  v_mul_f32 v109, v109, v102
  v_mul_f32 v110, v110, v102
  v_mul_f32 v111, v111, v102
  v_accvgpr_write_b32 a144, v108
  v_accvgpr_write_b32 a145, v109
  v_accvgpr_write_b32 a146, v110
  v_accvgpr_write_b32 a147, v111
  v_accvgpr_read_b32 v108, a148
  v_accvgpr_read_b32 v109, a149
  v_accvgpr_read_b32 v110, a150
  v_accvgpr_read_b32 v111, a151
  v_mul_f32 v108, v108, v103
  v_mul_f32 v109, v109, v103
  v_mul_f32 v110, v110, v103
  v_mul_f32 v111, v111, v103
  v_accvgpr_write_b32 a148, v108
  v_accvgpr_write_b32 a149, v109
  v_accvgpr_write_b32 a150, v110
  v_accvgpr_write_b32 a151, v111
  v_accvgpr_read_b32 v108, a152
  v_accvgpr_read_b32 v109, a153
  v_accvgpr_read_b32 v110, a154
  v_accvgpr_read_b32 v111, a155
  v_mul_f32 v108, v108, v102
  v_mul_f32 v109, v109, v102
  v_mul_f32 v110, v110, v102
  v_mul_f32 v111, v111, v102
  v_accvgpr_write_b32 a152, v108
  v_accvgpr_write_b32 a153, v109
  v_accvgpr_write_b32 a154, v110
  v_accvgpr_write_b32 a155, v111
  v_accvgpr_read_b32 v108, a156
  v_accvgpr_read_b32 v109, a157
  v_accvgpr_read_b32 v110, a158
  v_accvgpr_read_b32 v111, a159
  v_mul_f32 v108, v108, v103
  v_mul_f32 v109, v109, v103
  v_mul_f32 v110, v110, v103
  v_mul_f32 v111, v111, v103
  v_accvgpr_write_b32 a156, v108
  v_accvgpr_write_b32 a157, v109
  v_accvgpr_write_b32 a158, v110
  v_accvgpr_write_b32 a159, v111
  v_accvgpr_read_b32 v108, a160
  v_accvgpr_read_b32 v109, a161
  v_accvgpr_read_b32 v110, a162
  v_accvgpr_read_b32 v111, a163
  v_mul_f32 v108, v108, v102
  v_mul_f32 v109, v109, v102
  v_mul_f32 v110, v110, v102
  v_mul_f32 v111, v111, v102
  v_accvgpr_write_b32 a160, v108
  v_accvgpr_write_b32 a161, v109
  v_accvgpr_write_b32 a162, v110
  v_accvgpr_write_b32 a163, v111
  v_accvgpr_read_b32 v108, a164
  v_accvgpr_read_b32 v109, a165
  v_accvgpr_read_b32 v110, a166
  v_accvgpr_read_b32 v111, a167
  v_mul_f32 v108, v108, v103
  v_mul_f32 v109, v109, v103
  v_mul_f32 v110, v110, v103
  v_mul_f32 v111, v111, v103
  v_accvgpr_write_b32 a164, v108
  v_accvgpr_write_b32 a165, v109
  v_accvgpr_write_b32 a166, v110
  v_accvgpr_write_b32 a167, v111
  v_accvgpr_read_b32 v108, a168
  v_accvgpr_read_b32 v109, a169
  v_accvgpr_read_b32 v110, a170
  v_accvgpr_read_b32 v111, a171
  v_mul_f32 v108, v108, v102
  v_mul_f32 v109, v109, v102
  v_mul_f32 v110, v110, v102
  v_mul_f32 v111, v111, v102
  v_accvgpr_write_b32 a168, v108
  v_accvgpr_write_b32 a169, v109
  v_accvgpr_write_b32 a170, v110
  v_accvgpr_write_b32 a171, v111
  v_accvgpr_read_b32 v108, a172
  v_accvgpr_read_b32 v109, a173
  v_accvgpr_read_b32 v110, a174
  v_accvgpr_read_b32 v111, a175
  v_mul_f32 v108, v108, v103
  v_mul_f32 v109, v109, v103
  v_mul_f32 v110, v110, v103
  v_mul_f32 v111, v111, v103
  v_accvgpr_write_b32 a172, v108
  v_accvgpr_write_b32 a173, v109
  v_accvgpr_write_b32 a174, v110
  v_accvgpr_write_b32 a175, v111
  v_accvgpr_read_b32 v108, a176
  v_accvgpr_read_b32 v109, a177
  v_accvgpr_read_b32 v110, a178
  v_accvgpr_read_b32 v111, a179
  v_mul_f32 v108, v108, v102
  v_mul_f32 v109, v109, v102
  v_mul_f32 v110, v110, v102
  v_mul_f32 v111, v111, v102
  v_accvgpr_write_b32 a176, v108
  v_accvgpr_write_b32 a177, v109
  v_accvgpr_write_b32 a178, v110
  v_accvgpr_write_b32 a179, v111
  v_accvgpr_read_b32 v108, a180
  v_accvgpr_read_b32 v109, a181
  v_accvgpr_read_b32 v110, a182
  v_accvgpr_read_b32 v111, a183
  v_mul_f32 v108, v108, v103
  v_mul_f32 v109, v109, v103
  v_mul_f32 v110, v110, v103
  v_mul_f32 v111, v111, v103
  v_accvgpr_write_b32 a180, v108
  v_accvgpr_write_b32 a181, v109
  v_accvgpr_write_b32 a182, v110
  v_accvgpr_write_b32 a183, v111
  v_accvgpr_read_b32 v108, a184
  v_accvgpr_read_b32 v109, a185
  v_accvgpr_read_b32 v110, a186
  v_accvgpr_read_b32 v111, a187
  v_mul_f32 v108, v108, v102
  v_mul_f32 v109, v109, v102
  v_mul_f32 v110, v110, v102
  v_mul_f32 v111, v111, v102
  v_accvgpr_write_b32 a184, v108
  v_accvgpr_write_b32 a185, v109
  v_accvgpr_write_b32 a186, v110
  v_accvgpr_write_b32 a187, v111
  v_accvgpr_read_b32 v108, a188
  v_accvgpr_read_b32 v109, a189
  v_accvgpr_read_b32 v110, a190
  v_accvgpr_read_b32 v111, a191
  v_mul_f32 v108, v108, v103
  v_mul_f32 v109, v109, v103
  v_mul_f32 v110, v110, v103
  v_mul_f32 v111, v111, v103
  v_accvgpr_write_b32 a188, v108
  v_accvgpr_write_b32 a189, v109
  v_accvgpr_write_b32 a190, v110
  v_accvgpr_write_b32 a191, v111
  v_accvgpr_read_b32 v108, a192
  v_accvgpr_read_b32 v109, a193
  v_accvgpr_read_b32 v110, a194
  v_accvgpr_read_b32 v111, a195
  v_mul_f32 v108, v108, v102
  v_mul_f32 v109, v109, v102
  v_mul_f32 v110, v110, v102
  v_mul_f32 v111, v111, v102
  v_accvgpr_write_b32 a192, v108
  v_accvgpr_write_b32 a193, v109
  v_accvgpr_write_b32 a194, v110
  v_accvgpr_write_b32 a195, v111
  v_accvgpr_read_b32 v108, a196
  v_accvgpr_read_b32 v109, a197
  v_accvgpr_read_b32 v110, a198
  v_accvgpr_read_b32 v111, a199
  v_mul_f32 v108, v108, v103
  v_mul_f32 v109, v109, v103
  v_mul_f32 v110, v110, v103
  v_mul_f32 v111, v111, v103
  v_accvgpr_write_b32 a196, v108
  v_accvgpr_write_b32 a197, v109
  v_accvgpr_write_b32 a198, v110
  v_accvgpr_write_b32 a199, v111
  v_accvgpr_read_b32 v108, a200
  v_accvgpr_read_b32 v109, a201
  v_accvgpr_read_b32 v110, a202
  v_accvgpr_read_b32 v111, a203
  v_mul_f32 v108, v108, v102
  v_mul_f32 v109, v109, v102
  v_mul_f32 v110, v110, v102
  v_mul_f32 v111, v111, v102
  v_accvgpr_write_b32 a200, v108
  v_accvgpr_write_b32 a201, v109
  v_accvgpr_write_b32 a202, v110
  v_accvgpr_write_b32 a203, v111
  v_accvgpr_read_b32 v108, a204
  v_accvgpr_read_b32 v109, a205
  v_accvgpr_read_b32 v110, a206
  v_accvgpr_read_b32 v111, a207
  v_mul_f32 v108, v108, v103
  v_mul_f32 v109, v109, v103
  v_mul_f32 v110, v110, v103
  v_mul_f32 v111, v111, v103
  v_accvgpr_write_b32 a204, v108
  v_accvgpr_write_b32 a205, v109
  v_accvgpr_write_b32 a206, v110
  v_accvgpr_write_b32 a207, v111
  v_accvgpr_read_b32 v108, a208
  v_accvgpr_read_b32 v109, a209
  v_accvgpr_read_b32 v110, a210
  v_accvgpr_read_b32 v111, a211
  v_mul_f32 v108, v108, v102
  v_mul_f32 v109, v109, v102
  v_mul_f32 v110, v110, v102
  v_mul_f32 v111, v111, v102
  v_accvgpr_write_b32 a208, v108
  v_accvgpr_write_b32 a209, v109
  v_accvgpr_write_b32 a210, v110
  v_accvgpr_write_b32 a211, v111
  v_accvgpr_read_b32 v108, a212
  v_accvgpr_read_b32 v109, a213
  v_accvgpr_read_b32 v110, a214
  v_accvgpr_read_b32 v111, a215
  v_mul_f32 v108, v108, v103
  v_mul_f32 v109, v109, v103
  v_mul_f32 v110, v110, v103
  v_mul_f32 v111, v111, v103
  v_accvgpr_write_b32 a212, v108
  v_accvgpr_write_b32 a213, v109
  v_accvgpr_write_b32 a214, v110
  v_accvgpr_write_b32 a215, v111
  v_accvgpr_read_b32 v108, a216
  v_accvgpr_read_b32 v109, a217
  v_accvgpr_read_b32 v110, a218
  v_accvgpr_read_b32 v111, a219
  v_mul_f32 v108, v108, v102
  v_mul_f32 v109, v109, v102
  v_mul_f32 v110, v110, v102
  v_mul_f32 v111, v111, v102
  v_accvgpr_write_b32 a216, v108
  v_accvgpr_write_b32 a217, v109
  v_accvgpr_write_b32 a218, v110
  v_accvgpr_write_b32 a219, v111
  v_accvgpr_read_b32 v108, a220
  v_accvgpr_read_b32 v109, a221
  v_accvgpr_read_b32 v110, a222
  v_accvgpr_read_b32 v111, a223
  v_mul_f32 v108, v108, v103
  v_mul_f32 v109, v109, v103
  v_mul_f32 v110, v110, v103
  v_mul_f32 v111, v111, v103
  v_accvgpr_write_b32 a220, v108
  v_accvgpr_write_b32 a221, v109
  v_accvgpr_write_b32 a222, v110
  v_accvgpr_write_b32 a223, v111
  v_accvgpr_read_b32 v108, a224
  v_accvgpr_read_b32 v109, a225
  v_accvgpr_read_b32 v110, a226
  v_accvgpr_read_b32 v111, a227
  v_mul_f32 v108, v108, v102
  v_mul_f32 v109, v109, v102
  v_mul_f32 v110, v110, v102
  v_mul_f32 v111, v111, v102
  v_accvgpr_write_b32 a224, v108
  v_accvgpr_write_b32 a225, v109
  v_accvgpr_write_b32 a226, v110
  v_accvgpr_write_b32 a227, v111
  v_accvgpr_read_b32 v108, a228
  v_accvgpr_read_b32 v109, a229
  v_accvgpr_read_b32 v110, a230
  v_accvgpr_read_b32 v111, a231
  v_mul_f32 v108, v108, v103
  v_mul_f32 v109, v109, v103
  v_mul_f32 v110, v110, v103
  v_mul_f32 v111, v111, v103
  v_accvgpr_write_b32 a228, v108
  v_accvgpr_write_b32 a229, v109
  v_accvgpr_write_b32 a230, v110
  v_accvgpr_write_b32 a231, v111
  v_accvgpr_read_b32 v108, a232
  v_accvgpr_read_b32 v109, a233
  v_accvgpr_read_b32 v110, a234
  v_accvgpr_read_b32 v111, a235
  v_mul_f32 v108, v108, v102
  v_mul_f32 v109, v109, v102
  v_mul_f32 v110, v110, v102
  v_mul_f32 v111, v111, v102
  v_accvgpr_write_b32 a232, v108
  v_accvgpr_write_b32 a233, v109
  v_accvgpr_write_b32 a234, v110
  v_accvgpr_write_b32 a235, v111
  v_accvgpr_read_b32 v108, a236
  v_accvgpr_read_b32 v109, a237
  v_accvgpr_read_b32 v110, a238
  v_accvgpr_read_b32 v111, a239
  v_mul_f32 v108, v108, v103
  v_mul_f32 v109, v109, v103
  v_mul_f32 v110, v110, v103
  v_mul_f32 v111, v111, v103
  v_accvgpr_write_b32 a236, v108
  v_accvgpr_write_b32 a237, v109
  v_accvgpr_write_b32 a238, v110
  v_accvgpr_write_b32 a239, v111
  v_accvgpr_read_b32 v108, a240
  v_accvgpr_read_b32 v109, a241
  v_accvgpr_read_b32 v110, a242
  v_accvgpr_read_b32 v111, a243
  v_mul_f32 v108, v108, v102
  v_mul_f32 v109, v109, v102
  v_mul_f32 v110, v110, v102
  v_mul_f32 v111, v111, v102
  v_accvgpr_write_b32 a240, v108
  v_accvgpr_write_b32 a241, v109
  v_accvgpr_write_b32 a242, v110
  v_accvgpr_write_b32 a243, v111
  v_accvgpr_read_b32 v108, a244
  v_accvgpr_read_b32 v109, a245
  v_accvgpr_read_b32 v110, a246
  v_accvgpr_read_b32 v111, a247
  v_mul_f32 v108, v108, v103
  v_mul_f32 v109, v109, v103
  v_mul_f32 v110, v110, v103
  v_mul_f32 v111, v111, v103
  v_accvgpr_write_b32 a244, v108
  v_accvgpr_write_b32 a245, v109
  v_accvgpr_write_b32 a246, v110
  v_accvgpr_write_b32 a247, v111
  v_accvgpr_read_b32 v108, a248
  v_accvgpr_read_b32 v109, a249
  v_accvgpr_read_b32 v110, a250
  v_accvgpr_read_b32 v111, a251
  v_mul_f32 v108, v108, v102
  v_mul_f32 v109, v109, v102
  v_mul_f32 v110, v110, v102
  v_mul_f32 v111, v111, v102
  v_accvgpr_write_b32 a248, v108
  v_accvgpr_write_b32 a249, v109
  v_accvgpr_write_b32 a250, v110
  v_accvgpr_write_b32 a251, v111
  v_accvgpr_read_b32 v108, a252
  v_accvgpr_read_b32 v109, a253
  v_accvgpr_read_b32 v110, a254
  v_accvgpr_read_b32 v111, a255
  v_mul_f32 v108, v108, v103
  v_mul_f32 v109, v109, v103
  v_mul_f32 v110, v110, v103
  v_mul_f32 v111, v111, v103
  v_accvgpr_write_b32 a252, v108
  v_accvgpr_write_b32 a253, v109
  v_accvgpr_write_b32 a254, v110
  v_accvgpr_write_b32 a255, v111
  v_exp_f32 v12, v36
  v_exp_f32 v13, v37
  v_exp_f32 v14, v38
  v_exp_f32 v15, v39
  v_add_f32 v9, v12, v13
  v_cvt_pk_bf16_f32 v28, v12, v13
  v_add_f32 v9, v9, v14
  v_add_f32 v9, v9, v15
  v_cvt_pk_bf16_f32 v29, v14, v15
  v_exp_f32 v16, v44
  v_exp_f32 v17, v45
  v_exp_f32 v18, v46
  v_exp_f32 v19, v47
  v_add_f32 v9, v9, v16
  v_add_f32 v9, v9, v17
  v_cvt_pk_bf16_f32 v30, v16, v17
  v_add_f32 v9, v9, v18
  v_add_f32 v9, v9, v19
  v_cvt_pk_bf16_f32 v31, v18, v19
  v_exp_f32 v12, v40
  v_exp_f32 v13, v41
  v_exp_f32 v14, v42
  v_exp_f32 v15, v43
  v_add_f32 v10, v12, v13
  v_cvt_pk_bf16_f32 v32, v12, v13
  v_add_f32 v10, v10, v14
  v_add_f32 v10, v10, v15
  v_cvt_pk_bf16_f32 v33, v14, v15
  v_exp_f32 v16, v48
  v_exp_f32 v17, v49
  v_exp_f32 v18, v50
  v_exp_f32 v19, v51
  v_add_f32 v10, v10, v16
  v_add_f32 v10, v10, v17
  v_cvt_pk_bf16_f32 v34, v16, v17
  v_add_f32 v10, v10, v18
  v_add_f32 v10, v10, v19
  v_cvt_pk_bf16_f32 v35, v18, v19
  s_nop 3
  s_cmp_eq_u32 s44, 1
  s_cbranch_scc1 RETT0
  s_cmp_eq_u32 s44, 2
  s_cbranch_scc1 RETP0
  s_branch RETL0
RARE1:
  s_nop 15
  v_max3_f32 v100, v52, v53, v54
  v_max3_f32 v100, v100, v55, v60
  v_max3_f32 v100, v100, v61, v62
  v_max_f32 v100, v100, v63
  v_mov_b32 v104, v100
  s_nop 1
  v_permlane16_swap_b32 v100, v104
  v_max_f32 v100, v100, v104
  v_mov_b32 v104, v100
  s_nop 1
  v_permlane32_swap_b32 v100, v104
  v_max_f32 v100, v100, v104
  v_max_f32 v100, 0, v100
  v_sub_f32 v102, 0, v100
  v_exp_f32 v102, v102
  v_sub_f32 v36, v36, v100
  v_sub_f32 v37, v37, v100
  v_sub_f32 v38, v38, v100
  v_sub_f32 v39, v39, v100
  v_sub_f32 v44, v44, v100
  v_sub_f32 v45, v45, v100
  v_sub_f32 v46, v46, v100
  v_sub_f32 v47, v47, v100
  v_sub_f32 v52, v52, v100
  v_sub_f32 v53, v53, v100
  v_sub_f32 v54, v54, v100
  v_sub_f32 v55, v55, v100
  v_sub_f32 v60, v60, v100
  v_sub_f32 v61, v61, v100
  v_sub_f32 v62, v62, v100
  v_sub_f32 v63, v63, v100
  v_sub_f32 v20, v20, v100
  v_sub_f32 v21, v21, v100
  v_sub_f32 v22, v22, v100
  v_sub_f32 v23, v23, v100
  v_mul_f32 v7, v7, v102
  v_max3_f32 v101, v56, v57, v58
  v_max3_f32 v101, v101, v59, v64
  v_max3_f32 v101, v101, v65, v66
  v_max_f32 v101, v101, v67
  v_mov_b32 v104, v101
  s_nop 1
  v_permlane16_swap_b32 v101, v104
  v_max_f32 v101, v101, v104
  v_mov_b32 v104, v101
  s_nop 1
  v_permlane32_swap_b32 v101, v104
  v_max_f32 v101, v101, v104
  v_max_f32 v101, 0, v101
  v_sub_f32 v103, 0, v101
  v_exp_f32 v103, v103
  v_sub_f32 v40, v40, v101
  v_sub_f32 v41, v41, v101
  v_sub_f32 v42, v42, v101
  v_sub_f32 v43, v43, v101
  v_sub_f32 v48, v48, v101
  v_sub_f32 v49, v49, v101
  v_sub_f32 v50, v50, v101
  v_sub_f32 v51, v51, v101
  v_sub_f32 v56, v56, v101
  v_sub_f32 v57, v57, v101
  v_sub_f32 v58, v58, v101
  v_sub_f32 v59, v59, v101
  v_sub_f32 v64, v64, v101
  v_sub_f32 v65, v65, v101
  v_sub_f32 v66, v66, v101
  v_sub_f32 v67, v67, v101
  v_sub_f32 v24, v24, v101
  v_sub_f32 v25, v25, v101
  v_sub_f32 v26, v26, v101
  v_sub_f32 v27, v27, v101
  v_mul_f32 v8, v8, v103
  v_mul_f32 v128, v128, v102
  v_mul_f32 v129, v129, v102
  v_mul_f32 v130, v130, v102
  v_mul_f32 v131, v131, v102
  v_mul_f32 v132, v132, v103
  v_mul_f32 v133, v133, v103
  v_mul_f32 v134, v134, v103
  v_mul_f32 v135, v135, v103
  v_mul_f32 v136, v136, v102
  v_mul_f32 v137, v137, v102
  v_mul_f32 v138, v138, v102
  v_mul_f32 v139, v139, v102
  v_mul_f32 v140, v140, v103
  v_mul_f32 v141, v141, v103
  v_mul_f32 v142, v142, v103
  v_mul_f32 v143, v143, v103
  v_mul_f32 v144, v144, v102
  v_mul_f32 v145, v145, v102
  v_mul_f32 v146, v146, v102
  v_mul_f32 v147, v147, v102
  v_mul_f32 v148, v148, v103
  v_mul_f32 v149, v149, v103
  v_mul_f32 v150, v150, v103
  v_mul_f32 v151, v151, v103
  v_mul_f32 v152, v152, v102
  v_mul_f32 v153, v153, v102
  v_mul_f32 v154, v154, v102
  v_mul_f32 v155, v155, v102
  v_mul_f32 v156, v156, v103
  v_mul_f32 v157, v157, v103
  v_mul_f32 v158, v158, v103
  v_mul_f32 v159, v159, v103
  v_mul_f32 v160, v160, v102
  v_mul_f32 v161, v161, v102
  v_mul_f32 v162, v162, v102
  v_mul_f32 v163, v163, v102
  v_mul_f32 v164, v164, v103
  v_mul_f32 v165, v165, v103
  v_mul_f32 v166, v166, v103
  v_mul_f32 v167, v167, v103
  v_mul_f32 v168, v168, v102
  v_mul_f32 v169, v169, v102
  v_mul_f32 v170, v170, v102
  v_mul_f32 v171, v171, v102
  v_mul_f32 v172, v172, v103
  v_mul_f32 v173, v173, v103
  v_mul_f32 v174, v174, v103
  v_mul_f32 v175, v175, v103
  v_mul_f32 v176, v176, v102
  v_mul_f32 v177, v177, v102
  v_mul_f32 v178, v178, v102
  v_mul_f32 v179, v179, v102
  v_mul_f32 v180, v180, v103
  v_mul_f32 v181, v181, v103
  v_mul_f32 v182, v182, v103
  v_mul_f32 v183, v183, v103
  v_mul_f32 v184, v184, v102
  v_mul_f32 v185, v185, v102
  v_mul_f32 v186, v186, v102
  v_mul_f32 v187, v187, v102
  v_mul_f32 v188, v188, v103
  v_mul_f32 v189, v189, v103
  v_mul_f32 v190, v190, v103
  v_mul_f32 v191, v191, v103
  v_mul_f32 v192, v192, v102
  v_mul_f32 v193, v193, v102
  v_mul_f32 v194, v194, v102
  v_mul_f32 v195, v195, v102
  v_mul_f32 v196, v196, v103
  v_mul_f32 v197, v197, v103
  v_mul_f32 v198, v198, v103
  v_mul_f32 v199, v199, v103
  v_mul_f32 v200, v200, v102
  v_mul_f32 v201, v201, v102
  v_mul_f32 v202, v202, v102
  v_mul_f32 v203, v203, v102
  v_mul_f32 v204, v204, v103
  v_mul_f32 v205, v205, v103
  v_mul_f32 v206, v206, v103
  v_mul_f32 v207, v207, v103
  v_mul_f32 v208, v208, v102
  v_mul_f32 v209, v209, v102
  v_mul_f32 v210, v210, v102
  v_mul_f32 v211, v211, v102
  v_mul_f32 v212, v212, v103
  v_mul_f32 v213, v213, v103
  v_mul_f32 v214, v214, v103
  v_mul_f32 v215, v215, v103
  v_mul_f32 v216, v216, v102
  v_mul_f32 v217, v217, v102
  v_mul_f32 v218, v218, v102
  v_mul_f32 v219, v219, v102
  v_mul_f32 v220, v220, v103
  v_mul_f32 v221, v221, v103
  v_mul_f32 v222, v222, v103
  v_mul_f32 v223, v223, v103
  v_mul_f32 v224, v224, v102
  v_mul_f32 v225, v225, v102
  v_mul_f32 v226, v226, v102
  v_mul_f32 v227, v227, v102
  v_mul_f32 v228, v228, v103
  v_mul_f32 v229, v229, v103
  v_mul_f32 v230, v230, v103
  v_mul_f32 v231, v231, v103
  v_mul_f32 v232, v232, v102
  v_mul_f32 v233, v233, v102
  v_mul_f32 v234, v234, v102
  v_mul_f32 v235, v235, v102
  v_mul_f32 v236, v236, v103
  v_mul_f32 v237, v237, v103
  v_mul_f32 v238, v238, v103
  v_mul_f32 v239, v239, v103
  v_mul_f32 v240, v240, v102
  v_mul_f32 v241, v241, v102
  v_mul_f32 v242, v242, v102
  v_mul_f32 v243, v243, v102
  v_mul_f32 v244, v244, v103
  v_mul_f32 v245, v245, v103
  v_mul_f32 v246, v246, v103
  v_mul_f32 v247, v247, v103
  v_mul_f32 v248, v248, v102
  v_mul_f32 v249, v249, v102
  v_mul_f32 v250, v250, v102
  v_mul_f32 v251, v251, v102
  v_mul_f32 v252, v252, v103
  v_mul_f32 v253, v253, v103
  v_mul_f32 v254, v254, v103
  v_mul_f32 v255, v255, v103
  v_accvgpr_read_b32 v108, a128
  v_accvgpr_read_b32 v109, a129
  v_accvgpr_read_b32 v110, a130
  v_accvgpr_read_b32 v111, a131
  v_mul_f32 v108, v108, v102
  v_mul_f32 v109, v109, v102
  v_mul_f32 v110, v110, v102
  v_mul_f32 v111, v111, v102
  v_accvgpr_write_b32 a128, v108
  v_accvgpr_write_b32 a129, v109
  v_accvgpr_write_b32 a130, v110
  v_accvgpr_write_b32 a131, v111
  v_accvgpr_read_b32 v108, a132
  v_accvgpr_read_b32 v109, a133
  v_accvgpr_read_b32 v110, a134
  v_accvgpr_read_b32 v111, a135
  v_mul_f32 v108, v108, v103
  v_mul_f32 v109, v109, v103
  v_mul_f32 v110, v110, v103
  v_mul_f32 v111, v111, v103
  v_accvgpr_write_b32 a132, v108
  v_accvgpr_write_b32 a133, v109
  v_accvgpr_write_b32 a134, v110
  v_accvgpr_write_b32 a135, v111
  v_accvgpr_read_b32 v108, a136
  v_accvgpr_read_b32 v109, a137
  v_accvgpr_read_b32 v110, a138
  v_accvgpr_read_b32 v111, a139
  v_mul_f32 v108, v108, v102
  v_mul_f32 v109, v109, v102
  v_mul_f32 v110, v110, v102
  v_mul_f32 v111, v111, v102
  v_accvgpr_write_b32 a136, v108
  v_accvgpr_write_b32 a137, v109
  v_accvgpr_write_b32 a138, v110
  v_accvgpr_write_b32 a139, v111
  v_accvgpr_read_b32 v108, a140
  v_accvgpr_read_b32 v109, a141
  v_accvgpr_read_b32 v110, a142
  v_accvgpr_read_b32 v111, a143
  v_mul_f32 v108, v108, v103
  v_mul_f32 v109, v109, v103
  v_mul_f32 v110, v110, v103
  v_mul_f32 v111, v111, v103
  v_accvgpr_write_b32 a140, v108
  v_accvgpr_write_b32 a141, v109
  v_accvgpr_write_b32 a142, v110
  v_accvgpr_write_b32 a143, v111
  v_accvgpr_read_b32 v108, a144
  v_accvgpr_read_b32 v109, a145
  v_accvgpr_read_b32 v110, a146
  v_accvgpr_read_b32 v111, a147
  v_mul_f32 v108, v108, v102
  v_mul_f32 v109, v109, v102
  v_mul_f32 v110, v110, v102
  v_mul_f32 v111, v111, v102
  v_accvgpr_write_b32 a144, v108
  v_accvgpr_write_b32 a145, v109
  v_accvgpr_write_b32 a146, v110
  v_accvgpr_write_b32 a147, v111
  v_accvgpr_read_b32 v108, a148
  v_accvgpr_read_b32 v109, a149
  v_accvgpr_read_b32 v110, a150
  v_accvgpr_read_b32 v111, a151
  v_mul_f32 v108, v108, v103
  v_mul_f32 v109, v109, v103
  v_mul_f32 v110, v110, v103
  v_mul_f32 v111, v111, v103
  v_accvgpr_write_b32 a148, v108
  v_accvgpr_write_b32 a149, v109
  v_accvgpr_write_b32 a150, v110
  v_accvgpr_write_b32 a151, v111
  v_accvgpr_read_b32 v108, a152
  v_accvgpr_read_b32 v109, a153
  v_accvgpr_read_b32 v110, a154
  v_accvgpr_read_b32 v111, a155
  v_mul_f32 v108, v108, v102
  v_mul_f32 v109, v109, v102
  v_mul_f32 v110, v110, v102
  v_mul_f32 v111, v111, v102
  v_accvgpr_write_b32 a152, v108
  v_accvgpr_write_b32 a153, v109
  v_accvgpr_write_b32 a154, v110
  v_accvgpr_write_b32 a155, v111
  v_accvgpr_read_b32 v108, a156
  v_accvgpr_read_b32 v109, a157
  v_accvgpr_read_b32 v110, a158
  v_accvgpr_read_b32 v111, a159
  v_mul_f32 v108, v108, v103
  v_mul_f32 v109, v109, v103
  v_mul_f32 v110, v110, v103
  v_mul_f32 v111, v111, v103
  v_accvgpr_write_b32 a156, v108
  v_accvgpr_write_b32 a157, v109
  v_accvgpr_write_b32 a158, v110
  v_accvgpr_write_b32 a159, v111
  v_accvgpr_read_b32 v108, a160
  v_accvgpr_read_b32 v109, a161
  v_accvgpr_read_b32 v110, a162
  v_accvgpr_read_b32 v111, a163
  v_mul_f32 v108, v108, v102
  v_mul_f32 v109, v109, v102
  v_mul_f32 v110, v110, v102
  v_mul_f32 v111, v111, v102
  v_accvgpr_write_b32 a160, v108
  v_accvgpr_write_b32 a161, v109
  v_accvgpr_write_b32 a162, v110
  v_accvgpr_write_b32 a163, v111
  v_accvgpr_read_b32 v108, a164
  v_accvgpr_read_b32 v109, a165
  v_accvgpr_read_b32 v110, a166
  v_accvgpr_read_b32 v111, a167
  v_mul_f32 v108, v108, v103
  v_mul_f32 v109, v109, v103
  v_mul_f32 v110, v110, v103
  v_mul_f32 v111, v111, v103
  v_accvgpr_write_b32 a164, v108
  v_accvgpr_write_b32 a165, v109
  v_accvgpr_write_b32 a166, v110
  v_accvgpr_write_b32 a167, v111
  v_accvgpr_read_b32 v108, a168
  v_accvgpr_read_b32 v109, a169
  v_accvgpr_read_b32 v110, a170
  v_accvgpr_read_b32 v111, a171
  v_mul_f32 v108, v108, v102
  v_mul_f32 v109, v109, v102
  v_mul_f32 v110, v110, v102
  v_mul_f32 v111, v111, v102
  v_accvgpr_write_b32 a168, v108
  v_accvgpr_write_b32 a169, v109
  v_accvgpr_write_b32 a170, v110
  v_accvgpr_write_b32 a171, v111
  v_accvgpr_read_b32 v108, a172
  v_accvgpr_read_b32 v109, a173
  v_accvgpr_read_b32 v110, a174
  v_accvgpr_read_b32 v111, a175
  v_mul_f32 v108, v108, v103
  v_mul_f32 v109, v109, v103
  v_mul_f32 v110, v110, v103
  v_mul_f32 v111, v111, v103
  v_accvgpr_write_b32 a172, v108
  v_accvgpr_write_b32 a173, v109
  v_accvgpr_write_b32 a174, v110
  v_accvgpr_write_b32 a175, v111
  v_accvgpr_read_b32 v108, a176
  v_accvgpr_read_b32 v109, a177
  v_accvgpr_read_b32 v110, a178
  v_accvgpr_read_b32 v111, a179
  v_mul_f32 v108, v108, v102
  v_mul_f32 v109, v109, v102
  v_mul_f32 v110, v110, v102
  v_mul_f32 v111, v111, v102
  v_accvgpr_write_b32 a176, v108
  v_accvgpr_write_b32 a177, v109
  v_accvgpr_write_b32 a178, v110
  v_accvgpr_write_b32 a179, v111
  v_accvgpr_read_b32 v108, a180
  v_accvgpr_read_b32 v109, a181
  v_accvgpr_read_b32 v110, a182
  v_accvgpr_read_b32 v111, a183
  v_mul_f32 v108, v108, v103
  v_mul_f32 v109, v109, v103
  v_mul_f32 v110, v110, v103
  v_mul_f32 v111, v111, v103
  v_accvgpr_write_b32 a180, v108
  v_accvgpr_write_b32 a181, v109
  v_accvgpr_write_b32 a182, v110
  v_accvgpr_write_b32 a183, v111
  v_accvgpr_read_b32 v108, a184
  v_accvgpr_read_b32 v109, a185
  v_accvgpr_read_b32 v110, a186
  v_accvgpr_read_b32 v111, a187
  v_mul_f32 v108, v108, v102
  v_mul_f32 v109, v109, v102
  v_mul_f32 v110, v110, v102
  v_mul_f32 v111, v111, v102
  v_accvgpr_write_b32 a184, v108
  v_accvgpr_write_b32 a185, v109
  v_accvgpr_write_b32 a186, v110
  v_accvgpr_write_b32 a187, v111
  v_accvgpr_read_b32 v108, a188
  v_accvgpr_read_b32 v109, a189
  v_accvgpr_read_b32 v110, a190
  v_accvgpr_read_b32 v111, a191
  v_mul_f32 v108, v108, v103
  v_mul_f32 v109, v109, v103
  v_mul_f32 v110, v110, v103
  v_mul_f32 v111, v111, v103
  v_accvgpr_write_b32 a188, v108
  v_accvgpr_write_b32 a189, v109
  v_accvgpr_write_b32 a190, v110
  v_accvgpr_write_b32 a191, v111
  v_accvgpr_read_b32 v108, a192
  v_accvgpr_read_b32 v109, a193
  v_accvgpr_read_b32 v110, a194
  v_accvgpr_read_b32 v111, a195
  v_mul_f32 v108, v108, v102
  v_mul_f32 v109, v109, v102
  v_mul_f32 v110, v110, v102
  v_mul_f32 v111, v111, v102
  v_accvgpr_write_b32 a192, v108
  v_accvgpr_write_b32 a193, v109
  v_accvgpr_write_b32 a194, v110
  v_accvgpr_write_b32 a195, v111
  v_accvgpr_read_b32 v108, a196
  v_accvgpr_read_b32 v109, a197
  v_accvgpr_read_b32 v110, a198
  v_accvgpr_read_b32 v111, a199
  v_mul_f32 v108, v108, v103
  v_mul_f32 v109, v109, v103
  v_mul_f32 v110, v110, v103
  v_mul_f32 v111, v111, v103
  v_accvgpr_write_b32 a196, v108
  v_accvgpr_write_b32 a197, v109
  v_accvgpr_write_b32 a198, v110
  v_accvgpr_write_b32 a199, v111
  v_accvgpr_read_b32 v108, a200
  v_accvgpr_read_b32 v109, a201
  v_accvgpr_read_b32 v110, a202
  v_accvgpr_read_b32 v111, a203
  v_mul_f32 v108, v108, v102
  v_mul_f32 v109, v109, v102
  v_mul_f32 v110, v110, v102
  v_mul_f32 v111, v111, v102
  v_accvgpr_write_b32 a200, v108
  v_accvgpr_write_b32 a201, v109
  v_accvgpr_write_b32 a202, v110
  v_accvgpr_write_b32 a203, v111
  v_accvgpr_read_b32 v108, a204
  v_accvgpr_read_b32 v109, a205
  v_accvgpr_read_b32 v110, a206
  v_accvgpr_read_b32 v111, a207
  v_mul_f32 v108, v108, v103
  v_mul_f32 v109, v109, v103
  v_mul_f32 v110, v110, v103
  v_mul_f32 v111, v111, v103
  v_accvgpr_write_b32 a204, v108
  v_accvgpr_write_b32 a205, v109
  v_accvgpr_write_b32 a206, v110
  v_accvgpr_write_b32 a207, v111
  v_accvgpr_read_b32 v108, a208
  v_accvgpr_read_b32 v109, a209
  v_accvgpr_read_b32 v110, a210
  v_accvgpr_read_b32 v111, a211
  v_mul_f32 v108, v108, v102
  v_mul_f32 v109, v109, v102
  v_mul_f32 v110, v110, v102
  v_mul_f32 v111, v111, v102
  v_accvgpr_write_b32 a208, v108
  v_accvgpr_write_b32 a209, v109
  v_accvgpr_write_b32 a210, v110
  v_accvgpr_write_b32 a211, v111
  v_accvgpr_read_b32 v108, a212
  v_accvgpr_read_b32 v109, a213
  v_accvgpr_read_b32 v110, a214
  v_accvgpr_read_b32 v111, a215
  v_mul_f32 v108, v108, v103
  v_mul_f32 v109, v109, v103
  v_mul_f32 v110, v110, v103
  v_mul_f32 v111, v111, v103
  v_accvgpr_write_b32 a212, v108
  v_accvgpr_write_b32 a213, v109
  v_accvgpr_write_b32 a214, v110
  v_accvgpr_write_b32 a215, v111
  v_accvgpr_read_b32 v108, a216
  v_accvgpr_read_b32 v109, a217
  v_accvgpr_read_b32 v110, a218
  v_accvgpr_read_b32 v111, a219
  v_mul_f32 v108, v108, v102
  v_mul_f32 v109, v109, v102
  v_mul_f32 v110, v110, v102
  v_mul_f32 v111, v111, v102
  v_accvgpr_write_b32 a216, v108
  v_accvgpr_write_b32 a217, v109
  v_accvgpr_write_b32 a218, v110
  v_accvgpr_write_b32 a219, v111
  v_accvgpr_read_b32 v108, a220
  v_accvgpr_read_b32 v109, a221
  v_accvgpr_read_b32 v110, a222
  v_accvgpr_read_b32 v111, a223
  v_mul_f32 v108, v108, v103
  v_mul_f32 v109, v109, v103
  v_mul_f32 v110, v110, v103
  v_mul_f32 v111, v111, v103
  v_accvgpr_write_b32 a220, v108
  v_accvgpr_write_b32 a221, v109
  v_accvgpr_write_b32 a222, v110
  v_accvgpr_write_b32 a223, v111
  v_accvgpr_read_b32 v108, a224
  v_accvgpr_read_b32 v109, a225
  v_accvgpr_read_b32 v110, a226
  v_accvgpr_read_b32 v111, a227
  v_mul_f32 v108, v108, v102
  v_mul_f32 v109, v109, v102
  v_mul_f32 v110, v110, v102
  v_mul_f32 v111, v111, v102
  v_accvgpr_write_b32 a224, v108
  v_accvgpr_write_b32 a225, v109
  v_accvgpr_write_b32 a226, v110
  v_accvgpr_write_b32 a227, v111
  v_accvgpr_read_b32 v108, a228
  v_accvgpr_read_b32 v109, a229
  v_accvgpr_read_b32 v110, a230
  v_accvgpr_read_b32 v111, a231
  v_mul_f32 v108, v108, v103
  v_mul_f32 v109, v109, v103
  v_mul_f32 v110, v110, v103
  v_mul_f32 v111, v111, v103
  v_accvgpr_write_b32 a228, v108
  v_accvgpr_write_b32 a229, v109
  v_accvgpr_write_b32 a230, v110
  v_accvgpr_write_b32 a231, v111
  v_accvgpr_read_b32 v108, a232
  v_accvgpr_read_b32 v109, a233
  v_accvgpr_read_b32 v110, a234
  v_accvgpr_read_b32 v111, a235
  v_mul_f32 v108, v108, v102
  v_mul_f32 v109, v109, v102
  v_mul_f32 v110, v110, v102
  v_mul_f32 v111, v111, v102
  v_accvgpr_write_b32 a232, v108
  v_accvgpr_write_b32 a233, v109
  v_accvgpr_write_b32 a234, v110
  v_accvgpr_write_b32 a235, v111
  v_accvgpr_read_b32 v108, a236
  v_accvgpr_read_b32 v109, a237
  v_accvgpr_read_b32 v110, a238
  v_accvgpr_read_b32 v111, a239
  v_mul_f32 v108, v108, v103
  v_mul_f32 v109, v109, v103
  v_mul_f32 v110, v110, v103
  v_mul_f32 v111, v111, v103
  v_accvgpr_write_b32 a236, v108
  v_accvgpr_write_b32 a237, v109
  v_accvgpr_write_b32 a238, v110
  v_accvgpr_write_b32 a239, v111
  v_accvgpr_read_b32 v108, a240
  v_accvgpr_read_b32 v109, a241
  v_accvgpr_read_b32 v110, a242
  v_accvgpr_read_b32 v111, a243
  v_mul_f32 v108, v108, v102
  v_mul_f32 v109, v109, v102
  v_mul_f32 v110, v110, v102
  v_mul_f32 v111, v111, v102
  v_accvgpr_write_b32 a240, v108
  v_accvgpr_write_b32 a241, v109
  v_accvgpr_write_b32 a242, v110
  v_accvgpr_write_b32 a243, v111
  v_accvgpr_read_b32 v108, a244
  v_accvgpr_read_b32 v109, a245
  v_accvgpr_read_b32 v110, a246
  v_accvgpr_read_b32 v111, a247
  v_mul_f32 v108, v108, v103
  v_mul_f32 v109, v109, v103
  v_mul_f32 v110, v110, v103
  v_mul_f32 v111, v111, v103
  v_accvgpr_write_b32 a244, v108
  v_accvgpr_write_b32 a245, v109
  v_accvgpr_write_b32 a246, v110
  v_accvgpr_write_b32 a247, v111
  v_accvgpr_read_b32 v108, a248
  v_accvgpr_read_b32 v109, a249
  v_accvgpr_read_b32 v110, a250
  v_accvgpr_read_b32 v111, a251
  v_mul_f32 v108, v108, v102
  v_mul_f32 v109, v109, v102
  v_mul_f32 v110, v110, v102
  v_mul_f32 v111, v111, v102
  v_accvgpr_write_b32 a248, v108
  v_accvgpr_write_b32 a249, v109
  v_accvgpr_write_b32 a250, v110
  v_accvgpr_write_b32 a251, v111
  v_accvgpr_read_b32 v108, a252
  v_accvgpr_read_b32 v109, a253
  v_accvgpr_read_b32 v110, a254
  v_accvgpr_read_b32 v111, a255
  v_mul_f32 v108, v108, v103
  v_mul_f32 v109, v109, v103
  v_mul_f32 v110, v110, v103
  v_mul_f32 v111, v111, v103
  v_accvgpr_write_b32 a252, v108
  v_accvgpr_write_b32 a253, v109
  v_accvgpr_write_b32 a254, v110
  v_accvgpr_write_b32 a255, v111
  v_exp_f32 v12, v52
  v_exp_f32 v13, v53
  v_exp_f32 v14, v54
  v_exp_f32 v15, v55
  v_add_f32 v9, v12, v13
  v_cvt_pk_bf16_f32 v28, v12, v13
  v_add_f32 v9, v9, v14
  v_add_f32 v9, v9, v15
  v_cvt_pk_bf16_f32 v29, v14, v15
  v_exp_f32 v16, v60
  v_exp_f32 v17, v61
  v_exp_f32 v18, v62
  v_exp_f32 v19, v63
  v_add_f32 v9, v9, v16
  v_add_f32 v9, v9, v17
  v_cvt_pk_bf16_f32 v30, v16, v17
  v_add_f32 v9, v9, v18
  v_add_f32 v9, v9, v19
  v_cvt_pk_bf16_f32 v31, v18, v19
  v_exp_f32 v12, v56
  v_exp_f32 v13, v57
  v_exp_f32 v14, v58
  v_exp_f32 v15, v59
  v_add_f32 v10, v12, v13
  v_cvt_pk_bf16_f32 v32, v12, v13
  v_add_f32 v10, v10, v14
  v_add_f32 v10, v10, v15
  v_cvt_pk_bf16_f32 v33, v14, v15
  v_exp_f32 v16, v64
  v_exp_f32 v17, v65
  v_exp_f32 v18, v66
  v_exp_f32 v19, v67
  v_add_f32 v10, v10, v16
  v_add_f32 v10, v10, v17
  v_cvt_pk_bf16_f32 v34, v16, v17
  v_add_f32 v10, v10, v18
  v_add_f32 v10, v10, v19
  v_cvt_pk_bf16_f32 v35, v18, v19
  s_nop 3
  s_cmp_eq_u32 s44, 1
  s_cbranch_scc1 RETT1
  s_cmp_eq_u32 s44, 2
  s_cbranch_scc1 RETP1
  s_branch RETL1
.section .rodata,"a"
.p2align 6
.amdhsa_kernel standalone__conformer_family_e_branchformer__speech_kernel
  .amdhsa_next_free_vgpr 512
  .amdhsa_next_free_sgpr 102
  .amdhsa_accum_offset 256
  .amdhsa_group_segment_fixed_size 0
  .amdhsa_kernarg_size 88
  .amdhsa_user_sgpr_count 2
  .amdhsa_user_sgpr_kernarg_segment_ptr 1
  .amdhsa_system_sgpr_workgroup_id_x 1
  .amdhsa_float_denorm_mode_32 3
.end_amdhsa_kernel
.text
```
